```python
import torch

def _softmax(x, axis=-1):
    return torch.softmax(x, dim=axis)
def _gelu(x):
    return torch.nn.functional.gelu(x, approximate="tanh")
def _silu(x):
    return torch.nn.functional.silu(x)
def _sigmoid(x):
    return torch.sigmoid(x)
def _layernorm(x, axis=-1, eps=1e-5):
    m = x.mean(dim=axis, keepdim=True)
    v = x.var(dim=axis, keepdim=True, unbiased=False)
    return (x - m) / torch.sqrt(v + eps)
def _scatter_add(tgt, idx, src, axis=0):
    return tgt.clone().index_add_(axis, idx, src)
def _segment_sum(src, seg, n):
    out = torch.zeros((n,) + src.shape[1:], dtype=src.dtype)
    return out.index_add_(0, seg, src)
def _pad(x, pw):
    flat = tuple(v for pair in reversed(pw) for v in pair)
    return torch.nn.functional.pad(x, flat)

kernel_name = 'interleave_layers__linear_attn_block__glu_gated_geglu__prompt'

def setup_inputs():

    _w = (lambda a: (lambda t: t.to(torch.bfloat16) if t.is_floating_point() else t)(torch.as_tensor(a)))
    def _A_setup():
        B, S, D = 1, 2048, 576
        return {
            "x": _w((lambda *s: torch.randn(*s, dtype=torch.bfloat16) * 0.05)(B, S, D)),
            "wqkv": _w((lambda *s: torch.randn(*s, dtype=torch.bfloat16) * 0.05)(D, 3 * D)),
            "wo": _w((lambda *s: torch.randn(*s, dtype=torch.bfloat16) * 0.05)(D, D)),
        }
    _A_in = _A_setup()

    def _B_setup():
        B, S, Dm, Df = 1, 2048, 576, 4608
        return {
            "x": _w((lambda *s: torch.randn(*s, dtype=torch.bfloat16) * 0.05)(B, S, Dm)),
            "w_gate": _w((lambda *s: torch.randn(*s, dtype=torch.bfloat16) * 0.8)(Dm, Df) * (Dm ** -0.5)),
            "w_up": _w((lambda *s: torch.randn(*s, dtype=torch.bfloat16) * 0.8)(Dm, Df) * (Dm ** -0.5)),
            "w_down": _w((lambda *s: torch.randn(*s, dtype=torch.bfloat16) * 0.8)(Df, Dm) * (Df ** -0.5)),
        }
    _B_in = _B_setup()

    return {
        "A_x": _A_in["x"],
        "A_wqkv": _A_in["wqkv"],
        "A_wo": _A_in["wo"],
        "B_x": _B_in["x"],
        "B_w_gate": _B_in["w_gate"],
        "B_w_up": _B_in["w_up"],
        "B_w_down": _B_in["w_down"],
    }

def reference(A_x, A_wqkv, A_wo, B_x, B_w_gate, B_w_up, B_w_down):
    def _A_ref(x, wqkv, wo):
        B, S, D = x.shape
        H = 32; Dh = D // H
        qkv = (lambda x, *d: x.permute(*d))((x @ wqkv).reshape(B, S, 3, H, Dh), 2, 0, 3, 1, 4)
        q, k, v = qkv[0], qkv[1], qkv[2]
        phi = lambda t: torch.where(t > 0, t + 1, torch.exp(t)) + 1e-6
        pq, pk = phi(q), phi(k)
        kv = torch.einsum("bhsd,bhse->bhde", pk, v)
        z = torch.einsum("bhsd->bhd", pk)
        num = torch.einsum("bhqd,bhde->bhqe", pq, kv)
        den = torch.einsum("bhqd,bhd->bhq", pq, z)[..., None] + 1e-6
        o = num / den
        return (lambda x, *d: x.permute(*d))(o, 0, 2, 1, 3).reshape(B, S, D) @ wo

    def _B_ref(x, w_gate, w_up, w_down):
        g = torch.einsum("bsd,df->bsf", x, w_gate)
        u = torch.einsum("bsd,df->bsf", x, w_up)
        h = _gelu(g) * u
        return torch.einsum("bsf,fd->bsd", h, w_down)

    x = A_x
    x = x + _A_ref(_layernorm(x, axis=-1), A_wqkv, A_wo)
    x = x + _B_ref(_layernorm(x, axis=-1), B_w_gate, B_w_up, B_w_down)
    x = x + _A_ref(_layernorm(x, axis=-1), A_wqkv, A_wo)
    x = x + _B_ref(_layernorm(x, axis=-1), B_w_gate, B_w_up, B_w_down)
    return x
```

```asm
; @launch grid=(256,1,1) block=(256,1,1) lds=163840
.amdgcn_target "amdgcn-amd-amdhsa--gfx950"
.text
.globl interleave_layers__linear_attn_block__glu_gated_geglu__prompt_kernel
.p2align 8
.type interleave_layers__linear_attn_block__glu_gated_geglu__prompt_kernel,@function
interleave_layers__linear_attn_block__glu_gated_geglu__prompt_kernel:
s_cmp_ge_u32 s2, 256
s_cbranch_scc1 Lexit
s_load_dwordx16 s[64:79], s[0:1], 0
s_load_dwordx2 s[4:5], s[0:1], 72
s_getpc_b64 s[52:53]
v_and_b32 v1, 0xfc, v0
v_lshlrev_b32 v1, 5, v1
global_load_dword v255, v1, s[52:53]
s_lshr_b32 s54, s2, 3
s_lshl_b32 s54, s54, 4
s_add_u32 s54, s54, 64
v_lshrrev_b32 v1, 4, v0
v_add_lshl_u32 v1, v1, s54, 7
v_min_u32 v1, Lcode_end-interleave_layers__linear_attn_block__glu_gated_geglu__prompt_kernel-64, v1
global_load_dword v255, v1, s[52:53]
v_and_b32 v1, 63, v0
v_lshrrev_b32 v2, 6, v0
v_lshlrev_b32 v4, 4, v1
v_readfirstlane_b32 s3, v2
v_and_b32 v2, 15, v1
v_lshrrev_b32 v3, 4, v1
v_mov_b32 v14, 0x7fff0000
v_cmp_gt_u32 vcc, 32, v1
v_lshlrev_b32 v13, 2, v1
v_mov_b32 v15, 0
v_cndmask_b32 v13, v14, v13, vcc
s_mov_b32 s12, 20971520
s_mov_b32 s13, 0
s_and_b32 s14, s2, 7
s_lshr_b32 s15, s2, 3
s_lshr_b32 s6, s14, 1
s_lshl_b32 s6, s6, 2
s_lshr_b32 s7, s15, 3
s_add_u32 s6, s6, s7
s_and_b32 s7, s14, 1
s_lshl_b32 s7, s7, 3
s_and_b32 s16, s15, 7
s_add_u32 s7, s7, s16
v_and_b32 v16, 7, v1
v_lshrrev_b32 v17, 3, v1
v_mov_b32 v18, 0
s_mov_b32 s16, 99614720
s_lshl_b32 s17, s6, 4
s_add_u32 s17, s17, s7
s_lshl_b32 s17, s17, 2
s_add_u32 s17, s17, s3
s_mul_i32 s17, s17, 2304
v_min_u32 v19, 17, v1
v_lshlrev_b32 v19, 7, v19
s_waitcnt lgkmcnt(0)
s_mov_b32 s24, s64
s_mov_b32 s25, s65
s_mov_b32 s26, 0x240000
s_mov_b32 s27, 0x20000
buffer_load_dword v255, v19, s[24:27], s17 offen
s_mov_b32 s8, s4
s_mov_b32 s9, s5
s_mov_b32 s10, 0xf000000
s_mov_b32 s11, 0x20000
buffer_load_dword v12, v18, s[8:11], s16 offen sc1
s_lshl_b32 s36, s15, 2
s_add_u32 s36, s36, s3
s_mul_i32 s37, s14, 126
s_add_u32 s37, s37, s36
s_mul_i32 s38, s37, 74899
s_lshr_b32 s38, s38, 20
s_mul_i32 s39, s38, 14
s_sub_u32 s39, s37, s39
s_lshl_b32 s51, s39, 3
v_add_u32 v5, s51, v17
v_mul_u32_u24 v6, 147, v5
v_lshrrev_b32 v6, 10, v6
v_mul_u32_u24 v7, 7, v6
v_sub_u32 v5, v5, v7
v_cmp_gt_u32 vcc, 6, v5
v_lshlrev_b32 v7, 1, v16
v_mul_u32_u24 v11, 36, v6
v_cndmask_b32 v8, v16, v5, vcc
v_cndmask_b32 v7, 16, v7, vcc
v_lshrrev_b32 v9, 1, v8
v_add_u32 v9, 1, v9
v_cmp_gt_u32 vcc, 3, v9
v_mul_u32_u24 v10, 576, v9
v_and_b32 v9, 1, v8
v_mad_u32_u24 v7, v9, 18, v7
v_cndmask_b32 v10, 0, v10, vcc
v_cmp_gt_u32 vcc, 6, v8
v_add3_u32 v7, v7, v10, v11
v_lshlrev_b32 v7, 1, v7
s_cmp_lt_u32 s36, 126
s_cselect_b64 s[46:47], -1, 0
s_and_b64 vcc, vcc, s[46:47]
v_cndmask_b32 v7, v14, v7, vcc
s_mul_i32 s42, s38, 27648
v_mov_b32 v20, v7
s_mov_b32 s50, s42
s_mov_b32 s28, s66
s_mov_b32 s29, s67
s_mov_b32 s30, 0x1e6000
s_mov_b32 s31, 0x20000
buffer_load_dword v176, v20, s[28:31], s50 offen nt
s_add_u32 s50, s50, 3456
buffer_load_dword v177, v20, s[28:31], s50 offen nt
s_add_u32 s50, s50, 3456
buffer_load_dword v178, v20, s[28:31], s50 offen nt
s_add_u32 s50, s50, 3456
buffer_load_dword v179, v20, s[28:31], s50 offen nt
s_add_u32 s50, s50, 3456
buffer_load_dword v180, v20, s[28:31], s50 offen nt
s_add_u32 s50, s50, 3456
buffer_load_dword v181, v20, s[28:31], s50 offen nt
s_add_u32 s50, s50, 3456
buffer_load_dword v182, v20, s[28:31], s50 offen nt
s_add_u32 s50, s50, 3456
buffer_load_dword v183, v20, s[28:31], s50 offen nt
s_add_u32 s50, s50, 3456
s_lshr_b32 s40, s38, 3
v_lshlrev_b32 v5, 2, v5
s_mov_b32 s41, 52568627
v_bfe_u32 v9, s41, v5, 4
s_mov_b32 s41, 34607120
v_bfe_u32 v10, s41, v5, 4
s_mov_b32 s41, 5583616
v_bfe_u32 v11, s41, v5, 4
v_mul_u32_u24 v6, 129024, v6
v_lshl_add_u32 v6, v16, 4, v6
v_mad_u32_u24 v10, v11, 9, v10
v_mad_u32_u24 v9, v9, s40, v10
v_lshl_add_u32 v9, v9, 11, v6
v_cndmask_b32 v9, v14, v9, s[46:47]
s_and_b32 s44, s38, 7
s_lshl_b32 s44, s44, 8
s_mov_b32 s62, 0x05040100
s_mov_b32 s63, 0x07060302
s_lshl_b32 s36, s3, 5
s_add_u32 s36, s36, s15
s_mul_i32 s37, s14, 81
s_add_u32 s37, s37, s36
s_mul_i32 s38, s37, 116509
s_lshr_b32 s38, s38, 20
s_mul_i32 s39, s38, 9
s_sub_u32 s39, s37, s39
s_lshr_b32 s40, s38, 2
s_and_b32 s41, s38, 3
v_lshrrev_b32 v5, 2, v2
v_and_b32 v6, 3, v2
v_lshl_add_u32 v5, v5, 3, v6
v_lshrrev_b32 v6, 1, v3
v_lshl_add_u32 v5, v6, 5, v5
v_and_b32 v6, 1, v3
v_lshl_add_u32 v5, v6, 2, v5
v_mul_u32_u24 v7, 9, v3
s_lshr_b32 s42, s39, 1
s_mul_i32 s42, s42, 9
s_and_b32 s43, s39, 1
s_lshl_b32 s43, s43, 2
s_add_u32 s42, s42, s43
s_cmp_lt_u32 s39, 8
s_cselect_b64 vcc, -1, 0
s_cselect_b32 s42, s42, 8
v_cndmask_b32 v5, v1, v5, vcc
v_cndmask_b32 v7, v7, v3, vcc
v_lshlrev_b32 v5, 1, v5
v_mul_u32_u24 v7, 18432, v7
v_lshl_add_u32 v7, v2, 4, v7
s_mul_i32 s48, s42, 18432
s_lshl_b32 s43, s38, 8
s_add_u32 s48, s48, s43
s_add_u32 s48, s48, 2097152
s_mul_i32 s42, s40, 36
s_and_b32 s43, s41, 1
s_lshl_b32 s43, s43, 3
s_add_u32 s42, s42, s43
s_lshr_b32 s43, s41, 1
s_add_u32 s42, s42, s43
s_mul_i32 s43, s40, 288
s_mul_i32 s45, s41, 18
s_add_u32 s43, s43, s45
s_sub_u32 s43, s43, 4592
s_cmp_lt_u32 s36, 81
s_cselect_b64 vcc, -1, 0
v_cndmask_b32 v5, v14, v5, vcc
v_cndmask_b32 v10, v14, v7, vcc
s_cmp_lt_u32 s40, 16
s_cselect_b32 s42, s42, s43
s_cselect_b32 s80, 2, 1
s_cselect_b32 s81, 2, 71
s_cselect_b32 s82, 12, 71
s_mul_i32 s42, s42, 1152
s_lshl_b32 s43, s39, 7
s_add_u32 s42, s42, s43
s_mul_i32 s80, s80, 1152
s_mul_i32 s81, s81, 1152
s_mul_i32 s82, s82, 1152
s_mov_b32 s32, s68
s_mov_b32 s33, s69
s_mov_b32 s34, 0xa2000
s_mov_b32 s35, 0x20000
buffer_load_ushort v192, v5, s[32:35], s42 offen
s_mov_b32 s45, s42
s_add_u32 s42, s42, s80
buffer_load_ushort v193, v5, s[32:35], s42 offen
s_cmp_eq_u32 s39, 1
s_cselect_b32 s45, s42, s45
s_add_u32 s42, s42, s81
buffer_load_ushort v194, v5, s[32:35], s42 offen
s_cmp_eq_u32 s39, 2
s_cselect_b32 s45, s42, s45
s_add_u32 s42, s42, s80
buffer_load_ushort v195, v5, s[32:35], s42 offen
s_cmp_eq_u32 s39, 3
s_cselect_b32 s45, s42, s45
s_add_u32 s42, s42, s82
buffer_load_ushort v196, v5, s[32:35], s42 offen
s_cmp_eq_u32 s39, 4
s_cselect_b32 s45, s42, s45
s_add_u32 s42, s42, s80
buffer_load_ushort v197, v5, s[32:35], s42 offen
s_cmp_eq_u32 s39, 5
s_cselect_b32 s45, s42, s45
s_add_u32 s42, s42, s81
buffer_load_ushort v198, v5, s[32:35], s42 offen
s_cmp_eq_u32 s39, 6
s_cselect_b32 s45, s42, s45
s_add_u32 s42, s42, s80
buffer_load_ushort v199, v5, s[32:35], s42 offen
s_cmp_eq_u32 s39, 7
s_cselect_b32 s45, s42, s45
s_lshl_b32 s18, s6, 2
s_add_u32 s18, s18, s3
s_mul_i32 s19, s18, 36864
s_mul_i32 s20, s3, 36864
v_lshrrev_b32 v19, 1, v17
v_xor_b32 v19, v19, v16
v_lshlrev_b32 v19, 4, v19
v_mul_u32_u24 v18, 1152, v17
v_add_u32 v19, v19, v18
v_xor_b32 v18, 64, v19
s_sub_u32 s24, s24, 3072
s_subb_u32 s25, s25, 0
s_add_u32 s26, s26, 3072
s_sub_u32 s45, s45, s43
s_cmp_lt_u32 s39, 8
s_cselect_b32 s40, s36, 99
s_cmp_lt_u32 s40, 81
s_cselect_b64 vcc, -1, 0
v_cndmask_b32 v5, v14, v4, vcc
s_cselect_b64 vcc, 0xff, 0
v_cndmask_b32 v6, v14, v4, vcc
v_mov_b32 v204, v6
buffer_load_dwordx4 v[104:107], v5, s[32:35], s45 offen
buffer_load_dwordx4 v[108:111], v6, s[32:35], s45 offen offset:1024
s_lshl_b32 s49, s38, 7
s_lshl_b32 s40, s39, 1
s_add_u32 s49, s49, s40
s_add_u32 s49, s49, 2760704
s_add_u32 m0, s20, 0
s_add_u32 s17, s19, 0xc00
buffer_load_dwordx4 v19, s[24:27], s17 offen offset:0 lds
s_add_u32 s17, s19, 0x2c00
buffer_load_dwordx4 v18, s[24:27], s17 offen offset:1024 lds
s_add_u32 s17, s19, 0x480
buffer_load_dwordx4 v19, s[24:27], s17 offen offset:2048 lds
s_add_u32 s17, s19, 0x2480
buffer_load_dwordx4 v18, s[24:27], s17 offen offset:3072 lds
s_add_u32 m0, s20, 4096
s_add_u32 s17, s19, 0xd00
buffer_load_dwordx4 v19, s[24:27], s17 offen offset:0 lds
s_add_u32 s17, s19, 0x2d00
buffer_load_dwordx4 v18, s[24:27], s17 offen offset:1024 lds
s_add_u32 s17, s19, 0x580
buffer_load_dwordx4 v19, s[24:27], s17 offen offset:2048 lds
s_add_u32 s17, s19, 0x2580
buffer_load_dwordx4 v18, s[24:27], s17 offen offset:3072 lds
s_lshl_b32 s83, s2, 7
s_add_u32 s83, s83, 0x60e0000
s_cmp_eq_u32 s3, 0
s_cselect_b64 vcc, -1, 0
v_cndmask_b32 v11, v14, v13, vcc
s_lshr_b32 s21, s2, 7
s_mul_i32 s21, s21, 37748736
s_and_b32 s22, s2, 127
s_lshl_b32 s22, s22, 9
s_add_u32 s21, s21, s22
s_add_u32 s21, s21, 28311552
v_cmp_gt_u32 vcc, 32, v0
v_mov_b32 v20, 0
v_mov_b32 v21, 0
v_mov_b32 v22, 0
v_mov_b32 v23, 0
v_cndmask_b32 v8, v14, v4, vcc
buffer_store_dwordx4 v[20:23], v8, s[8:11], s21 offen sc1
s_mov_b32 s16, 1664525
s_waitcnt vmcnt(27)
v_mul_lo_u32 v12, v12, s16
v_add_u32 v12, 1013904223, v12
v_not_b32 v24, v12
v_not_b32 v25, v12
v_not_b32 v26, v12
v_not_b32 v27, v12
v_lshlrev_b32 v28, 4, v16
v_lshl_add_u32 v28, v17, 17, v28
v_bfe_u32 v29, v1, 4, 1
v_mul_u32_u24 v29, 1835008, v29
v_cmp_gt_u32 vcc, 32, v1
v_add_u32 v28, v28, v29
s_lshl_b32 s16, s2, 2
s_add_u32 s16, s16, s3
s_lshl_b32 s16, s16, 7
s_add_u32 s16, s16, 101711872
v_cndmask_b32 v28, v14, v28, vcc
buffer_store_dwordx4 v[24:27], v28, s[8:11], s16 offen sc1
s_waitcnt vmcnt(26)
v_perm_b32 v184, v177, v176, s62
s_waitcnt vmcnt(24)
v_perm_b32 v185, v179, v178, s62
s_waitcnt vmcnt(22)
v_perm_b32 v186, v181, v180, s62
s_waitcnt vmcnt(20)
v_perm_b32 v187, v183, v182, s62
buffer_store_dwordx4 v[184:187], v9, s[8:11], s44 offen offset:0 sc1
v_perm_b32 v188, v177, v176, s63
v_perm_b32 v189, v179, v178, s63
v_perm_b32 v190, v181, v180, s63
v_perm_b32 v191, v183, v182, s63
buffer_store_dwordx4 v[188:191], v9, s[8:11], s44 offen offset:128 sc1
s_waitcnt vmcnt(20)
v_perm_b32 v200, v193, v192, s62
s_waitcnt vmcnt(18)
v_perm_b32 v201, v195, v194, s62
s_waitcnt vmcnt(16)
v_perm_b32 v202, v197, v196, s62
s_waitcnt vmcnt(14)
v_perm_b32 v203, v199, v198, s62
buffer_store_dwordx4 v[200:203], v10, s[8:11], s48 offen sc1
s_mov_b32 s16, 0x3f803f80
v_dot2_f32_bf16 v27, v184, s16, 0
v_dot2_f32_bf16 v28, v188, s16, 0
v_dot2_f32_bf16 v27, v185, s16, v27
v_dot2_f32_bf16 v28, v189, s16, v28
v_dot2_f32_bf16 v27, v186, s16, v27
v_dot2_f32_bf16 v28, v190, s16, v28
v_dot2_f32_bf16 v27, v187, s16, v27
v_dot2_f32_bf16 v28, v191, s16, v28
v_add_u32 v29, s51, v17
v_lshl_add_u32 v29, v29, 4, v16
v_lshlrev_b32 v29, 2, v29
v_cndmask_b32 v29, v14, v29, s[46:47]
s_waitcnt vmcnt(14)
v_dot2_f32_bf16 v20, v104, s16, 0
v_dot2_f32_bf16 v21, v105, s16, 0
v_dot2_f32_bf16 v20, v106, s16, v20
v_dot2_f32_bf16 v21, v107, s16, v21
s_waitcnt vmcnt(13)
v_dot2_f32_bf16 v20, v108, s16, v20
v_dot2_f32_bf16 v21, v109, s16, v21
v_dot2_f32_bf16 v20, v110, s16, v20
v_dot2_f32_bf16 v21, v111, s16, v21
s_nop 2
v_add_f32 v20, v20, v21
s_nop 1
v_add_f32_dpp v20, v20, v20 row_ror:1 row_mask:0xf bank_mask:0xf
s_nop 1
v_add_f32_dpp v20, v20, v20 row_ror:2 row_mask:0xf bank_mask:0xf
s_nop 1
v_add_f32_dpp v20, v20, v20 row_ror:4 row_mask:0xf bank_mask:0xf
s_nop 1
v_add_f32_dpp v20, v20, v20 row_ror:8 row_mask:0xf bank_mask:0xf
v_mov_b32 v21, v20
s_nop 1
v_permlane16_swap_b32 v20, v21
v_add_f32 v20, v20, v21
v_mov_b32 v21, v20
s_nop 1
v_permlane32_swap_b32 v20, v21
v_add_f32 v20, v20, v21
v_mul_f32 v20, 0x3ae38e39, v20
v_cmp_eq_u32 vcc, 0, v1
v_cvt_pk_bf16_f32 v21, v20, v20
v_lshlrev_b32 v22, 16, v21
v_sub_f32 v22, v20, v22
v_cvt_pk_bf16_f32 v22, v22, v22
v_cndmask_b32 v21, v22, v21, vcc
buffer_store_short v21, v204, s[8:11], s49 offen sc1
s_add_u32 m0, s20, 8192
s_add_u32 s17, s19, 0xe00
buffer_load_dwordx4 v19, s[24:27], s17 offen offset:0 lds
s_add_u32 s17, s19, 0x2e00
buffer_load_dwordx4 v18, s[24:27], s17 offen offset:1024 lds
s_add_u32 s17, s19, 0x680
buffer_load_dwordx4 v19, s[24:27], s17 offen offset:2048 lds
s_add_u32 s17, s19, 0x2680
buffer_load_dwordx4 v18, s[24:27], s17 offen offset:3072 lds
s_add_u32 m0, s20, 12288
s_add_u32 s17, s19, 0xf00
buffer_load_dwordx4 v19, s[24:27], s17 offen offset:0 lds
s_add_u32 s17, s19, 0x2f00
buffer_load_dwordx4 v18, s[24:27], s17 offen offset:1024 lds
s_add_u32 s17, s19, 0x780
buffer_load_dwordx4 v19, s[24:27], s17 offen offset:2048 lds
s_add_u32 s17, s19, 0x2780
buffer_load_dwordx4 v18, s[24:27], s17 offen offset:3072 lds
s_add_u32 m0, s20, 16384
s_add_u32 s17, s19, 0x1000
buffer_load_dwordx4 v19, s[24:27], s17 offen offset:0 lds
s_add_u32 s17, s19, 0x3000
buffer_load_dwordx4 v18, s[24:27], s17 offen offset:1024 lds
s_add_u32 m0, s20, 18432
s_add_u32 s17, s19, 0x5400
buffer_load_dwordx4 v19, s[24:27], s17 offen offset:0 lds
s_add_u32 s17, s19, 0x7400
buffer_load_dwordx4 v18, s[24:27], s17 offen offset:1024 lds
s_add_u32 s17, s19, 0x4c80
buffer_load_dwordx4 v19, s[24:27], s17 offen offset:2048 lds
s_add_u32 s17, s19, 0x6c80
buffer_load_dwordx4 v18, s[24:27], s17 offen offset:3072 lds
s_add_u32 m0, s20, 22528
s_add_u32 s17, s19, 0x5500
buffer_load_dwordx4 v19, s[24:27], s17 offen offset:0 lds
s_add_u32 s17, s19, 0x7500
buffer_load_dwordx4 v18, s[24:27], s17 offen offset:1024 lds
s_lshl_b32 s84, s2, 2
s_add_u32 s84, s84, s3
s_mul_i32 s85, s84, 18725
s_lshr_b32 s85, s85, 20
s_mul_i32 s86, s85, 56
s_sub_u32 s86, s84, s86
v_mul_u32_u24 v30, 73728, v17
v_lshl_add_u32 v30, v16, 4, v30
v_lshlrev_b32 v31, 8, v17
v_lshl_add_u32 v31, v16, 4, v31
s_cmp_lt_u32 s84, 1008
s_cselect_b64 vcc, -1, 0
v_cndmask_b32 v30, v14, v30, vcc
v_cndmask_b32 v31, v14, v31, vcc
s_lshr_b32 s88, s85, 1
s_mul_i32 s88, s88, 589824
s_lshl_b32 s89, s86, 7
s_add_u32 s88, s88, s89
s_bitcmp1_b32 s85, 0
s_cselect_b32 s56, s74, s72
s_cselect_b32 s57, s75, s73
s_mov_b32 s58, 5308416
s_mov_b32 s59, 0x20000
s_and_b32 s87, s86, 7
s_mul_i32 s87, s87, 1327104
s_lshr_b32 s89, s86, 3
s_mul_i32 s89, s89, 36864
s_add_u32 s87, s87, s89
s_and_b32 s89, s85, 1
s_lshl_b32 s89, s89, 11
s_add_u32 s87, s87, s89
s_add_u32 s87, s87, 3145728
s_lshr_b32 s85, s85, 1
s_and_b32 s89, s86, 1
s_lshl_b32 s89, s89, 2
s_mov_b32 s90, s85
s_lshl_b32 s90, s90, 12
s_add_u32 s90, s90, s87
s_mov_b32 s91, s85
s_lshl_b32 s91, s91, 12
s_add_u32 s91, s91, s87
s_add_u32 s91, s91, 331776
s_mov_b32 s92, s85
s_lshl_b32 s92, s92, 12
s_add_u32 s92, s92, s87
s_add_u32 s92, s92, 663552
s_mov_b32 s93, s85
s_lshl_b32 s93, s93, 12
s_add_u32 s93, s93, s87
s_add_u32 s93, s93, 995328
v_mov_b32 v20, 0x3f803f80
v_mov_b32 v21, 0x3f803f80
v_mov_b32 v22, 0x3f803f80
v_mov_b32 v23, 0x3f803f80
v_and_b32 v5, 3, v2
v_cmp_eq_u32 s[40:41], 1, v5
v_cmp_eq_u32 s[42:43], 2, v5
v_cmp_eq_u32 s[44:45], 3, v5
v_lshrrev_b32 v24, 2, v2
v_lshl_add_u32 v24, v24, 4, v2
v_lshlrev_b32 v24, 2, v24
v_lshrrev_b32 v182, 1, v2
v_xor_b32 v182, v182, v3
v_lshlrev_b32 v182, 4, v182
v_lshlrev_b32 v183, 7, v2
v_add3_u32 v182, v182, v183, s20
v_xor_b32 v183, 64, v182
v_lshrrev_b32 v6, 2, v2
v_cmp_eq_u32 vcc, v6, v3
v_and_b32 v6, 1, v2
v_lshlrev_b32 v6, 4, v6
v_mov_b32 v7, 0x3f80
v_lshlrev_b32 v6, v6, v7
v_cndmask_b32 v6, 0, v6, vcc
v_cmp_gt_u32 vcc, 2, v5
v_mov_b32 v176, 0
v_mov_b32 v177, 0
v_mov_b32 v180, 0
v_mov_b32 v181, 0
v_cndmask_b32 v178, 0, v6, vcc
v_cndmask_b32 v179, v6, 0, vcc
s_mov_b32 s46, 0x3ae38e39
s_waitcnt vmcnt(16)
s_barrier
buffer_store_dword v12, v11, s[8:11], s83 offen sc1
ds_read_b128 v[32:35], v182 offset:0
ds_read_b128 v[36:39], v183 offset:0
ds_read_b128 v[40:43], v182 offset:2048
ds_read_b128 v[44:47], v183 offset:2048
ds_read_b128 v[48:51], v182 offset:4096
ds_read_b128 v[52:55], v183 offset:4096
s_add_u32 s17, s19, 0x4d80
s_waitcnt lgkmcnt(5)
v_mfma_f32_16x16x32_bf16 v[204:207], v[20:23], v[32:35], 0
buffer_load_dwordx4 v19, s[24:27], s17 offen offset:2048 lds
s_waitcnt lgkmcnt(4)
v_mfma_f32_16x16x32_bf16 v[204:207], v[20:23], v[36:39], v[204:207]
ds_read_b128 v[56:59], v182 offset:6144
ds_read_b128 v[60:63], v183 offset:6144
s_add_u32 s17, s19, 0x6d80
s_waitcnt lgkmcnt(5)
v_mfma_f32_16x16x32_bf16 v[204:207], v[20:23], v[40:43], v[204:207]
buffer_load_dwordx4 v18, s[24:27], s17 offen offset:3072 lds
s_waitcnt lgkmcnt(4)
v_mfma_f32_16x16x32_bf16 v[204:207], v[20:23], v[44:47], v[204:207]
s_waitcnt vmcnt(17)
ds_read_b128 v[64:67], v182 offset:8192
ds_read_b128 v[68:71], v183 offset:8192
s_add_u32 m0, s20, 26624
s_add_u32 s17, s19, 0x5600
s_waitcnt lgkmcnt(5)
v_mfma_f32_16x16x32_bf16 v[204:207], v[20:23], v[48:51], v[204:207]
buffer_load_dwordx4 v19, s[24:27], s17 offen offset:0 lds
s_waitcnt lgkmcnt(4)
v_mfma_f32_16x16x32_bf16 v[204:207], v[20:23], v[52:55], v[204:207]
s_waitcnt vmcnt(16)
ds_read_b128 v[72:75], v182 offset:10240
ds_read_b128 v[76:79], v183 offset:10240
s_add_u32 s17, s19, 0x7600
s_waitcnt lgkmcnt(5)
v_mfma_f32_16x16x32_bf16 v[204:207], v[20:23], v[56:59], v[204:207]
buffer_load_dwordx4 v18, s[24:27], s17 offen offset:1024 lds
s_waitcnt lgkmcnt(4)
v_mfma_f32_16x16x32_bf16 v[204:207], v[20:23], v[60:63], v[204:207]
s_waitcnt vmcnt(15)
ds_read_b128 v[80:83], v182 offset:12288
ds_read_b128 v[84:87], v183 offset:12288
s_waitcnt lgkmcnt(5)
v_mfma_f32_16x16x32_bf16 v[204:207], v[20:23], v[64:67], v[204:207]
s_add_u32 s17, s19, 0x4e80
s_waitcnt lgkmcnt(4)
v_mfma_f32_16x16x32_bf16 v[204:207], v[20:23], v[68:71], v[204:207]
buffer_load_dwordx4 v19, s[24:27], s17 offen offset:2048 lds
s_waitcnt vmcnt(14)
ds_read_b128 v[88:91], v182 offset:14336
ds_read_b128 v[92:95], v183 offset:14336
s_waitcnt lgkmcnt(5)
v_mfma_f32_16x16x32_bf16 v[204:207], v[20:23], v[72:75], v[204:207]
s_add_u32 s17, s19, 0x6e80
s_waitcnt lgkmcnt(4)
v_mfma_f32_16x16x32_bf16 v[204:207], v[20:23], v[76:79], v[204:207]
buffer_load_dwordx4 v18, s[24:27], s17 offen offset:3072 lds
s_waitcnt vmcnt(13)
ds_read_b128 v[96:99], v182 offset:16384
ds_read_b128 v[100:103], v183 offset:16384
s_waitcnt lgkmcnt(5)
v_mfma_f32_16x16x32_bf16 v[204:207], v[20:23], v[80:83], v[204:207]
s_add_u32 m0, s20, 30720
s_add_u32 s17, s19, 0x5700
s_waitcnt lgkmcnt(4)
v_mfma_f32_16x16x32_bf16 v[204:207], v[20:23], v[84:87], v[204:207]
buffer_load_dwordx4 v19, s[24:27], s17 offen offset:0 lds
s_waitcnt lgkmcnt(3)
v_mfma_f32_16x16x32_bf16 v[204:207], v[20:23], v[88:91], v[204:207]
s_add_u32 s17, s19, 0x7700
s_waitcnt lgkmcnt(2)
v_mfma_f32_16x16x32_bf16 v[204:207], v[20:23], v[92:95], v[204:207]
buffer_load_dwordx4 v18, s[24:27], s17 offen offset:1024 lds
s_waitcnt lgkmcnt(1)
v_mfma_f32_16x16x32_bf16 v[204:207], v[20:23], v[96:99], v[204:207]
s_waitcnt lgkmcnt(0)
v_mfma_f32_16x16x32_bf16 v[204:207], v[20:23], v[100:103], v[204:207]
s_nop 7
v_mul_f32 v204, 0xbae38e39, v204
v_mul_f32 v205, 0xbae38e39, v205
v_mul_f32 v206, 0xbae38e39, v206
v_mul_f32 v207, 0xbae38e39, v207
s_add_u32 s17, s19, 0x4f80
s_nop 0
v_mfma_f32_16x16x32_bf16 v[184:187], v[178:181], v[32:35], v[204:207]
buffer_load_dwordx4 v19, s[24:27], s17 offen offset:2048 lds
v_mfma_f32_16x16x32_bf16 v[188:191], v[176:179], v[32:35], v[204:207]
v_mfma_f32_16x16x32_bf16 v[208:211], v[32:35], v[32:35], 0
s_add_u32 s17, s19, 0x6f80
v_mfma_f32_16x16x32_bf16 v[192:195], v[178:181], v[36:39], v[204:207]
buffer_load_dwordx4 v18, s[24:27], s17 offen offset:3072 lds
v_mfma_f32_16x16x32_bf16 v[196:199], v[176:179], v[36:39], v[204:207]
s_nop 0
v_cvt_pk_bf16_f32 v32, v184, v185
v_mfma_f32_16x16x32_bf16 v[208:211], v[36:39], v[36:39], v[208:211]
v_cvt_pk_bf16_f32 v33, v186, v187
v_cvt_pk_bf16_f32 v34, v188, v189
v_cvt_pk_bf16_f32 v35, v190, v191
s_add_u32 m0, s20, 34816
s_add_u32 s17, s19, 0x5800
v_mfma_f32_16x16x32_bf16 v[184:187], v[178:181], v[40:43], v[204:207]
buffer_load_dwordx4 v19, s[24:27], s17 offen offset:0 lds
v_accvgpr_write_b32 a0, v32
v_accvgpr_write_b32 a1, v33
v_mfma_f32_16x16x32_bf16 v[188:191], v[176:179], v[40:43], v[204:207]
v_accvgpr_write_b32 a2, v34
v_accvgpr_write_b32 a3, v35
v_cvt_pk_bf16_f32 v36, v192, v193
v_mfma_f32_16x16x32_bf16 v[208:211], v[40:43], v[40:43], v[208:211]
v_cvt_pk_bf16_f32 v37, v194, v195
v_cvt_pk_bf16_f32 v38, v196, v197
v_cvt_pk_bf16_f32 v39, v198, v199
s_add_u32 s17, s19, 0x7800
v_mfma_f32_16x16x32_bf16 v[192:195], v[178:181], v[44:47], v[204:207]
buffer_load_dwordx4 v18, s[24:27], s17 offen offset:1024 lds
v_accvgpr_write_b32 a8, v36
v_accvgpr_write_b32 a9, v37
v_mfma_f32_16x16x32_bf16 v[196:199], v[176:179], v[44:47], v[204:207]
v_accvgpr_write_b32 a10, v38
v_accvgpr_write_b32 a11, v39
v_cvt_pk_bf16_f32 v40, v184, v185
v_mfma_f32_16x16x32_bf16 v[208:211], v[44:47], v[44:47], v[208:211]
v_cvt_pk_bf16_f32 v41, v186, v187
v_cvt_pk_bf16_f32 v42, v188, v189
v_cvt_pk_bf16_f32 v43, v190, v191
v_mfma_f32_16x16x32_bf16 v[184:187], v[178:181], v[48:51], v[204:207]
buffer_load_dwordx4 v[220:223], v30, s[56:59], s88 offen nt
s_add_u32 s88, s88, 9216
v_accvgpr_write_b32 a16, v40
v_accvgpr_write_b32 a17, v41
v_mfma_f32_16x16x32_bf16 v[188:191], v[176:179], v[48:51], v[204:207]
v_accvgpr_write_b32 a18, v42
v_accvgpr_write_b32 a19, v43
v_cvt_pk_bf16_f32 v44, v192, v193
v_mfma_f32_16x16x32_bf16 v[208:211], v[48:51], v[48:51], v[208:211]
v_cvt_pk_bf16_f32 v45, v194, v195
v_cvt_pk_bf16_f32 v46, v196, v197
v_cvt_pk_bf16_f32 v47, v198, v199
v_mfma_f32_16x16x32_bf16 v[192:195], v[178:181], v[52:55], v[204:207]
buffer_load_dwordx4 v[224:227], v30, s[56:59], s88 offen nt
s_add_u32 s88, s88, 9216
v_accvgpr_write_b32 a24, v44
v_accvgpr_write_b32 a25, v45
v_mfma_f32_16x16x32_bf16 v[196:199], v[176:179], v[52:55], v[204:207]
v_accvgpr_write_b32 a26, v46
v_accvgpr_write_b32 a27, v47
v_cvt_pk_bf16_f32 v48, v184, v185
v_mfma_f32_16x16x32_bf16 v[208:211], v[52:55], v[52:55], v[208:211]
v_cvt_pk_bf16_f32 v49, v186, v187
v_cvt_pk_bf16_f32 v50, v188, v189
v_cvt_pk_bf16_f32 v51, v190, v191
v_mfma_f32_16x16x32_bf16 v[184:187], v[178:181], v[56:59], v[204:207]
buffer_load_dwordx4 v[228:231], v30, s[56:59], s88 offen nt
s_add_u32 s88, s88, 9216
v_accvgpr_write_b32 a32, v48
v_accvgpr_write_b32 a33, v49
v_mfma_f32_16x16x32_bf16 v[188:191], v[176:179], v[56:59], v[204:207]
v_accvgpr_write_b32 a34, v50
v_accvgpr_write_b32 a35, v51
v_cvt_pk_bf16_f32 v52, v192, v193
v_mfma_f32_16x16x32_bf16 v[208:211], v[56:59], v[56:59], v[208:211]
v_cvt_pk_bf16_f32 v53, v194, v195
v_cvt_pk_bf16_f32 v54, v196, v197
v_cvt_pk_bf16_f32 v55, v198, v199
v_mfma_f32_16x16x32_bf16 v[192:195], v[178:181], v[60:63], v[204:207]
v_accvgpr_write_b32 a40, v52
v_accvgpr_write_b32 a41, v53
v_mfma_f32_16x16x32_bf16 v[196:199], v[176:179], v[60:63], v[204:207]
buffer_load_dwordx4 v[232:235], v30, s[56:59], s88 offen nt
s_add_u32 s88, s88, 9216
v_accvgpr_write_b32 a42, v54
v_accvgpr_write_b32 a43, v55
v_cvt_pk_bf16_f32 v56, v184, v185
v_mfma_f32_16x16x32_bf16 v[208:211], v[60:63], v[60:63], v[208:211]
v_cvt_pk_bf16_f32 v57, v186, v187
v_cvt_pk_bf16_f32 v58, v188, v189
v_cvt_pk_bf16_f32 v59, v190, v191
v_mfma_f32_16x16x32_bf16 v[184:187], v[178:181], v[64:67], v[204:207]
v_accvgpr_write_b32 a48, v56
v_accvgpr_write_b32 a49, v57
v_mfma_f32_16x16x32_bf16 v[188:191], v[176:179], v[64:67], v[204:207]
buffer_load_dwordx4 v[236:239], v30, s[56:59], s88 offen nt
s_add_u32 s88, s88, 9216
v_accvgpr_write_b32 a50, v58
v_accvgpr_write_b32 a51, v59
v_cvt_pk_bf16_f32 v60, v192, v193
v_mfma_f32_16x16x32_bf16 v[208:211], v[64:67], v[64:67], v[208:211]
v_cvt_pk_bf16_f32 v61, v194, v195
v_cvt_pk_bf16_f32 v62, v196, v197
v_cvt_pk_bf16_f32 v63, v198, v199
v_mfma_f32_16x16x32_bf16 v[192:195], v[178:181], v[68:71], v[204:207]
v_accvgpr_write_b32 a56, v60
v_accvgpr_write_b32 a57, v61
v_mfma_f32_16x16x32_bf16 v[196:199], v[176:179], v[68:71], v[204:207]
buffer_load_dwordx4 v[240:243], v30, s[56:59], s88 offen nt
s_add_u32 s88, s88, 9216
v_accvgpr_write_b32 a58, v62
v_accvgpr_write_b32 a59, v63
v_cvt_pk_bf16_f32 v64, v184, v185
v_mfma_f32_16x16x32_bf16 v[208:211], v[68:71], v[68:71], v[208:211]
v_cvt_pk_bf16_f32 v65, v186, v187
v_cvt_pk_bf16_f32 v66, v188, v189
v_cvt_pk_bf16_f32 v67, v190, v191
v_mfma_f32_16x16x32_bf16 v[184:187], v[178:181], v[72:75], v[204:207]
v_accvgpr_write_b32 a64, v64
v_accvgpr_write_b32 a65, v65
v_mfma_f32_16x16x32_bf16 v[188:191], v[176:179], v[72:75], v[204:207]
buffer_load_dwordx4 v[244:247], v30, s[56:59], s88 offen nt
s_add_u32 s88, s88, 9216
v_accvgpr_write_b32 a66, v66
v_accvgpr_write_b32 a67, v67
v_cvt_pk_bf16_f32 v68, v192, v193
v_mfma_f32_16x16x32_bf16 v[208:211], v[72:75], v[72:75], v[208:211]
v_cvt_pk_bf16_f32 v69, v194, v195
v_cvt_pk_bf16_f32 v70, v196, v197
v_cvt_pk_bf16_f32 v71, v198, v199
v_mfma_f32_16x16x32_bf16 v[192:195], v[178:181], v[76:79], v[204:207]
v_accvgpr_write_b32 a72, v68
v_accvgpr_write_b32 a73, v69
v_mfma_f32_16x16x32_bf16 v[196:199], v[176:179], v[76:79], v[204:207]
buffer_load_dwordx4 v[248:251], v30, s[56:59], s88 offen nt
s_add_u32 s88, s88, 9216
v_accvgpr_write_b32 a74, v70
v_accvgpr_write_b32 a75, v71
v_cvt_pk_bf16_f32 v72, v184, v185
v_mfma_f32_16x16x32_bf16 v[208:211], v[76:79], v[76:79], v[208:211]
v_cvt_pk_bf16_f32 v73, v186, v187
v_cvt_pk_bf16_f32 v74, v188, v189
v_cvt_pk_bf16_f32 v75, v190, v191
v_mfma_f32_16x16x32_bf16 v[184:187], v[178:181], v[80:83], v[204:207]
v_accvgpr_write_b32 a80, v72
v_accvgpr_write_b32 a81, v73
v_mfma_f32_16x16x32_bf16 v[188:191], v[176:179], v[80:83], v[204:207]
v_accvgpr_write_b32 a82, v74
v_accvgpr_write_b32 a83, v75
v_cvt_pk_bf16_f32 v76, v192, v193
v_mfma_f32_16x16x32_bf16 v[208:211], v[80:83], v[80:83], v[208:211]
v_cvt_pk_bf16_f32 v77, v194, v195
v_cvt_pk_bf16_f32 v78, v196, v197
v_cvt_pk_bf16_f32 v79, v198, v199
v_mfma_f32_16x16x32_bf16 v[192:195], v[178:181], v[84:87], v[204:207]
v_accvgpr_write_b32 a88, v76
v_accvgpr_write_b32 a89, v77
v_mfma_f32_16x16x32_bf16 v[196:199], v[176:179], v[84:87], v[204:207]
v_accvgpr_write_b32 a90, v78
v_accvgpr_write_b32 a91, v79
v_cvt_pk_bf16_f32 v80, v184, v185
v_mfma_f32_16x16x32_bf16 v[208:211], v[84:87], v[84:87], v[208:211]
v_cvt_pk_bf16_f32 v81, v186, v187
v_cvt_pk_bf16_f32 v82, v188, v189
v_cvt_pk_bf16_f32 v83, v190, v191
v_mfma_f32_16x16x32_bf16 v[184:187], v[178:181], v[88:91], v[204:207]
v_accvgpr_write_b32 a96, v80
v_accvgpr_write_b32 a97, v81
v_mfma_f32_16x16x32_bf16 v[188:191], v[176:179], v[88:91], v[204:207]
v_accvgpr_write_b32 a98, v82
v_accvgpr_write_b32 a99, v83
v_cvt_pk_bf16_f32 v84, v192, v193
v_mfma_f32_16x16x32_bf16 v[208:211], v[88:91], v[88:91], v[208:211]
v_cvt_pk_bf16_f32 v85, v194, v195
v_cvt_pk_bf16_f32 v86, v196, v197
v_cvt_pk_bf16_f32 v87, v198, v199
v_mfma_f32_16x16x32_bf16 v[192:195], v[178:181], v[92:95], v[204:207]
v_accvgpr_write_b32 a104, v84
v_accvgpr_write_b32 a105, v85
v_mfma_f32_16x16x32_bf16 v[196:199], v[176:179], v[92:95], v[204:207]
v_accvgpr_write_b32 a106, v86
v_accvgpr_write_b32 a107, v87
v_cvt_pk_bf16_f32 v88, v184, v185
v_mfma_f32_16x16x32_bf16 v[208:211], v[92:95], v[92:95], v[208:211]
v_cvt_pk_bf16_f32 v89, v186, v187
v_cvt_pk_bf16_f32 v90, v188, v189
v_cvt_pk_bf16_f32 v91, v190, v191
v_mfma_f32_16x16x32_bf16 v[184:187], v[178:181], v[96:99], v[204:207]
v_accvgpr_write_b32 a112, v88
v_accvgpr_write_b32 a113, v89
v_mfma_f32_16x16x32_bf16 v[188:191], v[176:179], v[96:99], v[204:207]
v_accvgpr_write_b32 a114, v90
v_accvgpr_write_b32 a115, v91
v_cvt_pk_bf16_f32 v92, v192, v193
v_mfma_f32_16x16x32_bf16 v[208:211], v[96:99], v[96:99], v[208:211]
v_cvt_pk_bf16_f32 v93, v194, v195
v_cvt_pk_bf16_f32 v94, v196, v197
v_cvt_pk_bf16_f32 v95, v198, v199
v_mfma_f32_16x16x32_bf16 v[192:195], v[178:181], v[100:103], v[204:207]
v_accvgpr_write_b32 a120, v92
v_accvgpr_write_b32 a121, v93
v_mfma_f32_16x16x32_bf16 v[196:199], v[176:179], v[100:103], v[204:207]
v_accvgpr_write_b32 a122, v94
v_accvgpr_write_b32 a123, v95
v_cvt_pk_bf16_f32 v96, v184, v185
v_mfma_f32_16x16x32_bf16 v[208:211], v[100:103], v[100:103], v[208:211]
v_cvt_pk_bf16_f32 v97, v186, v187
v_cvt_pk_bf16_f32 v98, v188, v189
v_cvt_pk_bf16_f32 v99, v190, v191
v_accvgpr_write_b32 a128, v96
v_accvgpr_write_b32 a129, v97
v_accvgpr_write_b32 a130, v98
v_accvgpr_write_b32 a131, v99
v_cvt_pk_bf16_f32 v100, v192, v193
v_cvt_pk_bf16_f32 v101, v194, v195
v_cvt_pk_bf16_f32 v102, v196, v197
v_cvt_pk_bf16_f32 v103, v198, v199
v_accvgpr_write_b32 a136, v100
v_accvgpr_write_b32 a137, v101
v_accvgpr_write_b32 a138, v102
v_accvgpr_write_b32 a139, v103
s_mov_b32 s29, 0x60e0000
v_lshlrev_b32 v25, 7, v0
s_mul_i32 s22, s7, 129024
s_lshl_b32 s23, s3, 11
s_add_u32 s22, s22, s23
v_cndmask_b32 v208, v208, v209, s[40:41]
v_cndmask_b32 v208, v208, v210, s[42:43]
v_cndmask_b32 v208, v208, v211, s[44:45]
ds_bpermute_b32 v209, v24, v208
v_mul_f32 v210, v204, v204
s_waitcnt lgkmcnt(0)
v_fma_f32 v208, v209, s46, -v210
v_max_f32 v208, 0, v208
v_add_f32 v208, 0x3727c5ac, v208
v_rsq_f32 v208, v208
s_waitcnt vmcnt(25)
ds_read_b128 v[104:107], v182 offset:18432
ds_read_b128 v[108:111], v183 offset:18432
s_waitcnt vmcnt(23)
ds_read_b128 v[112:115], v182 offset:20480
ds_read_b128 v[116:119], v183 offset:20480
s_waitcnt vmcnt(21)
ds_read_b128 v[120:123], v182 offset:22528
ds_read_b128 v[124:127], v183 offset:22528
s_waitcnt lgkmcnt(5)
v_mfma_f32_16x16x32_bf16 v[212:215], v[20:23], v[104:107], 0
s_waitcnt lgkmcnt(4)
v_mfma_f32_16x16x32_bf16 v[212:215], v[20:23], v[108:111], v[212:215]
s_waitcnt vmcnt(18)
ds_read_b128 v[128:131], v182 offset:24576
ds_read_b128 v[132:135], v183 offset:24576
s_waitcnt lgkmcnt(5)
v_mfma_f32_16x16x32_bf16 v[212:215], v[20:23], v[112:115], v[212:215]
s_waitcnt lgkmcnt(4)
v_mfma_f32_16x16x32_bf16 v[212:215], v[20:23], v[116:119], v[212:215]
s_waitcnt vmcnt(16)
ds_read_b128 v[136:139], v182 offset:26624
ds_read_b128 v[140:143], v183 offset:26624
s_waitcnt lgkmcnt(5)
v_mfma_f32_16x16x32_bf16 v[212:215], v[20:23], v[120:123], v[212:215]
s_waitcnt lgkmcnt(4)
v_mfma_f32_16x16x32_bf16 v[212:215], v[20:23], v[124:127], v[212:215]
s_waitcnt vmcnt(14)
ds_read_b128 v[144:147], v182 offset:28672
ds_read_b128 v[148:151], v183 offset:28672
s_waitcnt lgkmcnt(5)
v_mfma_f32_16x16x32_bf16 v[212:215], v[20:23], v[128:131], v[212:215]
s_waitcnt lgkmcnt(4)
v_mfma_f32_16x16x32_bf16 v[212:215], v[20:23], v[132:135], v[212:215]
s_waitcnt vmcnt(12)
ds_read_b128 v[152:155], v182 offset:30720
ds_read_b128 v[156:159], v183 offset:30720
s_waitcnt lgkmcnt(5)
v_mfma_f32_16x16x32_bf16 v[212:215], v[20:23], v[136:139], v[212:215]
s_waitcnt lgkmcnt(4)
v_mfma_f32_16x16x32_bf16 v[212:215], v[20:23], v[140:143], v[212:215]
s_waitcnt vmcnt(10)
ds_read_b128 v[160:163], v182 offset:32768
ds_read_b128 v[164:167], v183 offset:32768
s_waitcnt lgkmcnt(5)
v_mfma_f32_16x16x32_bf16 v[212:215], v[20:23], v[144:147], v[212:215]
s_waitcnt lgkmcnt(4)
v_mfma_f32_16x16x32_bf16 v[212:215], v[20:23], v[148:151], v[212:215]
s_waitcnt vmcnt(8)
ds_read_b128 v[168:171], v182 offset:34816
ds_read_b128 v[172:175], v183 offset:34816
s_waitcnt lgkmcnt(5)
v_mfma_f32_16x16x32_bf16 v[212:215], v[20:23], v[152:155], v[212:215]
buffer_load_dword v26, v25, s[8:11], s29 offen sc1
s_waitcnt lgkmcnt(4)
v_mfma_f32_16x16x32_bf16 v[212:215], v[20:23], v[156:159], v[212:215]
s_waitcnt lgkmcnt(3)
v_mfma_f32_16x16x32_bf16 v[212:215], v[20:23], v[160:163], v[212:215]
s_waitcnt lgkmcnt(2)
v_mfma_f32_16x16x32_bf16 v[212:215], v[20:23], v[164:167], v[212:215]
s_waitcnt lgkmcnt(1)
v_mfma_f32_16x16x32_bf16 v[212:215], v[20:23], v[168:171], v[212:215]
s_waitcnt lgkmcnt(0)
v_mfma_f32_16x16x32_bf16 v[212:215], v[20:23], v[172:175], v[212:215]
s_nop 7
v_mul_f32 v212, 0xbae38e39, v212
v_mul_f32 v213, 0xbae38e39, v213
v_mul_f32 v214, 0xbae38e39, v214
v_mul_f32 v215, 0xbae38e39, v215
s_nop 1
v_mfma_f32_16x16x32_bf16 v[184:187], v[178:181], v[104:107], v[212:215]
v_mfma_f32_16x16x32_bf16 v[188:191], v[176:179], v[104:107], v[212:215]
v_mfma_f32_16x16x32_bf16 v[216:219], v[104:107], v[104:107], 0
v_mfma_f32_16x16x32_bf16 v[192:195], v[178:181], v[108:111], v[212:215]
v_mfma_f32_16x16x32_bf16 v[196:199], v[176:179], v[108:111], v[212:215]
s_nop 3
v_cvt_pk_bf16_f32 v104, v184, v185
v_mfma_f32_16x16x32_bf16 v[216:219], v[108:111], v[108:111], v[216:219]
v_cvt_pk_bf16_f32 v105, v186, v187
v_cvt_pk_bf16_f32 v106, v188, v189
v_cvt_pk_bf16_f32 v107, v190, v191
v_mfma_f32_16x16x32_bf16 v[184:187], v[178:181], v[112:115], v[212:215]
v_accvgpr_write_b32 a4, v104
v_accvgpr_write_b32 a5, v105
v_mfma_f32_16x16x32_bf16 v[188:191], v[176:179], v[112:115], v[212:215]
v_accvgpr_write_b32 a6, v106
v_accvgpr_write_b32 a7, v107
v_cvt_pk_bf16_f32 v108, v192, v193
v_mfma_f32_16x16x32_bf16 v[216:219], v[112:115], v[112:115], v[216:219]
v_cvt_pk_bf16_f32 v109, v194, v195
v_cvt_pk_bf16_f32 v110, v196, v197
v_cvt_pk_bf16_f32 v111, v198, v199
v_mfma_f32_16x16x32_bf16 v[192:195], v[178:181], v[116:119], v[212:215]
v_accvgpr_write_b32 a12, v108
v_accvgpr_write_b32 a13, v109
v_mfma_f32_16x16x32_bf16 v[196:199], v[176:179], v[116:119], v[212:215]
v_accvgpr_write_b32 a14, v110
v_accvgpr_write_b32 a15, v111
v_cvt_pk_bf16_f32 v112, v184, v185
v_mfma_f32_16x16x32_bf16 v[216:219], v[116:119], v[116:119], v[216:219]
v_cvt_pk_bf16_f32 v113, v186, v187
v_cvt_pk_bf16_f32 v114, v188, v189
v_cvt_pk_bf16_f32 v115, v190, v191
v_mfma_f32_16x16x32_bf16 v[184:187], v[178:181], v[120:123], v[212:215]
v_accvgpr_write_b32 a20, v112
v_accvgpr_write_b32 a21, v113
v_mfma_f32_16x16x32_bf16 v[188:191], v[176:179], v[120:123], v[212:215]
v_accvgpr_write_b32 a22, v114
v_accvgpr_write_b32 a23, v115
v_cvt_pk_bf16_f32 v116, v192, v193
v_mfma_f32_16x16x32_bf16 v[216:219], v[120:123], v[120:123], v[216:219]
v_cvt_pk_bf16_f32 v117, v194, v195
v_cvt_pk_bf16_f32 v118, v196, v197
v_cvt_pk_bf16_f32 v119, v198, v199
v_mfma_f32_16x16x32_bf16 v[192:195], v[178:181], v[124:127], v[212:215]
v_accvgpr_write_b32 a28, v116
v_accvgpr_write_b32 a29, v117
v_mfma_f32_16x16x32_bf16 v[196:199], v[176:179], v[124:127], v[212:215]
v_accvgpr_write_b32 a30, v118
v_accvgpr_write_b32 a31, v119
v_cvt_pk_bf16_f32 v120, v184, v185
v_mfma_f32_16x16x32_bf16 v[216:219], v[124:127], v[124:127], v[216:219]
v_cvt_pk_bf16_f32 v121, v186, v187
v_cvt_pk_bf16_f32 v122, v188, v189
v_cvt_pk_bf16_f32 v123, v190, v191
v_mfma_f32_16x16x32_bf16 v[184:187], v[178:181], v[128:131], v[212:215]
v_accvgpr_write_b32 a36, v120
v_accvgpr_write_b32 a37, v121
v_mfma_f32_16x16x32_bf16 v[188:191], v[176:179], v[128:131], v[212:215]
v_accvgpr_write_b32 a38, v122
v_accvgpr_write_b32 a39, v123
v_cvt_pk_bf16_f32 v124, v192, v193
v_mfma_f32_16x16x32_bf16 v[216:219], v[128:131], v[128:131], v[216:219]
v_cvt_pk_bf16_f32 v125, v194, v195
v_cvt_pk_bf16_f32 v126, v196, v197
v_cvt_pk_bf16_f32 v127, v198, v199
v_mfma_f32_16x16x32_bf16 v[192:195], v[178:181], v[132:135], v[212:215]
v_accvgpr_write_b32 a44, v124
v_accvgpr_write_b32 a45, v125
v_mfma_f32_16x16x32_bf16 v[196:199], v[176:179], v[132:135], v[212:215]
v_accvgpr_write_b32 a46, v126
v_accvgpr_write_b32 a47, v127
v_cvt_pk_bf16_f32 v128, v184, v185
v_mfma_f32_16x16x32_bf16 v[216:219], v[132:135], v[132:135], v[216:219]
v_cvt_pk_bf16_f32 v129, v186, v187
v_cvt_pk_bf16_f32 v130, v188, v189
v_cvt_pk_bf16_f32 v131, v190, v191
v_mfma_f32_16x16x32_bf16 v[184:187], v[178:181], v[136:139], v[212:215]
v_accvgpr_write_b32 a52, v128
v_accvgpr_write_b32 a53, v129
v_mfma_f32_16x16x32_bf16 v[188:191], v[176:179], v[136:139], v[212:215]
s_waitcnt vmcnt(0)
v_cmp_ne_u32 vcc, v12, v26
s_nop 1
s_cbranch_vccnz Lsp1
Lok1:
s_barrier
s_add_u32 m0, s23, 73728
s_nop 0
buffer_load_dwordx4 v4, s[8:11], s22 offen offset:0 sc1 lds
buffer_load_dwordx4 v4, s[8:11], s22 offen offset:1024 sc1 lds
s_add_u32 s22, s22, 8192
s_add_u32 m0, s23, 81920
s_nop 0
buffer_load_dwordx4 v4, s[8:11], s22 offen offset:0 sc1 lds
buffer_load_dwordx4 v4, s[8:11], s22 offen offset:1024 sc1 lds
s_add_u32 s22, s22, 8192
v_accvgpr_write_b32 a54, v130
v_accvgpr_write_b32 a55, v131
v_cvt_pk_bf16_f32 v132, v192, v193
s_add_u32 m0, s23, 90112
v_mfma_f32_16x16x32_bf16 v[216:219], v[136:139], v[136:139], v[216:219]
buffer_load_dwordx4 v4, s[8:11], s22 offen offset:0 sc1 lds
v_cvt_pk_bf16_f32 v133, v194, v195
v_cvt_pk_bf16_f32 v134, v196, v197
v_cvt_pk_bf16_f32 v135, v198, v199
v_mfma_f32_16x16x32_bf16 v[192:195], v[178:181], v[140:143], v[212:215]
v_accvgpr_write_b32 a60, v132
v_accvgpr_write_b32 a61, v133
v_mfma_f32_16x16x32_bf16 v[196:199], v[176:179], v[140:143], v[212:215]
v_accvgpr_write_b32 a62, v134
v_accvgpr_write_b32 a63, v135
v_cvt_pk_bf16_f32 v136, v184, v185
v_mfma_f32_16x16x32_bf16 v[216:219], v[140:143], v[140:143], v[216:219]
buffer_load_dwordx4 v4, s[8:11], s22 offen offset:1024 sc1 lds
s_add_u32 s22, s22, 8192
v_cvt_pk_bf16_f32 v137, v186, v187
v_cvt_pk_bf16_f32 v138, v188, v189
v_cvt_pk_bf16_f32 v139, v190, v191
v_mfma_f32_16x16x32_bf16 v[184:187], v[178:181], v[144:147], v[212:215]
v_accvgpr_write_b32 a68, v136
v_accvgpr_write_b32 a69, v137
v_mfma_f32_16x16x32_bf16 v[188:191], v[176:179], v[144:147], v[212:215]
v_accvgpr_write_b32 a70, v138
v_accvgpr_write_b32 a71, v139
v_cvt_pk_bf16_f32 v140, v192, v193
v_mfma_f32_16x16x32_bf16 v[216:219], v[144:147], v[144:147], v[216:219]
v_cvt_pk_bf16_f32 v141, v194, v195
v_cvt_pk_bf16_f32 v142, v196, v197
v_cvt_pk_bf16_f32 v143, v198, v199
s_add_u32 m0, s23, 98304
v_mfma_f32_16x16x32_bf16 v[192:195], v[178:181], v[148:151], v[212:215]
buffer_load_dwordx4 v4, s[8:11], s22 offen offset:0 sc1 lds
v_accvgpr_write_b32 a76, v140
v_accvgpr_write_b32 a77, v141
v_mfma_f32_16x16x32_bf16 v[196:199], v[176:179], v[148:151], v[212:215]
v_accvgpr_write_b32 a78, v142
v_accvgpr_write_b32 a79, v143
v_cvt_pk_bf16_f32 v144, v184, v185
v_mfma_f32_16x16x32_bf16 v[216:219], v[148:151], v[148:151], v[216:219]
v_cvt_pk_bf16_f32 v145, v186, v187
v_cvt_pk_bf16_f32 v146, v188, v189
v_cvt_pk_bf16_f32 v147, v190, v191
v_mfma_f32_16x16x32_bf16 v[184:187], v[178:181], v[152:155], v[212:215]
buffer_load_dwordx4 v4, s[8:11], s22 offen offset:1024 sc1 lds
s_add_u32 s22, s22, 8192
v_accvgpr_write_b32 a84, v144
v_accvgpr_write_b32 a85, v145
v_mfma_f32_16x16x32_bf16 v[188:191], v[176:179], v[152:155], v[212:215]
v_accvgpr_write_b32 a86, v146
v_accvgpr_write_b32 a87, v147
v_cvt_pk_bf16_f32 v148, v192, v193
v_mfma_f32_16x16x32_bf16 v[216:219], v[152:155], v[152:155], v[216:219]
v_cvt_pk_bf16_f32 v149, v194, v195
v_cvt_pk_bf16_f32 v150, v196, v197
v_cvt_pk_bf16_f32 v151, v198, v199
v_mfma_f32_16x16x32_bf16 v[192:195], v[178:181], v[156:159], v[212:215]
v_accvgpr_write_b32 a92, v148
v_accvgpr_write_b32 a93, v149
s_add_u32 m0, s23, 106496
v_mfma_f32_16x16x32_bf16 v[196:199], v[176:179], v[156:159], v[212:215]
buffer_load_dwordx4 v4, s[8:11], s22 offen offset:0 sc1 lds
v_accvgpr_write_b32 a94, v150
v_accvgpr_write_b32 a95, v151
v_cvt_pk_bf16_f32 v152, v184, v185
v_mfma_f32_16x16x32_bf16 v[216:219], v[156:159], v[156:159], v[216:219]
v_cvt_pk_bf16_f32 v153, v186, v187
v_cvt_pk_bf16_f32 v154, v188, v189
v_cvt_pk_bf16_f32 v155, v190, v191
v_mfma_f32_16x16x32_bf16 v[184:187], v[178:181], v[160:163], v[212:215]
v_accvgpr_write_b32 a100, v152
v_accvgpr_write_b32 a101, v153
v_mfma_f32_16x16x32_bf16 v[188:191], v[176:179], v[160:163], v[212:215]
buffer_load_dwordx4 v4, s[8:11], s22 offen offset:1024 sc1 lds
s_add_u32 s22, s22, 8192
v_accvgpr_write_b32 a102, v154
v_accvgpr_write_b32 a103, v155
v_cvt_pk_bf16_f32 v156, v192, v193
v_mfma_f32_16x16x32_bf16 v[216:219], v[160:163], v[160:163], v[216:219]
v_cvt_pk_bf16_f32 v157, v194, v195
v_cvt_pk_bf16_f32 v158, v196, v197
v_cvt_pk_bf16_f32 v159, v198, v199
v_mfma_f32_16x16x32_bf16 v[192:195], v[178:181], v[164:167], v[212:215]
v_accvgpr_write_b32 a108, v156
v_accvgpr_write_b32 a109, v157
v_mfma_f32_16x16x32_bf16 v[196:199], v[176:179], v[164:167], v[212:215]
v_accvgpr_write_b32 a110, v158
v_accvgpr_write_b32 a111, v159
v_cvt_pk_bf16_f32 v160, v184, v185
s_add_u32 m0, s23, 114688
v_mfma_f32_16x16x32_bf16 v[216:219], v[164:167], v[164:167], v[216:219]
buffer_load_dwordx4 v4, s[8:11], s22 offen offset:0 sc1 lds
v_cvt_pk_bf16_f32 v161, v186, v187
v_cvt_pk_bf16_f32 v162, v188, v189
v_cvt_pk_bf16_f32 v163, v190, v191
v_mfma_f32_16x16x32_bf16 v[184:187], v[178:181], v[168:171], v[212:215]
v_accvgpr_write_b32 a116, v160
v_accvgpr_write_b32 a117, v161
v_mfma_f32_16x16x32_bf16 v[188:191], v[176:179], v[168:171], v[212:215]
v_accvgpr_write_b32 a118, v162
v_accvgpr_write_b32 a119, v163
v_cvt_pk_bf16_f32 v164, v192, v193
v_mfma_f32_16x16x32_bf16 v[216:219], v[168:171], v[168:171], v[216:219]
buffer_load_dwordx4 v4, s[8:11], s22 offen offset:1024 sc1 lds
s_add_u32 s22, s22, 8192
v_cvt_pk_bf16_f32 v165, v194, v195
v_cvt_pk_bf16_f32 v166, v196, v197
v_cvt_pk_bf16_f32 v167, v198, v199
v_mfma_f32_16x16x32_bf16 v[192:195], v[178:181], v[172:175], v[212:215]
v_accvgpr_write_b32 a124, v164
v_accvgpr_write_b32 a125, v165
v_mfma_f32_16x16x32_bf16 v[196:199], v[176:179], v[172:175], v[212:215]
v_accvgpr_write_b32 a126, v166
v_accvgpr_write_b32 a127, v167
v_cvt_pk_bf16_f32 v168, v184, v185
v_mfma_f32_16x16x32_bf16 v[216:219], v[172:175], v[172:175], v[216:219]
v_cvt_pk_bf16_f32 v169, v186, v187
v_cvt_pk_bf16_f32 v170, v188, v189
v_cvt_pk_bf16_f32 v171, v190, v191
v_accvgpr_write_b32 a132, v168
v_accvgpr_write_b32 a133, v169
v_accvgpr_write_b32 a134, v170
v_accvgpr_write_b32 a135, v171
v_cvt_pk_bf16_f32 v172, v192, v193
v_cvt_pk_bf16_f32 v173, v194, v195
v_cvt_pk_bf16_f32 v174, v196, v197
v_cvt_pk_bf16_f32 v175, v198, v199
v_accvgpr_write_b32 a140, v172
v_accvgpr_write_b32 a141, v173
v_accvgpr_write_b32 a142, v174
v_accvgpr_write_b32 a143, v175
v_add_u32 v5, 0x10000, v4
v_add_u32 v26, 0x20000, v4
v_mov_b32 v210, v27
v_mov_b32 v211, v28
v_mov_b32 v205, v29
s_and_b32 s51, s14, 1
s_lshl_b32 s51, s51, 13
s_bfe_u32 s50, s14, 0x10001
s_mul_i32 s50, s50, 37748736
s_add_u32 s51, s51, s50
s_add_u32 s51, s51, 28360704
s_waitcnt vmcnt(8)
s_barrier
ds_read_b128 v[96:99], v5 offset:8192
ds_read_b128 v[100:103], v5 offset:9216
ds_read_b128 v[104:107], v5 offset:10240
ds_read_b128 v[108:111], v5 offset:11264
ds_read_b128 v[112:115], v5 offset:12288
ds_read_b128 v[116:119], v5 offset:13312
ds_read_b128 v[120:123], v5 offset:14336
ds_read_b128 v[124:127], v5 offset:15360
s_waitcnt lgkmcnt(4)
v_mfma_f32_16x16x32_bf16 v[32:35], a[0:3], v[96:99], 0
s_add_u32 m0, s23, 122880
ds_read_b128 v[128:131], v5 offset:16384
v_cndmask_b32 v216, v216, v217, s[40:41]
v_mfma_f32_16x16x32_bf16 v[32:35], a[8:11], v[100:103], v[32:35]
buffer_load_dwordx4 v4, s[8:11], s22 offen offset:0 sc1 lds
v_mfma_f32_16x16x32_bf16 v[36:39], a[4:7], v[96:99], 0
ds_read_b128 v[132:135], v5 offset:17408
v_cndmask_b32 v216, v216, v218, s[42:43]
v_mfma_f32_16x16x32_bf16 v[36:39], a[12:15], v[100:103], v[36:39]
v_cndmask_b32 v216, v216, v219, s[44:45]
v_mfma_f32_16x16x32_bf16 v[40:43], a[0:3], v[104:107], 0
ds_read_b128 v[136:139], v5 offset:18432
ds_bpermute_b32 v217, v24, v216
v_mfma_f32_16x16x32_bf16 v[40:43], a[8:11], v[108:111], v[40:43]
buffer_load_dwordx4 v4, s[8:11], s22 offen offset:1024 sc1 lds
v_mfma_f32_16x16x32_bf16 v[44:47], a[4:7], v[104:107], 0
s_add_u32 s22, s22, 8192
ds_read_b128 v[140:143], v5 offset:19456
v_mul_f32 v218, v212, v212
v_mfma_f32_16x16x32_bf16 v[44:47], a[12:15], v[108:111], v[44:47]
s_waitcnt lgkmcnt(5)
s_waitcnt lgkmcnt(1)
v_fma_f32 v216, v217, s46, -v218
v_mfma_f32_16x16x32_bf16 v[64:67], a[0:3], v[112:115], 0
s_add_u32 m0, s23, 131072
ds_read_b128 v[96:99], v5 offset:20480
v_max_f32 v216, 0, v216
v_mfma_f32_16x16x32_bf16 v[64:67], a[8:11], v[116:119], v[64:67]
buffer_load_dwordx4 v4, s[8:11], s22 offen offset:0 sc1 lds
v_mfma_f32_16x16x32_bf16 v[68:71], a[4:7], v[112:115], 0
ds_read_b128 v[100:103], v5 offset:21504
v_add_f32 v216, 0x3727c5ac, v216
v_mfma_f32_16x16x32_bf16 v[68:71], a[12:15], v[116:119], v[68:71]
v_rsq_f32 v216, v216
v_mfma_f32_16x16x32_bf16 v[88:91], v[112:115], a[0:3], 0
v_mfma_f32_16x16x32_bf16 v[88:91], v[116:119], a[8:11], v[88:91]
buffer_load_dwordx4 v4, s[8:11], s22 offen offset:1024 sc1 lds
v_mfma_f32_16x16x32_bf16 v[92:95], v[112:115], a[4:7], 0
s_add_u32 s22, s22, 8192
s_and_b32 s39, s15, 3
s_mul_i32 s39, s39, 9
v_mfma_f32_16x16x32_bf16 v[92:95], v[116:119], a[12:15], v[92:95]
s_lshl_b32 s34, s3, 1
s_add_u32 s34, s34, s39
v_mfma_f32_16x16x32_bf16 v[32:35], a[16:19], v[120:123], v[32:35]
s_add_u32 m0, s23, 139264
s_mul_i32 s34, s34, 18432
ds_read_b128 v[104:107], v5 offset:22528
v_mfma_f32_16x16x32_bf16 v[32:35], a[24:27], v[124:127], v[32:35]
buffer_load_dwordx4 v4, s[8:11], s22 offen offset:0 sc1 lds
v_mfma_f32_16x16x32_bf16 v[36:39], a[20:23], v[120:123], v[36:39]
s_add_u32 s34, s34, 2097152
s_add_u32 s35, s34, 18432
ds_read_b128 v[108:111], v5 offset:23552
v_mfma_f32_16x16x32_bf16 v[36:39], a[28:31], v[124:127], v[36:39]
s_waitcnt lgkmcnt(4)
s_mul_i32 s39, s39, 18432
s_add_u32 s39, s39, 2244608
v_mfma_f32_16x16x32_bf16 v[40:43], a[16:19], v[128:131], v[40:43]
s_waitcnt vmcnt(9)
s_barrier
ds_read_b128 v[112:115], v5 offset:24576
v_mfma_f32_16x16x32_bf16 v[40:43], a[24:27], v[132:135], v[40:43]
buffer_load_dwordx4 v4, s[8:11], s22 offen offset:1024 sc1 lds
v_mfma_f32_16x16x32_bf16 v[44:47], a[20:23], v[128:131], v[44:47]
s_add_u32 s22, s22, 8192
s_lshl_b32 s36, s3, 12
ds_read_b128 v[116:119], v5 offset:25600
v_mfma_f32_16x16x32_bf16 v[44:47], a[28:31], v[132:135], v[44:47]
s_add_u32 s36, s36, s39
s_lshr_b32 s37, s3, 1
s_lshl_b32 s37, s37, 10
v_mfma_f32_16x16x32_bf16 v[64:67], a[16:19], v[136:139], v[64:67]
s_add_u32 m0, s23, 0
s_add_u32 s37, s37, s39
ds_read_b128 v[120:123], v5 offset:26624
v_mfma_f32_16x16x32_bf16 v[64:67], a[24:27], v[140:143], v[64:67]
buffer_load_dwordx4 v4, s[8:11], s22 offen offset:0 sc1 lds
v_mfma_f32_16x16x32_bf16 v[68:71], a[20:23], v[136:139], v[68:71]
s_and_b32 s38, s3, 1
s_lshl_b32 s38, s38, 3
ds_read_b128 v[124:127], v5 offset:27648
v_mfma_f32_16x16x32_bf16 v[68:71], a[28:31], v[140:143], v[68:71]
s_add_u32 s37, s37, s38
s_add_u32 s37, s37, 16384
v_lshlrev_b32 v214, 7, v3
v_mfma_f32_16x16x32_bf16 v[88:91], v[136:139], a[16:19], v[88:91]
s_lshl_b32 s40, s3, 11
s_add_u32 s40, s40, 2760704
v_lshl_add_u32 v214, v2, 4, v214
v_cmp_gt_u32 vcc, 2, v2
v_mfma_f32_16x16x32_bf16 v[88:91], v[140:143], a[24:27], v[88:91]
buffer_load_dwordx4 v4, s[8:11], s22 offen offset:1024 sc1 lds
v_cndmask_b32 v214, v14, v214, vcc
v_mfma_f32_16x16x32_bf16 v[92:95], v[136:139], a[20:23], v[92:95]
s_add_u32 s22, s22, 8192
s_lshr_b32 s41, s3, 1
s_lshl_b32 s41, s41, 9
v_mfma_f32_16x16x32_bf16 v[92:95], v[140:143], a[28:31], v[92:95]
s_waitcnt lgkmcnt(4)
s_add_u32 s41, s41, s38
s_add_u32 s41, s41, 2768896
v_mfma_f32_16x16x32_bf16 v[32:35], a[32:35], v[96:99], v[32:35]
s_add_u32 m0, s23, 8192
s_cmp_eq_u32 s2, 0
s_cselect_b64 vcc, -1, 0
ds_read_b128 v[128:131], v5 offset:28672
v_mfma_f32_16x16x32_bf16 v[32:35], a[40:43], v[100:103], v[32:35]
buffer_load_dwordx4 v4, s[8:11], s22 offen offset:0 sc1 lds
v_cmp_eq_u32 s[48:49], 0, v0
v_mfma_f32_16x16x32_bf16 v[36:39], a[36:39], v[96:99], v[36:39]
s_nop 0
s_and_b64 vcc, vcc, s[48:49]
s_mov_b32 s30, 99614720
ds_read_b128 v[132:135], v5 offset:29696
v_cndmask_b32 v25, v14, v0, vcc
v_mfma_f32_16x16x32_bf16 v[36:39], a[44:47], v[100:103], v[36:39]
buffer_store_dword v12, v25, s[8:11], s30 offen sc1
v_mfma_f32_16x16x32_bf16 v[40:43], a[32:35], v[104:107], v[40:43]
ds_read_b128 v[136:139], v5 offset:30720
v_not_b32 v20, v12
v_not_b32 v21, v12
v_mfma_f32_16x16x32_bf16 v[40:43], a[40:43], v[108:111], v[40:43]
buffer_load_dwordx4 v4, s[8:11], s22 offen offset:1024 sc1 lds
v_not_b32 v22, v12
v_mfma_f32_16x16x32_bf16 v[44:47], a[36:39], v[104:107], v[44:47]
s_add_u32 s22, s22, 8192
ds_read_b128 v[140:143], v5 offset:31744
v_not_b32 v23, v12
v_lshrrev_b32 v24, 3, v1
v_mfma_f32_16x16x32_bf16 v[44:47], a[44:47], v[108:111], v[44:47]
s_waitcnt lgkmcnt(4)
v_and_b32 v25, 7, v1
v_lshlrev_b32 v25, 4, v25
v_mfma_f32_16x16x32_bf16 v[64:67], a[32:35], v[112:115], v[64:67]
s_add_u32 m0, s23, 16384
ds_read_b128 v[96:99], v5 offset:32768
v_lshl_add_u32 v25, v24, 17, v25
v_mfma_f32_16x16x32_bf16 v[64:67], a[40:43], v[116:119], v[64:67]
buffer_load_dwordx4 v4, s[8:11], s22 offen offset:0 sc1 lds
v_mfma_f32_16x16x32_bf16 v[68:71], a[36:39], v[112:115], v[68:71]
s_lshl_b32 s30, s2, 2
ds_read_b128 v[100:103], v5 offset:33792
v_cmp_gt_u32 vcc, 7, v24
v_mfma_f32_16x16x32_bf16 v[68:71], a[44:47], v[116:119], v[68:71]
s_add_u32 s30, s30, s3
s_lshl_b32 s30, s30, 7
s_add_u32 s30, s30, 100663296
v_mfma_f32_16x16x32_bf16 v[88:91], v[112:115], a[32:35], v[88:91]
v_cndmask_b32 v24, v14, v25, vcc
v_mfma_f32_16x16x32_bf16 v[88:91], v[116:119], a[40:43], v[88:91]
buffer_load_dwordx4 v4, s[8:11], s22 offen offset:1024 sc1 lds
v_mfma_f32_16x16x32_bf16 v[92:95], v[112:115], a[36:39], v[92:95]
s_add_u32 s22, s22, 8192
v_mfma_f32_16x16x32_bf16 v[92:95], v[116:119], a[44:47], v[92:95]
buffer_store_dwordx4 v[20:23], v24, s[8:11], s30 offen sc1
v_mfma_f32_16x16x32_bf16 v[32:35], a[48:51], v[120:123], v[32:35]
s_add_u32 m0, s23, 24576
s_add_u32 s31, s30, 0x200000
ds_read_b128 v[104:107], v5 offset:34816
v_mfma_f32_16x16x32_bf16 v[32:35], a[56:59], v[124:127], v[32:35]
buffer_load_dwordx4 v4, s[8:11], s22 offen offset:0 sc1 lds
v_mfma_f32_16x16x32_bf16 v[36:39], a[52:55], v[120:123], v[36:39]
ds_read_b128 v[108:111], v5 offset:35840
v_mfma_f32_16x16x32_bf16 v[36:39], a[60:63], v[124:127], v[36:39]
s_waitcnt lgkmcnt(4)
buffer_store_dwordx4 v[20:23], v25, s[8:11], s31 offen sc1
v_mfma_f32_16x16x32_bf16 v[40:43], a[48:51], v[128:131], v[40:43]
s_mov_b32 s16, s6
s_mov_b32 s17, s7
ds_read_b128 v[112:115], v5 offset:36864
v_mfma_f32_16x16x32_bf16 v[40:43], a[56:59], v[132:135], v[40:43]
buffer_load_dwordx4 v4, s[8:11], s22 offen offset:1024 sc1 lds
v_mfma_f32_16x16x32_bf16 v[44:47], a[52:55], v[128:131], v[44:47]
s_add_u32 s22, s22, 8192
s_lshl_b32 s18, s16, 2
ds_read_b128 v[116:119], v5 offset:37888
v_mfma_f32_16x16x32_bf16 v[44:47], a[60:63], v[132:135], v[44:47]
s_add_u32 s18, s18, s3
s_mul_i32 s20, s18, 36864
s_add_u32 s20, s20, s12
v_mfma_f32_16x16x32_bf16 v[64:67], a[48:51], v[136:139], v[64:67]
s_add_u32 m0, s23, 32768
s_add_u32 s21, s20, 18432
ds_read_b128 v[120:123], v5 offset:38912
v_mfma_f32_16x16x32_bf16 v[64:67], a[56:59], v[140:143], v[64:67]
buffer_load_dwordx4 v4, s[8:11], s22 offen offset:0 sc1 lds
v_mfma_f32_16x16x32_bf16 v[68:71], a[52:55], v[136:139], v[68:71]
ds_read_b128 v[124:127], v5 offset:39936
v_lshrrev_b32 v9, 4, v0
v_mfma_f32_16x16x32_bf16 v[68:71], a[60:63], v[140:143], v[68:71]
v_subrev_u32 v11, 160, v0
v_lshrrev_b32 v20, 1, v11
v_mfma_f32_16x16x32_bf16 v[88:91], v[136:139], a[48:51], v[88:91]
s_mov_b32 s24, 0xB3A266
v_cmp_gt_u32 s[42:43], 64, v11
v_lshrrev_b32 v22, 2, v2
v_mfma_f32_16x16x32_bf16 v[88:91], v[140:143], a[56:59], v[88:91]
buffer_load_dwordx4 v4, s[8:11], s22 offen offset:1024 sc1 lds
v_mfma_f32_16x16x32_bf16 v[92:95], v[136:139], a[52:55], v[92:95]
s_add_u32 s22, s22, 8192
v_cndmask_b32 v9, v9, v20, s[42:43]
v_lshlrev_b32 v20, 2, v9
v_mfma_f32_16x16x32_bf16 v[92:95], v[140:143], a[60:63], v[92:95]
s_waitcnt lgkmcnt(4)
s_add_u32 m0, s23, 40960
v_lshrrev_b32 v20, v20, s24
v_mfma_f32_16x16x32_bf16 v[32:35], a[64:67], v[96:99], v[32:35]
s_waitcnt vmcnt(17)
s_barrier
ds_read_b128 v[128:131], v5 offset:40960
v_mfma_f32_16x16x32_bf16 v[32:35], a[72:75], v[100:103], v[32:35]
buffer_load_dwordx4 v4, s[8:11], s22 offen offset:0 sc1 lds
v_mfma_f32_16x16x32_bf16 v[36:39], a[68:71], v[96:99], v[36:39]
ds_read_b128 v[132:135], v5 offset:41984
v_and_b32 v20, 15, v20
v_mfma_f32_16x16x32_bf16 v[36:39], a[76:79], v[100:103], v[36:39]
v_lshrrev_b32 v21, v9, 50
v_and_b32 v21, 1, v21
v_mfma_f32_16x16x32_bf16 v[40:43], a[64:67], v[104:107], v[40:43]
ds_read_b128 v[136:139], v5 offset:43008
v_lshlrev_b32 v22, 8, v22
v_mfma_f32_16x16x32_bf16 v[40:43], a[72:75], v[108:111], v[40:43]
buffer_load_dwordx4 v4, s[8:11], s22 offen offset:1024 sc1 lds
v_mfma_f32_16x16x32_bf16 v[44:47], a[68:71], v[104:107], v[44:47]
s_add_u32 s22, s22, 8192
ds_read_b128 v[140:143], v5 offset:44032
v_and_b32 v23, 3, v2
v_mfma_f32_16x16x32_bf16 v[44:47], a[76:79], v[108:111], v[44:47]
s_waitcnt lgkmcnt(4)
v_lshl_add_u32 v22, v23, 2, v22
v_lshl_add_u32 v22, v21, 10, v22
v_mfma_f32_16x16x32_bf16 v[64:67], a[64:67], v[112:115], v[64:67]
s_add_u32 m0, s23, 49152
ds_read_b128 v[96:99], v5 offset:45056
v_add_u32 v22, 2048, v22
v_mfma_f32_16x16x32_bf16 v[64:67], a[72:75], v[116:119], v[64:67]
buffer_load_dwordx4 v4, s[8:11], s22 offen offset:0 sc1 lds
v_mfma_f32_16x16x32_bf16 v[68:71], a[68:71], v[112:115], v[68:71]
ds_read_b128 v[100:103], v5 offset:46080
v_and_b32 v23, 1, v0
v_mfma_f32_16x16x32_bf16 v[68:71], a[76:79], v[116:119], v[68:71]
v_lshlrev_b32 v24, 9, v23
v_lshl_add_u32 v24, v21, 2, v24
v_mfma_f32_16x16x32_bf16 v[88:91], v[112:115], a[64:67], v[88:91]
v_add_u32 v24, 6144, v24
v_cndmask_b32 v22, v22, v24, s[42:43]
v_mfma_f32_16x16x32_bf16 v[88:91], v[116:119], a[72:75], v[88:91]
v_lshl_add_u32 v22, v20, 4, v22
v_subrev_u32 v11, 96, v0
v_mfma_f32_16x16x32_bf16 v[92:95], v[112:115], a[68:71], v[92:95]
buffer_load_dwordx4 v4, s[8:11], s22 offen offset:1024 sc1 lds
v_mfma_f32_16x16x32_bf16 v[92:95], v[116:119], a[76:79], v[92:95]
s_add_u32 s22, s22, 8192
v_cmp_gt_u32 vcc, 64, v11
v_mfma_f32_16x16x32_bf16 v[32:35], a[80:83], v[120:123], v[32:35]
ds_read_b128 v[104:107], v5 offset:47104
v_lshrrev_b32 v24, 5, v11
v_mfma_f32_16x16x32_bf16 v[32:35], a[88:91], v[124:127], v[32:35]
v_lshlrev_b32 v24, 9, v24
v_bfe_u32 v25, v11, 1, 4
v_mfma_f32_16x16x32_bf16 v[36:39], a[84:87], v[120:123], v[36:39]
ds_read_b128 v[108:111], v5 offset:48128
v_lshl_add_u32 v24, v25, 4, v24
v_mfma_f32_16x16x32_bf16 v[36:39], a[92:95], v[124:127], v[36:39]
s_waitcnt lgkmcnt(4)
buffer_load_dwordx4 a[144:147], v4, s[8:11], s34 offen offset:0 sc1
v_mfma_f32_16x16x32_bf16 v[40:43], a[80:83], v[128:131], v[40:43]
ds_read_b128 v[112:115], v5 offset:49152
v_mul_u32_u24 v25, 1028, v23
v_mfma_f32_16x16x32_bf16 v[40:43], a[88:91], v[132:135], v[40:43]
v_add_u32 v24, v24, v25
v_add_u32 v24, 4096, v24
v_mfma_f32_16x16x32_bf16 v[44:47], a[84:87], v[128:131], v[44:47]
ds_read_b128 v[116:119], v5 offset:50176
v_cndmask_b32 v6, v22, v24, vcc
v_mfma_f32_16x16x32_bf16 v[44:47], a[92:95], v[132:135], v[44:47]
buffer_load_dwordx4 a[148:151], v4, s[8:11], s35 offen offset:0 sc1
v_mfma_f32_16x16x32_bf16 v[64:67], a[80:83], v[136:139], v[64:67]
ds_read_b128 v[120:123], v5 offset:51200
v_mfma_f32_16x16x32_bf16 v[64:67], a[88:91], v[140:143], v[64:67]
v_and_b32 v6, 0x1fff, v6
v_add_u32 v27, 147456, v6
v_mfma_f32_16x16x32_bf16 v[68:71], a[84:87], v[136:139], v[68:71]
ds_read_b128 v[124:127], v5 offset:52224
v_mfma_f32_16x16x32_bf16 v[68:71], a[92:95], v[140:143], v[68:71]
s_and_b32 s24, s3, 1
s_mul_i32 s24, s24, 7168
v_add_u32 v6, 55296, v6
v_mfma_f32_16x16x32_bf16 v[88:91], v[136:139], a[80:83], v[88:91]
s_lshr_b32 s25, s3, 1
s_mul_i32 s25, s25, 92160
s_add_u32 s24, s24, s25
v_mfma_f32_16x16x32_bf16 v[88:91], v[140:143], a[88:91], v[88:91]
buffer_load_dwordx4 a[152:155], v4, s[8:11], s34 offen offset:1024 sc1
v_mfma_f32_16x16x32_bf16 v[92:95], v[136:139], a[84:87], v[92:95]
s_add_u32 s24, s24, 55296
v_add_u32 v7, s24, v4
v_cmp_gt_u32 vcc, 172, v0
v_mfma_f32_16x16x32_bf16 v[92:95], v[140:143], a[92:95], v[92:95]
s_waitcnt lgkmcnt(4)
v_lshlrev_b32 v9, 2, v0
v_add_u32 v8, 55296, v9
v_mfma_f32_16x16x32_bf16 v[32:35], a[96:99], v[96:99], v[32:35]
ds_read_b128 v[128:131], v5 offset:53248
v_add_u32 v28, 147456, v9
v_mfma_f32_16x16x32_bf16 v[32:35], a[104:107], v[100:103], v[32:35]
buffer_load_dwordx4 a[156:159], v4, s[8:11], s35 offen offset:1024 sc1
v_mfma_f32_16x16x32_bf16 v[36:39], a[100:103], v[96:99], v[36:39]
ds_read_b128 v[132:135], v5 offset:54272
v_cndmask_b32 v10, v14, v9, vcc
v_mfma_f32_16x16x32_bf16 v[36:39], a[108:111], v[100:103], v[36:39]
v_and_b32 v20, 7, v1
v_cmp_gt_u32 s[44:45], 2, v20
v_mfma_f32_16x16x32_bf16 v[40:43], a[96:99], v[104:107], v[40:43]
ds_read_b128 v[136:139], v5 offset:55296
v_cmp_eq_u32 s[46:47], 6, v2
buffer_atomic_add_f32 v210, v205, s[8:11], s51 offen offset:0
v_mfma_f32_16x16x32_bf16 v[40:43], a[104:107], v[108:111], v[40:43]
v_mov_b32 v218, 0xff800000
v_mfma_f32_16x16x32_bf16 v[44:47], a[100:103], v[104:107], v[44:47]
ds_read_b128 v[140:143], v5 offset:56320
v_mov_b32 v219, 0x358637bd
v_mfma_f32_16x16x32_bf16 v[44:47], a[108:111], v[108:111], v[44:47]
s_waitcnt lgkmcnt(4)
buffer_load_dwordx4 a[160:163], v4, s[8:11], s34 offen offset:2048 sc1
v_mfma_f32_16x16x32_bf16 v[64:67], a[96:99], v[112:115], v[64:67]
s_or_b64 s[44:45], s[44:45], s[46:47]
ds_read_b128 v[96:99], v5 offset:57344
v_cndmask_b32 v219, v218, v219, s[44:45]
v_mfma_f32_16x16x32_bf16 v[64:67], a[104:107], v[116:119], v[64:67]
v_cndmask_b32 v218, v218, 0, s[44:45]
v_mfma_f32_16x16x32_bf16 v[68:71], a[100:103], v[112:115], v[68:71]
ds_read_b128 v[100:103], v5 offset:58368
v_and_b32 v21, 16, v1
v_mfma_f32_16x16x32_bf16 v[68:71], a[108:111], v[116:119], v[68:71]
v_cmp_ne_u32 vcc, 0, v21
v_mfma_f32_16x16x32_bf16 v[88:91], v[112:115], a[96:99], v[88:91]
buffer_load_dwordx4 a[164:167], v4, s[8:11], s35 offen offset:2048 sc1
v_mfma_f32_16x16x32_bf16 v[88:91], v[116:119], a[104:107], v[88:91]
v_lshrrev_b32 v20, 5, v1
v_lshl_add_u32 v20, v20, 4, v2
v_mfma_f32_16x16x32_bf16 v[92:95], v[112:115], a[100:103], v[92:95]
v_lshlrev_b32 v20, 3, v20
v_mfma_f32_16x16x32_bf16 v[92:95], v[116:119], a[108:111], v[92:95]
s_mul_i32 s25, s17, 2816
v_cndmask_b32 v11, v14, v20, vcc
v_mfma_f32_16x16x32_bf16 v[32:35], a[112:115], v[120:123], v[32:35]
s_add_u32 s25, s25, s12
s_add_u32 s25, s25, 7340032
ds_read_b128 v[104:107], v5 offset:59392
v_mfma_f32_16x16x32_bf16 v[32:35], a[120:123], v[124:127], v[32:35]
buffer_load_dwordx4 a[168:171], v4, s[8:11], s34 offen offset:3072 sc1
v_mfma_f32_16x16x32_bf16 v[36:39], a[116:119], v[120:123], v[36:39]
s_lshl_b32 s26, s18, 15
s_lshl_b32 s27, s17, 10
ds_read_b128 v[108:111], v5 offset:60416
v_mfma_f32_16x16x32_bf16 v[36:39], a[124:127], v[124:127], v[36:39]
s_waitcnt lgkmcnt(4)
s_add_u32 s26, s26, s27
s_add_u32 s26, s26, s12
v_mfma_f32_16x16x32_bf16 v[40:43], a[112:115], v[128:131], v[40:43]
s_add_u32 s26, s26, 4718592
s_add_u32 s28, s26, 16384
ds_read_b128 v[112:115], v5 offset:61440
v_mfma_f32_16x16x32_bf16 v[40:43], a[120:123], v[132:135], v[40:43]
buffer_load_dwordx4 a[172:175], v4, s[8:11], s35 offen offset:3072 sc1
v_mfma_f32_16x16x32_bf16 v[44:47], a[116:119], v[128:131], v[44:47]
s_add_u32 s34, s34, 4096
s_lshl_b32 s27, s18, 4
ds_read_b128 v[116:119], v5 offset:62464
v_mfma_f32_16x16x32_bf16 v[44:47], a[124:127], v[132:135], v[44:47]
s_add_u32 s35, s35, 4096
s_add_u32 s27, s27, s17
s_lshl_b32 s27, s27, 8
v_mfma_f32_16x16x32_bf16 v[64:67], a[112:115], v[136:139], v[64:67]
s_add_u32 s27, s27, s12
s_add_u32 s27, s27, 6815744
ds_read_b128 v[120:123], v5 offset:63488
v_mfma_f32_16x16x32_bf16 v[64:67], a[120:123], v[140:143], v[64:67]
s_lshl_b32 s32, s13, 21
s_add_u32 s32, s32, 0x6020000
s_lshl_b32 s33, s2, 9
s_add_u32 s32, s32, s33
v_mfma_f32_16x16x32_bf16 v[68:71], a[116:119], v[136:139], v[68:71]
s_cmp_eq_u32 s3, 0
s_cselect_b64 vcc, -1, 0
ds_read_b128 v[124:127], v5 offset:64512
v_cndmask_b32 v29, v14, v13, vcc
v_mfma_f32_16x16x32_bf16 v[68:71], a[124:127], v[140:143], v[68:71]
buffer_load_dwordx4 a[176:179], v4, s[8:11], s34 offen offset:0 sc1
v_and_b32 v212, 1, v3
v_mfma_f32_16x16x32_bf16 v[88:91], v[136:139], a[112:115], v[88:91]
s_and_b32 s83, s7, 3
s_lshr_b32 s82, s7, 2
v_cmp_eq_u32 vcc, 1, v212
v_mov_b32 v24, v208
v_mfma_f32_16x16x32_bf16 v[88:91], v[140:143], a[120:123], v[88:91]
v_mov_b32 v25, v216
v_cndmask_b32 v208, -v204, -v215, vcc
v_mov_b32 v209, 0
v_mfma_f32_16x16x32_bf16 v[92:95], v[136:139], a[116:119], v[92:95]
v_lshlrev_b32 v213, 4, v3
v_cmp_gt_u32 vcc, 32, v1
v_mfma_f32_16x16x32_bf16 v[92:95], v[140:143], a[124:127], v[92:95]
s_waitcnt lgkmcnt(4)
buffer_load_dwordx4 a[180:183], v4, s[8:11], s35 offen offset:0 sc1
v_mfma_f32_16x16x32_bf16 v[32:35], a[128:131], v[96:99], v[32:35]
s_waitcnt vmcnt(23)
s_barrier
ds_read_b128 v[128:131], v26 offset:0
v_mfma_f32_16x16x32_bf16 v[32:35], a[136:139], v[100:103], v[32:35]
ds_bpermute_b32 v16, v213, v24 offset:0
ds_bpermute_b32 v17, v213, v24 offset:4
v_mfma_f32_16x16x32_bf16 v[36:39], a[132:135], v[96:99], v[36:39]
ds_read_b128 v[132:135], v26 offset:1024
ds_bpermute_b32 v18, v213, v24 offset:8
v_mfma_f32_16x16x32_bf16 v[36:39], a[140:143], v[100:103], v[36:39]
ds_bpermute_b32 v19, v213, v24 offset:12
ds_bpermute_b32 v20, v213, v25 offset:0
v_mfma_f32_16x16x32_bf16 v[40:43], a[128:131], v[104:107], v[40:43]
ds_read_b128 v[136:139], v26 offset:2048
ds_bpermute_b32 v21, v213, v25 offset:4
v_mfma_f32_16x16x32_bf16 v[40:43], a[136:139], v[108:111], v[40:43]
buffer_load_dwordx4 a[184:187], v4, s[8:11], s34 offen offset:1024 sc1
v_mfma_f32_16x16x32_bf16 v[44:47], a[132:135], v[104:107], v[44:47]
ds_read_b128 v[140:143], v26 offset:3072
ds_bpermute_b32 v22, v213, v25 offset:8
v_mfma_f32_16x16x32_bf16 v[44:47], a[140:143], v[108:111], v[44:47]
s_waitcnt lgkmcnt(11)
s_lshl_b32 s30, s83, 12
s_add_u32 s31, s30, s21
s_add_u32 s30, s30, s20
s_add_u32 s20, s20, 16384
s_add_u32 s21, s21, 16384
s_lshl_b32 s29, s18, 9
s_add_u32 s29, s29, 28377088
ds_bpermute_b32 v23, v213, v25 offset:12
v_cndmask_b32 v212, v14, v4, vcc
v_mfma_f32_16x16x32_bf16 v[64:67], a[128:131], v[112:115], v[64:67]
ds_read_b128 v[96:99], v26 offset:4096
v_mfma_f32_16x16x32_bf16 v[64:67], a[136:139], v[116:119], v[64:67]
buffer_load_dwordx4 a[188:191], v4, s[8:11], s35 offen offset:1024 sc1
v_mfma_f32_16x16x32_bf16 v[68:71], a[132:135], v[112:115], v[68:71]
ds_read_b128 v[100:103], v26 offset:5120
v_mfma_f32_16x16x32_bf16 v[68:71], a[140:143], v[116:119], v[68:71]
v_mfma_f32_16x16x32_bf16 v[88:91], v[112:115], a[128:131], v[88:91]
v_perm_b32 v252, v224, v220, s62
v_perm_b32 v253, v232, v228, s62
s_waitcnt lgkmcnt(12)
v_mul_f32 v32, v32, v16
v_mfma_f32_16x16x32_bf16 v[88:91], v[116:119], a[136:139], v[88:91]
v_perm_b32 v254, v240, v236, s62
s_waitcnt lgkmcnt(11)
v_mul_f32 v33, v33, v17
s_waitcnt lgkmcnt(9)
v_mul_f32 v34, v34, v18
v_mfma_f32_16x16x32_bf16 v[92:95], v[112:115], a[132:135], v[92:95]
s_waitcnt lgkmcnt(8)
v_mul_f32 v35, v35, v19
s_waitcnt lgkmcnt(7)
v_mul_f32 v36, v36, v20
s_waitcnt lgkmcnt(5)
v_mul_f32 v37, v37, v21
v_mfma_f32_16x16x32_bf16 v[92:95], v[116:119], a[140:143], v[92:95]
buffer_load_dwordx4 a[192:195], v4, s[8:11], s34 offen offset:2048 sc1
s_waitcnt lgkmcnt(3)
v_mul_f32 v38, v38, v22
v_mfma_f32_16x16x32_bf16 v[48:51], a[0:3], v[120:123], 0
ds_read_b128 v[104:107], v26 offset:6144
v_perm_b32 v255, v248, v244, s62
s_waitcnt lgkmcnt(3)
v_mul_f32 v39, v39, v23
v_mfma_f32_16x16x32_bf16 v[48:51], a[8:11], v[124:127], v[48:51]
v_mul_f32 v164, 0x3fb8aa3b, v32
v_exp_f32 v164, v164 clamp
v_mfma_f32_16x16x32_bf16 v[52:55], a[4:7], v[120:123], 0
ds_read_b128 v[108:111], v26 offset:7168
v_mul_f32 v165, 0x3fb8aa3b, v33
v_mul_f32 v166, 0x3fb8aa3b, v34
v_mfma_f32_16x16x32_bf16 v[52:55], a[12:15], v[124:127], v[52:55]
buffer_load_dwordx4 a[196:199], v4, s[8:11], s35 offen offset:2048 sc1
v_mul_f32 v167, 0x3fb8aa3b, v35
v_mfma_f32_16x16x32_bf16 v[56:59], a[0:3], v[128:131], 0
ds_read_b128 v[112:115], v26 offset:8192
v_exp_f32 v165, v165 clamp
v_mfma_f32_16x16x32_bf16 v[56:59], a[8:11], v[132:135], v[56:59]
buffer_store_dwordx4 v[252:255], v31, s[8:11], s90 offen offset:0 sc1
v_mul_f32 v168, 0x3fb8aa3b, v36
v_mfma_f32_16x16x32_bf16 v[60:63], a[4:7], v[128:131], 0
ds_read_b128 v[116:119], v26 offset:9216
v_exp_f32 v166, v166 clamp
v_mfma_f32_16x16x32_bf16 v[60:63], a[12:15], v[132:135], v[60:63]
v_perm_b32 v252, v224, v220, s63
v_exp_f32 v167, v167 clamp
v_mfma_f32_16x16x32_bf16 v[48:51], a[16:19], v[136:139], v[48:51]
ds_read_b128 v[120:123], v26 offset:10240
v_exp_f32 v168, v168 clamp
v_mfma_f32_16x16x32_bf16 v[48:51], a[24:27], v[140:143], v[48:51]
buffer_load_dwordx4 a[200:203], v4, s[8:11], s34 offen offset:3072 sc1
v_mul_f32 v169, 0x3fb8aa3b, v37
v_mfma_f32_16x16x32_bf16 v[52:55], a[20:23], v[136:139], v[52:55]
ds_read_b128 v[124:127], v26 offset:11264
v_exp_f32 v169, v169 clamp
v_mfma_f32_16x16x32_bf16 v[52:55], a[28:31], v[140:143], v[52:55]
s_waitcnt lgkmcnt(4)
v_perm_b32 v253, v232, v228, s63
v_mul_f32 v170, 0x3fb8aa3b, v38
v_mul_f32 v171, 0x3fb8aa3b, v39
v_mfma_f32_16x16x32_bf16 v[56:59], a[16:19], v[96:99], v[56:59]
ds_read_b128 v[128:131], v26 offset:12288
v_exp_f32 v170, v170 clamp
v_mfma_f32_16x16x32_bf16 v[56:59], a[24:27], v[100:103], v[56:59]
v_perm_b32 v254, v240, v236, s63
v_exp_f32 v171, v171 clamp
v_mfma_f32_16x16x32_bf16 v[60:63], a[20:23], v[96:99], v[60:63]
ds_read_b128 v[132:135], v26 offset:13312
v_max_f32 v32, 0x358637bd, v32
v_max_f32 v33, 0x358637bd, v33
v_mfma_f32_16x16x32_bf16 v[60:63], a[28:31], v[100:103], v[60:63]
buffer_load_dwordx4 a[204:207], v4, s[8:11], s35 offen offset:3072 sc1
v_max_f32 v34, 0x358637bd, v34
v_mfma_f32_16x16x32_bf16 v[48:51], a[32:35], v[104:107], v[48:51]
s_add_u32 s34, s34, 4096
ds_read_b128 v[136:139], v26 offset:14336
v_perm_b32 v255, v248, v244, s63
v_max_f32 v35, 0x358637bd, v35
buffer_atomic_add_f32 v211, v205, s[8:11], s51 offen offset:32
v_mfma_f32_16x16x32_bf16 v[48:51], a[40:43], v[108:111], v[48:51]
s_add_u32 s35, s35, 4096
v_max_f32 v36, 0x358637bd, v36
v_max_f32 v37, 0x358637bd, v37
v_max_f32 v38, 0x358637bd, v38
v_mfma_f32_16x16x32_bf16 v[52:55], a[36:39], v[104:107], v[52:55]
ds_read_b128 v[140:143], v26 offset:15360
v_max_f32 v39, 0x358637bd, v39
v_add_f32 v32, v32, v164
v_mfma_f32_16x16x32_bf16 v[52:55], a[44:47], v[108:111], v[52:55]
s_waitcnt lgkmcnt(4)
buffer_load_dwordx4 a[208:211], v4, s[8:11], s34 offen offset:0 sc1
v_add_f32 v33, v33, v165
v_mfma_f32_16x16x32_bf16 v[56:59], a[32:35], v[112:115], v[56:59]
ds_read_b128 v[96:99], v4 offset:0
v_add_f32 v34, v34, v166
v_add_f32 v35, v35, v167
v_mfma_f32_16x16x32_bf16 v[56:59], a[40:43], v[116:119], v[56:59]
buffer_store_dwordx4 v[252:255], v31, s[8:11], s90 offen offset:128 sc1
v_add_f32 v36, v36, v168
v_mfma_f32_16x16x32_bf16 v[60:63], a[36:39], v[112:115], v[60:63]
ds_read_b128 v[100:103], v4 offset:1024
v_add_f32 v37, v37, v169
v_add_f32 v38, v38, v170
v_mfma_f32_16x16x32_bf16 v[60:63], a[44:47], v[116:119], v[60:63]
v_add_f32 v39, v39, v171
v_cvt_pk_bf16_f32 v144, v32, v33
v_cvt_pk_bf16_f32 v145, v34, v35
v_mfma_f32_16x16x32_bf16 v[48:51], a[48:51], v[120:123], v[48:51]
ds_read_b128 v[104:107], v4 offset:2048
v_perm_b32 v252, v225, v221, s62
v_cvt_pk_bf16_f32 v146, v36, v37
v_mfma_f32_16x16x32_bf16 v[48:51], a[56:59], v[124:127], v[48:51]
buffer_load_dwordx4 a[212:215], v4, s[8:11], s35 offen offset:0 sc1
v_cvt_pk_bf16_f32 v147, v38, v39
v_mfma_f32_16x16x32_bf16 v[52:55], a[52:55], v[120:123], v[52:55]
ds_read_b128 v[108:111], v4 offset:3072
v_mul_f32 v40, v40, v16
v_mul_f32 v41, v41, v17
v_mfma_f32_16x16x32_bf16 v[52:55], a[60:63], v[124:127], v[52:55]
s_waitcnt lgkmcnt(4)
v_perm_b32 v253, v233, v229, s62
v_mul_f32 v42, v42, v18
v_mul_f32 v43, v43, v19
v_mfma_f32_16x16x32_bf16 v[56:59], a[48:51], v[128:131], v[56:59]
ds_read_b128 v[112:115], v4 offset:4096
v_mul_f32 v44, v44, v20
v_mul_f32 v45, v45, v21
v_mfma_f32_16x16x32_bf16 v[56:59], a[56:59], v[132:135], v[56:59]
buffer_load_dwordx4 a[216:219], v4, s[8:11], s36 offen offset:0 sc1
v_mul_f32 v46, v46, v22
v_mfma_f32_16x16x32_bf16 v[60:63], a[52:55], v[128:131], v[60:63]
ds_read_b128 v[116:119], v4 offset:5120
v_mul_f32 v47, v47, v23
v_mul_f32 v172, 0x3fb8aa3b, v40
v_mfma_f32_16x16x32_bf16 v[60:63], a[60:63], v[132:135], v[60:63]
v_perm_b32 v254, v241, v237, s62
v_exp_f32 v172, v172 clamp
v_mfma_f32_16x16x32_bf16 v[48:51], a[64:67], v[136:139], v[48:51]
ds_read_b128 v[120:123], v4 offset:6144
v_mul_f32 v173, 0x3fb8aa3b, v41
v_mul_f32 v174, 0x3fb8aa3b, v42
v_mfma_f32_16x16x32_bf16 v[48:51], a[72:75], v[140:143], v[48:51]
v_perm_b32 v255, v249, v245, s62
v_exp_f32 v173, v173 clamp
v_mfma_f32_16x16x32_bf16 v[52:55], a[68:71], v[136:139], v[52:55]
ds_read_b128 v[124:127], v4 offset:7168
v_exp_f32 v174, v174 clamp
v_mfma_f32_16x16x32_bf16 v[52:55], a[76:79], v[140:143], v[52:55]
s_waitcnt lgkmcnt(4)
buffer_load_dwordx4 a[220:223], v4, s[8:11], s36 offen offset:1024 sc1
v_mul_f32 v175, 0x3fb8aa3b, v43
v_mfma_f32_16x16x32_bf16 v[56:59], a[64:67], v[96:99], v[56:59]
ds_read_b128 v[128:131], v4 offset:8192
v_exp_f32 v175, v175 clamp
v_mfma_f32_16x16x32_bf16 v[56:59], a[72:75], v[100:103], v[56:59]
buffer_store_dwordx4 v[252:255], v31, s[8:11], s91 offen offset:0 sc1
v_mul_f32 v176, 0x3fb8aa3b, v44
v_mfma_f32_16x16x32_bf16 v[60:63], a[68:71], v[96:99], v[60:63]
ds_read_b128 v[132:135], v4 offset:9216
v_exp_f32 v176, v176 clamp
v_mfma_f32_16x16x32_bf16 v[60:63], a[76:79], v[100:103], v[60:63]
buffer_load_dwordx4 a[224:227], v4, s[8:11], s36 offen offset:2048 sc1
v_mul_f32 v177, 0x3fb8aa3b, v45
v_mfma_f32_16x16x32_bf16 v[48:51], a[80:83], v[104:107], v[48:51]
ds_read_b128 v[136:139], v4 offset:10240
v_exp_f32 v177, v177 clamp
v_mfma_f32_16x16x32_bf16 v[48:51], a[88:91], v[108:111], v[48:51]
v_perm_b32 v252, v225, v221, s63
v_mul_f32 v178, 0x3fb8aa3b, v46
v_mul_f32 v179, 0x3fb8aa3b, v47
v_mfma_f32_16x16x32_bf16 v[52:55], a[84:87], v[104:107], v[52:55]
ds_read_b128 v[140:143], v4 offset:11264
v_exp_f32 v178, v178 clamp
v_mfma_f32_16x16x32_bf16 v[52:55], a[92:95], v[108:111], v[52:55]
s_waitcnt lgkmcnt(4)
v_perm_b32 v253, v233, v229, s63
v_exp_f32 v179, v179 clamp
v_mfma_f32_16x16x32_bf16 v[56:59], a[80:83], v[112:115], v[56:59]
ds_read_b128 v[96:99], v4 offset:12288
v_max_f32 v40, 0x358637bd, v40
v_max_f32 v41, 0x358637bd, v41
v_mfma_f32_16x16x32_bf16 v[56:59], a[88:91], v[116:119], v[56:59]
buffer_load_dwordx4 a[228:231], v4, s[8:11], s36 offen offset:3072 sc1
v_max_f32 v42, 0x358637bd, v42
v_mfma_f32_16x16x32_bf16 v[60:63], a[84:87], v[112:115], v[60:63]
ds_read_b128 v[100:103], v4 offset:13312
v_max_f32 v43, 0x358637bd, v43
v_max_f32 v44, 0x358637bd, v44
v_mfma_f32_16x16x32_bf16 v[60:63], a[92:95], v[116:119], v[60:63]
v_perm_b32 v254, v241, v237, s63
v_max_f32 v45, 0x358637bd, v45
v_max_f32 v46, 0x358637bd, v46
v_mfma_f32_16x16x32_bf16 v[48:51], a[96:99], v[120:123], v[48:51]
ds_read_b128 v[104:107], v4 offset:14336
v_max_f32 v47, 0x358637bd, v47
v_add_f32 v40, v40, v172
v_mfma_f32_16x16x32_bf16 v[48:51], a[104:107], v[124:127], v[48:51]
buffer_load_dwordx2 a[232:233], v4, s[8:11], s37 offen sc1
v_add_f32 v41, v41, v173
v_mfma_f32_16x16x32_bf16 v[52:55], a[100:103], v[120:123], v[52:55]
ds_read_b128 v[108:111], v4 offset:15360
v_add_f32 v42, v42, v174
v_add_f32 v43, v43, v175
v_add_f32 v44, v44, v176
v_mfma_f32_16x16x32_bf16 v[52:55], a[108:111], v[124:127], v[52:55]
s_waitcnt lgkmcnt(4)
v_perm_b32 v255, v249, v245, s63
v_add_f32 v45, v45, v177
v_add_f32 v46, v46, v178
v_add_f32 v47, v47, v179
v_mfma_f32_16x16x32_bf16 v[56:59], a[96:99], v[128:131], v[56:59]
s_waitcnt vmcnt(28)
s_barrier
ds_read_b128 v[112:115], v4 offset:16384
v_cvt_pk_bf16_f32 v148, v40, v41
v_cvt_pk_bf16_f32 v149, v42, v43
v_mfma_f32_16x16x32_bf16 v[56:59], a[104:107], v[132:135], v[56:59]
buffer_store_dwordx4 v[252:255], v31, s[8:11], s91 offen offset:128 sc1
v_cvt_pk_bf16_f32 v150, v44, v45
v_cvt_pk_bf16_f32 v151, v46, v47
v_mfma_f32_16x16x32_bf16 v[60:63], a[100:103], v[128:131], v[60:63]
ds_read_b128 v[116:119], v4 offset:17408
v_mul_f32 v64, v64, v16
v_mul_f32 v65, v65, v17
v_mul_f32 v66, v66, v18
s_cmp_eq_u32 s82, s3
s_cbranch_scc0 Lxt_e
buffer_store_dwordx4 v[208:211], v212, s[8:11], s29 offen sc1
s_cmp_lt_u32 s83, 2
s_cbranch_scc0 Lxt2
buffer_store_dwordx4 a[128:131], v4, s[8:11], s20 offen offset:0 sc1
buffer_store_dwordx4 a[132:135], v4, s[8:11], s21 offen offset:0 sc1
s_cmp_lt_u32 s83, 1
s_cbranch_scc0 Lxt1
buffer_store_dwordx4 a[0:3], v4, s[8:11], s30 offen offset:0 sc1
buffer_store_dwordx4 a[8:11], v4, s[8:11], s30 offen offset:1024 sc1
buffer_store_dwordx4 a[16:19], v4, s[8:11], s30 offen offset:2048 sc1
buffer_store_dwordx4 a[24:27], v4, s[8:11], s30 offen offset:3072 sc1
buffer_store_dwordx4 a[4:7], v4, s[8:11], s31 offen offset:0 sc1
buffer_store_dwordx4 a[12:15], v4, s[8:11], s31 offen offset:1024 sc1
buffer_store_dwordx4 a[20:23], v4, s[8:11], s31 offen offset:2048 sc1
buffer_store_dwordx4 a[28:31], v4, s[8:11], s31 offen offset:3072 sc1
s_branch Lxt_e
Lxt1:
buffer_store_dwordx4 a[32:35], v4, s[8:11], s30 offen offset:0 sc1
buffer_store_dwordx4 a[40:43], v4, s[8:11], s30 offen offset:1024 sc1
buffer_store_dwordx4 a[48:51], v4, s[8:11], s30 offen offset:2048 sc1
buffer_store_dwordx4 a[56:59], v4, s[8:11], s30 offen offset:3072 sc1
buffer_store_dwordx4 a[36:39], v4, s[8:11], s31 offen offset:0 sc1
buffer_store_dwordx4 a[44:47], v4, s[8:11], s31 offen offset:1024 sc1
buffer_store_dwordx4 a[52:55], v4, s[8:11], s31 offen offset:2048 sc1
buffer_store_dwordx4 a[60:63], v4, s[8:11], s31 offen offset:3072 sc1
s_branch Lxt_e
Lxt2:
buffer_store_dwordx4 a[136:139], v4, s[8:11], s20 offen offset:1024 sc1
buffer_store_dwordx4 a[140:143], v4, s[8:11], s21 offen offset:1024 sc1
s_cmp_lt_u32 s83, 3
s_cbranch_scc0 Lxt3
buffer_store_dwordx4 a[64:67], v4, s[8:11], s30 offen offset:0 sc1
buffer_store_dwordx4 a[72:75], v4, s[8:11], s30 offen offset:1024 sc1
buffer_store_dwordx4 a[80:83], v4, s[8:11], s30 offen offset:2048 sc1
buffer_store_dwordx4 a[88:91], v4, s[8:11], s30 offen offset:3072 sc1
buffer_store_dwordx4 a[68:71], v4, s[8:11], s31 offen offset:0 sc1
buffer_store_dwordx4 a[76:79], v4, s[8:11], s31 offen offset:1024 sc1
buffer_store_dwordx4 a[84:87], v4, s[8:11], s31 offen offset:2048 sc1
buffer_store_dwordx4 a[92:95], v4, s[8:11], s31 offen offset:3072 sc1
s_branch Lxt_e
Lxt3:
buffer_store_dwordx4 a[96:99], v4, s[8:11], s30 offen offset:0 sc1
buffer_store_dwordx4 a[104:107], v4, s[8:11], s30 offen offset:1024 sc1
buffer_store_dwordx4 a[112:115], v4, s[8:11], s30 offen offset:2048 sc1
buffer_store_dwordx4 a[120:123], v4, s[8:11], s30 offen offset:3072 sc1
buffer_store_dwordx4 a[100:103], v4, s[8:11], s31 offen offset:0 sc1
buffer_store_dwordx4 a[108:111], v4, s[8:11], s31 offen offset:1024 sc1
buffer_store_dwordx4 a[116:119], v4, s[8:11], s31 offen offset:2048 sc1
buffer_store_dwordx4 a[124:127], v4, s[8:11], s31 offen offset:3072 sc1
Lxt_e:
v_mfma_f32_16x16x32_bf16 v[60:63], a[108:111], v[132:135], v[60:63]
buffer_load_dwordx4 a[236:239], v214, s[8:11], s40 offen offset:0 sc1
v_mul_f32 v67, v67, v19
v_mul_f32 v68, v68, v20
v_mfma_f32_16x16x32_bf16 v[48:51], a[112:115], v[136:139], v[48:51]
ds_read_b128 v[120:123], v4 offset:18432
v_mul_f32 v69, v69, v21
v_mul_f32 v70, v70, v22
v_mul_f32 v71, v71, v23
v_mfma_f32_16x16x32_bf16 v[48:51], a[120:123], v[140:143], v[48:51]
v_fmamk_f32 v164, v64, 0x3fb8aa3b, v218
v_exp_f32 v164, v164 clamp
v_fmamk_f32 v165, v65, 0x3fb8aa3b, v218
v_mfma_f32_16x16x32_bf16 v[52:55], a[116:119], v[136:139], v[52:55]
ds_read_b128 v[124:127], v4 offset:19456
v_exp_f32 v165, v165 clamp
v_fmamk_f32 v166, v66, 0x3fb8aa3b, v218
v_mfma_f32_16x16x32_bf16 v[52:55], a[124:127], v[140:143], v[52:55]
s_waitcnt lgkmcnt(4)
buffer_load_dwordx4 a[240:243], v214, s[8:11], s40 offen offset:512 sc1
v_exp_f32 v166, v166 clamp
v_mfma_f32_16x16x32_bf16 v[56:59], a[112:115], v[96:99], v[56:59]
ds_read_b128 v[128:131], v4 offset:20480
v_perm_b32 v252, v226, v222, s62
v_fmamk_f32 v167, v67, 0x3fb8aa3b, v218
v_fmamk_f32 v168, v68, 0x3fb8aa3b, v218
v_mfma_f32_16x16x32_bf16 v[56:59], a[120:123], v[100:103], v[56:59]
v_exp_f32 v167, v167 clamp
v_exp_f32 v168, v168 clamp
v_mfma_f32_16x16x32_bf16 v[60:63], a[116:119], v[96:99], v[60:63]
ds_read_b128 v[132:135], v4 offset:21504
v_perm_b32 v253, v234, v230, s62
v_fmamk_f32 v169, v69, 0x3fb8aa3b, v218
v_fmamk_f32 v170, v70, 0x3fb8aa3b, v218
v_mfma_f32_16x16x32_bf16 v[60:63], a[124:127], v[100:103], v[60:63]
v_exp_f32 v169, v169 clamp
v_exp_f32 v170, v170 clamp
v_mfma_f32_16x16x32_bf16 v[48:51], a[128:131], v[104:107], v[48:51]
ds_read_b128 v[136:139], v4 offset:22528
v_perm_b32 v254, v242, v238, s62
v_fmamk_f32 v171, v71, 0x3fb8aa3b, v218
v_max_f32 v64, v219, v64
v_mfma_f32_16x16x32_bf16 v[48:51], a[136:139], v[108:111], v[48:51]
buffer_load_dwordx4 a[244:247], v214, s[8:11], s40 offen offset:1024 sc1
v_exp_f32 v171, v171 clamp
v_mfma_f32_16x16x32_bf16 v[52:55], a[132:135], v[104:107], v[52:55]
ds_read_b128 v[140:143], v4 offset:23552
v_max_f32 v65, v219, v65
v_max_f32 v66, v219, v66
v_max_f32 v67, v219, v67
v_mfma_f32_16x16x32_bf16 v[52:55], a[140:143], v[108:111], v[52:55]
s_waitcnt lgkmcnt(4)
v_perm_b32 v255, v250, v246, s62
v_max_f32 v68, v219, v68
v_max_f32 v69, v219, v69
v_max_f32 v70, v219, v70
v_mfma_f32_16x16x32_bf16 v[56:59], a[128:131], v[112:115], v[56:59]
ds_read_b128 v[96:99], v4 offset:24576
v_max_f32 v71, v219, v71
v_add_f32 v64, v64, v164
v_add_f32 v65, v65, v165
v_mfma_f32_16x16x32_bf16 v[56:59], a[136:139], v[116:119], v[56:59]
buffer_load_dwordx4 a[248:251], v214, s[8:11], s40 offen offset:1536 sc1
v_add_f32 v66, v66, v166
v_add_f32 v67, v67, v167
v_mfma_f32_16x16x32_bf16 v[60:63], a[132:135], v[112:115], v[60:63]
ds_read_b128 v[100:103], v4 offset:25600
v_add_f32 v68, v68, v168
v_add_f32 v69, v69, v169
v_add_f32 v70, v70, v170
v_mfma_f32_16x16x32_bf16 v[60:63], a[140:143], v[116:119], v[60:63]
buffer_store_dwordx4 v[252:255], v31, s[8:11], s92 offen offset:0 sc1
v_add_f32 v71, v71, v171
v_cvt_pk_bf16_f32 v160, v64, v65
v_mfma_f32_16x16x32_bf16 v[72:75], v[120:123], a[0:3], 0
ds_read_b128 v[104:107], v4 offset:26624
v_cvt_pk_bf16_f32 v161, v66, v67
v_cvt_pk_bf16_f32 v162, v68, v69
v_cvt_pk_bf16_f32 v163, v70, v71
v_mfma_f32_16x16x32_bf16 v[72:75], v[124:127], a[8:11], v[72:75]
v_mul_f32 v48, v48, v16
v_mul_f32 v49, v49, v17
v_cvt_pk_bf16_f32 v152, v48, v49
v_mul_f32 v50, v50, v18
v_mul_f32 v51, v51, v19
v_cvt_pk_bf16_f32 v153, v50, v51
v_mfma_f32_16x16x32_bf16 v[76:79], v[120:123], a[4:7], 0
ds_read_b128 v[108:111], v4 offset:27648
v_mul_f32 v52, v52, v20
v_mul_f32 v53, v53, v21
v_cvt_pk_bf16_f32 v154, v52, v53
v_mul_f32 v54, v54, v22
v_mul_f32 v55, v55, v23
v_cvt_pk_bf16_f32 v155, v54, v55
v_mfma_f32_16x16x32_bf16 v[76:79], v[124:127], a[12:15], v[76:79]
s_waitcnt lgkmcnt(4)
buffer_load_dwordx2 a[234:235], v214, s[8:11], s41 offen sc1
v_mfma_f32_16x16x32_bf16 v[80:83], v[128:131], a[0:3], 0
ds_read_b128 v[112:115], v4 offset:28672
v_mul_f32 v56, v56, v16
v_mul_f32 v57, v57, v17
v_cvt_pk_bf16_f32 v156, v56, v57
v_mul_f32 v58, v58, v18
v_mul_f32 v59, v59, v19
v_cvt_pk_bf16_f32 v157, v58, v59
v_mfma_f32_16x16x32_bf16 v[80:83], v[132:135], a[8:11], v[80:83]
v_perm_b32 v252, v226, v222, s63
v_mul_f32 v60, v60, v20
v_mul_f32 v61, v61, v21
v_cvt_pk_bf16_f32 v158, v60, v61
v_mul_f32 v62, v62, v22
v_mul_f32 v63, v63, v23
v_cvt_pk_bf16_f32 v159, v62, v63
v_mfma_f32_16x16x32_bf16 v[188:191], v[144:147], v[160:163], 0
v_mfma_f32_16x16x32_bf16 v[192:195], v[148:151], v[160:163], 0
v_mfma_f32_16x16x32_bf16 v[204:207], v[160:163], v[160:163], 0
v_mfma_f32_16x16x32_bf16 v[180:183], v[144:147], v[152:155], 0
v_mfma_f32_16x16x32_bf16 v[196:199], v[160:163], v[152:155], 0
v_mfma_f32_16x16x32_bf16 v[184:187], v[148:151], v[156:159], 0
v_mfma_f32_16x16x32_bf16 v[200:203], v[160:163], v[156:159], 0
s_nop 1
ds_write_b128 v7, v[188:191] offset:2048
v_mfma_f32_16x16x32_bf16 v[84:87], v[128:131], a[4:7], 0
ds_read_b128 v[116:119], v4 offset:29696
v_mfma_f32_16x16x32_bf16 v[84:87], v[132:135], a[12:15], v[84:87]
ds_write_b128 v7, v[192:195] offset:3072
v_perm_b32 v253, v234, v230, s63
v_mfma_f32_16x16x32_bf16 v[72:75], v[136:139], a[16:19], v[72:75]
ds_read_b128 v[120:123], v4 offset:30720
v_mfma_f32_16x16x32_bf16 v[72:75], v[140:143], a[24:27], v[72:75]
ds_write_b64 v7, v[204:205] offset:6144
v_perm_b32 v254, v242, v238, s63
v_mfma_f32_16x16x32_bf16 v[76:79], v[136:139], a[20:23], v[76:79]
ds_read_b128 v[124:127], v4 offset:31744
ds_write_b128 v7, v[180:183] offset:0
v_mfma_f32_16x16x32_bf16 v[76:79], v[140:143], a[28:31], v[76:79]
s_waitcnt lgkmcnt(8)
buffer_load_dwordx4 a[0:3], v4, s[8:11], s34 offen offset:1024 sc1
v_perm_b32 v255, v250, v246, s63
v_mfma_f32_16x16x32_bf16 v[80:83], v[96:99], a[16:19], v[80:83]
ds_read_b128 v[128:131], v4 offset:32768
ds_write_b64 v7, v[196:197] offset:4096
v_mfma_f32_16x16x32_bf16 v[80:83], v[100:103], a[24:27], v[80:83]
buffer_store_dwordx4 v[252:255], v31, s[8:11], s92 offen offset:128 sc1
ds_write_b128 v7, v[184:187] offset:1024
v_mfma_f32_16x16x32_bf16 v[84:87], v[96:99], a[20:23], v[84:87]
ds_read_b128 v[132:135], v4 offset:33792
v_mfma_f32_16x16x32_bf16 v[84:87], v[100:103], a[28:31], v[84:87]
buffer_load_dwordx4 a[4:7], v4, s[8:11], s35 offen offset:1024 sc1
ds_write_b64 v7, v[200:201] offset:5120
v_mfma_f32_16x16x32_bf16 v[72:75], v[104:107], a[32:35], v[72:75]
ds_read_b128 v[136:139], v4 offset:34816
v_mfma_f32_16x16x32_bf16 v[72:75], v[108:111], a[40:43], v[72:75]
v_perm_b32 v252, v227, v223, s62
v_mfma_f32_16x16x32_bf16 v[76:79], v[104:107], a[36:39], v[76:79]
ds_read_b128 v[140:143], v4 offset:35840
s_waitcnt lgkmcnt(2)
s_barrier
v_mfma_f32_16x16x32_bf16 v[76:79], v[108:111], a[44:47], v[76:79]
ds_read2st64_b32 v[164:165], v8 offset0:0 offset1:28
v_perm_b32 v253, v235, v231, s62
v_mfma_f32_16x16x32_bf16 v[80:83], v[112:115], a[32:35], v[80:83]
ds_read_b128 v[96:99], v4 offset:36864
ds_read2st64_b32 v[166:167], v28 offset0:0 offset1:28
v_mfma_f32_16x16x32_bf16 v[80:83], v[116:119], a[40:43], v[80:83]
buffer_load_dwordx4 a[8:11], v4, s[8:11], s34 offen offset:2048 sc1
ds_read2st64_b32 v[168:169], v8 offset0:4 offset1:32
v_perm_b32 v254, v243, v239, s62
v_mfma_f32_16x16x32_bf16 v[84:87], v[112:115], a[36:39], v[84:87]
ds_read_b128 v[100:103], v4 offset:37888
ds_read2st64_b32 v[170:171], v28 offset0:4 offset1:32
v_mfma_f32_16x16x32_bf16 v[84:87], v[116:119], a[44:47], v[84:87]
ds_read2st64_b32 v[172:173], v6 offset0:0 offset1:28
v_perm_b32 v255, v251, v247, s62
v_mfma_f32_16x16x32_bf16 v[72:75], v[120:123], a[48:51], v[72:75]
ds_read_b128 v[104:107], v4 offset:38912
ds_read2st64_b32 v[174:175], v27 offset0:0 offset1:28
v_mfma_f32_16x16x32_bf16 v[72:75], v[124:127], a[56:59], v[72:75]
buffer_store_dwordx4 v[252:255], v31, s[8:11], s93 offen offset:0 sc1
v_mfma_f32_16x16x32_bf16 v[76:79], v[120:123], a[52:55], v[76:79]
ds_read_b128 v[108:111], v4 offset:39936
v_mfma_f32_16x16x32_bf16 v[76:79], v[124:127], a[60:63], v[76:79]
s_waitcnt lgkmcnt(10)
buffer_load_dwordx4 a[12:15], v4, s[8:11], s35 offen offset:2048 sc1
v_mfma_f32_16x16x32_bf16 v[80:83], v[128:131], a[48:51], v[80:83]
ds_read_b128 v[112:115], v4 offset:40960
s_waitcnt lgkmcnt(10)
v_add_f32 v164, v164, v165
s_waitcnt lgkmcnt(8)
v_add_f32 v166, v166, v167
v_mfma_f32_16x16x32_bf16 v[80:83], v[132:135], a[56:59], v[80:83]
v_perm_b32 v252, v227, v223, s63
s_waitcnt lgkmcnt(7)
v_add_f32 v168, v168, v169
s_waitcnt lgkmcnt(5)
v_add_f32 v170, v170, v171
v_mfma_f32_16x16x32_bf16 v[84:87], v[128:131], a[52:55], v[84:87]
ds_read_b128 v[116:119], v4 offset:41984
s_waitcnt lgkmcnt(5)
v_add_f32 v172, v172, v173
s_waitcnt lgkmcnt(3)
v_add_f32 v174, v174, v175
v_mfma_f32_16x16x32_bf16 v[84:87], v[132:135], a[60:63], v[84:87]
buffer_load_dwordx4 a[16:19], v4, s[8:11], s34 offen offset:3072 sc1
v_perm_b32 v253, v235, v231, s63
v_add_f32 v164, v164, v166
v_mfma_f32_16x16x32_bf16 v[72:75], v[136:139], a[64:67], v[72:75]
ds_read_b128 v[120:123], v4 offset:43008
buffer_atomic_add_f32 v164, v9, s[8:11], s25 offen offset:0
v_mfma_f32_16x16x32_bf16 v[72:75], v[140:143], a[72:75], v[72:75]
v_perm_b32 v254, v243, v239, s63
v_add_f32 v168, v168, v170
v_add_f32 v172, v172, v174
v_mfma_f32_16x16x32_bf16 v[76:79], v[136:139], a[68:71], v[76:79]
ds_read_b128 v[124:127], v4 offset:44032
buffer_atomic_add_f32 v168, v9, s[8:11], s25 offen offset:1024
v_mfma_f32_16x16x32_bf16 v[76:79], v[140:143], a[76:79], v[76:79]
s_waitcnt lgkmcnt(4)
buffer_atomic_add_f32 v172, v10, s[8:11], s25 offen offset:2048
v_perm_b32 v255, v251, v247, s63
v_mfma_f32_16x16x32_bf16 v[80:83], v[96:99], a[64:67], v[80:83]
ds_read_b128 v[128:131], v4 offset:45056
buffer_load_dwordx4 a[20:23], v4, s[8:11], s35 offen offset:3072 sc1
v_mfma_f32_16x16x32_bf16 v[80:83], v[100:103], a[72:75], v[80:83]
buffer_store_dwordx4 v[252:255], v31, s[8:11], s93 offen offset:128 sc1
v_mfma_f32_16x16x32_bf16 v[84:87], v[96:99], a[68:71], v[84:87]
s_add_u32 s34, s34, 4096
ds_read_b128 v[132:135], v4 offset:46080
v_mul_f32 v88, v88, v24
v_mfma_f32_16x16x32_bf16 v[84:87], v[100:103], a[76:79], v[84:87]
s_add_u32 s35, s35, 4096
v_mul_f32 v89, v89, v24
v_mul_f32 v92, v92, v25
v_mfma_f32_16x16x32_bf16 v[72:75], v[104:107], a[80:83], v[72:75]
ds_read_b128 v[136:139], v4 offset:47104
v_mul_f32 v93, v93, v25
v_mfma_f32_16x16x32_bf16 v[72:75], v[108:111], a[88:91], v[72:75]
buffer_load_dwordx4 a[24:27], v4, s[8:11], s34 offen offset:0 sc1
v_mfma_f32_16x16x32_bf16 v[76:79], v[104:107], a[84:87], v[76:79]
ds_read_b128 v[140:143], v4 offset:48128
v_mfma_f32_16x16x32_bf16 v[76:79], v[108:111], a[92:95], v[76:79]
s_waitcnt lgkmcnt(4)
v_mul_f32 v32, 0x3fb8aa3b, v88
v_mul_f32 v33, 0x3fb8aa3b, v89
v_mfma_f32_16x16x32_bf16 v[80:83], v[112:115], a[80:83], v[80:83]
ds_read_b128 v[96:99], v4 offset:49152
v_mfma_f32_16x16x32_bf16 v[80:83], v[116:119], a[88:91], v[80:83]
v_exp_f32 v32, v32 clamp
v_mfma_f32_16x16x32_bf16 v[84:87], v[112:115], a[84:87], v[84:87]
ds_read_b128 v[100:103], v4 offset:50176
v_mfma_f32_16x16x32_bf16 v[84:87], v[116:119], a[92:95], v[84:87]
buffer_load_dwordx4 a[28:31], v4, s[8:11], s35 offen offset:0 sc1
v_mfma_f32_16x16x32_bf16 v[72:75], v[120:123], a[96:99], v[72:75]
ds_read_b128 v[104:107], v4 offset:51200
v_mul_f32 v34, 0x3fb8aa3b, v92
v_mfma_f32_16x16x32_bf16 v[72:75], v[124:127], a[104:107], v[72:75]
v_exp_f32 v33, v33 clamp
v_mfma_f32_16x16x32_bf16 v[76:79], v[120:123], a[100:103], v[76:79]
ds_read_b128 v[108:111], v4 offset:52224
v_mfma_f32_16x16x32_bf16 v[76:79], v[124:127], a[108:111], v[76:79]
s_waitcnt lgkmcnt(4)
buffer_load_dwordx4 a[32:35], v4, s[8:11], s34 offen offset:1024 sc1
v_mfma_f32_16x16x32_bf16 v[80:83], v[128:131], a[96:99], v[80:83]
ds_read_b128 v[112:115], v4 offset:53248
v_mfma_f32_16x16x32_bf16 v[80:83], v[132:135], a[104:107], v[80:83]
v_exp_f32 v34, v34 clamp
v_mfma_f32_16x16x32_bf16 v[84:87], v[128:131], a[100:103], v[84:87]
ds_read_b128 v[116:119], v4 offset:54272
v_mfma_f32_16x16x32_bf16 v[84:87], v[132:135], a[108:111], v[84:87]
v_mul_f32 v35, 0x3fb8aa3b, v93
v_mfma_f32_16x16x32_bf16 v[72:75], v[136:139], a[112:115], v[72:75]
v_exp_f32 v35, v35 clamp
v_mfma_f32_16x16x32_bf16 v[72:75], v[140:143], a[120:123], v[72:75]
buffer_load_dwordx4 a[36:39], v4, s[8:11], s35 offen offset:1024 sc1
v_mfma_f32_16x16x32_bf16 v[76:79], v[136:139], a[116:119], v[76:79]
v_mfma_f32_16x16x32_bf16 v[76:79], v[140:143], a[124:127], v[76:79]
s_waitcnt lgkmcnt(2)
v_max_f32 v88, 0x358637bd, v88
v_max_f32 v89, 0x358637bd, v89
v_mfma_f32_16x16x32_bf16 v[80:83], v[96:99], a[112:115], v[80:83]
v_max_f32 v92, 0x358637bd, v92
v_mfma_f32_16x16x32_bf16 v[80:83], v[100:103], a[120:123], v[80:83]
v_max_f32 v93, 0x358637bd, v93
v_mfma_f32_16x16x32_bf16 v[84:87], v[96:99], a[116:119], v[84:87]
buffer_load_dwordx4 a[40:43], v4, s[8:11], s34 offen offset:2048 sc1
v_mfma_f32_16x16x32_bf16 v[84:87], v[100:103], a[124:127], v[84:87]
v_add_f32 v88, v88, v32
v_mfma_f32_16x16x32_bf16 v[72:75], v[104:107], a[128:131], v[72:75]
v_add_f32 v89, v89, v33
v_mfma_f32_16x16x32_bf16 v[72:75], v[108:111], a[136:139], v[72:75]
v_add_f32 v92, v92, v34
v_add_f32 v93, v93, v35
v_mfma_f32_16x16x32_bf16 v[76:79], v[104:107], a[132:135], v[76:79]
v_cvt_pk_bf16_f32 v56, v88, v89
v_mfma_f32_16x16x32_bf16 v[76:79], v[108:111], a[140:143], v[76:79]
s_waitcnt lgkmcnt(0)
v_cvt_pk_bf16_f32 v57, v92, v93
v_mfma_f32_16x16x32_bf16 v[80:83], v[112:115], a[128:131], v[80:83]
buffer_load_dwordx4 a[44:47], v4, s[8:11], s35 offen offset:2048 sc1
v_mfma_f32_16x16x32_bf16 v[80:83], v[116:119], a[136:139], v[80:83]
buffer_store_dwordx2 v[56:57], v11, s[8:11], s27 offen sc1
v_mfma_f32_16x16x32_bf16 v[84:87], v[112:115], a[132:135], v[84:87]
v_mfma_f32_16x16x32_bf16 v[84:87], v[116:119], a[140:143], v[84:87]
s_mov_b32 s48, 0x3fb8aa3b
s_mov_b32 s49, s48
v_pk_mul_f32 v[72:73], v[72:73], v[24:25] op_sel:[0,0] op_sel_hi:[1,0]
v_pk_mul_f32 v[74:75], v[74:75], v[24:25] op_sel:[0,0] op_sel_hi:[1,0]
s_nop 0
v_pk_mul_f32 v[80:81], v[80:81], v[24:25] op_sel:[0,0] op_sel_hi:[1,0]
v_pk_mul_f32 v[82:83], v[82:83], v[24:25] op_sel:[0,0] op_sel_hi:[1,0]
v_pk_mul_f32 v[96:97], v[72:73], s[48:49]
v_pk_mul_f32 v[98:99], v[74:75], s[48:49]
v_pk_mul_f32 v[100:101], v[80:81], s[48:49]
v_pk_mul_f32 v[102:103], v[82:83], s[48:49]
v_exp_f32 v96, v96 clamp
v_max_f32 v72, 0x358637bd, v72
v_exp_f32 v97, v97 clamp
v_max_f32 v73, 0x358637bd, v73
v_exp_f32 v98, v98 clamp
v_max_f32 v74, 0x358637bd, v74
v_exp_f32 v99, v99 clamp
v_max_f32 v75, 0x358637bd, v75
v_exp_f32 v100, v100 clamp
v_max_f32 v80, 0x358637bd, v80
v_exp_f32 v101, v101 clamp
v_max_f32 v81, 0x358637bd, v81
v_exp_f32 v102, v102 clamp
v_max_f32 v82, 0x358637bd, v82
v_exp_f32 v103, v103 clamp
v_max_f32 v83, 0x358637bd, v83
v_pk_add_f32 v[72:73], v[72:73], v[96:97]
v_pk_add_f32 v[74:75], v[74:75], v[98:99]
v_pk_add_f32 v[80:81], v[80:81], v[100:101]
v_pk_add_f32 v[82:83], v[82:83], v[102:103]
v_cvt_pk_bf16_f32 v48, v72, v73
v_cvt_pk_bf16_f32 v49, v74, v75
v_cvt_pk_bf16_f32 v50, v80, v81
v_cvt_pk_bf16_f32 v51, v82, v83
buffer_store_dwordx4 v[48:51], v4, s[8:11], s26 offen sc1
v_pk_mul_f32 v[76:77], v[76:77], v[24:25] op_sel:[0,1] op_sel_hi:[1,1]
v_pk_mul_f32 v[78:79], v[78:79], v[24:25] op_sel:[0,1] op_sel_hi:[1,1]
v_pk_mul_f32 v[84:85], v[84:85], v[24:25] op_sel:[0,1] op_sel_hi:[1,1]
v_pk_mul_f32 v[86:87], v[86:87], v[24:25] op_sel:[0,1] op_sel_hi:[1,1]
v_pk_mul_f32 v[96:97], v[76:77], s[48:49]
v_pk_mul_f32 v[98:99], v[78:79], s[48:49]
v_pk_mul_f32 v[100:101], v[84:85], s[48:49]
v_pk_mul_f32 v[102:103], v[86:87], s[48:49]
v_exp_f32 v96, v96 clamp
v_max_f32 v76, 0x358637bd, v76
v_exp_f32 v97, v97 clamp
v_max_f32 v77, 0x358637bd, v77
v_exp_f32 v98, v98 clamp
v_max_f32 v78, 0x358637bd, v78
v_exp_f32 v99, v99 clamp
v_max_f32 v79, 0x358637bd, v79
v_exp_f32 v100, v100 clamp
v_max_f32 v84, 0x358637bd, v84
v_exp_f32 v101, v101 clamp
v_max_f32 v85, 0x358637bd, v85
v_exp_f32 v102, v102 clamp
v_max_f32 v86, 0x358637bd, v86
v_exp_f32 v103, v103 clamp
v_max_f32 v87, 0x358637bd, v87
v_pk_add_f32 v[76:77], v[76:77], v[96:97]
v_pk_add_f32 v[78:79], v[78:79], v[98:99]
v_pk_add_f32 v[84:85], v[84:85], v[100:101]
v_pk_add_f32 v[86:87], v[86:87], v[102:103]
v_cvt_pk_bf16_f32 v52, v76, v77
v_cvt_pk_bf16_f32 v53, v78, v79
v_cvt_pk_bf16_f32 v54, v84, v85
v_cvt_pk_bf16_f32 v55, v86, v87
buffer_store_dwordx4 v[52:55], v4, s[8:11], s28 offen sc1
s_waitcnt vmcnt(9)
s_barrier
buffer_store_dword v12, v29, s[8:11], s32 offen sc1
Lkb:
s_lshl_b32 s33, s13, 21
s_add_u32 s33, s33, 0x6020000
s_mov_b32 s86, s34
s_mov_b32 s87, s35
v_lshrrev_b32 v7, 4, v1
v_lshlrev_b32 v7, 1, v7
v_bfe_u32 v5, v1, 2, 2
v_lshl_add_u32 v7, v5, 6, v7
v_and_b32 v5, 3, v1
v_lshl_add_u32 v7, v5, 3, v7
v_lshlrev_b32 v7, 9, v7
s_lshr_b32 s37, s3, 1
s_and_b32 s39, s3, 1
s_lshl_b32 s39, s39, 5
s_add_u32 s37, s37, s39
s_lshl_b32 s37, s37, 9
s_add_u32 s33, s33, s37
v_lshrrev_b32 v10, 1, v3
v_lshl_add_u32 v9, v10, 4, v2
v_lshlrev_b32 v9, 3, v9
s_mul_i32 s20, s3, 11264
s_add_u32 s20, s20, s12
s_add_u32 s20, s20, 7340032
v_bfe_u32 v6, v2, 2, 1
v_cmp_gt_u32 s[42:43], 2, v5
v_lshl_add_u32 v166, v6, 1, v5
v_cmp_gt_u32 vcc, 8, v2
v_cndmask_b32 v166, v166, v5, s[42:43]
v_cndmask_b32 v6, v6, v5, s[42:43]
v_cmp_eq_u32 s[44:45], 0, v6
v_lshlrev_b32 v8, 6, v166
v_lshl_add_u32 v8, v3, 4, v8
v_lshlrev_b32 v166, 3, v166
v_lshl_add_u32 v10, v10, 2, v166
s_or_b64 s[46:47], vcc, s[42:43]
s_orn2_b64 s[48:49], s[42:43], vcc
v_cndmask_b32 v248, v14, v8, s[46:47]
v_cndmask_b32 v249, v14, v8, s[48:49]
v_cndmask_b32 v250, v14, v10, s[46:47]
v_cndmask_b32 v251, v14, v10, s[48:49]
v_lshlrev_b32 v252, 5, v3
v_lshl_add_u32 v252, v2, 4, v252
v_cmp_gt_u32 vcc, 2, v2
s_lshl_b32 s34, s3, 9
s_add_u32 s34, s34, 2760704
v_cndmask_b32 v252, v14, v252, vcc
s_and_b32 s39, s3, 1
s_lshl_b32 s39, s39, 3
s_lshl_b32 s35, s3, 7
s_add_u32 s35, s35, s39
s_add_u32 s35, s35, 2762752
s_lshl_b32 s16, s6, 2
s_lshr_b32 s18, s7, 2
s_add_u32 s16, s16, s18
s_and_b32 s17, s15, 3
s_lshl_b32 s21, s16, 15
s_lshl_b32 s22, s3, 12
s_add_u32 s21, s21, s22
s_add_u32 s21, s21, s12
s_add_u32 s21, s21, 4718592
s_add_u32 s22, s21, 16384
s_lshl_b32 s23, s16, 12
s_lshl_b32 s24, s3, 10
s_add_u32 s23, s23, s24
s_add_u32 s23, s23, s12
s_add_u32 s23, s23, 6815744
v_and_b32 v6, 1, v3
v_cmp_eq_u32 s[50:51], 1, v6
s_lshl_b32 s28, s13, 21
s_add_u32 s28, s28, 0x6100000
s_lshl_b32 s84, s6, 2
s_add_u32 s84, s84, s3
s_lshl_b32 s84, s84, 4
s_add_u32 s84, s84, s18
s_lshl_b32 s84, s84, 5
s_add_u32 s84, s84, s17
s_lshl_b32 s84, s84, 2
s_add_u32 s84, s84, s28
v_lshlrev_b32 v167, 9, v1
s_lshl_b32 s37, s6, 4
s_add_u32 s37, s37, s7
s_lshl_b32 s37, s37, 2
s_add_u32 s37, s37, s3
s_lshl_b32 s37, s37, 7
s_add_u32 s28, s28, s37
s_waitcnt vmcnt(1) lgkmcnt(0)
s_mov_b64 exec, 0xf
buffer_store_dword v12, v167, s[8:11], s84 offen sc1
s_mov_b64 exec, -1
buffer_load_dwordx4 a[48:51], v4, s[8:11], s86 offen offset:3072 sc1
buffer_load_dwordx4 a[52:55], v4, s[8:11], s87 offen offset:3072 sc1
s_add_u32 s86, s86, 4096
s_add_u32 s87, s87, 4096
buffer_load_dwordx4 a[56:59], v4, s[8:11], s86 offen offset:0 sc1
buffer_load_dwordx4 a[60:63], v4, s[8:11], s87 offen offset:0 sc1
buffer_load_dwordx4 a[64:67], v4, s[8:11], s86 offen offset:1024 sc1
buffer_load_dwordx4 a[68:71], v4, s[8:11], s87 offen offset:1024 sc1
v_cndmask_b32 v10, v14, v9, s[50:51]
v_mov_b32 v81, 0
v_mov_b32 v87, 0
v_mov_b32 v89, 0
v_mov_b32 v95, 0
v_mov_b32 v97, 0
v_mov_b32 v103, 0
v_mov_b32 v105, 0
v_mov_b32 v111, 0
v_mov_b32 v113, 0
v_mov_b32 v119, 0
v_mov_b32 v121, 0
v_mov_b32 v127, 0
v_mov_b32 v129, 0
v_mov_b32 v135, 0
v_mov_b32 v137, 0
v_mov_b32 v143, 0
v_mov_b32 v31, 0
v_mov_b32 v47, 0
v_mov_b32 v63, 0
v_mov_b32 v79, 0
v_mov_b32 v192, 0x358637bd
v_mov_b32 v193, 0x358637bd
v_mov_b32 v194, 0
v_mov_b32 v195, 0
s_lshl_b32 s37, s3, 13
s_add_u32 s37, s37, 110592
v_add_u32 v8, s37, v4
s_lshr_b32 s37, s3, 1
s_lshl_b32 s37, s37, 11
s_add_u32 s37, s37, s39
s_add_u32 s37, s37, 143360
v_add_u32 v246, s37, v4
v_add_u32 v247, 110592, v4
s_lshl_b32 s37, s3, 11
s_add_u32 s37, s37, 147456
v_add_u32 v253, s37, v4
s_lshl_b32 s37, s3, 2
s_add_u32 s37, s37, 155648
v_lshlrev_b32 v255, 9, v3
v_lshl_add_u32 v255, v2, 4, v255
v_add_u32 v255, s37, v255
s_lshl_b32 s61, s2, 2
s_add_u32 s61, s61, s3
v_and_b32 v5, 7, v1
v_lshrrev_b32 v6, 3, v1
s_mov_b32 s58, 5308416
s_mov_b32 s59, 0x20000
s_cmp_lt_u32 s61, 648
s_cbranch_scc1 Lbb_d
s_sub_u32 s38, s61, 648
s_lshr_b32 s39, s38, 4
s_and_b32 s38, s38, 15
s_bitcmp1_b32 s39, 0
s_cselect_b32 s56, s74, s72
s_cselect_b32 s57, s75, s73
s_lshr_b32 s39, s39, 1
s_mul_i32 s60, s39, 589824
s_lshl_b32 s38, s38, 7
s_add_u32 s60, s60, s38
s_add_u32 s60, s60, 7168
v_mul_u32_u24 v254, 73728, v6
v_lshl_add_u32 v254, v5, 4, v254
s_branch Lbb_e
Lbb_d:
s_mul_i32 s38, s61, 116509
s_lshr_b32 s38, s38, 20
s_mul_i32 s39, s38, 9
s_sub_u32 s39, s61, s39
s_mov_b32 s56, s76
s_mov_b32 s57, s77
s_mul_i32 s60, s38, 73728
s_lshl_b32 s38, s39, 7
s_add_u32 s60, s60, s38
v_mul_u32_u24 v254, 1152, v6
v_lshl_add_u32 v254, v5, 4, v254
Lbb_e:
s_cmp_lt_u32 s61, 936
s_cselect_b32 s38, s13, 1
s_cmp_eq_u32 s38, 0
s_cselect_b64 vcc, -1, 0
v_cndmask_b32 v254, v14, v254, vcc
s_mul_i32 s38, s16, 36864
s_add_u32 s38, s38, s12
s_lshl_b32 s39, s17, 2
s_add_u32 s39, s39, s3
s_lshl_b32 s39, s39, 10
s_add_u32 s26, s38, s39
s_add_u32 s27, s26, 18432
s_lshl_b32 s39, s17, 9
s_add_u32 s30, s38, s39
s_add_u32 s30, s30, 16384
s_and_b32 s39, s3, 1
s_mul_i32 s39, s39, 18432
s_add_u32 s30, s30, s39
v_lshlrev_b32 v5, 1, v9
v_and_b32 v6, 1, v3
v_lshl_add_u32 v5, v6, 3, v5
s_cmp_eq_u32 s3, 0
s_cselect_b64 s[40:41], -1, 0
s_cmp_eq_u32 s3, 1
s_cselect_b64 s[52:53], -1, 0
s_or_b64 vcc, s[40:41], s[52:53]
v_cndmask_b32 v5, v14, v5, vcc
s_and_b32 s39, s3, 1
s_lshl_b32 s39, s39, 10
s_add_u32 s39, s39, 147456
v_add_u32 v197, s39, v4
v_lshlrev_b32 v198, 4, v2
v_add_u32 v198, 155648, v198
v_lshlrev_b32 v199, 3, v2
v_cmp_gt_u32 vcc, 32, v1
v_lshl_add_u32 v199, v3, 2, v199
s_nop 0
v_cndmask_b32 v199, v14, v199, vcc
s_lshl_b32 s32, s16, 9
s_add_u32 s32, s32, s12
s_add_u32 s92, s32, 7405568
v_lshlrev_b32 v196, 4, v2
s_mov_b64 s[88:89], s[26:27]
s_mov_b32 s90, s30
s_and_b32 s24, s14, 3
s_lshl_b32 s24, s24, 3
s_and_b32 s25, s15, 7
s_add_u32 s24, s24, s25
s_mul_i32 s24, s24, 331776
s_mul_i32 s25, s3, 9216
s_add_u32 s24, s24, s25
s_add_u32 s24, s24, 3145728
buffer_load_dwordx4 v[152:155], v4, s[8:11], s88 offen sc1
buffer_load_dwordx2 v[162:163], v196, s[8:11], s92 offen offset:0 sc1
buffer_load_dwordx4 v[156:159], v4, s[8:11], s89 offen sc1
buffer_load_dwordx2 v[164:165], v196, s[8:11], s92 offen offset:256 sc1
buffer_load_dwordx2 v[160:161], v5, s[8:11], s90 offen sc1
s_add_u32 s26, s26, 2359296
s_add_u32 s27, s27, 2359296
s_add_u32 s30, s30, 2359296
s_lshl_b32 s31, s17, 2
s_add_u32 s31, s31, s3
s_and_b32 s36, s16, 1
s_lshl_b32 s36, s36, 2
s_add_u32 s36, s36, s17
s_lshl_b32 s36, s36, 2
s_lshr_b32 s29, s16, 1
s_lshl_b32 s29, s29, 2
s_add_u32 s29, s29, s3
s_lshl_b32 s29, s29, 10
s_add_u32 s36, s36, s29
s_lshl_b32 s29, s13, 21
s_add_u32 s29, s29, 0x6040000
s_add_u32 s29, s29, s36
s_cmp_eq_u32 s31, 1
s_cselect_b64 vcc, -1, 0
v_cndmask_b32 v166, v14, v13, vcc
s_lshl_b32 s31, s31, 13
s_lshl_b32 s32, s16, 7
s_add_u32 s32, s32, s12
s_add_u32 s31, s31, s32
s_add_u32 s31, s31, 7438336
s_add_u32 s32, s32, 7569408
buffer_load_dword v11, v7, s[8:11], s33 offen sc1
v_mov_b32 v167, v12
s_mov_b64 exec, 0xf
v_mov_b32 v167, 0
buffer_atomic_or v167, v13, s[8:11], s28 offen sc0
s_mov_b64 exec, -1
s_waitcnt vmcnt(1)
v_cmp_ne_u32 vcc, v12, v11
s_nop 1
s_cbranch_vccnz Lsp2
Lok2:
buffer_load_dwordx4 v[16:19], v4, s[8:11], s20 offen sc1
buffer_load_dwordx4 v[20:23], v4, s[8:11], s20 offen offset:1024 sc1
buffer_load_dwordx4 v[24:27], v248, s[8:11], s20 offen offset:2048 sc1
buffer_load_dwordx2 v[28:29], v9, s[8:11], s20 offen offset:2432 sc1
buffer_load_dword v30, v250, s[8:11], s20 offen offset:2688 sc1
s_add_u32 s20, s20, 2816
s_waitcnt vmcnt(5)
v_cmp_ne_u32 vcc, v12, v167
s_nop 1
s_cbranch_vccnz Lsp3
Lok3:
buffer_load_dwordx2 v[144:145], v10, s[8:11], s23 offen offset:0 sc1
buffer_load_dwordx4 v[82:85], v4, s[8:11], s21 offen offset:0 sc1
buffer_load_dwordx4 v[90:93], v4, s[8:11], s22 offen offset:0 sc1
buffer_load_dwordx4 v[32:35], v4, s[8:11], s20 offen sc1
buffer_load_dwordx4 v[36:39], v4, s[8:11], s20 offen offset:1024 sc1
buffer_load_dwordx4 v[40:43], v249, s[8:11], s20 offen offset:2048 sc1
buffer_load_dwordx2 v[44:45], v9, s[8:11], s20 offen offset:2432 sc1
buffer_load_dword v46, v251, s[8:11], s20 offen offset:2688 sc1
s_add_u32 s20, s20, 2816
buffer_load_dwordx2 v[146:147], v10, s[8:11], s23 offen offset:256 sc1
buffer_load_dwordx4 v[98:101], v4, s[8:11], s21 offen offset:1024 sc1
buffer_load_dwordx4 v[106:109], v4, s[8:11], s22 offen offset:1024 sc1
buffer_load_dwordx4 v[48:51], v4, s[8:11], s20 offen sc1
buffer_load_dwordx4 v[52:55], v4, s[8:11], s20 offen offset:1024 sc1
buffer_load_dwordx4 v[56:59], v248, s[8:11], s20 offen offset:2048 sc1
buffer_load_dwordx2 v[60:61], v9, s[8:11], s20 offen offset:2432 sc1
buffer_load_dword v62, v250, s[8:11], s20 offen offset:2688 sc1
s_add_u32 s20, s20, 2816
buffer_load_dwordx2 v[148:149], v10, s[8:11], s23 offen offset:512 sc1
buffer_load_dwordx4 v[114:117], v4, s[8:11], s21 offen offset:2048 sc1
buffer_load_dwordx4 v[122:125], v4, s[8:11], s22 offen offset:2048 sc1
s_waitcnt vmcnt(23)
v_cvt_pk_bf16_f32 v19, v18, v19
v_cvt_pk_bf16_f32 v18, v16, v17
s_waitcnt vmcnt(22)
v_cvt_pk_bf16_f32 v20, v20, v21
v_cvt_pk_bf16_f32 v21, v22, v23
s_waitcnt vmcnt(21)
v_cvt_pk_bf16_f32 v27, v26, v27
v_cvt_pk_bf16_f32 v26, v24, v25
buffer_load_dwordx4 v[64:67], v4, s[8:11], s20 offen sc1
s_waitcnt vmcnt(21)
v_cvt_pk_bf16_f32 v16, v28, 0
v_cvt_pk_bf16_f32 v22, 0, v29
s_waitcnt vmcnt(20)
v_cvt_pk_bf16_f32 v24, v30, 0
v_cvt_pk_bf16_f32 v30, 0, v30
buffer_load_dwordx4 v[68:71], v4, s[8:11], s20 offen offset:1024 sc1
v_mov_b32 v17, 0
v_mov_b32 v23, 0
v_mov_b32 v25, 0
v_cndmask_b32 v28, v26, 0, s[44:45]
buffer_load_dwordx4 v[72:75], v249, s[8:11], s20 offen offset:2048 sc1
v_cndmask_b32 v29, v27, 0, s[44:45]
v_cndmask_b32 v26, 0, v26, s[44:45]
v_cndmask_b32 v27, 0, v27, s[44:45]
v_cndmask_b32 v24, 0, v24, s[44:45]
v_cndmask_b32 v30, v30, 0, s[44:45]
buffer_load_dwordx2 v[76:77], v9, s[8:11], s20 offen offset:2432 sc1
s_waitcnt vmcnt(22)
v_mov_b32 v80, v144
v_mov_b32 v86, v144
v_mov_b32 v88, v145
v_mov_b32 v94, v145
buffer_load_dword v78, v251, s[8:11], s20 offen offset:2688 sc1
s_waitcnt vmcnt(20)
v_cvt_pk_bf16_f32 v35, v34, v35
v_cvt_pk_bf16_f32 v34, v32, v33
s_waitcnt vmcnt(19)
v_cvt_pk_bf16_f32 v36, v36, v37
v_cvt_pk_bf16_f32 v37, v38, v39
s_add_u32 s20, s20, 2816
s_waitcnt vmcnt(18)
v_cvt_pk_bf16_f32 v43, v42, v43
v_mfma_f32_16x16x32_bf16 v[208:211], v[24:27], v[80:83], v[192:195]
v_cvt_pk_bf16_f32 v42, v40, v41
s_waitcnt vmcnt(17)
v_cvt_pk_bf16_f32 v32, v44, 0
v_mfma_f32_16x16x32_bf16 v[208:211], v[28:31], v[84:87], v[208:211]
buffer_load_dwordx2 v[150:151], v10, s[8:11], s23 offen offset:768 sc1
v_cvt_pk_bf16_f32 v38, 0, v45
s_waitcnt vmcnt(17)
v_cvt_pk_bf16_f32 v40, v46, 0
v_mfma_f32_16x16x32_bf16 v[220:223], v[24:27], v[88:91], v[192:195]
v_cvt_pk_bf16_f32 v46, 0, v46
buffer_load_dwordx4 v[130:133], v4, s[8:11], s21 offen offset:3072 sc1
v_mov_b32 v33, 0
v_mfma_f32_16x16x32_bf16 v[220:223], v[28:31], v[92:95], v[220:223]
v_mov_b32 v39, 0
v_mov_b32 v41, 0
buffer_load_dwordx4 v[138:141], v4, s[8:11], s22 offen offset:3072 sc1
v_mfma_f32_16x16x32_bf16 v[200:203], v[16:19], v[80:83], 0
buffer_load_dwordx4 a[80:83], v254, s[56:59], s60 offen nt
s_add_u32 s60, s60, 9216
v_cndmask_b32 v44, v42, 0, s[44:45]
v_cndmask_b32 v45, v43, 0, s[44:45]
v_mfma_f32_16x16x32_bf16 v[204:207], v[20:23], v[84:87], 0
v_cndmask_b32 v42, 0, v42, s[44:45]
v_cndmask_b32 v43, 0, v43, s[44:45]
v_mfma_f32_16x16x32_bf16 v[212:215], v[16:19], v[88:91], 0
buffer_load_dwordx4 a[84:87], v254, s[56:59], s60 offen nt
s_add_u32 s60, s60, 9216
v_cndmask_b32 v40, 0, v40, s[44:45]
v_cndmask_b32 v46, v46, 0, s[44:45]
v_mfma_f32_16x16x32_bf16 v[216:219], v[20:23], v[92:95], 0
s_waitcnt vmcnt(20)
v_mov_b32 v96, v146
v_mov_b32 v102, v146
v_mov_b32 v104, v147
v_mov_b32 v110, v147
v_rcp_f32 v232, v208
v_rcp_f32 v233, v209
v_rcp_f32 v235, v220
v_rcp_f32 v236, v221
s_waitcnt vmcnt(19)
v_mfma_f32_16x16x32_bf16 v[176:179], v[40:43], v[96:99], v[192:195]
buffer_load_dwordx4 a[88:91], v254, s[56:59], s60 offen nt
s_add_u32 s60, s60, 9216
v_mul_f32 v200, v200, v232
v_mul_f32 v201, v201, v232
v_mul_f32 v202, v202, v232
v_mul_f32 v203, v203, v232
v_mfma_f32_16x16x32_bf16 v[176:179], v[44:47], v[100:103], v[176:179]
v_mul_f32 v204, v204, v233
v_mul_f32 v205, v205, v233
v_mul_f32 v206, v206, v233
v_mul_f32 v207, v207, v233
s_waitcnt vmcnt(19)
v_mfma_f32_16x16x32_bf16 v[188:191], v[40:43], v[104:107], v[192:195]
buffer_load_dwordx4 a[92:95], v254, s[56:59], s60 offen nt
s_add_u32 s60, s60, 9216
v_cndmask_b32 v234, v232, v233, s[50:51]
v_cvt_pk_bf16_f32 v224, v200, v201
v_cvt_pk_bf16_f32 v225, v202, v203
v_mfma_f32_16x16x32_bf16 v[188:191], v[44:47], v[108:111], v[188:191]
v_cvt_pk_bf16_f32 v226, v204, v205
v_cvt_pk_bf16_f32 v227, v206, v207
v_mul_f32 v238, v210, v234
v_mul_f32 v239, v211, v234
v_mfma_f32_16x16x32_bf16 v[168:171], v[32:35], v[96:99], 0
buffer_load_dwordx4 a[96:99], v254, s[56:59], s60 offen nt
s_add_u32 s60, s60, 9216
v_mfma_f32_16x16x32_bf16 a[112:115], a[216:219], v[224:227], 0
ds_write_b128 v8, v[224:227] offset:0
v_mfma_f32_16x16x32_bf16 a[120:123], a[236:239], v[224:227], 0
buffer_load_dwordx4 a[100:103], v254, s[56:59], s60 offen nt
s_add_u32 s60, s60, 9216
v_mul_f32 v212, v212, v235
v_mfma_f32_16x16x32_bf16 v[172:175], v[36:39], v[100:103], 0
v_mul_f32 v213, v213, v235
v_mul_f32 v214, v214, v235
v_mul_f32 v215, v215, v235
v_mul_f32 v216, v216, v236
v_mfma_f32_16x16x32_bf16 v[180:183], v[32:35], v[104:107], 0
buffer_load_dwordx4 a[104:107], v254, s[56:59], s60 offen nt
s_add_u32 s60, s60, 9216
v_mul_f32 v217, v217, v236
v_mul_f32 v218, v218, v236
v_mul_f32 v219, v219, v236
v_mfma_f32_16x16x32_bf16 v[184:187], v[36:39], v[108:111], 0
v_cndmask_b32 v237, v235, v236, s[50:51]
v_cvt_pk_bf16_f32 v228, v212, v213
v_cvt_pk_bf16_f32 v229, v214, v215
v_cvt_pk_bf16_f32 v230, v216, v217
v_cvt_pk_bf16_f32 v231, v218, v219
v_mul_f32 v240, v222, v237
v_mul_f32 v241, v223, v237
v_mfma_f32_16x16x32_bf16 a[116:119], a[216:219], v[228:231], 0
buffer_load_dwordx4 a[108:111], v254, s[56:59], s60 offen nt
s_add_u32 s60, s60, 9216
ds_write_b128 v8, v[228:231] offset:1024
v_mfma_f32_16x16x32_bf16 a[124:127], a[236:239], v[228:231], 0
s_waitcnt vmcnt(23)
v_cvt_pk_bf16_f32 v51, v50, v51
v_cvt_pk_bf16_f32 v50, v48, v49
s_waitcnt vmcnt(22)
v_cvt_pk_bf16_f32 v52, v52, v53
v_cvt_pk_bf16_f32 v53, v54, v55
s_waitcnt vmcnt(21)
v_cvt_pk_bf16_f32 v59, v58, v59
v_cvt_pk_bf16_f32 v58, v56, v57
s_waitcnt vmcnt(20)
v_cvt_pk_bf16_f32 v48, v60, 0
v_cvt_pk_bf16_f32 v54, 0, v61
s_waitcnt vmcnt(19)
v_cvt_pk_bf16_f32 v56, v62, 0
v_cvt_pk_bf16_f32 v62, 0, v62
v_mov_b32 v49, 0
v_mov_b32 v55, 0
v_mov_b32 v57, 0
v_cndmask_b32 v60, v58, 0, s[44:45]
v_cndmask_b32 v61, v59, 0, s[44:45]
v_cndmask_b32 v58, 0, v58, s[44:45]
v_cndmask_b32 v59, 0, v59, s[44:45]
v_cndmask_b32 v56, 0, v56, s[44:45]
v_cndmask_b32 v62, v62, 0, s[44:45]
s_waitcnt vmcnt(18)
v_mov_b32 v112, v148
v_mov_b32 v118, v148
v_mov_b32 v120, v149
v_mov_b32 v126, v149
v_rcp_f32 v232, v176
v_rcp_f32 v233, v177
v_rcp_f32 v235, v188
v_rcp_f32 v236, v189
s_waitcnt vmcnt(17)
v_mfma_f32_16x16x32_bf16 v[208:211], v[56:59], v[112:115], v[192:195]
v_mul_f32 v168, v168, v232
v_mul_f32 v169, v169, v232
v_mul_f32 v170, v170, v232
v_mul_f32 v171, v171, v232
v_mfma_f32_16x16x32_bf16 v[208:211], v[60:63], v[116:119], v[208:211]
v_mul_f32 v172, v172, v233
v_mul_f32 v173, v173, v233
v_mul_f32 v174, v174, v233
v_mul_f32 v175, v175, v233
s_waitcnt vmcnt(16)
v_mfma_f32_16x16x32_bf16 v[220:223], v[56:59], v[120:123], v[192:195]
v_cndmask_b32 v234, v232, v233, s[50:51]
v_cvt_pk_bf16_f32 v224, v168, v169
v_cvt_pk_bf16_f32 v225, v170, v171
v_mfma_f32_16x16x32_bf16 v[220:223], v[60:63], v[124:127], v[220:223]
v_cvt_pk_bf16_f32 v226, v172, v173
v_cvt_pk_bf16_f32 v227, v174, v175
v_fmac_f32 v238, v178, v234
v_fmac_f32 v239, v179, v234
v_mfma_f32_16x16x32_bf16 v[200:203], v[48:51], v[112:115], 0
v_mfma_f32_16x16x32_bf16 a[112:115], a[220:223], v[224:227], a[112:115]
ds_write_b128 v8, v[224:227] offset:2048
v_mfma_f32_16x16x32_bf16 a[120:123], a[240:243], v[224:227], a[120:123]
v_cvt_pk_bf16_f32 v242, v238, v239
v_mfma_f32_16x16x32_bf16 v[204:207], v[52:55], v[116:119], 0
v_mul_f32 v180, v180, v235
v_mul_f32 v181, v181, v235
v_mul_f32 v182, v182, v235
v_mul_f32 v183, v183, v235
v_mfma_f32_16x16x32_bf16 v[212:215], v[48:51], v[120:123], 0
v_mul_f32 v184, v184, v236
v_mul_f32 v185, v185, v236
v_mul_f32 v186, v186, v236
v_mfma_f32_16x16x32_bf16 v[216:219], v[52:55], v[124:127], 0
v_mul_f32 v187, v187, v236
v_cndmask_b32 v237, v235, v236, s[50:51]
v_cvt_pk_bf16_f32 v228, v180, v181
v_cvt_pk_bf16_f32 v229, v182, v183
v_cvt_pk_bf16_f32 v230, v184, v185
v_cvt_pk_bf16_f32 v231, v186, v187
v_fmac_f32 v240, v190, v237
v_fmac_f32 v241, v191, v237
v_mfma_f32_16x16x32_bf16 a[116:119], a[220:223], v[228:231], a[116:119]
ds_write_b128 v8, v[228:231] offset:3072
v_mfma_f32_16x16x32_bf16 a[124:127], a[240:243], v[228:231], a[124:127]
v_cvt_pk_bf16_f32 v244, v240, v241
s_waitcnt vmcnt(15)
v_cvt_pk_bf16_f32 v67, v66, v67
v_cvt_pk_bf16_f32 v66, v64, v65
s_waitcnt vmcnt(14)
v_cvt_pk_bf16_f32 v68, v68, v69
v_cvt_pk_bf16_f32 v69, v70, v71
s_waitcnt vmcnt(13)
v_cvt_pk_bf16_f32 v75, v74, v75
v_cvt_pk_bf16_f32 v74, v72, v73
s_waitcnt vmcnt(12)
v_cvt_pk_bf16_f32 v64, v76, 0
v_cvt_pk_bf16_f32 v70, 0, v77
s_waitcnt vmcnt(11)
v_cvt_pk_bf16_f32 v72, v78, 0
v_cvt_pk_bf16_f32 v78, 0, v78
v_mov_b32 v65, 0
v_mov_b32 v71, 0
v_mov_b32 v73, 0
v_cndmask_b32 v76, v74, 0, s[44:45]
v_cndmask_b32 v77, v75, 0, s[44:45]
v_cndmask_b32 v74, 0, v74, s[44:45]
v_cndmask_b32 v75, 0, v75, s[44:45]
v_cndmask_b32 v72, 0, v72, s[44:45]
v_cndmask_b32 v78, v78, 0, s[44:45]
s_waitcnt vmcnt(10)
v_mov_b32 v128, v150
v_mov_b32 v134, v150
v_mov_b32 v136, v151
v_mov_b32 v142, v151
v_rcp_f32 v232, v208
v_rcp_f32 v233, v209
v_rcp_f32 v235, v220
v_rcp_f32 v236, v221
s_waitcnt vmcnt(9)
v_mfma_f32_16x16x32_bf16 v[176:179], v[72:75], v[128:131], v[192:195]
v_mul_f32 v200, v200, v232
v_mul_f32 v201, v201, v232
v_mul_f32 v202, v202, v232
v_mul_f32 v203, v203, v232
v_mfma_f32_16x16x32_bf16 v[176:179], v[76:79], v[132:135], v[176:179]
v_mul_f32 v204, v204, v233
v_mul_f32 v205, v205, v233
v_mul_f32 v206, v206, v233
v_mul_f32 v207, v207, v233
s_waitcnt vmcnt(8)
v_mfma_f32_16x16x32_bf16 v[188:191], v[72:75], v[136:139], v[192:195]
v_cndmask_b32 v234, v232, v233, s[50:51]
v_cvt_pk_bf16_f32 v224, v200, v201
v_cvt_pk_bf16_f32 v225, v202, v203
v_mfma_f32_16x16x32_bf16 v[188:191], v[76:79], v[140:143], v[188:191]
v_cvt_pk_bf16_f32 v226, v204, v205
v_cvt_pk_bf16_f32 v227, v206, v207
v_mul_f32 v238, v210, v234
v_mul_f32 v239, v211, v234
v_mfma_f32_16x16x32_bf16 v[168:171], v[64:67], v[128:131], 0
v_mfma_f32_16x16x32_bf16 a[112:115], a[224:227], v[224:227], a[112:115]
ds_write_b128 v8, v[224:227] offset:4096
v_mfma_f32_16x16x32_bf16 a[120:123], a[244:247], v[224:227], a[120:123]
v_mul_f32 v212, v212, v235
v_mfma_f32_16x16x32_bf16 v[172:175], v[68:71], v[132:135], 0
v_mul_f32 v213, v213, v235
v_mul_f32 v214, v214, v235
v_mul_f32 v215, v215, v235
v_mul_f32 v216, v216, v236
v_mfma_f32_16x16x32_bf16 v[180:183], v[64:67], v[136:139], 0
v_mul_f32 v217, v217, v236
v_mul_f32 v218, v218, v236
v_mul_f32 v219, v219, v236
v_mfma_f32_16x16x32_bf16 v[184:187], v[68:71], v[140:143], 0
v_cndmask_b32 v237, v235, v236, s[50:51]
v_cvt_pk_bf16_f32 v228, v212, v213
v_cvt_pk_bf16_f32 v229, v214, v215
v_cvt_pk_bf16_f32 v230, v216, v217
v_cvt_pk_bf16_f32 v231, v218, v219
v_mul_f32 v240, v222, v237
v_mul_f32 v241, v223, v237
v_mfma_f32_16x16x32_bf16 a[116:119], a[224:227], v[228:231], a[116:119]
ds_write_b128 v8, v[228:231] offset:5120
v_mfma_f32_16x16x32_bf16 a[124:127], a[244:247], v[228:231], a[124:127]
v_rcp_f32 v232, v176
v_rcp_f32 v233, v177
v_rcp_f32 v235, v188
v_rcp_f32 v236, v189
v_mul_f32 v168, v168, v232
v_mul_f32 v169, v169, v232
v_mul_f32 v170, v170, v232
v_mul_f32 v171, v171, v232
v_mul_f32 v172, v172, v233
v_mul_f32 v173, v173, v233
v_mul_f32 v174, v174, v233
v_mul_f32 v175, v175, v233
v_cndmask_b32 v234, v232, v233, s[50:51]
v_cvt_pk_bf16_f32 v224, v168, v169
v_cvt_pk_bf16_f32 v225, v170, v171
v_cvt_pk_bf16_f32 v226, v172, v173
v_cvt_pk_bf16_f32 v227, v174, v175
v_fmac_f32 v238, v178, v234
v_fmac_f32 v239, v179, v234
v_mfma_f32_16x16x32_bf16 a[112:115], a[228:231], v[224:227], a[112:115]
ds_write_b128 v8, v[224:227] offset:6144
v_mfma_f32_16x16x32_bf16 a[120:123], a[248:251], v[224:227], a[120:123]
v_cvt_pk_bf16_f32 v243, v238, v239
v_mul_f32 v180, v180, v235
v_mul_f32 v181, v181, v235
v_mul_f32 v182, v182, v235
v_mul_f32 v183, v183, v235
v_mul_f32 v184, v184, v236
v_mul_f32 v185, v185, v236
v_mul_f32 v186, v186, v236
v_mul_f32 v187, v187, v236
v_cndmask_b32 v237, v235, v236, s[50:51]
v_cvt_pk_bf16_f32 v228, v180, v181
v_cvt_pk_bf16_f32 v229, v182, v183
v_cvt_pk_bf16_f32 v230, v184, v185
v_cvt_pk_bf16_f32 v231, v186, v187
v_fmac_f32 v240, v190, v237
v_fmac_f32 v241, v191, v237
v_mfma_f32_16x16x32_bf16 a[116:119], a[228:231], v[228:231], a[116:119]
ds_write_b128 v8, v[228:231] offset:7168
v_mfma_f32_16x16x32_bf16 a[124:127], a[248:251], v[228:231], a[124:127]
v_cvt_pk_bf16_f32 v245, v240, v241
ds_write_b64 v246, v[242:243] offset:0
ds_write_b64 v246, v[244:245] offset:1024
v_mfma_f32_16x16x16_bf16 a[120:123], a[234:235], v[242:243], a[120:123]
s_nop 1
v_mfma_f32_16x16x16_bf16 a[124:127], a[234:235], v[244:245], a[124:127]
v_mfma_f32_16x16x16_bf16 a[112:115], a[232:233], v[242:243], a[112:115]
v_mfma_f32_16x16x16_bf16 a[116:119], a[232:233], v[244:245], a[116:119]
s_waitcnt lgkmcnt(0)
s_barrier
ds_read_b128 v[16:19], v247 offset:0
ds_read_b128 v[20:23], v247 offset:1024
ds_read_b128 v[24:27], v247 offset:2048
ds_read_b128 v[28:31], v247 offset:3072
ds_read_b128 v[32:35], v247 offset:4096
ds_read_b128 v[36:39], v247 offset:5120
ds_read_b128 v[40:43], v247 offset:6144
ds_read_b128 v[44:47], v247 offset:7168
v_accvgpr_read_b32 v232, a120
v_accvgpr_read_b32 v233, a121
v_accvgpr_read_b32 v234, a124
v_accvgpr_read_b32 v235, a125
v_add_f32 v232, v232, v233
v_add_f32 v234, v234, v235
ds_write_b32 v255, v232 offset:0
ds_write_b128 v253, a[112:115] offset:0
ds_write_b32 v255, v234 offset:256
ds_write_b128 v253, a[116:119] offset:1024
s_waitcnt lgkmcnt(8)
v_mfma_f32_16x16x32_bf16 v[64:67], a[144:147], v[16:19], 0
v_mfma_f32_16x16x32_bf16 v[64:67], a[152:155], v[24:27], v[64:67]
s_add_u32 m0, s25, 0
ds_read_b128 v[48:51], v247 offset:8192
v_mfma_f32_16x16x32_bf16 v[68:71], a[148:151], v[16:19], 0
buffer_load_dwordx4 v4, s[8:11], s24 offen offset:0 sc1 lds
v_mfma_f32_16x16x32_bf16 v[68:71], a[156:159], v[24:27], v[68:71]
ds_read_b128 v[52:55], v247 offset:9216
v_mfma_f32_16x16x32_bf16 v[72:75], a[144:147], v[20:23], 0
buffer_load_dwordx4 v4, s[8:11], s24 offen offset:1024 sc1 lds
s_waitcnt lgkmcnt(2)
s_barrier
v_mfma_f32_16x16x32_bf16 v[72:75], a[152:155], v[28:31], v[72:75]
ds_read_b128 v[56:59], v247 offset:10240
ds_read_b128 v[168:171], v198 offset:0
ds_read_b128 v[172:175], v198 offset:256
v_mfma_f32_16x16x32_bf16 v[76:79], a[148:151], v[20:23], 0
ds_read_b128 v[104:107], v197 offset:0
ds_read_b128 v[108:111], v197 offset:2048
v_mfma_f32_16x16x32_bf16 v[76:79], a[156:159], v[28:31], v[76:79]
ds_read_b128 v[60:63], v247 offset:11264
ds_read_b128 v[112:115], v197 offset:4096
v_mfma_f32_16x16x32_bf16 v[64:67], a[160:163], v[32:35], v[64:67]
buffer_load_dwordx4 v4, s[8:11], s24 offen offset:2048 sc1 lds
v_mfma_f32_16x16x32_bf16 v[64:67], a[168:171], v[40:43], v[64:67]
ds_read_b128 v[16:19], v247 offset:12288
ds_read_b128 v[116:119], v197 offset:6144
v_lshlrev_b32 v80, 16, v152
v_mfma_f32_16x16x32_bf16 v[68:71], a[164:167], v[32:35], v[68:71]
v_and_b32 v81, 0xffff0000, v152
v_lshlrev_b32 v82, 16, v153
v_mfma_f32_16x16x32_bf16 v[68:71], a[172:175], v[40:43], v[68:71]
ds_read_b128 v[20:23], v247 offset:13312
v_and_b32 v83, 0xffff0000, v153
v_mfma_f32_16x16x32_bf16 v[72:75], a[160:163], v[36:39], v[72:75]
buffer_load_dwordx4 v4, s[8:11], s24 offen offset:3072 sc1 lds
v_mfma_f32_16x16x32_bf16 v[72:75], a[168:171], v[44:47], v[72:75]
s_add_u32 s24, s24, 4096
ds_read_b128 v[24:27], v247 offset:14336
v_lshlrev_b32 v84, 16, v154
v_and_b32 v85, 0xffff0000, v154
v_mfma_f32_16x16x32_bf16 v[76:79], a[164:167], v[36:39], v[76:79]
s_add_u32 m0, s25, 4096
v_lshlrev_b32 v86, 16, v155
v_and_b32 v87, 0xffff0000, v155
v_mfma_f32_16x16x32_bf16 v[76:79], a[172:175], v[44:47], v[76:79]
s_waitcnt lgkmcnt(5)
ds_read_b128 v[28:31], v247 offset:15360
v_lshlrev_b32 v92, 16, v156
v_mfma_f32_16x16x32_bf16 v[64:67], a[176:179], v[48:51], v[64:67]
buffer_load_dwordx4 v4, s[8:11], s24 offen offset:0 sc1 lds
v_mfma_f32_16x16x32_bf16 v[64:67], a[184:187], v[56:59], v[64:67]
ds_read_b128 v[32:35], v247 offset:16384
v_and_b32 v93, 0xffff0000, v156
v_lshlrev_b32 v94, 16, v157
v_mfma_f32_16x16x32_bf16 v[68:71], a[180:183], v[48:51], v[68:71]
buffer_load_dwordx4 v4, s[8:11], s24 offen offset:1024 sc1 lds
v_mfma_f32_16x16x32_bf16 v[68:71], a[188:191], v[56:59], v[68:71]
ds_read_b128 v[36:39], v247 offset:17408
v_and_b32 v95, 0xffff0000, v157
v_mfma_f32_16x16x32_bf16 v[72:75], a[176:179], v[52:55], v[72:75]
v_lshlrev_b32 v96, 16, v158
v_and_b32 v97, 0xffff0000, v158
v_mfma_f32_16x16x32_bf16 v[72:75], a[184:187], v[60:63], v[72:75]
ds_read_b128 v[40:43], v247 offset:18432
v_lshlrev_b32 v98, 16, v159
v_and_b32 v99, 0xffff0000, v159
v_mfma_f32_16x16x32_bf16 v[76:79], a[180:183], v[52:55], v[76:79]
buffer_load_dwordx4 v4, s[8:11], s24 offen offset:2048 sc1 lds
v_mfma_f32_16x16x32_bf16 v[76:79], a[188:191], v[60:63], v[76:79]
s_waitcnt lgkmcnt(3)
ds_read_b128 v[44:47], v247 offset:19456
v_lshlrev_b32 v88, 16, v160
v_mfma_f32_16x16x32_bf16 v[64:67], a[192:195], v[16:19], v[64:67]
v_and_b32 v89, 0xffff0000, v160
v_lshlrev_b32 v90, 16, v161
v_mfma_f32_16x16x32_bf16 v[64:67], a[200:203], v[24:27], v[64:67]
ds_read_b128 v[48:51], v247 offset:20480
v_and_b32 v91, 0xffff0000, v161
v_add_f32 v168, v168, v169
v_mfma_f32_16x16x32_bf16 v[68:71], a[196:199], v[16:19], v[68:71]
buffer_load_dwordx4 v4, s[8:11], s24 offen offset:3072 sc1 lds
v_mfma_f32_16x16x32_bf16 v[68:71], a[204:207], v[24:27], v[68:71]
s_add_u32 s24, s24, 4096
ds_read_b128 v[52:55], v247 offset:21504
v_add_f32 v170, v170, v171
v_mfma_f32_16x16x32_bf16 v[72:75], a[192:195], v[20:23], v[72:75]
s_add_u32 m0, s25, 8192
v_add_f32 v172, v172, v173
v_add_f32 v174, v174, v175
v_mfma_f32_16x16x32_bf16 v[72:75], a[200:203], v[28:31], v[72:75]
ds_read_b128 v[56:59], v247 offset:22528
v_add_f32 v168, v168, v170
v_mfma_f32_16x16x32_bf16 v[76:79], a[196:199], v[20:23], v[76:79]
buffer_load_dwordx4 v4, s[8:11], s24 offen offset:0 sc1 lds
v_add_f32 v172, v172, v174
v_mfma_f32_16x16x32_bf16 v[76:79], a[204:207], v[28:31], v[76:79]
s_waitcnt lgkmcnt(3)
ds_read_b128 v[60:63], v247 offset:23552
v_add_f32 v162, v162, v168
v_mfma_f32_16x16x32_bf16 v[64:67], a[208:211], v[32:35], v[64:67]
s_add_u32 s24, s24, 28672
s_add_u32 m0, s25, 36864
v_add_f32 v168, v168, v163
v_mfma_f32_16x16x32_bf16 v[64:67], a[0:3], v[40:43], v[64:67]
ds_read_b128 v[16:19], v247 offset:24576
v_add_f32 v164, v164, v172
v_mfma_f32_16x16x32_bf16 v[68:71], a[212:215], v[32:35], v[68:71]
buffer_load_dwordx4 v4, s[8:11], s24 offen offset:0 sc1 lds
v_add_f32 v172, v172, v165
v_mfma_f32_16x16x32_bf16 v[68:71], a[4:7], v[40:43], v[68:71]
ds_read_b128 v[20:23], v247 offset:25600
v_cndmask_b32 v169, v168, v172, s[52:53]
v_mfma_f32_16x16x32_bf16 v[72:75], a[208:211], v[36:39], v[72:75]
buffer_load_dwordx4 v4, s[8:11], s24 offen offset:1024 sc1 lds
v_mfma_f32_16x16x32_bf16 v[72:75], a[0:3], v[44:47], v[72:75]
ds_read_b128 v[24:27], v247 offset:26624
v_cndmask_b32 v170, v162, v164, s[50:51]
v_mfma_f32_16x16x32_bf16 v[76:79], a[212:215], v[36:39], v[76:79]
v_sub_f32 v88, v88, v169
v_sub_f32 v89, v89, v169
v_sub_f32 v90, v90, v169
v_mfma_f32_16x16x32_bf16 v[76:79], a[4:7], v[44:47], v[76:79]
s_waitcnt lgkmcnt(3)
ds_read_b128 v[28:31], v247 offset:27648
v_sub_f32 v91, v91, v169
v_mfma_f32_16x16x32_bf16 v[64:67], a[8:11], v[48:51], v[64:67]
buffer_load_dwordx4 v4, s[8:11], s24 offen offset:2048 sc1 lds
v_mfma_f32_16x16x32_bf16 v[64:67], a[16:19], v[56:59], v[64:67]
ds_read_b128 v[32:35], v247 offset:28672
v_add_f32 v88, v88, v104
v_mfma_f32_16x16x32_bf16 v[68:71], a[12:15], v[48:51], v[68:71]
buffer_load_dwordx4 v4, s[8:11], s24 offen offset:3072 sc1 lds
v_add_f32 v89, v89, v105
v_mfma_f32_16x16x32_bf16 v[68:71], a[20:23], v[56:59], v[68:71]
s_add_u32 s24, s24, 4096
ds_read_b128 v[36:39], v247 offset:29696
v_add_f32 v90, v90, v106
v_mfma_f32_16x16x32_bf16 v[72:75], a[8:11], v[52:55], v[72:75]
v_add_f32 v91, v91, v107
v_add_f32 v88, v88, v108
v_mfma_f32_16x16x32_bf16 v[72:75], a[16:19], v[60:63], v[72:75]
ds_read_b128 v[40:43], v247 offset:30720
v_add_f32 v89, v89, v109
v_mfma_f32_16x16x32_bf16 v[76:79], a[12:15], v[52:55], v[76:79]
s_add_u32 m0, s25, 40960
v_add_f32 v90, v90, v110
v_add_f32 v91, v91, v111
v_add_f32 v88, v88, v112
v_mfma_f32_16x16x32_bf16 v[76:79], a[20:23], v[60:63], v[76:79]
s_waitcnt lgkmcnt(3)
ds_read_b128 v[44:47], v247 offset:31744
v_add_f32 v89, v89, v113
v_mfma_f32_16x16x32_bf16 v[64:67], a[24:27], v[16:19], v[64:67]
buffer_load_dwordx4 v4, s[8:11], s24 offen offset:0 sc1 lds
v_mfma_f32_16x16x32_bf16 v[64:67], a[32:35], v[24:27], v[64:67]
ds_read_b128 v[48:51], v247 offset:32768
v_add_f32 v90, v90, v114
v_mfma_f32_16x16x32_bf16 v[68:71], a[28:31], v[16:19], v[68:71]
buffer_load_dwordx4 v4, s[8:11], s24 offen offset:1024 sc1 lds
v_mfma_f32_16x16x32_bf16 v[68:71], a[36:39], v[24:27], v[68:71]
ds_read_b128 v[52:55], v247 offset:33792
v_add_f32 v91, v91, v115
v_add_f32 v88, v88, v116
v_mfma_f32_16x16x32_bf16 v[72:75], a[24:27], v[20:23], v[72:75]
v_add_f32 v89, v89, v117
v_add_f32 v90, v90, v118
v_mfma_f32_16x16x32_bf16 v[72:75], a[32:35], v[28:31], v[72:75]
ds_read_b128 v[56:59], v247 offset:34816
v_add_f32 v91, v91, v119
v_mfma_f32_16x16x32_bf16 v[76:79], a[28:31], v[20:23], v[76:79]
buffer_load_dwordx4 v4, s[8:11], s24 offen offset:2048 sc1 lds
v_mfma_f32_16x16x32_bf16 v[76:79], a[36:39], v[28:31], v[76:79]
s_waitcnt lgkmcnt(3)
ds_read_b128 v[60:63], v247 offset:35840
v_cvt_pk_bf16_f32 v144, v88, v89
v_cvt_pk_bf16_f32 v145, v90, v91
v_mfma_f32_16x16x32_bf16 v[64:67], a[40:43], v[32:35], v[64:67]
buffer_store_dwordx2 v[144:145], v5, s[8:11], s30 offen sc1
v_mfma_f32_16x16x32_bf16 v[64:67], a[48:51], v[40:43], v[64:67]
buffer_load_dwordx4 v4, s[8:11], s24 offen offset:3072 sc1 lds
v_mfma_f32_16x16x32_bf16 v[68:71], a[44:47], v[32:35], v[68:71]
s_add_u32 s24, s24, 4096
v_mul_f32 v148, v88, v88
v_fmac_f32 v148, v89, v89
v_mfma_f32_16x16x32_bf16 v[68:71], a[52:55], v[40:43], v[68:71]
buffer_store_dword v170, v166, s[8:11], s32 offen sc1
v_mfma_f32_16x16x32_bf16 v[72:75], a[40:43], v[36:39], v[72:75]
s_add_u32 m0, s25, 45056
v_fmac_f32 v148, v90, v90
v_fmac_f32 v148, v91, v91
v_cndmask_b32 v149, 0, v148, s[52:53]
v_mfma_f32_16x16x32_bf16 v[72:75], a[48:51], v[44:47], v[72:75]
buffer_load_dwordx4 v4, s[8:11], s24 offen offset:0 sc1 lds
v_cndmask_b32 v148, 0, v148, s[40:41]
v_mfma_f32_16x16x32_bf16 v[76:79], a[44:47], v[36:39], v[76:79]
s_add_u32 s24, s24, 28672
v_sub_f32 v80, v80, v168
v_sub_f32 v81, v81, v168
v_sub_f32 v82, v82, v168
v_mfma_f32_16x16x32_bf16 v[76:79], a[52:55], v[44:47], v[76:79]
s_waitcnt lgkmcnt(0)
s_add_u32 m0, s25, 73728
v_sub_f32 v83, v83, v168
v_mfma_f32_16x16x32_bf16 v[64:67], a[56:59], v[48:51], v[64:67]
buffer_load_dwordx4 v4, s[8:11], s24 offen offset:0 sc1 lds
v_mfma_f32_16x16x32_bf16 v[64:67], a[64:67], v[56:59], v[64:67]
v_sub_f32 v84, v84, v168
v_sub_f32 v85, v85, v168
v_mfma_f32_16x16x32_bf16 v[68:71], a[60:63], v[48:51], v[68:71]
v_sub_f32 v86, v86, v168
v_sub_f32 v87, v87, v168
v_mfma_f32_16x16x32_bf16 v[68:71], a[68:71], v[56:59], v[68:71]
v_sub_f32 v92, v92, v172
v_sub_f32 v93, v93, v172
v_mfma_f32_16x16x32_bf16 v[72:75], a[56:59], v[52:55], v[72:75]
buffer_load_dwordx4 v4, s[8:11], s24 offen offset:1024 sc1 lds
v_mfma_f32_16x16x32_bf16 v[72:75], a[64:67], v[60:63], v[72:75]
v_sub_f32 v94, v94, v172
v_sub_f32 v95, v95, v172
v_mfma_f32_16x16x32_bf16 v[76:79], a[60:63], v[52:55], v[76:79]
v_sub_f32 v96, v96, v172
v_sub_f32 v97, v97, v172
v_mfma_f32_16x16x32_bf16 v[76:79], a[68:71], v[60:63], v[76:79]
v_sub_f32 v98, v98, v172
v_sub_f32 v99, v99, v172
v_pk_add_f32 v[80:81], v[80:81], v[64:65]
v_pk_add_f32 v[82:83], v[82:83], v[66:67]
v_pk_add_f32 v[84:85], v[84:85], v[68:69]
v_pk_add_f32 v[86:87], v[86:87], v[70:71]
v_cvt_pk_bf16_f32 v136, v80, v81
v_cvt_pk_bf16_f32 v137, v82, v83
v_cvt_pk_bf16_f32 v138, v84, v85
v_cvt_pk_bf16_f32 v139, v86, v87
buffer_store_dwordx4 v[136:139], v4, s[8:11], s26 offen sc1
v_pk_add_f32 v[92:93], v[92:93], v[72:73]
v_pk_add_f32 v[94:95], v[94:95], v[74:75]
v_pk_add_f32 v[96:97], v[96:97], v[76:77]
v_pk_add_f32 v[98:99], v[98:99], v[78:79]
v_cvt_pk_bf16_f32 v140, v92, v93
v_cvt_pk_bf16_f32 v141, v94, v95
v_cvt_pk_bf16_f32 v142, v96, v97
v_cvt_pk_bf16_f32 v143, v98, v99
buffer_store_dwordx4 v[140:143], v4, s[8:11], s27 offen sc1
v_pk_mul_f32 v[64:65], v[80:81], v[80:81]
v_pk_mul_f32 v[66:67], v[92:93], v[92:93]
v_pk_fma_f32 v[64:65], v[82:83], v[82:83], v[64:65]
v_pk_fma_f32 v[66:67], v[94:95], v[94:95], v[66:67]
v_pk_fma_f32 v[64:65], v[84:85], v[84:85], v[64:65]
v_pk_fma_f32 v[66:67], v[96:97], v[96:97], v[66:67]
v_pk_fma_f32 v[64:65], v[86:87], v[86:87], v[64:65]
v_pk_fma_f32 v[66:67], v[98:99], v[98:99], v[66:67]
v_add_f32 v148, v148, v64
v_add_f32 v149, v149, v66
v_add_f32 v148, v148, v65
v_add_f32 v149, v149, v67
s_nop 1
v_permlane16_swap_b32 v148, v149
v_add_f32 v148, v148, v149
v_mov_b32 v149, v148
s_nop 1
v_permlane32_swap_b32 v148, v149
v_add_f32 v148, v148, v149
buffer_store_dword v148, v199, s[8:11], s31 offen sc1
Lffn:
s_and_b32 s18, s14, 3
s_and_b32 s16, s14, 4
s_lshr_b32 s19, s15, 3
s_add_u32 s16, s16, s19
s_and_b32 s17, s15, 7
s_lshl_b32 s19, s16, 2
s_add_u32 s19, s19, s3
s_mul_i32 s22, s19, 73728
s_add_u32 s22, s22, s12
s_add_u32 s22, s22, 2359296
s_add_u32 s21, s22, 18432
s_mov_b32 s20, 0
s_add_u32 s20, s20, s22
v_add_u32 v223, 18432, v4
v_add_u32 v5, 0, v4
v_add_u32 v6, 36864, v4
v_add_u32 v7, 73728, v4
v_add_u32 v8, 110592, v4
v_and_b32 v9, 1, v3
v_mul_u32_u24 v9, 147456, v9
v_lshrrev_b32 v10, 1, v3
v_lshl_add_u32 v9, v10, 8, v9
v_lshl_add_u32 v9, v2, 4, v9
s_mul_i32 s26, s19, 589824
s_mul_i32 s27, s18, 36864
s_add_u32 s26, s26, s27
s_lshl_b32 s27, s17, 9
s_add_u32 s26, s26, s27
s_add_u32 s26, s26, s12
s_add_u32 s26, s26, 17825792
s_add_u32 s27, s26, 294912
v_lshlrev_b32 v10, 15, v3
v_lshl_add_u32 v10, v2, 3, v10
s_lshl_b32 s28, s19, 8
s_add_u32 s28, s28, s12
s_add_u32 s28, s28, 7438336
s_lshl_b32 s30, s13, 21
s_add_u32 s30, s30, 0x6040000
s_lshl_b32 s31, s19, 12
s_add_u32 s30, s30, s31
s_lshl_b32 s31, s18, 3
s_add_u32 s31, s31, s17
s_lshl_b32 s31, s31, 7
s_add_u32 s30, s30, s31
v_and_b32 v16, 31, v1
v_lshlrev_b32 v16, 7, v16
s_lshl_b32 s38, s16, 2
s_add_u32 s38, s38, s18
s_lshl_b32 s38, s38, 12
s_lshl_b32 s40, s13, 21
s_add_u32 s40, s40, 0x6060000
s_add_u32 s40, s40, s38
s_lshr_b32 s38, s17, 2
s_lshl_b32 s38, s38, 1
s_lshr_b32 s39, s3, 1
s_add_u32 s38, s38, s39
s_lshl_b32 s38, s38, 7
s_add_u32 s41, s40, s38
s_lshl_b32 s38, s17, 2
s_add_u32 s38, s38, s3
s_lshl_b32 s38, s38, 7
s_add_u32 s40, s40, s38
s_and_b32 s42, s17, 3
s_lshl_b32 s38, s18, 2
s_add_u32 s38, s38, s42
s_mul_i32 s44, s38, 331776
s_add_u32 s44, s44, s25
s_add_u32 s44, s44, 14680064
s_lshl_b32 s43, s16, 3
s_and_b32 s39, s17, 4
s_add_u32 s43, s43, s39
s_add_u32 s43, s43, s3
s_lshl_b32 s51, s13, 21
s_add_u32 s51, s51, 0x60c0000
s_lshl_b32 s38, s43, 2
s_add_u32 s38, s38, s42
s_lshl_b32 s38, s38, 9
s_add_u32 s51, s51, s38
s_mul_i32 s46, s43, 294912
s_mul_i32 s47, s18, 36864
s_add_u32 s46, s46, s47
s_add_u32 s46, s46, s12
s_add_u32 s46, s46, 17825792
s_add_u32 s47, s46, 147456
s_mul_i32 s48, s43, 36864
s_mul_i32 s49, s18, 2359296
s_add_u32 s48, s48, s49
s_add_u32 s48, s48, s12
s_add_u32 s48, s48, 7602176
s_lshl_b32 s49, s42, 9
s_add_u32 s50, s48, s49
s_add_u32 s50, s50, 16384
s_lshl_b32 s49, s42, 12
s_add_u32 s48, s48, s49
s_add_u32 s49, s48, 18432
s_mul_i32 s45, s7, 129024
s_add_u32 s45, s45, s25
s_getpc_b64 s[80:81]
Lcp:
s_lshl_b32 s82, s15, 2
s_add_u32 s82, s82, s3
s_lshl_b32 s82, s82, 7
s_waitcnt vmcnt(0)
s_barrier
s_mov_b64 exec, 0xff
buffer_store_dword v12, v16, s[8:11], s29 offen sc1
s_mov_b64 exec, -1
buffer_load_dwordx4 v4, s[8:11], s24 offen offset:2048 sc1 lds
buffer_load_dwordx4 v4, s[8:11], s24 offen offset:3072 sc1 lds
s_add_u32 s24, s24, 4096
s_add_u32 m0, s25, 77824
s_nop 0
buffer_load_dwordx4 v4, s[8:11], s24 offen offset:0 sc1 lds
buffer_load_dwordx4 v4, s[8:11], s24 offen offset:1024 sc1 lds
buffer_load_dwordx4 v4, s[8:11], s24 offen offset:2048 sc1 lds
buffer_load_dwordx4 v4, s[8:11], s24 offen offset:3072 sc1 lds
s_add_u32 s24, s24, 4096
s_add_u32 m0, s25, 81920
s_nop 0
buffer_load_dwordx4 v4, s[8:11], s24 offen offset:0 sc1 lds
s_add_u32 s24, s24, 28672
s_mov_b32 s55, 0x62e0000
s_lshl_b32 s54, s2, 7
s_add_u32 s54, s54, s55
s_lshl_b32 s38, s3, 13
s_add_u32 s55, s55, s38
v_mov_b32 v212, v14
v_mov_b32 v213, v14
v_mov_b32 v214, v14
v_mov_b32 v215, v14
v_mov_b32 v216, v14
v_mov_b32 v217, v14
v_mov_b32 v218, v14
v_mov_b32 v219, v14
s_lshl_b32 s38, s3, 12
s_add_u32 s38, s38, 147456
v_add_u32 v220, s38, v4
s_cmp_lt_u32 s61, 936
s_cselect_b32 s38, s13, 1
s_cmp_eq_u32 s38, 0
s_cbranch_scc0 Lbp_e
v_accvgpr_read_b32 v28, a80
v_accvgpr_read_b32 v29, a81
v_accvgpr_read_b32 v30, a82
v_accvgpr_read_b32 v31, a83
v_accvgpr_read_b32 v32, a84
v_accvgpr_read_b32 v33, a85
v_accvgpr_read_b32 v34, a86
v_accvgpr_read_b32 v35, a87
v_accvgpr_read_b32 v36, a88
v_accvgpr_read_b32 v37, a89
v_accvgpr_read_b32 v38, a90
v_accvgpr_read_b32 v39, a91
v_accvgpr_read_b32 v40, a92
v_accvgpr_read_b32 v41, a93
v_accvgpr_read_b32 v42, a94
v_accvgpr_read_b32 v43, a95
v_accvgpr_read_b32 v44, a96
v_accvgpr_read_b32 v45, a97
v_accvgpr_read_b32 v46, a98
v_accvgpr_read_b32 v47, a99
v_accvgpr_read_b32 v48, a100
v_accvgpr_read_b32 v49, a101
v_accvgpr_read_b32 v50, a102
v_accvgpr_read_b32 v51, a103
v_accvgpr_read_b32 v52, a104
v_accvgpr_read_b32 v53, a105
v_accvgpr_read_b32 v54, a106
v_accvgpr_read_b32 v55, a107
v_accvgpr_read_b32 v56, a108
v_accvgpr_read_b32 v57, a109
v_accvgpr_read_b32 v58, a110
v_accvgpr_read_b32 v59, a111
v_perm_b32 v196, v32, v28, s62
v_perm_b32 v197, v40, v36, s62
v_perm_b32 v198, v48, v44, s62
v_perm_b32 v199, v56, v52, s62
v_perm_b32 v200, v32, v28, s63
v_perm_b32 v201, v40, v36, s63
v_perm_b32 v202, v48, v44, s63
v_perm_b32 v203, v56, v52, s63
v_perm_b32 v204, v33, v29, s62
v_perm_b32 v205, v41, v37, s62
v_perm_b32 v206, v49, v45, s62
v_perm_b32 v207, v57, v53, s62
v_perm_b32 v208, v33, v29, s63
v_perm_b32 v209, v41, v37, s63
v_perm_b32 v210, v49, v45, s63
v_perm_b32 v211, v57, v53, s63
v_perm_b32 v92, v34, v30, s62
v_perm_b32 v93, v42, v38, s62
v_perm_b32 v94, v50, v46, s62
v_perm_b32 v95, v58, v54, s62
ds_write_b128 v220, v[92:95] offset:0
v_perm_b32 v96, v34, v30, s63
v_perm_b32 v97, v42, v38, s63
v_perm_b32 v98, v50, v46, s63
v_perm_b32 v99, v58, v54, s63
ds_write_b128 v220, v[96:99] offset:1024
v_perm_b32 v100, v35, v31, s62
v_perm_b32 v101, v43, v39, s62
v_perm_b32 v102, v51, v47, s62
v_perm_b32 v103, v59, v55, s62
ds_write_b128 v220, v[100:103] offset:2048
v_perm_b32 v104, v35, v31, s63
v_perm_b32 v105, v43, v39, s63
v_perm_b32 v106, v51, v47, s63
v_perm_b32 v107, v59, v55, s63
ds_write_b128 v220, v[104:107] offset:3072
v_and_b32 v28, 7, v1
v_lshrrev_b32 v29, 3, v1
s_cmp_lt_u32 s61, 648
s_cbranch_scc1 Lbp_d
s_sub_u32 s38, s61, 648
s_lshr_b32 s39, s38, 4
s_and_b32 s52, s38, 7
s_bfe_u32 s53, s38, 0x10003
s_mul_i32 s52, s52, 1327104
s_mul_i32 s53, s53, 36864
s_add_u32 s52, s52, s53
s_and_b32 s53, s39, 1
s_lshl_b32 s53, s53, 11
s_add_u32 s52, s52, s53
s_add_u32 s52, s52, 3403776
s_lshr_b32 s39, s39, 1
s_and_b32 s53, s38, 1
s_lshl_b32 s53, s53, 2
s_mov_b32 s90, s39
s_lshl_b32 s90, s90, 12
s_add_u32 s90, s90, s52
s_mov_b32 s91, s39
s_lshl_b32 s91, s91, 12
s_add_u32 s91, s91, s52
s_add_u32 s91, s91, 331776
s_mov_b32 s92, s39
s_lshl_b32 s92, s92, 12
s_add_u32 s92, s92, s52
s_add_u32 s92, s92, 663552
s_mov_b32 s93, s39
s_lshl_b32 s93, s93, 12
s_add_u32 s93, s93, s52
s_add_u32 s93, s93, 995328
v_lshlrev_b32 v30, 8, v29
v_lshl_add_u32 v30, v28, 4, v30
v_add_u32 v34, 128, v30
v_add_u32 v212, s90, v30
v_add_u32 v213, s90, v34
v_add_u32 v214, s91, v30
v_add_u32 v215, s91, v34
v_add_u32 v216, s92, v30
v_add_u32 v217, s92, v34
v_add_u32 v218, s93, v30
v_add_u32 v219, s93, v34
s_branch Lbp_e
Lbp_d:
s_mul_i32 s38, s61, 116509
s_lshr_b32 s38, s38, 20
s_mul_i32 s39, s38, 9
s_sub_u32 s39, s61, s39
s_lshr_b32 s52, s38, 3
s_and_b32 s53, s38, 1
s_lshl_b32 s90, s52, 1
s_add_u32 s90, s90, s53
s_mul_i32 s91, s90, 18432
s_lshl_b32 s90, s90, 11
s_add_u32 s90, s90, 208896
s_cmp_lt_u32 s52, 6
s_cselect_b32 s52, s91, s90
s_cselect_b32 s90, 1, 6
s_lshl_b32 s90, s90, 11
s_bfe_u32 s53, s38, 0x20001
s_sub_u32 s92, 3, s53
s_mul_i32 s53, s53, 1327104
s_add_u32 s52, s52, s53
s_add_u32 s52, s52, 14680064
v_lshrrev_b32 v30, 2, v29
v_lshlrev_b32 v30, 10, v30
v_and_b32 v31, 3, v29
s_cmp_eq_u32 s39, 8
s_cbranch_scc1 Lbp_8
s_lshr_b32 s53, s39, 1
s_mul_i32 s53, s53, 331776
s_add_u32 s52, s52, s53
s_and_b32 s53, s39, 1
s_lshl_b32 s53, s53, 1
s_add_u32 s92, s92, s53
v_lshrrev_b32 v32, 2, v28
v_add_u32 v32, s92, v32
v_and_b32 v32, 3, v32
v_lshlrev_b32 v32, 1, v32
v_mad_u32_u24 v30, v32, s90, v30
v_add_u32 v30, s52, v30
v_and_b32 v32, 3, v28
v_lshl_add_u32 v32, v31, 2, v32
v_add_u32 v33, 0, v32
v_and_b32 v33, 15, v33
v_lshl_add_u32 v33, v33, 4, v30
v_add_u32 v212, 0, v33
v_add_u32 v216, s90, v212
v_add_u32 v33, 4, v32
v_and_b32 v33, 15, v33
v_lshl_add_u32 v33, v33, 4, v30
v_add_u32 v213, 256, v33
v_add_u32 v217, s90, v213
v_add_u32 v33, 8, v32
v_and_b32 v33, 15, v33
v_lshl_add_u32 v33, v33, 4, v30
v_add_u32 v214, 512, v33
v_add_u32 v218, s90, v214
v_add_u32 v33, 12, v32
v_and_b32 v33, 15, v33
v_lshl_add_u32 v33, v33, 4, v30
v_add_u32 v215, 768, v33
v_add_u32 v219, s90, v215
s_branch Lbp_e
Lbp_8:
s_cmp_eq_u32 s90, 2048
s_mov_b32 s91, 16384
s_cselect_b32 s91, s91, -12288
s_add_u32 s52, s52, s91
v_lshrrev_b32 v32, 1, v28
v_mul_u32_u24 v32, 331776, v32
v_add3_u32 v30, v30, v32, s52
v_and_b32 v32, 1, v28
v_lshl_add_u32 v32, v31, 1, v32
v_xor_b32 v33, 4, v32
v_lshl_add_u32 v32, v32, 4, v30
v_lshl_add_u32 v33, v33, 4, v30
v_add_u32 v212, 0, v32
v_add_u32 v213, 128, v32
v_add_u32 v214, 256, v33
v_add_u32 v215, 384, v33
v_add_u32 v216, 512, v32
v_add_u32 v217, 640, v32
v_add_u32 v218, 768, v33
v_add_u32 v219, 896, v33
Lbp_e:
v_mov_b32 v17, v12
s_mov_b64 exec, 0xff
v_mov_b32 v17, 0
buffer_atomic_or v17, v13, s[8:11], s30 offen sc0
s_mov_b64 exec, -1
s_waitcnt vmcnt(0)
v_cmp_ne_u32 vcc, v12, v17
s_nop 1
s_cbranch_vccnz Lsp4
Lok4:
buffer_load_dwordx4 a[0:3], v4, s[8:11], s20 offen offset:0 sc1
buffer_load_dwordx4 a[16:19], v4, s[8:11], s20 offen offset:1024 sc1
buffer_load_dwordx4 a[4:7], v223, s[8:11], s20 offen offset:0 sc1
buffer_load_dwordx4 a[20:23], v223, s[8:11], s20 offen offset:1024 sc1
s_barrier
ds_read_b128 v[148:151], v5 offset:0
ds_read_b128 v[152:155], v5 offset:1024
ds_read_b128 v[156:159], v5 offset:2048
ds_read_b128 v[160:163], v5 offset:3072
ds_read_b128 v[164:167], v6 offset:0
ds_read_b128 v[168:171], v6 offset:1024
ds_read_b128 v[172:175], v6 offset:2048
ds_read_b128 v[176:179], v6 offset:3072
buffer_load_dwordx4 a[32:35], v4, s[8:11], s20 offen offset:2048 sc1
buffer_load_dwordx4 a[48:51], v4, s[8:11], s20 offen offset:3072 sc1
buffer_load_dwordx4 a[36:39], v223, s[8:11], s20 offen offset:2048 sc1
buffer_load_dwordx4 a[52:55], v223, s[8:11], s20 offen offset:3072 sc1
s_add_u32 s20, s20, 4096
s_waitcnt vmcnt(4) lgkmcnt(4)
v_mfma_f32_16x16x32_bf16 v[28:31], v[148:151], a[0:3], 0
ds_read_b128 v[180:183], v7 offset:0
v_mfma_f32_16x16x32_bf16 v[28:31], v[152:155], a[16:19], v[28:31]
buffer_load_dwordx4 a[64:67], v4, s[8:11], s20 offen offset:0 sc1
v_mfma_f32_16x16x32_bf16 v[32:35], v[152:155], a[20:23], 0
ds_read_b128 v[184:187], v7 offset:1024
v_mfma_f32_16x16x32_bf16 v[32:35], v[148:151], a[4:7], v[32:35]
v_mfma_f32_16x16x32_bf16 v[40:43], v[156:159], a[4:7], 0
ds_read_b128 v[188:191], v7 offset:2048
v_mfma_f32_16x16x32_bf16 v[40:43], v[160:163], a[20:23], v[40:43]
buffer_load_dwordx4 a[80:83], v4, s[8:11], s20 offen offset:1024 sc1
v_mfma_f32_16x16x32_bf16 v[36:39], v[160:163], a[16:19], 0
ds_read_b128 v[192:195], v7 offset:3072
v_mfma_f32_16x16x32_bf16 v[36:39], v[156:159], a[0:3], v[36:39]
s_waitcnt lgkmcnt(4)
v_mfma_f32_16x16x32_bf16 v[44:47], v[164:167], a[0:3], 0
ds_read_b128 v[148:151], v5 offset:4096
v_mfma_f32_16x16x32_bf16 v[44:47], v[168:171], a[16:19], v[44:47]
v_mfma_f32_16x16x32_bf16 v[48:51], v[168:171], a[20:23], 0
ds_read_b128 v[152:155], v5 offset:5120
v_mfma_f32_16x16x32_bf16 v[48:51], v[164:167], a[4:7], v[48:51]
buffer_load_dwordx4 a[68:71], v223, s[8:11], s20 offen offset:0 sc1
v_mfma_f32_16x16x32_bf16 v[56:59], v[172:175], a[4:7], 0
ds_read_b128 v[156:159], v5 offset:6144
v_mfma_f32_16x16x32_bf16 v[56:59], v[176:179], a[20:23], v[56:59]
v_mfma_f32_16x16x32_bf16 v[52:55], v[176:179], a[16:19], 0
ds_read_b128 v[160:163], v5 offset:7168
v_mfma_f32_16x16x32_bf16 v[52:55], v[172:175], a[0:3], v[52:55]
s_waitcnt lgkmcnt(4)
v_mfma_f32_16x16x32_bf16 v[60:63], v[180:183], a[0:3], 0
ds_read_b128 v[164:167], v6 offset:4096
v_mfma_f32_16x16x32_bf16 v[60:63], v[184:187], a[16:19], v[60:63]
buffer_load_dwordx4 a[84:87], v223, s[8:11], s20 offen offset:1024 sc1
v_mfma_f32_16x16x32_bf16 v[64:67], v[184:187], a[20:23], 0
ds_read_b128 v[168:171], v6 offset:5120
v_mfma_f32_16x16x32_bf16 v[64:67], v[180:183], a[4:7], v[64:67]
v_mfma_f32_16x16x32_bf16 v[72:75], v[188:191], a[4:7], 0
ds_read_b128 v[172:175], v6 offset:6144
v_mfma_f32_16x16x32_bf16 v[72:75], v[192:195], a[20:23], v[72:75]
v_mfma_f32_16x16x32_bf16 v[68:71], v[192:195], a[16:19], 0
ds_read_b128 v[176:179], v6 offset:7168
v_mfma_f32_16x16x32_bf16 v[68:71], v[188:191], a[0:3], v[68:71]
s_waitcnt vmcnt(4) lgkmcnt(4)
buffer_load_dwordx4 a[96:99], v4, s[8:11], s20 offen offset:2048 sc1
v_mfma_f32_16x16x32_bf16 v[28:31], v[148:151], a[32:35], v[28:31]
ds_read_b128 v[180:183], v7 offset:4096
v_mfma_f32_16x16x32_bf16 v[28:31], v[152:155], a[48:51], v[28:31]
v_mfma_f32_16x16x32_bf16 v[32:35], v[152:155], a[52:55], v[32:35]
ds_read_b128 v[184:187], v7 offset:5120
v_mfma_f32_16x16x32_bf16 v[32:35], v[148:151], a[36:39], v[32:35]
buffer_load_dwordx4 a[112:115], v4, s[8:11], s20 offen offset:3072 sc1
v_mfma_f32_16x16x32_bf16 v[40:43], v[156:159], a[36:39], v[40:43]
ds_read_b128 v[188:191], v7 offset:6144
v_mfma_f32_16x16x32_bf16 v[40:43], v[160:163], a[52:55], v[40:43]
v_mfma_f32_16x16x32_bf16 v[36:39], v[160:163], a[48:51], v[36:39]
ds_read_b128 v[192:195], v7 offset:7168
v_mfma_f32_16x16x32_bf16 v[36:39], v[156:159], a[32:35], v[36:39]
s_waitcnt lgkmcnt(4)
buffer_load_dwordx2 v[124:125], v10, s[8:11], s28 offen offset:0 sc1
v_mfma_f32_16x16x32_bf16 v[44:47], v[164:167], a[32:35], v[44:47]
ds_read_b128 v[148:151], v5 offset:8192
v_mfma_f32_16x16x32_bf16 v[44:47], v[168:171], a[48:51], v[44:47]
buffer_load_dwordx4 a[100:103], v223, s[8:11], s20 offen offset:2048 sc1
v_mfma_f32_16x16x32_bf16 v[48:51], v[168:171], a[52:55], v[48:51]
ds_read_b128 v[152:155], v5 offset:9216
v_mfma_f32_16x16x32_bf16 v[48:51], v[164:167], a[36:39], v[48:51]
v_mfma_f32_16x16x32_bf16 v[56:59], v[172:175], a[36:39], v[56:59]
ds_read_b128 v[156:159], v5 offset:10240
v_mfma_f32_16x16x32_bf16 v[56:59], v[176:179], a[52:55], v[56:59]
v_mfma_f32_16x16x32_bf16 v[52:55], v[176:179], a[48:51], v[52:55]
ds_read_b128 v[160:163], v5 offset:11264
buffer_load_dwordx2 v[126:127], v10, s[8:11], s28 offen offset:128 sc1
v_mfma_f32_16x16x32_bf16 v[52:55], v[172:175], a[32:35], v[52:55]
s_waitcnt lgkmcnt(4)
buffer_load_dwordx4 a[116:119], v223, s[8:11], s20 offen offset:3072 sc1
v_mfma_f32_16x16x32_bf16 v[60:63], v[180:183], a[32:35], v[60:63]
s_add_u32 s20, s20, 4096
s_add_u32 s28, s28, 8192
ds_read_b128 v[164:167], v6 offset:8192
v_mfma_f32_16x16x32_bf16 v[60:63], v[184:187], a[48:51], v[60:63]
v_mfma_f32_16x16x32_bf16 v[64:67], v[184:187], a[52:55], v[64:67]
ds_read_b128 v[168:171], v6 offset:9216
v_mfma_f32_16x16x32_bf16 v[64:67], v[180:183], a[36:39], v[64:67]
v_mfma_f32_16x16x32_bf16 v[72:75], v[188:191], a[36:39], v[72:75]
ds_read_b128 v[172:175], v6 offset:10240
v_mfma_f32_16x16x32_bf16 v[72:75], v[192:195], a[52:55], v[72:75]
buffer_load_dwordx4 a[128:131], v4, s[8:11], s20 offen offset:0 sc1
v_mfma_f32_16x16x32_bf16 v[68:71], v[192:195], a[48:51], v[68:71]
ds_read_b128 v[176:179], v6 offset:11264
v_mfma_f32_16x16x32_bf16 v[68:71], v[188:191], a[32:35], v[68:71]
s_waitcnt vmcnt(7) lgkmcnt(4)
buffer_load_dwordx2 v[128:129], v10, s[8:11], s28 offen offset:0 sc1
v_mfma_f32_16x16x32_bf16 v[28:31], v[148:151], a[64:67], v[28:31]
ds_read_b128 v[180:183], v7 offset:8192
v_mfma_f32_16x16x32_bf16 v[28:31], v[152:155], a[80:83], v[28:31]
buffer_load_dwordx4 a[144:147], v4, s[8:11], s20 offen offset:1024 sc1
v_mfma_f32_16x16x32_bf16 v[32:35], v[152:155], a[84:87], v[32:35]
ds_read_b128 v[184:187], v7 offset:9216
v_mfma_f32_16x16x32_bf16 v[32:35], v[148:151], a[68:71], v[32:35]
v_mfma_f32_16x16x32_bf16 v[40:43], v[156:159], a[68:71], v[40:43]
ds_read_b128 v[188:191], v7 offset:10240
v_mfma_f32_16x16x32_bf16 v[40:43], v[160:163], a[84:87], v[40:43]
v_mfma_f32_16x16x32_bf16 v[36:39], v[160:163], a[80:83], v[36:39]
ds_read_b128 v[192:195], v7 offset:11264
buffer_load_dwordx2 v[130:131], v10, s[8:11], s28 offen offset:128 sc1
v_mfma_f32_16x16x32_bf16 v[36:39], v[156:159], a[64:67], v[36:39]
s_waitcnt lgkmcnt(4)
buffer_load_dwordx4 a[132:135], v223, s[8:11], s20 offen offset:0 sc1
v_mfma_f32_16x16x32_bf16 v[44:47], v[164:167], a[64:67], v[44:47]
s_add_u32 s28, s28, 8192
ds_read_b128 v[148:151], v5 offset:12288
v_mfma_f32_16x16x32_bf16 v[44:47], v[168:171], a[80:83], v[44:47]
v_mfma_f32_16x16x32_bf16 v[48:51], v[168:171], a[84:87], v[48:51]
ds_read_b128 v[152:155], v5 offset:13312
v_mfma_f32_16x16x32_bf16 v[48:51], v[164:167], a[68:71], v[48:51]
v_mfma_f32_16x16x32_bf16 v[56:59], v[172:175], a[68:71], v[56:59]
ds_read_b128 v[156:159], v5 offset:14336
v_mfma_f32_16x16x32_bf16 v[56:59], v[176:179], a[84:87], v[56:59]
buffer_load_dwordx4 a[148:151], v223, s[8:11], s20 offen offset:1024 sc1
v_mfma_f32_16x16x32_bf16 v[52:55], v[176:179], a[80:83], v[52:55]
ds_read_b128 v[160:163], v5 offset:15360
v_mfma_f32_16x16x32_bf16 v[52:55], v[172:175], a[64:67], v[52:55]
s_waitcnt lgkmcnt(4)
buffer_load_dwordx2 v[132:133], v10, s[8:11], s28 offen offset:0 sc1
v_mfma_f32_16x16x32_bf16 v[60:63], v[180:183], a[64:67], v[60:63]
ds_read_b128 v[164:167], v6 offset:12288
v_mfma_f32_16x16x32_bf16 v[60:63], v[184:187], a[80:83], v[60:63]
v_mfma_f32_16x16x32_bf16 v[64:67], v[184:187], a[84:87], v[64:67]
ds_read_b128 v[168:171], v6 offset:13312
v_mfma_f32_16x16x32_bf16 v[64:67], v[180:183], a[68:71], v[64:67]
buffer_load_dwordx4 a[160:163], v4, s[8:11], s20 offen offset:2048 sc1
v_mfma_f32_16x16x32_bf16 v[72:75], v[188:191], a[68:71], v[72:75]
ds_read_b128 v[172:175], v6 offset:14336
v_mfma_f32_16x16x32_bf16 v[72:75], v[192:195], a[84:87], v[72:75]
v_mfma_f32_16x16x32_bf16 v[68:71], v[192:195], a[80:83], v[68:71]
ds_read_b128 v[176:179], v6 offset:15360
v_mfma_f32_16x16x32_bf16 v[68:71], v[188:191], a[64:67], v[68:71]
s_waitcnt vmcnt(8) lgkmcnt(4)
buffer_load_dwordx2 v[134:135], v10, s[8:11], s28 offen offset:128 sc1
v_mfma_f32_16x16x32_bf16 v[28:31], v[148:151], a[96:99], v[28:31]
s_add_u32 s28, s28, 8192
ds_read_b128 v[180:183], v7 offset:12288
v_mfma_f32_16x16x32_bf16 v[28:31], v[152:155], a[112:115], v[28:31]
buffer_load_dwordx4 a[176:179], v4, s[8:11], s20 offen offset:3072 sc1
v_mfma_f32_16x16x32_bf16 v[32:35], v[152:155], a[116:119], v[32:35]
ds_read_b128 v[184:187], v7 offset:13312
v_mfma_f32_16x16x32_bf16 v[32:35], v[148:151], a[100:103], v[32:35]
v_mfma_f32_16x16x32_bf16 v[40:43], v[156:159], a[100:103], v[40:43]
ds_read_b128 v[188:191], v7 offset:14336
v_mfma_f32_16x16x32_bf16 v[40:43], v[160:163], a[116:119], v[40:43]
buffer_load_dwordx4 a[164:167], v223, s[8:11], s20 offen offset:2048 sc1
v_mfma_f32_16x16x32_bf16 v[36:39], v[160:163], a[112:115], v[36:39]
ds_read_b128 v[192:195], v7 offset:15360
v_mfma_f32_16x16x32_bf16 v[36:39], v[156:159], a[96:99], v[36:39]
s_waitcnt lgkmcnt(4)
buffer_load_dwordx2 v[136:137], v10, s[8:11], s28 offen offset:0 sc1
v_mfma_f32_16x16x32_bf16 v[44:47], v[164:167], a[96:99], v[44:47]
ds_read_b128 v[148:151], v5 offset:16384
v_mfma_f32_16x16x32_bf16 v[44:47], v[168:171], a[112:115], v[44:47]
v_mfma_f32_16x16x32_bf16 v[48:51], v[168:171], a[116:119], v[48:51]
ds_read_b128 v[152:155], v5 offset:17408
v_mfma_f32_16x16x32_bf16 v[48:51], v[164:167], a[100:103], v[48:51]
buffer_load_dwordx4 a[180:183], v223, s[8:11], s20 offen offset:3072 sc1
v_mfma_f32_16x16x32_bf16 v[56:59], v[172:175], a[100:103], v[56:59]
s_add_u32 s20, s20, 4096
ds_read_b128 v[156:159], v5 offset:18432
v_mfma_f32_16x16x32_bf16 v[56:59], v[176:179], a[116:119], v[56:59]
v_mfma_f32_16x16x32_bf16 v[52:55], v[176:179], a[112:115], v[52:55]
ds_read_b128 v[160:163], v5 offset:19456
v_mfma_f32_16x16x32_bf16 v[52:55], v[172:175], a[96:99], v[52:55]
s_waitcnt lgkmcnt(4)
buffer_load_dwordx2 v[138:139], v10, s[8:11], s28 offen offset:128 sc1
v_mfma_f32_16x16x32_bf16 v[60:63], v[180:183], a[96:99], v[60:63]
s_add_u32 s28, s28, 8192
ds_read_b128 v[164:167], v6 offset:16384
v_mfma_f32_16x16x32_bf16 v[60:63], v[184:187], a[112:115], v[60:63]
buffer_load_dwordx4 a[192:195], v4, s[8:11], s20 offen offset:0 sc1
v_mfma_f32_16x16x32_bf16 v[64:67], v[184:187], a[116:119], v[64:67]
ds_read_b128 v[168:171], v6 offset:17408
v_mfma_f32_16x16x32_bf16 v[64:67], v[180:183], a[100:103], v[64:67]
v_mfma_f32_16x16x32_bf16 v[72:75], v[188:191], a[100:103], v[72:75]
ds_read_b128 v[172:175], v6 offset:18432
v_mfma_f32_16x16x32_bf16 v[72:75], v[192:195], a[116:119], v[72:75]
v_mfma_f32_16x16x32_bf16 v[68:71], v[192:195], a[112:115], v[68:71]
ds_read_b128 v[176:179], v6 offset:19456
v_mfma_f32_16x16x32_bf16 v[68:71], v[188:191], a[96:99], v[68:71]
s_waitcnt vmcnt(9) lgkmcnt(4)
buffer_load_dwordx4 a[208:211], v4, s[8:11], s20 offen offset:1024 sc1
v_mfma_f32_16x16x32_bf16 v[28:31], v[148:151], a[128:131], v[28:31]
ds_read_b128 v[180:183], v7 offset:16384
v_mfma_f32_16x16x32_bf16 v[28:31], v[152:155], a[144:147], v[28:31]
v_mfma_f32_16x16x32_bf16 v[32:35], v[152:155], a[148:151], v[32:35]
ds_read_b128 v[184:187], v7 offset:17408
v_mfma_f32_16x16x32_bf16 v[32:35], v[148:151], a[132:135], v[32:35]
buffer_load_dwordx4 a[196:199], v223, s[8:11], s20 offen offset:0 sc1
v_mfma_f32_16x16x32_bf16 v[40:43], v[156:159], a[132:135], v[40:43]
ds_read_b128 v[188:191], v7 offset:18432
v_mfma_f32_16x16x32_bf16 v[40:43], v[160:163], a[148:151], v[40:43]
v_mfma_f32_16x16x32_bf16 v[36:39], v[160:163], a[144:147], v[36:39]
ds_read_b128 v[192:195], v7 offset:19456
v_mfma_f32_16x16x32_bf16 v[36:39], v[156:159], a[128:131], v[36:39]
s_waitcnt lgkmcnt(4)
v_mfma_f32_16x16x32_bf16 v[44:47], v[164:167], a[128:131], v[44:47]
ds_read_b128 v[148:151], v5 offset:20480
v_mfma_f32_16x16x32_bf16 v[44:47], v[168:171], a[144:147], v[44:47]
buffer_load_dwordx4 a[212:215], v223, s[8:11], s20 offen offset:1024 sc1
v_mfma_f32_16x16x32_bf16 v[48:51], v[168:171], a[148:151], v[48:51]
ds_read_b128 v[152:155], v5 offset:21504
v_mfma_f32_16x16x32_bf16 v[48:51], v[164:167], a[132:135], v[48:51]
v_mfma_f32_16x16x32_bf16 v[56:59], v[172:175], a[132:135], v[56:59]
ds_read_b128 v[156:159], v5 offset:22528
v_mfma_f32_16x16x32_bf16 v[56:59], v[176:179], a[148:151], v[56:59]
v_mfma_f32_16x16x32_bf16 v[52:55], v[176:179], a[144:147], v[52:55]
ds_read_b128 v[160:163], v5 offset:23552
v_mfma_f32_16x16x32_bf16 v[52:55], v[172:175], a[128:131], v[52:55]
s_waitcnt lgkmcnt(4)
buffer_load_dwordx4 a[224:227], v4, s[8:11], s20 offen offset:2048 sc1
v_mfma_f32_16x16x32_bf16 v[60:63], v[180:183], a[128:131], v[60:63]
ds_read_b128 v[164:167], v6 offset:20480
v_mfma_f32_16x16x32_bf16 v[60:63], v[184:187], a[144:147], v[60:63]
v_mfma_f32_16x16x32_bf16 v[64:67], v[184:187], a[148:151], v[64:67]
ds_read_b128 v[168:171], v6 offset:21504
v_mfma_f32_16x16x32_bf16 v[64:67], v[180:183], a[132:135], v[64:67]
v_mfma_f32_16x16x32_bf16 v[72:75], v[188:191], a[132:135], v[72:75]
ds_read_b128 v[172:175], v6 offset:22528
v_mfma_f32_16x16x32_bf16 v[72:75], v[192:195], a[148:151], v[72:75]
buffer_load_dwordx4 a[240:243], v4, s[8:11], s20 offen offset:3072 sc1
v_mfma_f32_16x16x32_bf16 v[68:71], v[192:195], a[144:147], v[68:71]
ds_read_b128 v[176:179], v6 offset:23552
v_mfma_f32_16x16x32_bf16 v[68:71], v[188:191], a[128:131], v[68:71]
s_waitcnt vmcnt(7) lgkmcnt(4)
v_mfma_f32_16x16x32_bf16 v[28:31], v[148:151], a[160:163], v[28:31]
ds_read_b128 v[180:183], v7 offset:20480
v_mfma_f32_16x16x32_bf16 v[28:31], v[152:155], a[176:179], v[28:31]
buffer_load_dwordx4 a[228:231], v223, s[8:11], s20 offen offset:2048 sc1
v_mfma_f32_16x16x32_bf16 v[32:35], v[152:155], a[180:183], v[32:35]
ds_read_b128 v[184:187], v7 offset:21504
v_mfma_f32_16x16x32_bf16 v[32:35], v[148:151], a[164:167], v[32:35]
v_mfma_f32_16x16x32_bf16 v[40:43], v[156:159], a[164:167], v[40:43]
ds_read_b128 v[188:191], v7 offset:22528
v_mfma_f32_16x16x32_bf16 v[40:43], v[160:163], a[180:183], v[40:43]
v_mfma_f32_16x16x32_bf16 v[36:39], v[160:163], a[176:179], v[36:39]
ds_read_b128 v[192:195], v7 offset:23552
v_mfma_f32_16x16x32_bf16 v[36:39], v[156:159], a[160:163], v[36:39]
s_waitcnt lgkmcnt(4)
buffer_load_dwordx4 a[244:247], v223, s[8:11], s20 offen offset:3072 sc1
v_mfma_f32_16x16x32_bf16 v[44:47], v[164:167], a[160:163], v[44:47]
s_add_u32 s20, s20, 4096
ds_read_b128 v[148:151], v5 offset:24576
v_mfma_f32_16x16x32_bf16 v[44:47], v[168:171], a[176:179], v[44:47]
v_mfma_f32_16x16x32_bf16 v[48:51], v[168:171], a[180:183], v[48:51]
ds_read_b128 v[152:155], v5 offset:25600
v_add_f32 v140, v124, v128
v_mfma_f32_16x16x32_bf16 v[48:51], v[164:167], a[164:167], v[48:51]
v_add_f32 v144, v132, v136
v_add_f32 v141, v125, v129
v_mfma_f32_16x16x32_bf16 v[56:59], v[172:175], a[164:167], v[56:59]
ds_read_b128 v[156:159], v5 offset:26624
v_add_f32 v145, v133, v137
v_mfma_f32_16x16x32_bf16 v[56:59], v[176:179], a[180:183], v[56:59]
buffer_load_dwordx4 v[224:227], v4, s[8:11], s20 offen offset:0 sc1
v_mfma_f32_16x16x32_bf16 v[52:55], v[176:179], a[176:179], v[52:55]
ds_read_b128 v[160:163], v5 offset:27648
v_add_f32 v142, v126, v130
v_mfma_f32_16x16x32_bf16 v[52:55], v[172:175], a[160:163], v[52:55]
s_waitcnt lgkmcnt(4)
s_waitcnt vmcnt(9)
v_add_f32 v146, v134, v138
v_add_f32 v143, v127, v131
v_mfma_f32_16x16x32_bf16 v[60:63], v[180:183], a[160:163], v[60:63]
ds_read_b128 v[164:167], v6 offset:24576
v_add_f32 v147, v135, v139
v_mfma_f32_16x16x32_bf16 v[60:63], v[184:187], a[176:179], v[60:63]
v_add_f32 v124, v140, v144
v_add_f32 v128, v141, v145
v_mfma_f32_16x16x32_bf16 v[64:67], v[184:187], a[180:183], v[64:67]
ds_read_b128 v[168:171], v6 offset:25600
v_add_f32 v132, v142, v146
v_mfma_f32_16x16x32_bf16 v[64:67], v[180:183], a[164:167], v[64:67]
buffer_load_dwordx4 v[240:243], v4, s[8:11], s20 offen offset:1024 sc1
v_mfma_f32_16x16x32_bf16 v[72:75], v[188:191], a[164:167], v[72:75]
ds_read_b128 v[172:175], v6 offset:26624
v_add_f32 v136, v143, v147
v_mfma_f32_16x16x32_bf16 v[72:75], v[192:195], a[180:183], v[72:75]
v_mov_b32 v125, v124
v_mov_b32 v129, v128
v_mfma_f32_16x16x32_bf16 v[68:71], v[192:195], a[176:179], v[68:71]
ds_read_b128 v[176:179], v6 offset:27648
v_mov_b32 v133, v132
v_mfma_f32_16x16x32_bf16 v[68:71], v[188:191], a[160:163], v[68:71]
s_waitcnt vmcnt(6) lgkmcnt(4)
v_permlane16_swap_b32 v124, v125
v_mfma_f32_16x16x32_bf16 v[28:31], v[148:151], a[192:195], v[28:31]
ds_read_b128 v[180:183], v7 offset:24576
v_mov_b32 v137, v136
v_mfma_f32_16x16x32_bf16 v[28:31], v[152:155], a[208:211], v[28:31]
buffer_load_dwordx4 v[228:231], v223, s[8:11], s20 offen offset:0 sc1
v_mfma_f32_16x16x32_bf16 v[32:35], v[152:155], a[212:215], v[32:35]
ds_read_b128 v[184:187], v7 offset:25600
v_add_f32 v124, v124, v125
v_mfma_f32_16x16x32_bf16 v[32:35], v[148:151], a[196:199], v[32:35]
v_permlane16_swap_b32 v128, v129
v_mfma_f32_16x16x32_bf16 v[40:43], v[156:159], a[196:199], v[40:43]
ds_read_b128 v[188:191], v7 offset:26624
v_add_f32 v128, v128, v129
v_mfma_f32_16x16x32_bf16 v[40:43], v[160:163], a[212:215], v[40:43]
buffer_load_dwordx4 v[244:247], v223, s[8:11], s20 offen offset:1024 sc1
v_mfma_f32_16x16x32_bf16 v[36:39], v[160:163], a[208:211], v[36:39]
s_add_u32 s20, s20, 20480
ds_read_b128 v[192:195], v7 offset:27648
v_mov_b32 v125, v124
v_mfma_f32_16x16x32_bf16 v[36:39], v[156:159], a[192:195], v[36:39]
s_waitcnt lgkmcnt(4)
v_permlane16_swap_b32 v132, v133
v_mfma_f32_16x16x32_bf16 v[44:47], v[164:167], a[192:195], v[44:47]
ds_read_b128 v[148:151], v5 offset:28672
v_add_f32 v132, v132, v133
v_mfma_f32_16x16x32_bf16 v[44:47], v[168:171], a[208:211], v[44:47]
v_permlane16_swap_b32 v136, v137
v_mfma_f32_16x16x32_bf16 v[48:51], v[168:171], a[212:215], v[48:51]
ds_read_b128 v[152:155], v5 offset:29696
v_add_f32 v136, v136, v137
v_mfma_f32_16x16x32_bf16 v[48:51], v[164:167], a[196:199], v[48:51]
buffer_load_dwordx4 a[8:11], v4, s[8:11], s20 offen offset:0 sc1
v_mfma_f32_16x16x32_bf16 v[56:59], v[172:175], a[196:199], v[56:59]
ds_read_b128 v[156:159], v5 offset:30720
v_mov_b32 v129, v128
v_mfma_f32_16x16x32_bf16 v[56:59], v[176:179], a[212:215], v[56:59]
v_permlane32_swap_b32 v124, v125
v_mfma_f32_16x16x32_bf16 v[52:55], v[176:179], a[208:211], v[52:55]
ds_read_b128 v[160:163], v5 offset:31744
v_mov_b32 v133, v132
v_mfma_f32_16x16x32_bf16 v[52:55], v[172:175], a[192:195], v[52:55]
s_waitcnt lgkmcnt(4)
v_permlane32_swap_b32 v128, v129
v_mfma_f32_16x16x32_bf16 v[60:63], v[180:183], a[192:195], v[60:63]
ds_read_b128 v[164:167], v6 offset:28672
v_mov_b32 v137, v136
v_mfma_f32_16x16x32_bf16 v[60:63], v[184:187], a[208:211], v[60:63]
buffer_load_dwordx4 a[24:27], v4, s[8:11], s20 offen offset:1024 sc1
v_mfma_f32_16x16x32_bf16 v[64:67], v[184:187], a[212:215], v[64:67]
ds_read_b128 v[168:171], v6 offset:29696
v_add_f32 v124, v124, v125
v_mfma_f32_16x16x32_bf16 v[64:67], v[180:183], a[196:199], v[64:67]
v_permlane32_swap_b32 v132, v133
v_mfma_f32_16x16x32_bf16 v[72:75], v[188:191], a[196:199], v[72:75]
ds_read_b128 v[172:175], v6 offset:30720
v_add_f32 v128, v128, v129
v_mfma_f32_16x16x32_bf16 v[72:75], v[192:195], a[212:215], v[72:75]
v_permlane32_swap_b32 v136, v137
v_mfma_f32_16x16x32_bf16 v[68:71], v[192:195], a[208:211], v[68:71]
ds_read_b128 v[176:179], v6 offset:31744
v_add_f32 v132, v132, v133
v_mfma_f32_16x16x32_bf16 v[68:71], v[188:191], a[192:195], v[68:71]
s_waitcnt vmcnt(6) lgkmcnt(4)
buffer_load_dwordx4 a[12:15], v223, s[8:11], s20 offen offset:0 sc1
v_mfma_f32_16x16x32_bf16 v[28:31], v[148:151], a[224:227], v[28:31]
ds_read_b128 v[180:183], v7 offset:28672
v_add_f32 v136, v136, v137
v_mfma_f32_16x16x32_bf16 v[28:31], v[152:155], a[240:243], v[28:31]
v_mov_b32 v125, 0x3727c5ac
v_fmamk_f32 v24, v124, 0x3ae38e39, v125
v_mfma_f32_16x16x32_bf16 v[32:35], v[152:155], a[244:247], v[32:35]
ds_read_b128 v[184:187], v7 offset:29696
v_fmamk_f32 v25, v128, 0x3ae38e39, v125
v_mfma_f32_16x16x32_bf16 v[32:35], v[148:151], a[228:231], v[32:35]
buffer_load_dwordx4 a[28:31], v223, s[8:11], s20 offen offset:1024 sc1
v_mfma_f32_16x16x32_bf16 v[40:43], v[156:159], a[228:231], v[40:43]
ds_read_b128 v[188:191], v7 offset:30720
v_fmamk_f32 v26, v132, 0x3ae38e39, v125
v_mfma_f32_16x16x32_bf16 v[40:43], v[160:163], a[244:247], v[40:43]
v_rsq_f32 v124, v24
v_mfma_f32_16x16x32_bf16 v[36:39], v[160:163], a[240:243], v[36:39]
ds_read_b128 v[192:195], v7 offset:31744
v_fmamk_f32 v27, v136, 0x3ae38e39, v125
v_mfma_f32_16x16x32_bf16 v[36:39], v[156:159], a[224:227], v[36:39]
s_waitcnt lgkmcnt(4)
v_rsq_f32 v128, v25
v_mfma_f32_16x16x32_bf16 v[44:47], v[164:167], a[224:227], v[44:47]
ds_read_b128 v[148:151], v5 offset:32768
v_mul_f32 v16, 0xc0135761, v124
v_mfma_f32_16x16x32_bf16 v[44:47], v[168:171], a[240:243], v[44:47]
buffer_load_dwordx4 a[40:43], v4, s[8:11], s20 offen offset:2048 sc1
v_mfma_f32_16x16x32_bf16 v[48:51], v[168:171], a[244:247], v[48:51]
ds_read_b128 v[152:155], v5 offset:33792
v_mul_f32 v17, 0xc0135761, v128
v_mfma_f32_16x16x32_bf16 v[48:51], v[164:167], a[228:231], v[48:51]
v_rsq_f32 v132, v26
v_mfma_f32_16x16x32_bf16 v[56:59], v[172:175], a[228:231], v[56:59]
ds_read_b128 v[156:159], v5 offset:34816
v_mul_f32 v18, 0xc0135761, v132
v_mfma_f32_16x16x32_bf16 v[56:59], v[176:179], a[244:247], v[56:59]
v_rsq_f32 v136, v27
v_mfma_f32_16x16x32_bf16 v[52:55], v[176:179], a[240:243], v[52:55]
ds_read_b128 v[160:163], v5 offset:35840
v_mul_f32 v19, 0xc0135761, v136
v_mfma_f32_16x16x32_bf16 v[52:55], v[172:175], a[224:227], v[52:55]
s_waitcnt lgkmcnt(4)
buffer_load_dwordx4 a[56:59], v4, s[8:11], s20 offen offset:3072 sc1
v_mfma_f32_16x16x32_bf16 v[60:63], v[180:183], a[224:227], v[60:63]
ds_read_b128 v[164:167], v6 offset:32768
v_mul_f32 v124, 0xbdd2d3e8, v124
v_mfma_f32_16x16x32_bf16 v[60:63], v[184:187], a[240:243], v[60:63]
v_rcp_f32 v126, v24
v_mfma_f32_16x16x32_bf16 v[64:67], v[184:187], a[244:247], v[64:67]
s_add_u32 m0, s25, 110592
ds_read_b128 v[168:171], v6 offset:33792
v_mul_f32 v128, 0xbdd2d3e8, v128
v_mfma_f32_16x16x32_bf16 v[64:67], v[180:183], a[228:231], v[64:67]
buffer_load_dwordx4 v4, s[8:11], s24 offen offset:0 sc1 lds
v_mfma_f32_16x16x32_bf16 v[72:75], v[188:191], a[228:231], v[72:75]
ds_read_b128 v[172:175], v6 offset:34816
v_mul_f32 v132, 0xbdd2d3e8, v132
v_mfma_f32_16x16x32_bf16 v[72:75], v[192:195], a[244:247], v[72:75]
buffer_load_dwordx4 a[44:47], v223, s[8:11], s20 offen offset:2048 sc1
v_mfma_f32_16x16x32_bf16 v[68:71], v[192:195], a[240:243], v[68:71]
ds_read_b128 v[176:179], v6 offset:35840
v_mul_f32 v136, 0xbdd2d3e8, v136
v_mfma_f32_16x16x32_bf16 v[68:71], v[188:191], a[224:227], v[68:71]
s_waitcnt vmcnt(8) lgkmcnt(4)
v_rcp_f32 v130, v25
v_mfma_f32_16x16x32_bf16 v[28:31], v[148:151], v[224:227], v[28:31]
ds_read_b128 v[180:183], v7 offset:32768
v_mul_f32 v20, v124, v126
v_mfma_f32_16x16x32_bf16 v[28:31], v[152:155], v[240:243], v[28:31]
buffer_load_dwordx4 a[60:63], v223, s[8:11], s20 offen offset:3072 sc1
v_mfma_f32_16x16x32_bf16 v[32:35], v[152:155], v[244:247], v[32:35]
s_add_u32 s20, s20, 4096
ds_read_b128 v[184:187], v7 offset:33792
v_mul_f32 v21, v128, v130
v_mfma_f32_16x16x32_bf16 v[32:35], v[148:151], v[228:231], v[32:35]
v_rcp_f32 v134, v26
v_mfma_f32_16x16x32_bf16 v[40:43], v[156:159], v[228:231], v[40:43]
ds_read_b128 v[188:191], v7 offset:34816
v_mul_f32 v22, v132, v134
v_mfma_f32_16x16x32_bf16 v[40:43], v[160:163], v[244:247], v[40:43]
v_rcp_f32 v138, v27
v_mfma_f32_16x16x32_bf16 v[36:39], v[160:163], v[240:243], v[36:39]
ds_read_b128 v[192:195], v7 offset:35840
v_mul_f32 v23, v136, v138
v_mfma_f32_16x16x32_bf16 v[36:39], v[156:159], v[224:227], v[36:39]
s_waitcnt lgkmcnt(4)
buffer_load_dwordx4 a[72:75], v4, s[8:11], s20 offen offset:0 sc1
v_mfma_f32_16x16x32_bf16 v[44:47], v[164:167], v[224:227], v[44:47]
ds_read_b128 v[148:151], v5 offset:0
v_and_b32 v140, 3, v2
v_mfma_f32_16x16x32_bf16 v[44:47], v[168:171], v[240:243], v[44:47]
v_add_u32 v141, v140, v3
v_lshrrev_b32 v142, 2, v2
v_mfma_f32_16x16x32_bf16 v[48:51], v[168:171], v[244:247], v[48:51]
ds_read_b128 v[152:155], v5 offset:1024
v_lshl_add_u32 v141, v141, 2, v142
v_mfma_f32_16x16x32_bf16 v[48:51], v[164:167], v[228:231], v[48:51]
buffer_load_dwordx4 v4, s[8:11], s24 offen offset:1024 sc1 lds
v_mfma_f32_16x16x32_bf16 v[56:59], v[172:175], v[228:231], v[56:59]
ds_read_b128 v[156:159], v5 offset:2048
v_and_b32 v141, 15, v141
v_mfma_f32_16x16x32_bf16 v[56:59], v[176:179], v[244:247], v[56:59]
buffer_load_dwordx4 a[88:91], v4, s[8:11], s20 offen offset:1024 sc1
v_mfma_f32_16x16x32_bf16 v[52:55], v[176:179], v[240:243], v[52:55]
ds_read_b128 v[160:163], v5 offset:3072
v_lshl_add_u32 v141, v140, 4, v141
v_mfma_f32_16x16x32_bf16 v[52:55], v[172:175], v[224:227], v[52:55]
s_waitcnt lgkmcnt(4)
v_lshlrev_b32 v10, 4, v141
v_add_u32 v10, 36864, v10
v_mfma_f32_16x16x32_bf16 v[60:63], v[180:183], v[224:227], v[60:63]
ds_read_b128 v[164:167], v6 offset:0
v_lshrrev_b32 v140, 3, v2
v_mfma_f32_16x16x32_bf16 v[60:63], v[184:187], v[240:243], v[60:63]
v_lshl_add_u32 v140, v3, 1, v140
v_and_b32 v141, 2, v2
v_mfma_f32_16x16x32_bf16 v[64:67], v[184:187], v[244:247], v[64:67]
ds_read_b128 v[168:171], v6 offset:1024
v_lshl_add_u32 v140, v141, 1, v140
v_mfma_f32_16x16x32_bf16 v[64:67], v[180:183], v[228:231], v[64:67]
buffer_load_dwordx4 a[76:79], v223, s[8:11], s20 offen offset:0 sc1
v_mfma_f32_16x16x32_bf16 v[72:75], v[188:191], v[228:231], v[72:75]
ds_read_b128 v[172:175], v6 offset:2048
v_and_b32 v140, 7, v140
v_mfma_f32_16x16x32_bf16 v[72:75], v[192:195], v[244:247], v[72:75]
v_and_b32 v141, 7, v2
v_lshl_add_u32 v140, v141, 3, v140
v_mfma_f32_16x16x32_bf16 v[68:71], v[192:195], v[240:243], v[68:71]
ds_read_b128 v[176:179], v6 offset:3072
v_lshlrev_b32 v11, 4, v140
v_mfma_f32_16x16x32_bf16 v[68:71], v[188:191], v[224:227], v[68:71]
s_waitcnt vmcnt(9) lgkmcnt(4)
v_add_u32 v11, 36864, v11
v_mfma_f32_16x16x32_bf16 v[76:79], v[148:151], a[8:11], 0
ds_read_b128 v[180:183], v7 offset:0
v_mfma_f32_16x16x32_bf16 v[76:79], v[152:155], a[24:27], v[76:79]
buffer_load_dwordx4 a[92:95], v223, s[8:11], s20 offen offset:1024 sc1
v_mfma_f32_16x16x32_bf16 v[80:83], v[152:155], a[28:31], 0
ds_read_b128 v[184:187], v7 offset:1024
v_mfma_f32_16x16x32_bf16 v[80:83], v[148:151], a[12:15], v[80:83]
v_mfma_f32_16x16x32_bf16 v[88:91], v[156:159], a[12:15], 0
ds_read_b128 v[188:191], v7 offset:2048
buffer_load_dwordx4 v4, s[8:11], s24 offen offset:2048 sc1 lds
v_mul_f32 v124, v28, v28
v_mfma_f32_16x16x32_bf16 v[88:91], v[160:163], a[28:31], v[88:91]
buffer_load_dwordx4 a[104:107], v4, s[8:11], s20 offen offset:2048 sc1
v_mfma_f32_16x16x32_bf16 v[84:87], v[160:163], a[24:27], 0
ds_read_b128 v[192:195], v7 offset:3072
v_mul_f32 v125, v29, v29
v_mfma_f32_16x16x32_bf16 v[84:87], v[156:159], a[8:11], v[84:87]
s_waitcnt lgkmcnt(4)
v_mul_f32 v126, v30, v30
v_mul_f32 v127, v31, v31
v_mfma_f32_16x16x32_bf16 v[92:95], v[164:167], a[8:11], 0
ds_read_b128 v[148:151], v5 offset:4096
v_fma_f32 v124, v124, v20, v16
v_mfma_f32_16x16x32_bf16 v[92:95], v[168:171], a[24:27], v[92:95]
v_fma_f32 v125, v125, v20, v16
v_fma_f32 v126, v126, v20, v16
v_mfma_f32_16x16x32_bf16 v[96:99], v[168:171], a[28:31], 0
ds_read_b128 v[152:155], v5 offset:5120
v_fma_f32 v127, v127, v20, v16
v_mfma_f32_16x16x32_bf16 v[96:99], v[164:167], a[12:15], v[96:99]
buffer_load_dwordx4 a[120:123], v4, s[8:11], s20 offen offset:3072 sc1
v_mfma_f32_16x16x32_bf16 v[104:107], v[172:175], a[12:15], 0
ds_read_b128 v[156:159], v5 offset:6144
v_mul_f32 v124, v124, v28
v_mfma_f32_16x16x32_bf16 v[104:107], v[176:179], a[28:31], v[104:107]
v_exp_f32 v124, v124
v_mfma_f32_16x16x32_bf16 v[100:103], v[176:179], a[24:27], 0
ds_read_b128 v[160:163], v5 offset:7168
v_mul_f32 v125, v125, v29
v_mul_f32 v126, v126, v30
v_mfma_f32_16x16x32_bf16 v[100:103], v[172:175], a[8:11], v[100:103]
s_waitcnt lgkmcnt(4)
v_exp_f32 v125, v125
v_mfma_f32_16x16x32_bf16 v[108:111], v[180:183], a[8:11], 0
ds_read_b128 v[164:167], v6 offset:4096
v_mul_f32 v127, v127, v31
v_mfma_f32_16x16x32_bf16 v[108:111], v[184:187], a[24:27], v[108:111]
buffer_load_dwordx4 a[108:111], v223, s[8:11], s20 offen offset:2048 sc1
v_mfma_f32_16x16x32_bf16 v[112:115], v[184:187], a[28:31], 0
ds_read_b128 v[168:171], v6 offset:5120
v_mul_f32 v128, v28, v36
v_mfma_f32_16x16x32_bf16 v[112:115], v[180:183], a[12:15], v[112:115]
v_exp_f32 v126, v126
v_mfma_f32_16x16x32_bf16 v[120:123], v[188:191], a[12:15], 0
ds_read_b128 v[172:175], v6 offset:6144
v_mul_f32 v129, v29, v37
v_mfma_f32_16x16x32_bf16 v[120:123], v[192:195], a[28:31], v[120:123]
buffer_load_dwordx4 v4, s[8:11], s24 offen offset:3072 sc1 lds
v_mfma_f32_16x16x32_bf16 v[116:119], v[192:195], a[24:27], 0
s_add_u32 s24, s24, 4096
ds_read_b128 v[176:179], v6 offset:7168
v_mul_f32 v130, v30, v38
v_mfma_f32_16x16x32_bf16 v[116:119], v[188:191], a[8:11], v[116:119]
s_waitcnt vmcnt(10) lgkmcnt(4)
buffer_load_dwordx4 a[124:127], v223, s[8:11], s20 offen offset:3072 sc1
v_mfma_f32_16x16x32_bf16 v[76:79], v[148:151], a[40:43], v[76:79]
s_add_u32 s20, s20, 4096
ds_read_b128 v[180:183], v7 offset:4096
v_exp_f32 v127, v127
v_mfma_f32_16x16x32_bf16 v[76:79], v[152:155], a[56:59], v[76:79]
v_mul_f32 v131, v31, v39
v_fma_f32 v124, v124, v24, v24
v_mfma_f32_16x16x32_bf16 v[80:83], v[152:155], a[60:63], v[80:83]
ds_read_b128 v[184:187], v7 offset:5120
v_fma_f32 v125, v125, v24, v24
v_mfma_f32_16x16x32_bf16 v[80:83], v[148:151], a[44:47], v[80:83]
buffer_load_dwordx4 a[136:139], v4, s[8:11], s20 offen offset:0 sc1
v_mfma_f32_16x16x32_bf16 v[88:91], v[156:159], a[44:47], v[88:91]
ds_read_b128 v[188:191], v7 offset:6144
v_fma_f32 v126, v126, v24, v24
v_mfma_f32_16x16x32_bf16 v[88:91], v[160:163], a[60:63], v[88:91]
v_rcp_f32 v124, v124
v_mfma_f32_16x16x32_bf16 v[84:87], v[160:163], a[56:59], v[84:87]
ds_read_b128 v[192:195], v7 offset:7168
v_fma_f32 v127, v127, v24, v24
v_mfma_f32_16x16x32_bf16 v[84:87], v[156:159], a[40:43], v[84:87]
s_waitcnt lgkmcnt(4)
v_rcp_f32 v125, v125
v_mfma_f32_16x16x32_bf16 v[92:95], v[164:167], a[40:43], v[92:95]
ds_read_b128 v[148:151], v5 offset:8192
v_mul_f32 v128, v128, v124
v_mfma_f32_16x16x32_bf16 v[92:95], v[168:171], a[56:59], v[92:95]
buffer_load_dwordx4 a[152:155], v4, s[8:11], s20 offen offset:1024 sc1
v_mfma_f32_16x16x32_bf16 v[96:99], v[168:171], a[60:63], v[96:99]
ds_read_b128 v[152:155], v5 offset:9216
v_rcp_f32 v126, v126
v_mfma_f32_16x16x32_bf16 v[96:99], v[164:167], a[44:47], v[96:99]
v_rcp_f32 v127, v127
v_mfma_f32_16x16x32_bf16 v[104:107], v[172:175], a[44:47], v[104:107]
ds_read_b128 v[156:159], v5 offset:10240
v_mul_f32 v129, v129, v125
v_mfma_f32_16x16x32_bf16 v[104:107], v[176:179], a[60:63], v[104:107]
v_mul_f32 v130, v130, v126
v_mul_f32 v131, v131, v127
v_mfma_f32_16x16x32_bf16 v[100:103], v[176:179], a[56:59], v[100:103]
s_add_u32 m0, s25, 114688
ds_read_b128 v[160:163], v5 offset:11264
v_cvt_pk_bf16_f32 v140, v128, v129
v_mfma_f32_16x16x32_bf16 v[100:103], v[172:175], a[40:43], v[100:103]
s_waitcnt lgkmcnt(4)
buffer_load_dwordx4 a[140:143], v223, s[8:11], s20 offen offset:0 sc1
v_mfma_f32_16x16x32_bf16 v[108:111], v[180:183], a[40:43], v[108:111]
ds_read_b128 v[164:167], v6 offset:8192
buffer_load_dwordx4 v4, s[8:11], s24 offen offset:0 sc1 lds
v_mfma_f32_16x16x32_bf16 v[108:111], v[184:187], a[56:59], v[108:111]
v_cvt_pk_bf16_f32 v141, v130, v131
v_mul_f32 v132, v32, v32
v_mfma_f32_16x16x32_bf16 v[112:115], v[184:187], a[60:63], v[112:115]
ds_read_b128 v[168:171], v6 offset:9216
v_mul_f32 v133, v33, v33
v_mfma_f32_16x16x32_bf16 v[112:115], v[180:183], a[44:47], v[112:115]
v_mul_f32 v134, v34, v34
v_mul_f32 v135, v35, v35
v_mfma_f32_16x16x32_bf16 v[120:123], v[188:191], a[44:47], v[120:123]
ds_read_b128 v[172:175], v6 offset:10240
v_fma_f32 v132, v132, v21, v17
v_fma_f32 v133, v133, v21, v17
v_mfma_f32_16x16x32_bf16 v[120:123], v[192:195], a[60:63], v[120:123]
buffer_load_dwordx4 a[156:159], v223, s[8:11], s20 offen offset:1024 sc1
v_mfma_f32_16x16x32_bf16 v[116:119], v[192:195], a[56:59], v[116:119]
ds_read_b128 v[176:179], v6 offset:11264
v_fma_f32 v134, v134, v21, v17
v_mfma_f32_16x16x32_bf16 v[116:119], v[188:191], a[40:43], v[116:119]
s_waitcnt vmcnt(11) lgkmcnt(4)
v_fma_f32 v135, v135, v21, v17
v_mul_f32 v132, v132, v32
v_mfma_f32_16x16x32_bf16 v[76:79], v[148:151], a[72:75], v[76:79]
ds_read_b128 v[180:183], v7 offset:8192
v_mul_f32 v133, v133, v33
v_mfma_f32_16x16x32_bf16 v[76:79], v[152:155], a[88:91], v[76:79]
buffer_load_dwordx4 a[168:171], v4, s[8:11], s20 offen offset:2048 sc1
v_mfma_f32_16x16x32_bf16 v[80:83], v[152:155], a[92:95], v[80:83]
ds_read_b128 v[184:187], v7 offset:9216
v_mul_f32 v134, v134, v34
v_mfma_f32_16x16x32_bf16 v[80:83], v[148:151], a[76:79], v[80:83]
v_exp_f32 v132, v132
v_mfma_f32_16x16x32_bf16 v[88:91], v[156:159], a[76:79], v[88:91]
ds_read_b128 v[188:191], v7 offset:10240
v_mul_f32 v135, v135, v35
v_mfma_f32_16x16x32_bf16 v[88:91], v[160:163], a[92:95], v[88:91]
v_exp_f32 v133, v133
v_mfma_f32_16x16x32_bf16 v[84:87], v[160:163], a[88:91], v[84:87]
ds_read_b128 v[192:195], v7 offset:11264
v_exp_f32 v134, v134
v_mfma_f32_16x16x32_bf16 v[84:87], v[156:159], a[72:75], v[84:87]
s_waitcnt lgkmcnt(4)
buffer_load_dwordx4 a[184:187], v4, s[8:11], s20 offen offset:3072 sc1
v_mfma_f32_16x16x32_bf16 v[92:95], v[164:167], a[72:75], v[92:95]
ds_read_b128 v[148:151], v5 offset:12288
v_mul_f32 v136, v32, v40
v_mfma_f32_16x16x32_bf16 v[92:95], v[168:171], a[88:91], v[92:95]
buffer_load_dwordx4 v4, s[8:11], s24 offen offset:1024 sc1 lds
v_mfma_f32_16x16x32_bf16 v[96:99], v[168:171], a[92:95], v[96:99]
ds_read_b128 v[152:155], v5 offset:13312
v_mul_f32 v137, v33, v41
v_mfma_f32_16x16x32_bf16 v[96:99], v[164:167], a[76:79], v[96:99]
v_exp_f32 v135, v135
v_mfma_f32_16x16x32_bf16 v[104:107], v[172:175], a[76:79], v[104:107]
ds_read_b128 v[156:159], v5 offset:14336
v_mul_f32 v138, v34, v42
v_mfma_f32_16x16x32_bf16 v[104:107], v[176:179], a[92:95], v[104:107]
buffer_load_dwordx4 a[172:175], v223, s[8:11], s20 offen offset:2048 sc1
v_mfma_f32_16x16x32_bf16 v[100:103], v[176:179], a[88:91], v[100:103]
ds_read_b128 v[160:163], v5 offset:15360
v_mul_f32 v139, v35, v43
v_mfma_f32_16x16x32_bf16 v[100:103], v[172:175], a[72:75], v[100:103]
s_waitcnt lgkmcnt(4)
v_fma_f32 v132, v132, v25, v25
v_fma_f32 v133, v133, v25, v25
v_mfma_f32_16x16x32_bf16 v[108:111], v[180:183], a[72:75], v[108:111]
ds_read_b128 v[164:167], v6 offset:12288
v_rcp_f32 v132, v132
v_mfma_f32_16x16x32_bf16 v[108:111], v[184:187], a[88:91], v[108:111]
v_rcp_f32 v133, v133
v_mfma_f32_16x16x32_bf16 v[112:115], v[184:187], a[92:95], v[112:115]
ds_read_b128 v[168:171], v6 offset:13312
v_fma_f32 v134, v134, v25, v25
v_mfma_f32_16x16x32_bf16 v[112:115], v[180:183], a[76:79], v[112:115]
buffer_load_dwordx4 a[188:191], v223, s[8:11], s20 offen offset:3072 sc1
v_mfma_f32_16x16x32_bf16 v[120:123], v[188:191], a[76:79], v[120:123]
s_add_u32 s20, s20, 4096
ds_read_b128 v[172:175], v6 offset:14336
v_fma_f32 v135, v135, v25, v25
v_mfma_f32_16x16x32_bf16 v[120:123], v[192:195], a[92:95], v[120:123]
v_rcp_f32 v134, v134
v_mfma_f32_16x16x32_bf16 v[116:119], v[192:195], a[88:91], v[116:119]
ds_read_b128 v[176:179], v6 offset:15360
v_mul_f32 v136, v136, v132
v_mfma_f32_16x16x32_bf16 v[116:119], v[188:191], a[72:75], v[116:119]
s_waitcnt vmcnt(10) lgkmcnt(4)
v_rcp_f32 v135, v135
v_mfma_f32_16x16x32_bf16 v[76:79], v[148:151], a[104:107], v[76:79]
ds_read_b128 v[180:183], v7 offset:12288
buffer_load_dwordx4 v4, s[8:11], s24 offen offset:2048 sc1 lds
v_mfma_f32_16x16x32_bf16 v[76:79], v[152:155], a[120:123], v[76:79]
buffer_load_dwordx4 a[200:203], v4, s[8:11], s20 offen offset:0 sc1
v_mfma_f32_16x16x32_bf16 v[80:83], v[152:155], a[124:127], v[80:83]
ds_read_b128 v[184:187], v7 offset:13312
v_mul_f32 v137, v137, v133
v_mul_f32 v138, v138, v134
v_mfma_f32_16x16x32_bf16 v[80:83], v[148:151], a[108:111], v[80:83]
v_mul_f32 v139, v139, v135
v_cvt_pk_bf16_f32 v142, v136, v137
v_mfma_f32_16x16x32_bf16 v[88:91], v[156:159], a[108:111], v[88:91]
ds_read_b128 v[188:191], v7 offset:14336
v_cvt_pk_bf16_f32 v143, v138, v139
v_mfma_f32_16x16x32_bf16 v[88:91], v[160:163], a[124:127], v[88:91]
buffer_load_dwordx4 a[216:219], v4, s[8:11], s20 offen offset:1024 sc1
v_mfma_f32_16x16x32_bf16 v[84:87], v[160:163], a[120:123], v[84:87]
ds_read_b128 v[192:195], v7 offset:15360
v_mul_f32 v124, v44, v44
v_mfma_f32_16x16x32_bf16 v[84:87], v[156:159], a[104:107], v[84:87]
s_waitcnt lgkmcnt(4)
v_permlane16_swap_b32 v140, v142
v_mfma_f32_16x16x32_bf16 v[92:95], v[164:167], a[104:107], v[92:95]
ds_read_b128 v[148:151], v5 offset:16384
v_mul_f32 v125, v45, v45
v_mfma_f32_16x16x32_bf16 v[92:95], v[168:171], a[120:123], v[92:95]
v_permlane16_swap_b32 v141, v143
v_mfma_f32_16x16x32_bf16 v[96:99], v[168:171], a[124:127], v[96:99]
ds_read_b128 v[152:155], v5 offset:17408
v_mul_f32 v126, v46, v46
v_mfma_f32_16x16x32_bf16 v[96:99], v[164:167], a[108:111], v[96:99]
buffer_load_dwordx4 a[204:207], v223, s[8:11], s20 offen offset:0 sc1
v_mfma_f32_16x16x32_bf16 v[104:107], v[172:175], a[108:111], v[104:107]
ds_read_b128 v[156:159], v5 offset:18432
v_mul_f32 v127, v47, v47
v_fma_f32 v124, v124, v20, v16
v_mfma_f32_16x16x32_bf16 v[104:107], v[176:179], a[124:127], v[104:107]
buffer_store_dwordx4 v[140:143], v9, s[8:11], s26 offen sc1
v_mfma_f32_16x16x32_bf16 v[100:103], v[176:179], a[120:123], v[100:103]
s_add_u32 s26, s26, 4096
ds_read_b128 v[160:163], v5 offset:19456
v_fma_f32 v125, v125, v20, v16
v_mfma_f32_16x16x32_bf16 v[100:103], v[172:175], a[104:107], v[100:103]
s_waitcnt lgkmcnt(4)
v_fma_f32 v126, v126, v20, v16
v_fma_f32 v127, v127, v20, v16
v_mfma_f32_16x16x32_bf16 v[108:111], v[180:183], a[104:107], v[108:111]
ds_read_b128 v[164:167], v6 offset:16384
v_mul_f32 v124, v124, v44
v_mfma_f32_16x16x32_bf16 v[108:111], v[184:187], a[120:123], v[108:111]
buffer_load_dwordx4 a[220:223], v223, s[8:11], s20 offen offset:1024 sc1
v_mfma_f32_16x16x32_bf16 v[112:115], v[184:187], a[124:127], v[112:115]
ds_read_b128 v[168:171], v6 offset:17408
v_mul_f32 v125, v125, v45
v_mfma_f32_16x16x32_bf16 v[112:115], v[180:183], a[108:111], v[112:115]
buffer_load_dwordx4 v4, s[8:11], s24 offen offset:3072 sc1 lds
v_mfma_f32_16x16x32_bf16 v[120:123], v[188:191], a[108:111], v[120:123]
s_add_u32 s24, s24, 4096
ds_read_b128 v[172:175], v6 offset:18432
v_mul_f32 v126, v126, v46
v_mfma_f32_16x16x32_bf16 v[120:123], v[192:195], a[124:127], v[120:123]
v_exp_f32 v124, v124
v_mfma_f32_16x16x32_bf16 v[116:119], v[192:195], a[120:123], v[116:119]
ds_read_b128 v[176:179], v6 offset:19456
v_exp_f32 v125, v125
v_mfma_f32_16x16x32_bf16 v[116:119], v[188:191], a[104:107], v[116:119]
s_waitcnt vmcnt(12) lgkmcnt(4)
buffer_load_dwordx4 a[232:235], v4, s[8:11], s20 offen offset:2048 sc1
v_mfma_f32_16x16x32_bf16 v[76:79], v[148:151], a[136:139], v[76:79]
ds_read_b128 v[180:183], v7 offset:16384
v_mul_f32 v127, v127, v47
v_mfma_f32_16x16x32_bf16 v[76:79], v[152:155], a[152:155], v[76:79]
v_exp_f32 v126, v126
v_mfma_f32_16x16x32_bf16 v[80:83], v[152:155], a[156:159], v[80:83]
ds_read_b128 v[184:187], v7 offset:17408
v_mul_f32 v128, v44, v52
v_mfma_f32_16x16x32_bf16 v[80:83], v[148:151], a[140:143], v[80:83]
buffer_load_dwordx4 a[248:251], v4, s[8:11], s20 offen offset:3072 sc1
v_mfma_f32_16x16x32_bf16 v[88:91], v[156:159], a[140:143], v[88:91]
s_add_u32 s83, s82, Lcw0-Lcp
ds_read_b128 v[188:191], v7 offset:18432
v_mul_f32 v129, v45, v53
v_mfma_f32_16x16x32_bf16 v[88:91], v[160:163], a[156:159], v[88:91]
s_min_u32 s83, s83, Lcode_end-Lcp-4
v_exp_f32 v127, v127
v_mfma_f32_16x16x32_bf16 v[84:87], v[160:163], a[152:155], v[84:87]
ds_read_b128 v[192:195], v7 offset:19456
v_mov_b32 v222, s83
v_mfma_f32_16x16x32_bf16 v[84:87], v[156:159], a[136:139], v[84:87]
s_waitcnt lgkmcnt(4)
global_load_dword v221, v222, s[80:81]
v_mfma_f32_16x16x32_bf16 v[92:95], v[164:167], a[136:139], v[92:95]
ds_read_b128 v[148:151], v5 offset:20480
v_mul_f32 v130, v46, v54
v_mul_f32 v131, v47, v55
v_mfma_f32_16x16x32_bf16 v[92:95], v[168:171], a[152:155], v[92:95]
buffer_load_dwordx4 a[236:239], v223, s[8:11], s20 offen offset:2048 sc1
v_mfma_f32_16x16x32_bf16 v[96:99], v[168:171], a[156:159], v[96:99]
ds_read_b128 v[152:155], v5 offset:21504
v_fma_f32 v124, v124, v24, v24
v_mfma_f32_16x16x32_bf16 v[96:99], v[164:167], a[140:143], v[96:99]
s_add_u32 m0, s25, 118784
v_rcp_f32 v124, v124
v_mfma_f32_16x16x32_bf16 v[104:107], v[172:175], a[140:143], v[104:107]
ds_read_b128 v[156:159], v5 offset:22528
v_fma_f32 v125, v125, v24, v24
v_mfma_f32_16x16x32_bf16 v[104:107], v[176:179], a[156:159], v[104:107]
buffer_load_dwordx4 v4, s[8:11], s24 offen offset:0 sc1 lds
s_add_u32 s24, s24, 28672
v_mfma_f32_16x16x32_bf16 v[100:103], v[176:179], a[152:155], v[100:103]
ds_read_b128 v[160:163], v5 offset:23552
v_fma_f32 v126, v126, v24, v24
v_mfma_f32_16x16x32_bf16 v[100:103], v[172:175], a[136:139], v[100:103]
s_waitcnt lgkmcnt(4)
buffer_load_dwordx4 a[252:255], v223, s[8:11], s20 offen offset:3072 sc1
v_mfma_f32_16x16x32_bf16 v[108:111], v[180:183], a[136:139], v[108:111]
s_add_u32 s20, s20, 4096
ds_read_b128 v[164:167], v6 offset:20480
v_fma_f32 v127, v127, v24, v24
v_mfma_f32_16x16x32_bf16 v[108:111], v[184:187], a[152:155], v[108:111]
v_rcp_f32 v125, v125
v_mfma_f32_16x16x32_bf16 v[112:115], v[184:187], a[156:159], v[112:115]
ds_read_b128 v[168:171], v6 offset:21504
v_mul_f32 v128, v128, v124
v_mfma_f32_16x16x32_bf16 v[112:115], v[180:183], a[140:143], v[112:115]
v_rcp_f32 v126, v126
v_mul_f32 v129, v129, v125
v_mfma_f32_16x16x32_bf16 v[120:123], v[188:191], a[140:143], v[120:123]
ds_read_b128 v[172:175], v6 offset:22528
v_mul_f32 v130, v130, v126
v_mfma_f32_16x16x32_bf16 v[120:123], v[192:195], a[156:159], v[120:123]
buffer_load_dwordx4 v[232:235], v4, s[8:11], s20 offen offset:0 sc1
v_mfma_f32_16x16x32_bf16 v[116:119], v[192:195], a[152:155], v[116:119]
ds_read_b128 v[176:179], v6 offset:23552
v_cvt_pk_bf16_f32 v144, v128, v129
v_mfma_f32_16x16x32_bf16 v[116:119], v[188:191], a[136:139], v[116:119]
s_waitcnt vmcnt(14) lgkmcnt(4)
v_rcp_f32 v127, v127
v_mfma_f32_16x16x32_bf16 v[76:79], v[148:151], a[168:171], v[76:79]
ds_read_b128 v[180:183], v7 offset:20480
v_mul_f32 v131, v131, v127
v_mfma_f32_16x16x32_bf16 v[76:79], v[152:155], a[184:187], v[76:79]
buffer_load_dwordx4 v[248:251], v4, s[8:11], s20 offen offset:1024 sc1
v_mfma_f32_16x16x32_bf16 v[80:83], v[152:155], a[188:191], v[80:83]
ds_read_b128 v[184:187], v7 offset:21504
v_cvt_pk_bf16_f32 v145, v130, v131
v_mfma_f32_16x16x32_bf16 v[80:83], v[148:151], a[172:175], v[80:83]
v_mul_f32 v132, v48, v48
v_mul_f32 v133, v49, v49
v_mfma_f32_16x16x32_bf16 v[88:91], v[156:159], a[172:175], v[88:91]
ds_read_b128 v[188:191], v7 offset:22528
v_mul_f32 v134, v50, v50
v_mfma_f32_16x16x32_bf16 v[88:91], v[160:163], a[188:191], v[88:91]
v_mul_f32 v135, v51, v51
v_fma_f32 v132, v132, v21, v17
v_fma_f32 v133, v133, v21, v17
v_mfma_f32_16x16x32_bf16 v[84:87], v[160:163], a[184:187], v[84:87]
ds_read_b128 v[192:195], v7 offset:23552
v_fma_f32 v134, v134, v21, v17
v_mfma_f32_16x16x32_bf16 v[84:87], v[156:159], a[168:171], v[84:87]
s_waitcnt lgkmcnt(4)
buffer_load_dwordx4 v[236:239], v223, s[8:11], s20 offen offset:0 sc1
v_mfma_f32_16x16x32_bf16 v[92:95], v[164:167], a[168:171], v[92:95]
ds_read_b128 v[148:151], v5 offset:24576
v_fma_f32 v135, v135, v21, v17
v_mfma_f32_16x16x32_bf16 v[92:95], v[168:171], a[184:187], v[92:95]
v_mul_f32 v132, v132, v48
v_mul_f32 v133, v133, v49
v_mfma_f32_16x16x32_bf16 v[96:99], v[168:171], a[188:191], v[96:99]
ds_read_b128 v[152:155], v5 offset:25600
v_mul_f32 v134, v134, v50
v_mfma_f32_16x16x32_bf16 v[96:99], v[164:167], a[172:175], v[96:99]
v_exp_f32 v132, v132
v_mfma_f32_16x16x32_bf16 v[104:107], v[172:175], a[172:175], v[104:107]
ds_read_b128 v[156:159], v5 offset:26624
v_mul_f32 v135, v135, v51
v_mfma_f32_16x16x32_bf16 v[104:107], v[176:179], a[188:191], v[104:107]
buffer_load_dwordx4 v[252:255], v223, s[8:11], s20 offen offset:1024 sc1
v_mfma_f32_16x16x32_bf16 v[100:103], v[176:179], a[184:187], v[100:103]
s_add_u32 s20, s20, 20480
ds_read_b128 v[160:163], v5 offset:27648
v_mul_f32 v136, v48, v56
v_mfma_f32_16x16x32_bf16 v[100:103], v[172:175], a[168:171], v[100:103]
s_waitcnt lgkmcnt(4)
v_exp_f32 v133, v133
v_mul_f32 v137, v49, v57
v_mfma_f32_16x16x32_bf16 v[108:111], v[180:183], a[168:171], v[108:111]
ds_read_b128 v[164:167], v6 offset:24576
v_mul_f32 v138, v50, v58
v_mfma_f32_16x16x32_bf16 v[108:111], v[184:187], a[184:187], v[108:111]
v_exp_f32 v134, v134
v_mfma_f32_16x16x32_bf16 v[112:115], v[184:187], a[188:191], v[112:115]
ds_read_b128 v[168:171], v6 offset:25600
v_mul_f32 v139, v51, v59
v_mfma_f32_16x16x32_bf16 v[112:115], v[180:183], a[172:175], v[112:115]
v_exp_f32 v135, v135
v_mfma_f32_16x16x32_bf16 v[120:123], v[188:191], a[172:175], v[120:123]
ds_read_b128 v[172:175], v6 offset:26624
v_fma_f32 v132, v132, v25, v25
v_mfma_f32_16x16x32_bf16 v[120:123], v[192:195], a[188:191], v[120:123]
v_rcp_f32 v132, v132
v_mfma_f32_16x16x32_bf16 v[116:119], v[192:195], a[184:187], v[116:119]
ds_read_b128 v[176:179], v6 offset:27648
v_fma_f32 v133, v133, v25, v25
v_mfma_f32_16x16x32_bf16 v[116:119], v[188:191], a[168:171], v[116:119]
s_waitcnt vmcnt(11) lgkmcnt(4)
v_rcp_f32 v133, v133
v_mfma_f32_16x16x32_bf16 v[76:79], v[148:151], a[200:203], v[76:79]
ds_read_b128 v[180:183], v7 offset:24576
v_fma_f32 v134, v134, v25, v25
v_mfma_f32_16x16x32_bf16 v[76:79], v[152:155], a[216:219], v[76:79]
v_rcp_f32 v134, v134
v_fma_f32 v135, v135, v25, v25
v_mfma_f32_16x16x32_bf16 v[80:83], v[152:155], a[220:223], v[80:83]
ds_read_b128 v[184:187], v7 offset:25600
v_mul_f32 v136, v136, v132
v_mfma_f32_16x16x32_bf16 v[80:83], v[148:151], a[204:207], v[80:83]
v_rcp_f32 v135, v135
v_mfma_f32_16x16x32_bf16 v[88:91], v[156:159], a[204:207], v[88:91]
ds_read_b128 v[188:191], v7 offset:26624
v_mul_f32 v137, v137, v133
v_mfma_f32_16x16x32_bf16 v[88:91], v[160:163], a[220:223], v[88:91]
v_mul_f32 v138, v138, v134
v_mul_f32 v139, v139, v135
v_mfma_f32_16x16x32_bf16 v[84:87], v[160:163], a[216:219], v[84:87]
ds_read_b128 v[192:195], v7 offset:27648
v_cvt_pk_bf16_f32 v146, v136, v137
v_mfma_f32_16x16x32_bf16 v[84:87], v[156:159], a[200:203], v[84:87]
s_waitcnt lgkmcnt(4)
v_permlane16_swap_b32 v144, v146
v_mfma_f32_16x16x32_bf16 v[92:95], v[164:167], a[200:203], v[92:95]
ds_read_b128 v[148:151], v5 offset:28672
v_cvt_pk_bf16_f32 v147, v138, v139
v_mfma_f32_16x16x32_bf16 v[92:95], v[168:171], a[216:219], v[92:95]
s_nop 0
v_permlane16_swap_b32 v145, v147
v_mfma_f32_16x16x32_bf16 v[96:99], v[168:171], a[220:223], v[96:99]
ds_read_b128 v[152:155], v5 offset:29696
v_mul_f32 v124, v60, v60
v_mfma_f32_16x16x32_bf16 v[96:99], v[164:167], a[204:207], v[96:99]
buffer_store_dwordx4 v[144:147], v9, s[8:11], s26 offen sc1
v_mfma_f32_16x16x32_bf16 v[104:107], v[172:175], a[204:207], v[104:107]
s_add_u32 s26, s26, 4096
ds_read_b128 v[156:159], v5 offset:30720
v_mul_f32 v125, v61, v61
v_mul_f32 v126, v62, v62
v_mfma_f32_16x16x32_bf16 v[104:107], v[176:179], a[220:223], v[104:107]
v_mul_f32 v127, v63, v63
v_fma_f32 v124, v124, v20, v16
v_fma_f32 v125, v125, v20, v16
v_mfma_f32_16x16x32_bf16 v[100:103], v[176:179], a[216:219], v[100:103]
ds_read_b128 v[160:163], v5 offset:31744
v_fma_f32 v126, v126, v20, v16
v_fma_f32 v127, v127, v20, v16
v_mfma_f32_16x16x32_bf16 v[100:103], v[172:175], a[200:203], v[100:103]
s_waitcnt lgkmcnt(4)
v_mul_f32 v124, v124, v60
v_exp_f32 v124, v124
v_mfma_f32_16x16x32_bf16 v[108:111], v[180:183], a[200:203], v[108:111]
ds_read_b128 v[164:167], v6 offset:28672
v_mul_f32 v125, v125, v61
v_mul_f32 v126, v126, v62
v_mfma_f32_16x16x32_bf16 v[108:111], v[184:187], a[216:219], v[108:111]
v_exp_f32 v125, v125
v_mul_f32 v127, v127, v63
v_mfma_f32_16x16x32_bf16 v[112:115], v[184:187], a[220:223], v[112:115]
ds_read_b128 v[168:171], v6 offset:29696
v_mul_f32 v128, v60, v68
v_mfma_f32_16x16x32_bf16 v[112:115], v[180:183], a[204:207], v[112:115]
v_exp_f32 v126, v126
v_mfma_f32_16x16x32_bf16 v[120:123], v[188:191], a[204:207], v[120:123]
ds_read_b128 v[172:175], v6 offset:30720
v_mul_f32 v129, v61, v69
v_mfma_f32_16x16x32_bf16 v[120:123], v[192:195], a[220:223], v[120:123]
v_exp_f32 v127, v127
v_mfma_f32_16x16x32_bf16 v[116:119], v[192:195], a[216:219], v[116:119]
ds_read_b128 v[176:179], v6 offset:31744
v_mul_f32 v130, v62, v70
v_mfma_f32_16x16x32_bf16 v[116:119], v[188:191], a[200:203], v[116:119]
s_waitcnt vmcnt(5) lgkmcnt(4)
v_mul_f32 v131, v63, v71
v_fma_f32 v124, v124, v24, v24
v_mfma_f32_16x16x32_bf16 v[76:79], v[148:151], a[232:235], v[76:79]
ds_read_b128 v[180:183], v7 offset:28672
v_fma_f32 v125, v125, v24, v24
v_mfma_f32_16x16x32_bf16 v[76:79], v[152:155], a[248:251], v[76:79]
v_rcp_f32 v124, v124
v_mfma_f32_16x16x32_bf16 v[80:83], v[152:155], a[252:255], v[80:83]
ds_read_b128 v[184:187], v7 offset:29696
v_fma_f32 v126, v126, v24, v24
v_mfma_f32_16x16x32_bf16 v[80:83], v[148:151], a[236:239], v[80:83]
v_rcp_f32 v125, v125
v_mfma_f32_16x16x32_bf16 v[88:91], v[156:159], a[236:239], v[88:91]
ds_read_b128 v[188:191], v7 offset:30720
v_fma_f32 v127, v127, v24, v24
v_mfma_f32_16x16x32_bf16 v[88:91], v[160:163], a[252:255], v[88:91]
v_rcp_f32 v126, v126
v_mfma_f32_16x16x32_bf16 v[84:87], v[160:163], a[248:251], v[84:87]
ds_read_b128 v[192:195], v7 offset:31744
v_mul_f32 v128, v128, v124
v_mfma_f32_16x16x32_bf16 v[84:87], v[156:159], a[232:235], v[84:87]
s_waitcnt lgkmcnt(4)
v_rcp_f32 v127, v127
v_mfma_f32_16x16x32_bf16 v[92:95], v[164:167], a[232:235], v[92:95]
ds_read_b128 v[148:151], v5 offset:32768
v_mul_f32 v129, v129, v125
v_mfma_f32_16x16x32_bf16 v[92:95], v[168:171], a[248:251], v[92:95]
v_mul_f32 v130, v130, v126
v_mul_f32 v131, v131, v127
v_mfma_f32_16x16x32_bf16 v[96:99], v[168:171], a[252:255], v[96:99]
ds_read_b128 v[152:155], v5 offset:33792
v_cvt_pk_bf16_f32 v140, v128, v129
v_mfma_f32_16x16x32_bf16 v[96:99], v[164:167], a[236:239], v[96:99]
v_cvt_pk_bf16_f32 v141, v130, v131
v_mul_f32 v132, v64, v64
v_mfma_f32_16x16x32_bf16 v[104:107], v[172:175], a[236:239], v[104:107]
ds_read_b128 v[156:159], v5 offset:34816
v_mul_f32 v133, v65, v65
v_mfma_f32_16x16x32_bf16 v[104:107], v[176:179], a[252:255], v[104:107]
v_mul_f32 v134, v66, v66
v_mul_f32 v135, v67, v67
v_mfma_f32_16x16x32_bf16 v[100:103], v[176:179], a[248:251], v[100:103]
ds_read_b128 v[160:163], v5 offset:35840
v_fma_f32 v132, v132, v21, v17
v_mfma_f32_16x16x32_bf16 v[100:103], v[172:175], a[232:235], v[100:103]
s_waitcnt lgkmcnt(4)
v_fma_f32 v133, v133, v21, v17
v_fma_f32 v134, v134, v21, v17
v_mfma_f32_16x16x32_bf16 v[108:111], v[180:183], a[232:235], v[108:111]
ds_read_b128 v[164:167], v6 offset:32768
v_fma_f32 v135, v135, v21, v17
v_mfma_f32_16x16x32_bf16 v[108:111], v[184:187], a[248:251], v[108:111]
v_mul_f32 v132, v132, v64
v_mul_f32 v133, v133, v65
v_mfma_f32_16x16x32_bf16 v[112:115], v[184:187], a[252:255], v[112:115]
ds_read_b128 v[168:171], v6 offset:33792
v_mul_f32 v134, v134, v66
v_mfma_f32_16x16x32_bf16 v[112:115], v[180:183], a[236:239], v[112:115]
v_exp_f32 v132, v132
v_mfma_f32_16x16x32_bf16 v[120:123], v[188:191], a[236:239], v[120:123]
ds_read_b128 v[172:175], v6 offset:34816
v_mul_f32 v135, v135, v67
v_mfma_f32_16x16x32_bf16 v[120:123], v[192:195], a[252:255], v[120:123]
v_exp_f32 v133, v133
v_mfma_f32_16x16x32_bf16 v[116:119], v[192:195], a[248:251], v[116:119]
ds_read_b128 v[176:179], v6 offset:35840
v_mul_f32 v136, v64, v72
v_mfma_f32_16x16x32_bf16 v[116:119], v[188:191], a[232:235], v[116:119]
s_waitcnt vmcnt(1) lgkmcnt(4)
v_exp_f32 v134, v134
v_mfma_f32_16x16x32_bf16 v[76:79], v[148:151], v[232:235], v[76:79]
ds_read_b128 v[180:183], v7 offset:32768
v_mul_f32 v137, v65, v73
v_mfma_f32_16x16x32_bf16 v[76:79], v[152:155], v[248:251], v[76:79]
v_exp_f32 v135, v135
v_mfma_f32_16x16x32_bf16 v[80:83], v[152:155], v[252:255], v[80:83]
ds_read_b128 v[184:187], v7 offset:33792
v_mul_f32 v138, v66, v74
v_mfma_f32_16x16x32_bf16 v[80:83], v[148:151], v[236:239], v[80:83]
v_mul_f32 v139, v67, v75
v_fma_f32 v132, v132, v25, v25
v_mfma_f32_16x16x32_bf16 v[88:91], v[156:159], v[236:239], v[88:91]
ds_read_b128 v[188:191], v7 offset:34816
v_fma_f32 v133, v133, v25, v25
v_mfma_f32_16x16x32_bf16 v[88:91], v[160:163], v[252:255], v[88:91]
v_rcp_f32 v132, v132
v_mfma_f32_16x16x32_bf16 v[84:87], v[160:163], v[248:251], v[84:87]
ds_read_b128 v[192:195], v7 offset:35840
v_fma_f32 v134, v134, v25, v25
v_mfma_f32_16x16x32_bf16 v[84:87], v[156:159], v[232:235], v[84:87]
s_waitcnt lgkmcnt(4)
v_rcp_f32 v133, v133
v_mfma_f32_16x16x32_bf16 v[92:95], v[164:167], v[232:235], v[92:95]
s_barrier
ds_read_b128 v[148:151], v8 offset:0
v_mfma_f32_16x16x32_bf16 v[92:95], v[168:171], v[248:251], v[92:95]
v_rcp_f32 v134, v134
v_mfma_f32_16x16x32_bf16 v[96:99], v[168:171], v[252:255], v[96:99]
s_add_u32 m0, s25, 0
ds_read_b128 v[152:155], v8 offset:1024
v_fma_f32 v135, v135, v25, v25
v_mfma_f32_16x16x32_bf16 v[96:99], v[164:167], v[236:239], v[96:99]
buffer_load_dwordx4 v4, s[8:11], s24 offen offset:0 sc1 lds
v_mfma_f32_16x16x32_bf16 v[104:107], v[172:175], v[236:239], v[104:107]
ds_read_b128 v[156:159], v8 offset:2048
v_mul_f32 v136, v136, v132
v_mfma_f32_16x16x32_bf16 v[104:107], v[176:179], v[252:255], v[104:107]
v_rcp_f32 v135, v135
v_mfma_f32_16x16x32_bf16 v[100:103], v[176:179], v[248:251], v[100:103]
ds_read_b128 v[160:163], v8 offset:3072
v_mul_f32 v137, v137, v133
v_mfma_f32_16x16x32_bf16 v[100:103], v[172:175], v[232:235], v[100:103]
s_waitcnt lgkmcnt(4)
v_mul_f32 v138, v138, v134
v_mul_f32 v139, v139, v135
v_mfma_f32_16x16x32_bf16 v[108:111], v[180:183], v[232:235], v[108:111]
ds_read_b128 v[164:167], v8 offset:4096
v_cvt_pk_bf16_f32 v142, v136, v137
v_mfma_f32_16x16x32_bf16 v[108:111], v[184:187], v[248:251], v[108:111]
buffer_load_dwordx4 v4, s[8:11], s24 offen offset:1024 sc1 lds
v_mfma_f32_16x16x32_bf16 v[112:115], v[184:187], v[252:255], v[112:115]
ds_read_b128 v[168:171], v8 offset:5120
v_cvt_pk_bf16_f32 v143, v138, v139
v_mfma_f32_16x16x32_bf16 v[112:115], v[180:183], v[236:239], v[112:115]
v_permlane16_swap_b32 v140, v142
v_mfma_f32_16x16x32_bf16 v[120:123], v[188:191], v[236:239], v[120:123]
ds_read_b128 v[172:175], v8 offset:6144
v_mfma_f32_16x16x32_bf16 v[120:123], v[192:195], v[252:255], v[120:123]
v_permlane16_swap_b32 v141, v143
v_mfma_f32_16x16x32_bf16 v[116:119], v[192:195], v[248:251], v[116:119]
ds_read_b128 v[176:179], v8 offset:7168
v_mfma_f32_16x16x32_bf16 v[116:119], v[188:191], v[232:235], v[116:119]
s_waitcnt lgkmcnt(4)
buffer_load_dwordx4 v4, s[8:11], s24 offen offset:2048 sc1 lds
buffer_store_dwordx4 v[140:143], v9, s[8:11], s26 offen sc1
s_add_u32 s26, s26, 4096
v_mfma_f32_16x16x32_bf16 v[28:31], v[148:151], a[0:3], 0
Lcw0:
buffer_store_dwordx4 v[196:199], v212, s[8:11], 0 offen sc1
v_mfma_f32_16x16x32_bf16 v[28:31], v[152:155], a[16:19], v[28:31]
ds_read_b128 v[180:183], v8 offset:8192
ds_read_b128 v[196:199], v220 offset:0
v_mfma_f32_16x16x32_bf16 v[32:35], v[152:155], a[20:23], 0
v_mul_f32 v124, v76, v76
v_mul_f32 v125, v77, v77
v_mfma_f32_16x16x32_bf16 v[32:35], v[148:151], a[4:7], v[32:35]
v_mul_f32 v126, v78, v78
v_mul_f32 v127, v79, v79
v_mfma_f32_16x16x32_bf16 v[44:47], v[148:151], a[8:11], 0
v_fma_f32 v124, v124, v22, v18
v_fma_f32 v125, v125, v22, v18
v_mfma_f32_16x16x32_bf16 v[44:47], v[152:155], a[24:27], v[44:47]
ds_read_b128 v[184:187], v8 offset:9216
v_fma_f32 v126, v126, v22, v18
v_mfma_f32_16x16x32_bf16 v[48:51], v[152:155], a[28:31], 0
buffer_load_dwordx4 v4, s[8:11], s24 offen offset:3072 sc1 lds
v_mfma_f32_16x16x32_bf16 v[48:51], v[148:151], a[12:15], v[48:51]
s_add_u32 s24, s24, 4096
v_fma_f32 v127, v127, v22, v18
v_mul_f32 v124, v124, v76
v_mfma_f32_16x16x32_bf16 v[56:59], v[156:159], a[12:15], 0
v_exp_f32 v124, v124
v_mfma_f32_16x16x32_bf16 v[56:59], v[160:163], a[28:31], v[56:59]
ds_read_b128 v[188:191], v8 offset:10240
v_mul_f32 v125, v125, v77
v_mfma_f32_16x16x32_bf16 v[52:55], v[160:163], a[24:27], 0
v_exp_f32 v125, v125
v_mfma_f32_16x16x32_bf16 v[52:55], v[156:159], a[8:11], v[52:55]
s_add_u32 m0, s25, 4096
v_mul_f32 v126, v126, v78
v_mul_f32 v127, v127, v79
v_mfma_f32_16x16x32_bf16 v[40:43], v[156:159], a[4:7], 0
buffer_load_dwordx4 v4, s[8:11], s24 offen offset:0 sc1 lds
v_mfma_f32_16x16x32_bf16 v[40:43], v[160:163], a[20:23], v[40:43]
ds_read_b128 v[192:195], v8 offset:11264
v_mul_f32 v128, v76, v84
v_mfma_f32_16x16x32_bf16 v[36:39], v[160:163], a[16:19], 0
v_exp_f32 v126, v126
v_mfma_f32_16x16x32_bf16 v[36:39], v[156:159], a[0:3], v[36:39]
s_waitcnt lgkmcnt(5)
v_exp_f32 v127, v127
v_mfma_f32_16x16x32_bf16 v[28:31], v[164:167], a[32:35], v[28:31]
v_mul_f32 v129, v77, v85
v_mul_f32 v130, v78, v86
v_mfma_f32_16x16x32_bf16 v[28:31], v[168:171], a[48:51], v[28:31]
ds_read_b128 v[148:151], v8 offset:12288
v_mul_f32 v131, v79, v87
v_mfma_f32_16x16x32_bf16 v[32:35], v[168:171], a[52:55], v[32:35]
buffer_load_dwordx4 v4, s[8:11], s24 offen offset:1024 sc1 lds
v_mfma_f32_16x16x32_bf16 v[32:35], v[164:167], a[36:39], v[32:35]
v_fma_f32 v124, v124, v26, v26
v_fma_f32 v125, v125, v26, v26
v_mfma_f32_16x16x32_bf16 v[44:47], v[164:167], a[40:43], v[44:47]
s_barrier
v_mfma_f32_16x16x32_bf16 v[44:47], v[168:171], a[56:59], v[44:47]
ds_read_b128 v[152:155], v8 offset:13312
v_fma_f32 v126, v126, v26, v26
v_mfma_f32_16x16x32_bf16 v[48:51], v[168:171], a[60:63], v[48:51]
v_rcp_f32 v124, v124
v_mfma_f32_16x16x32_bf16 v[48:51], v[164:167], a[44:47], v[48:51]
v_rcp_f32 v125, v125
v_mfma_f32_16x16x32_bf16 v[56:59], v[172:175], a[44:47], v[56:59]
buffer_load_dwordx4 v4, s[8:11], s24 offen offset:2048 sc1 lds
v_mfma_f32_16x16x32_bf16 v[56:59], v[176:179], a[60:63], v[56:59]
ds_read_b128 v[156:159], v8 offset:14336
v_fma_f32 v127, v127, v26, v26
v_mfma_f32_16x16x32_bf16 v[52:55], v[176:179], a[56:59], v[52:55]
v_rcp_f32 v126, v126
v_mfma_f32_16x16x32_bf16 v[52:55], v[172:175], a[40:43], v[52:55]
buffer_store_dwordx4 v[200:203], v213, s[8:11], 0 offen sc1
v_mfma_f32_16x16x32_bf16 v[40:43], v[172:175], a[36:39], v[40:43]
s_nop 0
ds_read_b128 v[200:203], v220 offset:1024
v_mul_f32 v128, v128, v124
v_mfma_f32_16x16x32_bf16 v[40:43], v[176:179], a[52:55], v[40:43]
ds_read_b128 v[160:163], v8 offset:15360
v_mul_f32 v129, v129, v125
v_mfma_f32_16x16x32_bf16 v[36:39], v[176:179], a[48:51], v[36:39]
v_rcp_f32 v127, v127
v_mfma_f32_16x16x32_bf16 v[36:39], v[172:175], a[32:35], v[36:39]
s_waitcnt lgkmcnt(5)
buffer_load_dwordx4 v4, s[8:11], s24 offen offset:3072 sc1 lds
v_mfma_f32_16x16x32_bf16 v[28:31], v[180:183], a[64:67], v[28:31]
s_add_u32 s24, s24, 4096
v_mul_f32 v130, v130, v126
v_mul_f32 v131, v131, v127
v_mfma_f32_16x16x32_bf16 v[28:31], v[184:187], a[80:83], v[28:31]
ds_read_b128 v[164:167], v8 offset:16384
v_cvt_pk_bf16_f32 v144, v128, v129
v_mfma_f32_16x16x32_bf16 v[32:35], v[184:187], a[84:87], v[32:35]
v_cvt_pk_bf16_f32 v145, v130, v131
v_mul_f32 v132, v80, v80
v_mfma_f32_16x16x32_bf16 v[32:35], v[180:183], a[68:71], v[32:35]
v_mul_f32 v133, v81, v81
v_mul_f32 v134, v82, v82
v_mfma_f32_16x16x32_bf16 v[44:47], v[180:183], a[72:75], v[44:47]
v_mul_f32 v135, v83, v83
v_fma_f32 v132, v132, v23, v19
v_mfma_f32_16x16x32_bf16 v[44:47], v[184:187], a[88:91], v[44:47]
s_add_u32 m0, s25, 8192
ds_read_b128 v[168:171], v8 offset:17408
v_fma_f32 v133, v133, v23, v19
v_mfma_f32_16x16x32_bf16 v[48:51], v[184:187], a[92:95], v[48:51]
buffer_load_dwordx4 v4, s[8:11], s24 offen offset:0 sc1 lds
v_mfma_f32_16x16x32_bf16 v[48:51], v[180:183], a[76:79], v[48:51]
s_add_u32 s24, s24, 28672
v_fma_f32 v134, v134, v23, v19
v_fma_f32 v135, v135, v23, v19
v_mfma_f32_16x16x32_bf16 v[56:59], v[188:191], a[76:79], v[56:59]
v_mul_f32 v132, v132, v80
v_mul_f32 v133, v133, v81
v_mfma_f32_16x16x32_bf16 v[56:59], v[192:195], a[92:95], v[56:59]
ds_read_b128 v[172:175], v8 offset:18432
v_mul_f32 v134, v134, v82
v_mfma_f32_16x16x32_bf16 v[52:55], v[192:195], a[88:91], v[52:55]
v_exp_f32 v132, v132
v_mfma_f32_16x16x32_bf16 v[52:55], v[188:191], a[72:75], v[52:55]
v_exp_f32 v133, v133
v_mfma_f32_16x16x32_bf16 v[40:43], v[188:191], a[68:71], v[40:43]
v_exp_f32 v134, v134
v_mfma_f32_16x16x32_bf16 v[40:43], v[192:195], a[84:87], v[40:43]
ds_read_b128 v[176:179], v8 offset:19456
v_mul_f32 v135, v135, v83
v_mfma_f32_16x16x32_bf16 v[36:39], v[192:195], a[80:83], v[36:39]
v_exp_f32 v135, v135
v_mfma_f32_16x16x32_bf16 v[36:39], v[188:191], a[64:67], v[36:39]
s_waitcnt lgkmcnt(4)
v_mul_f32 v136, v80, v88
v_mul_f32 v137, v81, v89
v_mfma_f32_16x16x32_bf16 v[28:31], v[148:151], a[96:99], v[28:31]
v_mul_f32 v138, v82, v90
v_mul_f32 v139, v83, v91
v_mfma_f32_16x16x32_bf16 v[28:31], v[152:155], a[112:115], v[28:31]
ds_read_b128 v[180:183], v8 offset:20480
v_fma_f32 v132, v132, v27, v27
v_mfma_f32_16x16x32_bf16 v[32:35], v[152:155], a[116:119], v[32:35]
s_add_u32 m0, s25, 36864
v_rcp_f32 v132, v132
v_mfma_f32_16x16x32_bf16 v[32:35], v[148:151], a[100:103], v[32:35]
buffer_load_dwordx4 v4, s[8:11], s24 offen offset:0 sc1 lds
v_mfma_f32_16x16x32_bf16 v[44:47], v[148:151], a[104:107], v[44:47]
v_fma_f32 v133, v133, v27, v27
v_fma_f32 v134, v134, v27, v27
v_mfma_f32_16x16x32_bf16 v[44:47], v[152:155], a[120:123], v[44:47]
ds_read_b128 v[184:187], v8 offset:21504
v_fma_f32 v135, v135, v27, v27
v_mfma_f32_16x16x32_bf16 v[48:51], v[152:155], a[124:127], v[48:51]
buffer_store_dwordx4 v[204:207], v214, s[8:11], 0 offen sc1
v_mfma_f32_16x16x32_bf16 v[48:51], v[148:151], a[108:111], v[48:51]
s_nop 0
ds_read_b128 v[204:207], v220 offset:2048
v_mul_f32 v136, v136, v132
v_mfma_f32_16x16x32_bf16 v[56:59], v[156:159], a[108:111], v[56:59]
v_rcp_f32 v133, v133
v_mfma_f32_16x16x32_bf16 v[56:59], v[160:163], a[124:127], v[56:59]
ds_read_b128 v[188:191], v8 offset:22528
v_mul_f32 v137, v137, v133
v_mfma_f32_16x16x32_bf16 v[52:55], v[160:163], a[120:123], v[52:55]
buffer_load_dwordx4 v4, s[8:11], s24 offen offset:1024 sc1 lds
v_mfma_f32_16x16x32_bf16 v[52:55], v[156:159], a[104:107], v[52:55]
v_rcp_f32 v134, v134
v_mfma_f32_16x16x32_bf16 v[40:43], v[156:159], a[100:103], v[40:43]
v_rcp_f32 v135, v135
v_mfma_f32_16x16x32_bf16 v[40:43], v[160:163], a[116:119], v[40:43]
ds_read_b128 v[192:195], v8 offset:23552
v_mul_f32 v138, v138, v134
v_mfma_f32_16x16x32_bf16 v[36:39], v[160:163], a[112:115], v[36:39]
v_mul_f32 v139, v139, v135
v_cvt_pk_bf16_f32 v146, v136, v137
v_mfma_f32_16x16x32_bf16 v[36:39], v[156:159], a[96:99], v[36:39]
s_waitcnt lgkmcnt(5)
v_permlane16_swap_b32 v144, v146
v_mfma_f32_16x16x32_bf16 v[28:31], v[164:167], a[128:131], v[28:31]
buffer_load_dwordx4 v4, s[8:11], s24 offen offset:2048 sc1 lds
v_mfma_f32_16x16x32_bf16 v[28:31], v[168:171], a[144:147], v[28:31]
ds_read_b128 v[148:151], v8 offset:24576
v_cvt_pk_bf16_f32 v147, v138, v139
v_mfma_f32_16x16x32_bf16 v[32:35], v[168:171], a[148:151], v[32:35]
s_nop 0
v_permlane16_swap_b32 v145, v147
v_mfma_f32_16x16x32_bf16 v[32:35], v[164:167], a[132:135], v[32:35]
buffer_store_dwordx4 v[144:147], v9, s[8:11], s27 offen sc1
v_mfma_f32_16x16x32_bf16 v[44:47], v[164:167], a[136:139], v[44:47]
s_add_u32 s27, s27, 4096
v_mul_f32 v124, v92, v92
v_mul_f32 v125, v93, v93
v_mfma_f32_16x16x32_bf16 v[44:47], v[168:171], a[152:155], v[44:47]
ds_read_b128 v[152:155], v8 offset:25600
v_mul_f32 v126, v94, v94
v_mfma_f32_16x16x32_bf16 v[48:51], v[168:171], a[156:159], v[48:51]
v_mul_f32 v127, v95, v95
v_fma_f32 v124, v124, v22, v18
v_mfma_f32_16x16x32_bf16 v[48:51], v[164:167], a[140:143], v[48:51]
v_fma_f32 v125, v125, v22, v18
v_fma_f32 v126, v126, v22, v18
v_mfma_f32_16x16x32_bf16 v[56:59], v[172:175], a[140:143], v[56:59]
buffer_load_dwordx4 v4, s[8:11], s24 offen offset:3072 sc1 lds
v_mfma_f32_16x16x32_bf16 v[56:59], v[176:179], a[156:159], v[56:59]
s_add_u32 s24, s24, 4096
ds_read_b128 v[156:159], v8 offset:26624
v_fma_f32 v127, v127, v22, v18
v_mfma_f32_16x16x32_bf16 v[52:55], v[176:179], a[152:155], v[52:55]
v_mul_f32 v124, v124, v92
v_mul_f32 v125, v125, v93
v_mfma_f32_16x16x32_bf16 v[52:55], v[172:175], a[136:139], v[52:55]
v_exp_f32 v124, v124
v_mfma_f32_16x16x32_bf16 v[40:43], v[172:175], a[132:135], v[40:43]
v_exp_f32 v125, v125
v_mfma_f32_16x16x32_bf16 v[40:43], v[176:179], a[148:151], v[40:43]
ds_read_b128 v[160:163], v8 offset:27648
v_mul_f32 v126, v126, v94
v_mfma_f32_16x16x32_bf16 v[36:39], v[176:179], a[144:147], v[36:39]
s_add_u32 m0, s25, 40960
v_exp_f32 v126, v126
v_mfma_f32_16x16x32_bf16 v[36:39], v[172:175], a[128:131], v[36:39]
s_waitcnt lgkmcnt(4)
buffer_load_dwordx4 v4, s[8:11], s24 offen offset:0 sc1 lds
v_mfma_f32_16x16x32_bf16 v[28:31], v[180:183], a[160:163], v[28:31]
buffer_store_dwordx4 v[208:211], v215, s[8:11], 0 offen sc1
v_mfma_f32_16x16x32_bf16 v[28:31], v[184:187], a[176:179], v[28:31]
ds_read_b128 v[164:167], v8 offset:28672
ds_read_b128 v[208:211], v220 offset:3072
v_mfma_f32_16x16x32_bf16 v[32:35], v[184:187], a[180:183], v[32:35]
v_mul_f32 v127, v127, v95
v_mul_f32 v128, v92, v100
v_mfma_f32_16x16x32_bf16 v[32:35], v[180:183], a[164:167], v[32:35]
v_exp_f32 v127, v127
v_mfma_f32_16x16x32_bf16 v[44:47], v[180:183], a[168:171], v[44:47]
v_mul_f32 v129, v93, v101
v_mul_f32 v130, v94, v102
v_mfma_f32_16x16x32_bf16 v[44:47], v[184:187], a[184:187], v[44:47]
ds_read_b128 v[168:171], v8 offset:29696
v_mul_f32 v131, v95, v103
v_mfma_f32_16x16x32_bf16 v[48:51], v[184:187], a[188:191], v[48:51]
v_fma_f32 v124, v124, v26, v26
v_fma_f32 v125, v125, v26, v26
v_mfma_f32_16x16x32_bf16 v[48:51], v[180:183], a[172:175], v[48:51]
buffer_load_dwordx4 v4, s[8:11], s24 offen offset:1024 sc1 lds
v_mfma_f32_16x16x32_bf16 v[56:59], v[188:191], a[172:175], v[56:59]
v_rcp_f32 v124, v124
v_mfma_f32_16x16x32_bf16 v[56:59], v[192:195], a[188:191], v[56:59]
ds_read_b128 v[172:175], v8 offset:30720
v_fma_f32 v126, v126, v26, v26
v_mfma_f32_16x16x32_bf16 v[52:55], v[192:195], a[184:187], v[52:55]
v_rcp_f32 v125, v125
v_mfma_f32_16x16x32_bf16 v[52:55], v[188:191], a[168:171], v[52:55]
v_rcp_f32 v126, v126
v_mfma_f32_16x16x32_bf16 v[40:43], v[188:191], a[164:167], v[40:43]
v_fma_f32 v127, v127, v26, v26
v_mul_f32 v128, v128, v124
v_mfma_f32_16x16x32_bf16 v[40:43], v[192:195], a[180:183], v[40:43]
ds_read_b128 v[176:179], v8 offset:31744
v_mul_f32 v129, v129, v125
v_mfma_f32_16x16x32_bf16 v[36:39], v[192:195], a[176:179], v[36:39]
v_rcp_f32 v127, v127
v_mfma_f32_16x16x32_bf16 v[36:39], v[188:191], a[160:163], v[36:39]
s_waitcnt lgkmcnt(5)
buffer_load_dwordx4 v4, s[8:11], s24 offen offset:2048 sc1 lds
v_mfma_f32_16x16x32_bf16 v[28:31], v[148:151], a[192:195], v[28:31]
v_mul_f32 v130, v130, v126
v_mul_f32 v131, v131, v127
v_mfma_f32_16x16x32_bf16 v[28:31], v[152:155], a[208:211], v[28:31]
ds_read_b128 v[180:183], v8 offset:32768
v_cvt_pk_bf16_f32 v140, v128, v129
v_mfma_f32_16x16x32_bf16 v[32:35], v[152:155], a[212:215], v[32:35]
v_cvt_pk_bf16_f32 v141, v130, v131
v_mul_f32 v132, v96, v96
v_mfma_f32_16x16x32_bf16 v[32:35], v[148:151], a[196:199], v[32:35]
v_mul_f32 v133, v97, v97
v_mul_f32 v134, v98, v98
v_mfma_f32_16x16x32_bf16 v[44:47], v[148:151], a[200:203], v[44:47]
v_mul_f32 v135, v99, v99
v_fma_f32 v132, v132, v23, v19
v_mfma_f32_16x16x32_bf16 v[44:47], v[152:155], a[216:219], v[44:47]
ds_read_b128 v[184:187], v8 offset:33792
v_fma_f32 v133, v133, v23, v19
v_mfma_f32_16x16x32_bf16 v[48:51], v[152:155], a[220:223], v[48:51]
buffer_load_dwordx4 v4, s[8:11], s24 offen offset:3072 sc1 lds
v_mfma_f32_16x16x32_bf16 v[48:51], v[148:151], a[204:207], v[48:51]
s_add_u32 s24, s24, 4096
v_fma_f32 v134, v134, v23, v19
v_fma_f32 v135, v135, v23, v19
v_mfma_f32_16x16x32_bf16 v[56:59], v[156:159], a[204:207], v[56:59]
v_mul_f32 v132, v132, v96
v_mul_f32 v133, v133, v97
v_mfma_f32_16x16x32_bf16 v[56:59], v[160:163], a[220:223], v[56:59]
ds_read_b128 v[188:191], v8 offset:34816
v_mul_f32 v134, v134, v98
v_mfma_f32_16x16x32_bf16 v[52:55], v[160:163], a[216:219], v[52:55]
v_exp_f32 v132, v132
v_mfma_f32_16x16x32_bf16 v[52:55], v[156:159], a[200:203], v[52:55]
buffer_store_dwordx4 v[196:199], v216, s[8:11], 0 offen sc1
v_mfma_f32_16x16x32_bf16 v[40:43], v[156:159], a[196:199], v[40:43]
v_exp_f32 v133, v133
v_mfma_f32_16x16x32_bf16 v[40:43], v[160:163], a[212:215], v[40:43]
s_add_u32 m0, s25, 45056
ds_read_b128 v[192:195], v8 offset:35840
v_mul_f32 v135, v135, v99
v_mfma_f32_16x16x32_bf16 v[36:39], v[160:163], a[208:211], v[36:39]
buffer_load_dwordx4 v4, s[8:11], s24 offen offset:0 sc1 lds
v_mfma_f32_16x16x32_bf16 v[36:39], v[156:159], a[192:195], v[36:39]
s_waitcnt lgkmcnt(4)
s_add_u32 s24, s24, 28672
v_mul_f32 v136, v96, v104
v_mfma_f32_16x16x32_bf16 v[28:31], v[164:167], a[224:227], v[28:31]
v_exp_f32 v134, v134
v_mfma_f32_16x16x32_bf16 v[28:31], v[168:171], a[240:243], v[28:31]
s_waitcnt vmcnt(13)
s_barrier
ds_read_b128 v[148:151], v5 offset:0
v_mfma_f32_16x16x32_bf16 v[32:35], v[168:171], a[244:247], v[32:35]
v_exp_f32 v135, v135
v_mfma_f32_16x16x32_bf16 v[32:35], v[164:167], a[228:231], v[32:35]
v_mul_f32 v137, v97, v105
v_mul_f32 v138, v98, v106
v_mfma_f32_16x16x32_bf16 v[44:47], v[164:167], a[232:235], v[44:47]
s_add_u32 m0, s25, 73728
v_mul_f32 v139, v99, v107
v_fma_f32 v132, v132, v27, v27
v_mfma_f32_16x16x32_bf16 v[44:47], v[168:171], a[248:251], v[44:47]
ds_read_b128 v[152:155], v5 offset:1024
v_fma_f32 v133, v133, v27, v27
v_mfma_f32_16x16x32_bf16 v[48:51], v[168:171], a[252:255], v[48:51]
buffer_load_dwordx4 v4, s[8:11], s24 offen offset:0 sc1 lds
v_mfma_f32_16x16x32_bf16 v[48:51], v[164:167], a[236:239], v[48:51]
v_rcp_f32 v132, v132
v_mfma_f32_16x16x32_bf16 v[56:59], v[172:175], a[236:239], v[56:59]
v_rcp_f32 v133, v133
v_mfma_f32_16x16x32_bf16 v[56:59], v[176:179], a[252:255], v[56:59]
ds_read_b128 v[156:159], v5 offset:2048
v_fma_f32 v134, v134, v27, v27
v_mfma_f32_16x16x32_bf16 v[52:55], v[176:179], a[248:251], v[52:55]
v_rcp_f32 v134, v134
v_mfma_f32_16x16x32_bf16 v[52:55], v[172:175], a[232:235], v[52:55]
v_fma_f32 v135, v135, v27, v27
v_mul_f32 v136, v136, v132
v_mfma_f32_16x16x32_bf16 v[40:43], v[172:175], a[228:231], v[40:43]
v_rcp_f32 v135, v135
v_mfma_f32_16x16x32_bf16 v[40:43], v[176:179], a[244:247], v[40:43]
ds_read_b128 v[160:163], v5 offset:3072
v_mul_f32 v137, v137, v133
v_mfma_f32_16x16x32_bf16 v[36:39], v[176:179], a[240:243], v[36:39]
v_mul_f32 v138, v138, v134
v_mul_f32 v139, v139, v135
v_mfma_f32_16x16x32_bf16 v[36:39], v[172:175], a[224:227], v[36:39]
s_waitcnt lgkmcnt(4)
v_cvt_pk_bf16_f32 v142, v136, v137
v_cvt_pk_bf16_f32 v143, v138, v139
v_mfma_f32_16x16x32_bf16 v[28:31], v[180:183], v[224:227], v[28:31]
v_permlane16_swap_b32 v140, v142
v_mfma_f32_16x16x32_bf16 v[28:31], v[184:187], v[240:243], v[28:31]
ds_read_b128 v[164:167], v5 offset:4096
v_mfma_f32_16x16x32_bf16 v[32:35], v[184:187], v[244:247], v[32:35]
v_permlane16_swap_b32 v141, v143
v_mfma_f32_16x16x32_bf16 v[32:35], v[180:183], v[228:231], v[32:35]
buffer_store_dwordx4 v[140:143], v9, s[8:11], s27 offen sc1
v_mfma_f32_16x16x32_bf16 v[44:47], v[180:183], v[232:235], v[44:47]
buffer_load_dwordx4 v4, s[8:11], s24 offen offset:1024 sc1 lds
v_mfma_f32_16x16x32_bf16 v[44:47], v[184:187], v[248:251], v[44:47]
ds_read_b128 v[168:171], v5 offset:5120
v_mfma_f32_16x16x32_bf16 v[48:51], v[184:187], v[252:255], v[48:51]
buffer_store_dwordx4 v[200:203], v217, s[8:11], 0 offen sc1
v_mfma_f32_16x16x32_bf16 v[48:51], v[180:183], v[236:239], v[48:51]
v_mfma_f32_16x16x32_bf16 v[56:59], v[188:191], v[236:239], v[56:59]
v_mfma_f32_16x16x32_bf16 v[56:59], v[192:195], v[252:255], v[56:59]
ds_read_b128 v[172:175], v5 offset:6144
v_mfma_f32_16x16x32_bf16 v[52:55], v[192:195], v[248:251], v[52:55]
v_mfma_f32_16x16x32_bf16 v[52:55], v[188:191], v[232:235], v[52:55]
v_mfma_f32_16x16x32_bf16 v[40:43], v[188:191], v[228:231], v[40:43]
v_mfma_f32_16x16x32_bf16 v[40:43], v[192:195], v[244:247], v[40:43]
ds_read_b128 v[176:179], v5 offset:7168
v_mfma_f32_16x16x32_bf16 v[36:39], v[192:195], v[240:243], v[36:39]
v_mfma_f32_16x16x32_bf16 v[36:39], v[188:191], v[224:227], v[36:39]
s_waitcnt lgkmcnt(4)
s_add_u32 s27, s27, 4096
v_mfma_f32_16x16x32_bf16 v[60:63], v[148:151], a[0:3], 0
v_mfma_f32_16x16x32_bf16 v[60:63], v[152:155], a[16:19], v[60:63]
ds_read_b128 v[180:183], v5 offset:8192
v_mfma_f32_16x16x32_bf16 v[64:67], v[152:155], a[20:23], 0
v_mul_f32 v124, v108, v108
v_mul_f32 v125, v109, v109
v_mul_f32 v126, v110, v110
v_mfma_f32_16x16x32_bf16 v[64:67], v[148:151], a[4:7], v[64:67]
v_mul_f32 v127, v111, v111
v_fma_f32 v124, v124, v22, v18
v_mfma_f32_16x16x32_bf16 v[76:79], v[148:151], a[8:11], 0
s_add_u32 s83, s82, Lcw1-Lcp
v_fma_f32 v125, v125, v22, v18
v_fma_f32 v126, v126, v22, v18
v_mfma_f32_16x16x32_bf16 v[76:79], v[152:155], a[24:27], v[76:79]
s_min_u32 s83, s83, Lcode_end-Lcp-4
ds_read_b128 v[184:187], v5 offset:9216
v_fma_f32 v127, v127, v22, v18
v_mfma_f32_16x16x32_bf16 v[80:83], v[152:155], a[28:31], 0
buffer_load_dwordx4 v4, s[8:11], s24 offen offset:2048 sc1 lds
v_mfma_f32_16x16x32_bf16 v[80:83], v[148:151], a[12:15], v[80:83]
v_mov_b32 v222, s83
v_mul_f32 v124, v124, v108
v_mfma_f32_16x16x32_bf16 v[88:91], v[156:159], a[12:15], 0
global_load_dword v223, v222, s[80:81]
v_mfma_f32_16x16x32_bf16 v[88:91], v[160:163], a[28:31], v[88:91]
ds_read_b128 v[188:191], v5 offset:10240
v_mul_f32 v125, v125, v109
v_mfma_f32_16x16x32_bf16 v[84:87], v[160:163], a[24:27], 0
v_exp_f32 v124, v124
v_mfma_f32_16x16x32_bf16 v[84:87], v[156:159], a[8:11], v[84:87]
v_exp_f32 v125, v125
v_mfma_f32_16x16x32_bf16 v[72:75], v[156:159], a[4:7], 0
v_mul_f32 v126, v126, v110
v_mul_f32 v127, v127, v111
v_mfma_f32_16x16x32_bf16 v[72:75], v[160:163], a[20:23], v[72:75]
ds_read_b128 v[192:195], v5 offset:11264
v_mul_f32 v128, v108, v116
v_mfma_f32_16x16x32_bf16 v[68:71], v[160:163], a[16:19], 0
v_exp_f32 v126, v126
v_mfma_f32_16x16x32_bf16 v[68:71], v[156:159], a[0:3], v[68:71]
s_waitcnt lgkmcnt(4)
v_exp_f32 v127, v127
v_mfma_f32_16x16x32_bf16 v[60:63], v[164:167], a[32:35], v[60:63]
buffer_store_dwordx4 v[204:207], v218, s[8:11], 0 offen sc1
v_mfma_f32_16x16x32_bf16 v[60:63], v[168:171], a[48:51], v[60:63]
ds_read_b128 v[148:151], v5 offset:12288
v_mul_f32 v129, v109, v117
v_mfma_f32_16x16x32_bf16 v[64:67], v[168:171], a[52:55], v[64:67]
v_mul_f32 v130, v110, v118
v_mul_f32 v131, v111, v119
v_mfma_f32_16x16x32_bf16 v[64:67], v[164:167], a[36:39], v[64:67]
v_fma_f32 v124, v124, v26, v26
v_fma_f32 v125, v125, v26, v26
v_mfma_f32_16x16x32_bf16 v[76:79], v[164:167], a[40:43], v[76:79]
v_rcp_f32 v124, v124
v_mfma_f32_16x16x32_bf16 v[76:79], v[168:171], a[56:59], v[76:79]
ds_read_b128 v[152:155], v5 offset:13312
v_fma_f32 v126, v126, v26, v26
v_mfma_f32_16x16x32_bf16 v[80:83], v[168:171], a[60:63], v[80:83]
buffer_load_dwordx4 v4, s[8:11], s24 offen offset:3072 sc1 lds
v_mfma_f32_16x16x32_bf16 v[80:83], v[164:167], a[44:47], v[80:83]
s_add_u32 s24, s24, 4096
v_rcp_f32 v125, v125
v_mfma_f32_16x16x32_bf16 v[88:91], v[172:175], a[44:47], v[88:91]
v_rcp_f32 v126, v126
v_mfma_f32_16x16x32_bf16 v[88:91], v[176:179], a[60:63], v[88:91]
ds_read_b128 v[156:159], v5 offset:14336
v_fma_f32 v127, v127, v26, v26
v_mfma_f32_16x16x32_bf16 v[84:87], v[176:179], a[56:59], v[84:87]
v_rcp_f32 v127, v127
v_mfma_f32_16x16x32_bf16 v[84:87], v[172:175], a[40:43], v[84:87]
v_mul_f32 v128, v128, v124
v_mul_f32 v129, v129, v125
v_mfma_f32_16x16x32_bf16 v[72:75], v[172:175], a[36:39], v[72:75]
v_mul_f32 v130, v130, v126
v_mul_f32 v131, v131, v127
v_mfma_f32_16x16x32_bf16 v[72:75], v[176:179], a[52:55], v[72:75]
ds_read_b128 v[160:163], v5 offset:15360
v_cvt_pk_bf16_f32 v144, v128, v129
v_mfma_f32_16x16x32_bf16 v[68:71], v[176:179], a[48:51], v[68:71]
v_cvt_pk_bf16_f32 v145, v130, v131
v_mul_f32 v132, v112, v112
v_mfma_f32_16x16x32_bf16 v[68:71], v[172:175], a[32:35], v[68:71]
s_waitcnt lgkmcnt(4)
v_mul_f32 v133, v113, v113
v_mul_f32 v134, v114, v114
v_mfma_f32_16x16x32_bf16 v[60:63], v[180:183], a[64:67], v[60:63]
v_mul_f32 v135, v115, v115
v_fma_f32 v132, v132, v23, v19
v_mfma_f32_16x16x32_bf16 v[60:63], v[184:187], a[80:83], v[60:63]
ds_read_b128 v[164:167], v5 offset:16384
v_fma_f32 v133, v133, v23, v19
v_mfma_f32_16x16x32_bf16 v[64:67], v[184:187], a[84:87], v[64:67]
v_fma_f32 v134, v134, v23, v19
v_fma_f32 v135, v135, v23, v19
v_mfma_f32_16x16x32_bf16 v[64:67], v[180:183], a[68:71], v[64:67]
v_mul_f32 v132, v132, v112
v_mul_f32 v133, v133, v113
v_mfma_f32_16x16x32_bf16 v[76:79], v[180:183], a[72:75], v[76:79]
v_exp_f32 v132, v132
v_mfma_f32_16x16x32_bf16 v[76:79], v[184:187], a[88:91], v[76:79]
ds_read_b128 v[168:171], v5 offset:17408
v_mul_f32 v134, v134, v114
v_mfma_f32_16x16x32_bf16 v[80:83], v[184:187], a[92:95], v[80:83]
s_add_u32 m0, s25, 77824
v_exp_f32 v133, v133
v_mfma_f32_16x16x32_bf16 v[80:83], v[180:183], a[76:79], v[80:83]
buffer_load_dwordx4 v4, s[8:11], s24 offen offset:0 sc1 lds
v_mfma_f32_16x16x32_bf16 v[88:91], v[188:191], a[76:79], v[88:91]
v_exp_f32 v134, v134
v_mfma_f32_16x16x32_bf16 v[88:91], v[192:195], a[92:95], v[88:91]
ds_read_b128 v[172:175], v5 offset:18432
v_mul_f32 v135, v135, v115
v_mfma_f32_16x16x32_bf16 v[84:87], v[192:195], a[88:91], v[84:87]
v_exp_f32 v135, v135
v_mfma_f32_16x16x32_bf16 v[84:87], v[188:191], a[72:75], v[84:87]
v_mul_f32 v136, v112, v120
v_mul_f32 v137, v113, v121
v_mfma_f32_16x16x32_bf16 v[72:75], v[188:191], a[68:71], v[72:75]
buffer_store_dwordx4 v[208:211], v219, s[8:11], 0 offen sc1
v_mfma_f32_16x16x32_bf16 v[72:75], v[192:195], a[84:87], v[72:75]
ds_read_b128 v[176:179], v5 offset:19456
v_mul_f32 v138, v114, v122
v_mfma_f32_16x16x32_bf16 v[68:71], v[192:195], a[80:83], v[68:71]
v_mul_f32 v139, v115, v123
v_fma_f32 v132, v132, v27, v27
v_mfma_f32_16x16x32_bf16 v[68:71], v[188:191], a[64:67], v[68:71]
s_waitcnt lgkmcnt(4)
v_rcp_f32 v132, v132
v_mfma_f32_16x16x32_bf16 v[60:63], v[148:151], a[96:99], v[60:63]
v_fma_f32 v133, v133, v27, v27
v_fma_f32 v134, v134, v27, v27
v_mfma_f32_16x16x32_bf16 v[60:63], v[152:155], a[112:115], v[60:63]
ds_read_b128 v[180:183], v5 offset:20480
v_fma_f32 v135, v135, v27, v27
v_mfma_f32_16x16x32_bf16 v[64:67], v[152:155], a[116:119], v[64:67]
v_rcp_f32 v133, v133
v_mfma_f32_16x16x32_bf16 v[64:67], v[148:151], a[100:103], v[64:67]
v_rcp_f32 v134, v134
v_mfma_f32_16x16x32_bf16 v[76:79], v[148:151], a[104:107], v[76:79]
v_rcp_f32 v135, v135
v_mfma_f32_16x16x32_bf16 v[76:79], v[152:155], a[120:123], v[76:79]
ds_read_b128 v[184:187], v5 offset:21504
v_mul_f32 v136, v136, v132
v_mfma_f32_16x16x32_bf16 v[80:83], v[152:155], a[124:127], v[80:83]
v_mul_f32 v137, v137, v133
v_mul_f32 v138, v138, v134
v_mfma_f32_16x16x32_bf16 v[80:83], v[148:151], a[108:111], v[80:83]
v_mul_f32 v139, v139, v135
v_cvt_pk_bf16_f32 v146, v136, v137
v_mfma_f32_16x16x32_bf16 v[88:91], v[156:159], a[108:111], v[88:91]
buffer_load_dwordx4 v4, s[8:11], s24 offen offset:1024 sc1 lds
v_mfma_f32_16x16x32_bf16 v[88:91], v[160:163], a[124:127], v[88:91]
ds_read_b128 v[188:191], v5 offset:22528
v_cvt_pk_bf16_f32 v147, v138, v139
v_mfma_f32_16x16x32_bf16 v[84:87], v[160:163], a[120:123], v[84:87]
v_permlane16_swap_b32 v144, v146
v_mfma_f32_16x16x32_bf16 v[84:87], v[156:159], a[104:107], v[84:87]
v_permlane16_swap_b32 v145, v147
v_mfma_f32_16x16x32_bf16 v[72:75], v[156:159], a[100:103], v[72:75]
buffer_store_dwordx4 v[144:147], v9, s[8:11], s27 offen sc1
v_mfma_f32_16x16x32_bf16 v[72:75], v[160:163], a[116:119], v[72:75]
s_add_u32 s27, s27, 4096
ds_read_b128 v[192:195], v5 offset:23552
v_mul_f32 v124, v28, v28
v_mfma_f32_16x16x32_bf16 v[68:71], v[160:163], a[112:115], v[68:71]
v_mul_f32 v125, v29, v29
v_mul_f32 v126, v30, v30
v_mfma_f32_16x16x32_bf16 v[68:71], v[156:159], a[96:99], v[68:71]
s_waitcnt lgkmcnt(4)
v_mul_f32 v127, v31, v31
v_fma_f32 v124, v124, v20, v16
v_mfma_f32_16x16x32_bf16 v[60:63], v[164:167], a[128:131], v[60:63]
v_fma_f32 v125, v125, v20, v16
v_fma_f32 v126, v126, v20, v16
v_mfma_f32_16x16x32_bf16 v[60:63], v[168:171], a[144:147], v[60:63]
ds_read_b128 v[148:151], v5 offset:24576
v_fma_f32 v127, v127, v20, v16
v_mfma_f32_16x16x32_bf16 v[64:67], v[168:171], a[148:151], v[64:67]
v_mul_f32 v124, v124, v28
v_mul_f32 v125, v125, v29
v_mfma_f32_16x16x32_bf16 v[64:67], v[164:167], a[132:135], v[64:67]
v_exp_f32 v124, v124
v_mfma_f32_16x16x32_bf16 v[76:79], v[164:167], a[136:139], v[76:79]
v_exp_f32 v125, v125
v_mfma_f32_16x16x32_bf16 v[76:79], v[168:171], a[152:155], v[76:79]
ds_read_b128 v[152:155], v5 offset:25600
v_mul_f32 v126, v126, v30
v_mfma_f32_16x16x32_bf16 v[80:83], v[168:171], a[156:159], v[80:83]
v_exp_f32 v126, v126
v_mfma_f32_16x16x32_bf16 v[80:83], v[164:167], a[140:143], v[80:83]
v_mul_f32 v127, v127, v31
v_mul_f32 v128, v28, v36
v_mfma_f32_16x16x32_bf16 v[88:91], v[172:175], a[140:143], v[88:91]
buffer_load_dwordx4 v4, s[8:11], s24 offen offset:2048 sc1 lds
v_mfma_f32_16x16x32_bf16 v[88:91], v[176:179], a[156:159], v[88:91]
ds_read_b128 v[156:159], v5 offset:26624
v_exp_f32 v127, v127
v_mfma_f32_16x16x32_bf16 v[84:87], v[176:179], a[152:155], v[84:87]
v_mul_f32 v129, v29, v37
v_mul_f32 v130, v30, v38
v_mfma_f32_16x16x32_bf16 v[84:87], v[172:175], a[136:139], v[84:87]
v_mul_f32 v131, v31, v39
v_fma_f32 v124, v124, v24, v24
v_mfma_f32_16x16x32_bf16 v[72:75], v[172:175], a[132:135], v[72:75]
v_rcp_f32 v124, v124
v_mfma_f32_16x16x32_bf16 v[72:75], v[176:179], a[148:151], v[72:75]
ds_read_b128 v[160:163], v5 offset:27648
v_fma_f32 v125, v125, v24, v24
v_mfma_f32_16x16x32_bf16 v[68:71], v[176:179], a[144:147], v[68:71]
v_rcp_f32 v125, v125
v_mfma_f32_16x16x32_bf16 v[68:71], v[172:175], a[128:131], v[68:71]
s_waitcnt lgkmcnt(4)
v_fma_f32 v126, v126, v24, v24
v_fma_f32 v127, v127, v24, v24
v_mfma_f32_16x16x32_bf16 v[60:63], v[180:183], a[160:163], v[60:63]
v_rcp_f32 v126, v126
v_mfma_f32_16x16x32_bf16 v[60:63], v[184:187], a[176:179], v[60:63]
ds_read_b128 v[164:167], v5 offset:28672
v_mul_f32 v128, v128, v124
v_mfma_f32_16x16x32_bf16 v[64:67], v[184:187], a[180:183], v[64:67]
v_rcp_f32 v127, v127
v_mfma_f32_16x16x32_bf16 v[64:67], v[180:183], a[164:167], v[64:67]
v_mul_f32 v129, v129, v125
v_mul_f32 v130, v130, v126
v_mfma_f32_16x16x32_bf16 v[76:79], v[180:183], a[168:171], v[76:79]
v_mul_f32 v131, v131, v127
v_cvt_pk_bf16_f32 v140, v128, v129
v_mfma_f32_16x16x32_bf16 v[76:79], v[184:187], a[184:187], v[76:79]
ds_read_b128 v[168:171], v5 offset:29696
v_cvt_pk_bf16_f32 v141, v130, v131
v_mfma_f32_16x16x32_bf16 v[80:83], v[184:187], a[188:191], v[80:83]
v_mul_f32 v132, v32, v32
v_mul_f32 v133, v33, v33
v_mfma_f32_16x16x32_bf16 v[80:83], v[180:183], a[172:175], v[80:83]
v_mul_f32 v134, v34, v34
v_mul_f32 v135, v35, v35
v_mfma_f32_16x16x32_bf16 v[88:91], v[188:191], a[172:175], v[88:91]
buffer_load_dwordx4 v4, s[8:11], s24 offen offset:3072 sc1 lds
v_mfma_f32_16x16x32_bf16 v[88:91], v[192:195], a[188:191], v[88:91]
s_add_u32 s24, s24, 4096
ds_read_b128 v[172:175], v5 offset:30720
v_fma_f32 v132, v132, v21, v17
v_mfma_f32_16x16x32_bf16 v[84:87], v[192:195], a[184:187], v[84:87]
v_fma_f32 v133, v133, v21, v17
v_fma_f32 v134, v134, v21, v17
v_mfma_f32_16x16x32_bf16 v[84:87], v[188:191], a[168:171], v[84:87]
v_fma_f32 v135, v135, v21, v17
v_mul_f32 v132, v132, v32
v_mfma_f32_16x16x32_bf16 v[72:75], v[188:191], a[164:167], v[72:75]
v_exp_f32 v132, v132
v_mfma_f32_16x16x32_bf16 v[72:75], v[192:195], a[180:183], v[72:75]
ds_read_b128 v[176:179], v5 offset:31744
v_mul_f32 v133, v133, v33
v_mfma_f32_16x16x32_bf16 v[68:71], v[192:195], a[176:179], v[68:71]
v_exp_f32 v133, v133
v_mfma_f32_16x16x32_bf16 v[68:71], v[188:191], a[160:163], v[68:71]
s_waitcnt lgkmcnt(4)
v_mul_f32 v134, v134, v34
v_mul_f32 v135, v135, v35
v_mfma_f32_16x16x32_bf16 v[60:63], v[148:151], a[192:195], v[60:63]
v_exp_f32 v134, v134
v_mfma_f32_16x16x32_bf16 v[60:63], v[152:155], a[208:211], v[60:63]
ds_read_b128 v[180:183], v5 offset:32768
v_mul_f32 v136, v32, v40
v_mfma_f32_16x16x32_bf16 v[64:67], v[152:155], a[212:215], v[64:67]
v_exp_f32 v135, v135
v_mfma_f32_16x16x32_bf16 v[64:67], v[148:151], a[196:199], v[64:67]
v_mul_f32 v137, v33, v41
v_mul_f32 v138, v34, v42
v_mfma_f32_16x16x32_bf16 v[76:79], v[148:151], a[200:203], v[76:79]
v_mul_f32 v139, v35, v43
v_fma_f32 v132, v132, v25, v25
v_mfma_f32_16x16x32_bf16 v[76:79], v[152:155], a[216:219], v[76:79]
ds_read_b128 v[184:187], v5 offset:33792
v_fma_f32 v133, v133, v25, v25
v_mfma_f32_16x16x32_bf16 v[80:83], v[152:155], a[220:223], v[80:83]
v_rcp_f32 v132, v132
v_mfma_f32_16x16x32_bf16 v[80:83], v[148:151], a[204:207], v[80:83]
v_rcp_f32 v133, v133
v_mfma_f32_16x16x32_bf16 v[88:91], v[156:159], a[204:207], v[88:91]
v_fma_f32 v134, v134, v25, v25
v_fma_f32 v135, v135, v25, v25
v_mfma_f32_16x16x32_bf16 v[88:91], v[160:163], a[220:223], v[88:91]
s_add_u32 m0, s25, 81920
ds_read_b128 v[188:191], v5 offset:34816
v_mul_f32 v136, v136, v132
v_mfma_f32_16x16x32_bf16 v[84:87], v[160:163], a[216:219], v[84:87]
buffer_load_dwordx4 v4, s[8:11], s24 offen offset:0 sc1 lds
v_mfma_f32_16x16x32_bf16 v[84:87], v[156:159], a[200:203], v[84:87]
s_add_u32 s24, s24, 28672
v_rcp_f32 v134, v134
v_mfma_f32_16x16x32_bf16 v[72:75], v[156:159], a[196:199], v[72:75]
v_rcp_f32 v135, v135
v_mfma_f32_16x16x32_bf16 v[72:75], v[160:163], a[212:215], v[72:75]
ds_read_b128 v[192:195], v5 offset:35840
v_mul_f32 v137, v137, v133
v_mfma_f32_16x16x32_bf16 v[68:71], v[160:163], a[208:211], v[68:71]
v_mul_f32 v138, v138, v134
v_mul_f32 v139, v139, v135
v_mfma_f32_16x16x32_bf16 v[68:71], v[156:159], a[192:195], v[68:71]
s_waitcnt lgkmcnt(4)
s_waitcnt vmcnt(5)
v_cvt_pk_bf16_f32 v142, v136, v137
v_mfma_f32_16x16x32_bf16 v[60:63], v[164:167], a[224:227], v[60:63]
s_nop 0
v_permlane16_swap_b32 v140, v142
v_mfma_f32_16x16x32_bf16 v[60:63], v[168:171], a[240:243], v[60:63]
s_barrier
ds_read_b128 v[148:151], v6 offset:0
v_mfma_f32_16x16x32_bf16 v[64:67], v[168:171], a[244:247], v[64:67]
v_cvt_pk_bf16_f32 v143, v138, v139
v_mul_f32 v124, v44, v44
v_mfma_f32_16x16x32_bf16 v[64:67], v[164:167], a[228:231], v[64:67]
v_permlane16_swap_b32 v141, v143
v_mfma_f32_16x16x32_bf16 v[76:79], v[164:167], a[232:235], v[76:79]
s_or_b32 s38, s3, s13
s_cselect_b64 vcc, 0, -1
v_lshlrev_b32 v221, 7, v1
v_mfma_f32_16x16x32_bf16 v[76:79], v[168:171], a[248:251], v[76:79]
ds_read_b128 v[152:155], v6 offset:1024
v_mul_f32 v125, v45, v45
v_mfma_f32_16x16x32_bf16 v[80:83], v[168:171], a[252:255], v[80:83]
v_cndmask_b32 v220, v14, v13, vcc
buffer_store_dword v12, v220, s[8:11], s54 offen sc1
v_mfma_f32_16x16x32_bf16 v[80:83], v[164:167], a[236:239], v[80:83]
buffer_store_dwordx4 v[140:143], v9, s[8:11], s26 offen sc1
v_mfma_f32_16x16x32_bf16 v[88:91], v[172:175], a[236:239], v[88:91]
s_add_u32 s26, s26, 4096
v_mul_f32 v126, v46, v46
v_mul_f32 v127, v47, v47
v_mfma_f32_16x16x32_bf16 v[88:91], v[176:179], a[252:255], v[88:91]
ds_read_b128 v[156:159], v6 offset:2048
v_fma_f32 v124, v124, v22, v18
v_mfma_f32_16x16x32_bf16 v[84:87], v[176:179], a[248:251], v[84:87]
v_fma_f32 v125, v125, v22, v18
v_fma_f32 v126, v126, v22, v18
v_mfma_f32_16x16x32_bf16 v[84:87], v[172:175], a[232:235], v[84:87]
v_fma_f32 v127, v127, v22, v18
v_mul_f32 v124, v124, v44
v_mfma_f32_16x16x32_bf16 v[72:75], v[172:175], a[228:231], v[72:75]
v_exp_f32 v124, v124
v_mfma_f32_16x16x32_bf16 v[72:75], v[176:179], a[244:247], v[72:75]
ds_read_b128 v[160:163], v6 offset:3072
v_mul_f32 v125, v125, v45
v_mfma_f32_16x16x32_bf16 v[68:71], v[176:179], a[240:243], v[68:71]
v_exp_f32 v125, v125
v_mfma_f32_16x16x32_bf16 v[68:71], v[172:175], a[224:227], v[68:71]
s_waitcnt lgkmcnt(4)
v_mul_f32 v126, v126, v46
v_mul_f32 v127, v127, v47
v_mfma_f32_16x16x32_bf16 v[60:63], v[180:183], v[224:227], v[60:63]
v_exp_f32 v126, v126
v_mfma_f32_16x16x32_bf16 v[60:63], v[184:187], v[240:243], v[60:63]
ds_read_b128 v[164:167], v6 offset:4096
v_mul_f32 v128, v44, v52
v_mfma_f32_16x16x32_bf16 v[64:67], v[184:187], v[244:247], v[64:67]
v_exp_f32 v127, v127
v_mfma_f32_16x16x32_bf16 v[64:67], v[180:183], v[228:231], v[64:67]
v_mul_f32 v129, v45, v53
v_mul_f32 v130, v46, v54
v_mfma_f32_16x16x32_bf16 v[76:79], v[180:183], v[232:235], v[76:79]
v_mul_f32 v131, v47, v55
v_fma_f32 v124, v124, v26, v26
v_mfma_f32_16x16x32_bf16 v[76:79], v[184:187], v[248:251], v[76:79]
ds_read_b128 v[168:171], v6 offset:5120
v_fma_f32 v125, v125, v26, v26
v_mfma_f32_16x16x32_bf16 v[80:83], v[184:187], v[252:255], v[80:83]
v_rcp_f32 v124, v124
v_mfma_f32_16x16x32_bf16 v[80:83], v[180:183], v[236:239], v[80:83]
v_rcp_f32 v125, v125
v_mfma_f32_16x16x32_bf16 v[88:91], v[188:191], v[236:239], v[88:91]
v_fma_f32 v126, v126, v26, v26
v_fma_f32 v127, v127, v26, v26
v_mfma_f32_16x16x32_bf16 v[88:91], v[192:195], v[252:255], v[88:91]
ds_read_b128 v[172:175], v6 offset:6144
v_mul_f32 v128, v128, v124
v_mfma_f32_16x16x32_bf16 v[84:87], v[192:195], v[248:251], v[84:87]
v_rcp_f32 v126, v126
v_mfma_f32_16x16x32_bf16 v[84:87], v[188:191], v[232:235], v[84:87]
v_rcp_f32 v127, v127
v_mfma_f32_16x16x32_bf16 v[72:75], v[188:191], v[228:231], v[72:75]
v_mul_f32 v129, v129, v125
v_mul_f32 v130, v130, v126
v_mfma_f32_16x16x32_bf16 v[72:75], v[192:195], v[244:247], v[72:75]
ds_read_b128 v[176:179], v6 offset:7168
v_mul_f32 v131, v131, v127
v_mfma_f32_16x16x32_bf16 v[68:71], v[192:195], v[240:243], v[68:71]
v_cvt_pk_bf16_f32 v144, v128, v129
v_cvt_pk_bf16_f32 v145, v130, v131
v_mfma_f32_16x16x32_bf16 v[68:71], v[188:191], v[224:227], v[68:71]
s_waitcnt lgkmcnt(4)
v_mul_f32 v132, v48, v48
v_mul_f32 v133, v49, v49
v_mfma_f32_16x16x32_bf16 v[92:95], v[148:151], a[0:3], 0
Lcw1:
v_mul_f32 v134, v50, v50
v_mul_f32 v135, v51, v51
v_mfma_f32_16x16x32_bf16 v[92:95], v[152:155], a[16:19], v[92:95]
ds_read_b128 v[180:183], v6 offset:8192
v_fma_f32 v132, v132, v23, v19
v_mfma_f32_16x16x32_bf16 v[96:99], v[152:155], a[20:23], 0
v_fma_f32 v133, v133, v23, v19
v_fma_f32 v134, v134, v23, v19
v_mfma_f32_16x16x32_bf16 v[96:99], v[148:151], a[4:7], v[96:99]
v_fma_f32 v135, v135, v23, v19
v_mul_f32 v132, v132, v48
v_mfma_f32_16x16x32_bf16 v[108:111], v[148:151], a[8:11], 0
v_exp_f32 v132, v132
v_mfma_f32_16x16x32_bf16 v[108:111], v[152:155], a[24:27], v[108:111]
ds_read_b128 v[184:187], v6 offset:9216
v_mul_f32 v133, v133, v49
v_mfma_f32_16x16x32_bf16 v[112:115], v[152:155], a[28:31], 0
v_exp_f32 v133, v133
v_mfma_f32_16x16x32_bf16 v[112:115], v[148:151], a[12:15], v[112:115]
v_mul_f32 v134, v134, v50
v_mul_f32 v135, v135, v51
v_mfma_f32_16x16x32_bf16 v[120:123], v[156:159], a[12:15], 0
v_exp_f32 v134, v134
v_mfma_f32_16x16x32_bf16 v[120:123], v[160:163], a[28:31], v[120:123]
ds_read_b128 v[188:191], v6 offset:10240
v_mul_f32 v136, v48, v56
v_mfma_f32_16x16x32_bf16 v[116:119], v[160:163], a[24:27], 0
v_exp_f32 v135, v135
v_mfma_f32_16x16x32_bf16 v[116:119], v[156:159], a[8:11], v[116:119]
v_mul_f32 v137, v49, v57
v_mul_f32 v138, v50, v58
v_mfma_f32_16x16x32_bf16 v[104:107], v[156:159], a[4:7], 0
v_mul_f32 v139, v51, v59
v_fma_f32 v132, v132, v27, v27
v_mfma_f32_16x16x32_bf16 v[104:107], v[160:163], a[20:23], v[104:107]
ds_read_b128 v[192:195], v6 offset:11264
v_fma_f32 v133, v133, v27, v27
v_mfma_f32_16x16x32_bf16 v[100:103], v[160:163], a[16:19], 0
v_rcp_f32 v132, v132
v_mfma_f32_16x16x32_bf16 v[100:103], v[156:159], a[0:3], v[100:103]
s_waitcnt lgkmcnt(4)
v_rcp_f32 v133, v133
v_mfma_f32_16x16x32_bf16 v[92:95], v[164:167], a[32:35], v[92:95]
v_fma_f32 v134, v134, v27, v27
v_fma_f32 v135, v135, v27, v27
v_mfma_f32_16x16x32_bf16 v[92:95], v[168:171], a[48:51], v[92:95]
ds_read_b128 v[148:151], v6 offset:12288
v_mul_f32 v136, v136, v132
v_mfma_f32_16x16x32_bf16 v[96:99], v[168:171], a[52:55], v[96:99]
v_rcp_f32 v134, v134
v_mfma_f32_16x16x32_bf16 v[96:99], v[164:167], a[36:39], v[96:99]
v_rcp_f32 v135, v135
v_mfma_f32_16x16x32_bf16 v[108:111], v[164:167], a[40:43], v[108:111]
v_mul_f32 v137, v137, v133
v_mul_f32 v138, v138, v134
v_mfma_f32_16x16x32_bf16 v[108:111], v[168:171], a[56:59], v[108:111]
ds_read_b128 v[152:155], v6 offset:13312
v_mul_f32 v139, v139, v135
v_mfma_f32_16x16x32_bf16 v[112:115], v[168:171], a[60:63], v[112:115]
v_cvt_pk_bf16_f32 v146, v136, v137
v_cvt_pk_bf16_f32 v147, v138, v139
v_mfma_f32_16x16x32_bf16 v[112:115], v[164:167], a[44:47], v[112:115]
v_permlane16_swap_b32 v144, v146
v_mfma_f32_16x16x32_bf16 v[120:123], v[172:175], a[44:47], v[120:123]
v_permlane16_swap_b32 v145, v147
v_mfma_f32_16x16x32_bf16 v[120:123], v[176:179], a[60:63], v[120:123]
ds_read_b128 v[156:159], v6 offset:14336
v_mul_f32 v124, v60, v60
v_mfma_f32_16x16x32_bf16 v[116:119], v[176:179], a[56:59], v[116:119]
buffer_store_dwordx4 v[144:147], v9, s[8:11], s27 offen sc1
v_mfma_f32_16x16x32_bf16 v[116:119], v[172:175], a[40:43], v[116:119]
s_add_u32 s27, s27, 4096
v_mul_f32 v125, v61, v61
v_mul_f32 v126, v62, v62
v_mfma_f32_16x16x32_bf16 v[104:107], v[172:175], a[36:39], v[104:107]
v_mul_f32 v127, v63, v63
v_fma_f32 v124, v124, v20, v16
v_mfma_f32_16x16x32_bf16 v[104:107], v[176:179], a[52:55], v[104:107]
ds_read_b128 v[160:163], v6 offset:15360
v_fma_f32 v125, v125, v20, v16
v_mfma_f32_16x16x32_bf16 v[100:103], v[176:179], a[48:51], v[100:103]
v_fma_f32 v126, v126, v20, v16
v_fma_f32 v127, v127, v20, v16
v_mfma_f32_16x16x32_bf16 v[100:103], v[172:175], a[32:35], v[100:103]
s_waitcnt lgkmcnt(4)
v_mul_f32 v124, v124, v60
v_mul_f32 v125, v125, v61
v_mfma_f32_16x16x32_bf16 v[92:95], v[180:183], a[64:67], v[92:95]
v_exp_f32 v124, v124
v_mfma_f32_16x16x32_bf16 v[92:95], v[184:187], a[80:83], v[92:95]
ds_read_b128 v[164:167], v6 offset:16384
v_mul_f32 v126, v126, v62
v_mfma_f32_16x16x32_bf16 v[96:99], v[184:187], a[84:87], v[96:99]
v_exp_f32 v125, v125
v_mfma_f32_16x16x32_bf16 v[96:99], v[180:183], a[68:71], v[96:99]
v_exp_f32 v126, v126
v_mfma_f32_16x16x32_bf16 v[108:111], v[180:183], a[72:75], v[108:111]
v_mul_f32 v127, v127, v63
v_mul_f32 v128, v60, v68
v_mfma_f32_16x16x32_bf16 v[108:111], v[184:187], a[88:91], v[108:111]
ds_read_b128 v[168:171], v6 offset:17408
v_mul_f32 v129, v61, v69
v_mfma_f32_16x16x32_bf16 v[112:115], v[184:187], a[92:95], v[112:115]
v_exp_f32 v127, v127
v_mfma_f32_16x16x32_bf16 v[112:115], v[180:183], a[76:79], v[112:115]
v_mul_f32 v130, v62, v70
v_mul_f32 v131, v63, v71
v_mfma_f32_16x16x32_bf16 v[120:123], v[188:191], a[76:79], v[120:123]
v_fma_f32 v124, v124, v24, v24
v_fma_f32 v125, v125, v24, v24
v_mfma_f32_16x16x32_bf16 v[120:123], v[192:195], a[92:95], v[120:123]
ds_read_b128 v[172:175], v6 offset:18432
v_fma_f32 v126, v126, v24, v24
v_mfma_f32_16x16x32_bf16 v[116:119], v[192:195], a[88:91], v[116:119]
v_rcp_f32 v124, v124
v_mfma_f32_16x16x32_bf16 v[116:119], v[188:191], a[72:75], v[116:119]
v_rcp_f32 v125, v125
v_mfma_f32_16x16x32_bf16 v[104:107], v[188:191], a[68:71], v[104:107]
v_rcp_f32 v126, v126
v_mfma_f32_16x16x32_bf16 v[104:107], v[192:195], a[84:87], v[104:107]
ds_read_b128 v[176:179], v6 offset:19456
v_fma_f32 v127, v127, v24, v24
v_mfma_f32_16x16x32_bf16 v[100:103], v[192:195], a[80:83], v[100:103]
v_rcp_f32 v127, v127
v_mfma_f32_16x16x32_bf16 v[100:103], v[188:191], a[64:67], v[100:103]
s_waitcnt lgkmcnt(4)
v_mul_f32 v128, v128, v124
v_mul_f32 v129, v129, v125
v_mfma_f32_16x16x32_bf16 v[92:95], v[148:151], a[96:99], v[92:95]
v_mul_f32 v130, v130, v126
v_mul_f32 v131, v131, v127
v_mfma_f32_16x16x32_bf16 v[92:95], v[152:155], a[112:115], v[92:95]
ds_read_b128 v[180:183], v6 offset:20480
v_cvt_pk_bf16_f32 v140, v128, v129
v_mfma_f32_16x16x32_bf16 v[96:99], v[152:155], a[116:119], v[96:99]
v_cvt_pk_bf16_f32 v141, v130, v131
v_mul_f32 v132, v64, v64
v_mfma_f32_16x16x32_bf16 v[96:99], v[148:151], a[100:103], v[96:99]
v_mul_f32 v133, v65, v65
v_mul_f32 v134, v66, v66
v_mfma_f32_16x16x32_bf16 v[108:111], v[148:151], a[104:107], v[108:111]
v_mul_f32 v135, v67, v67
v_fma_f32 v132, v132, v21, v17
v_mfma_f32_16x16x32_bf16 v[108:111], v[152:155], a[120:123], v[108:111]
ds_read_b128 v[184:187], v6 offset:21504
v_fma_f32 v133, v133, v21, v17
v_mfma_f32_16x16x32_bf16 v[112:115], v[152:155], a[124:127], v[112:115]
v_fma_f32 v134, v134, v21, v17
v_fma_f32 v135, v135, v21, v17
v_mfma_f32_16x16x32_bf16 v[112:115], v[148:151], a[108:111], v[112:115]
v_mul_f32 v132, v132, v64
v_mul_f32 v133, v133, v65
v_mfma_f32_16x16x32_bf16 v[120:123], v[156:159], a[108:111], v[120:123]
v_exp_f32 v132, v132
v_mfma_f32_16x16x32_bf16 v[120:123], v[160:163], a[124:127], v[120:123]
ds_read_b128 v[188:191], v6 offset:22528
v_mul_f32 v134, v134, v66
v_mfma_f32_16x16x32_bf16 v[116:119], v[160:163], a[120:123], v[116:119]
v_exp_f32 v133, v133
v_mfma_f32_16x16x32_bf16 v[116:119], v[156:159], a[104:107], v[116:119]
v_exp_f32 v134, v134
v_mfma_f32_16x16x32_bf16 v[104:107], v[156:159], a[100:103], v[104:107]
buffer_load_dword v220, v221, s[8:11], s55 offen sc1
v_mfma_f32_16x16x32_bf16 v[104:107], v[160:163], a[116:119], v[104:107]
ds_read_b128 v[192:195], v6 offset:23552
v_mul_f32 v135, v135, v67
v_mfma_f32_16x16x32_bf16 v[100:103], v[160:163], a[112:115], v[100:103]
v_exp_f32 v135, v135
v_mfma_f32_16x16x32_bf16 v[100:103], v[156:159], a[96:99], v[100:103]
s_waitcnt lgkmcnt(4)
v_mul_f32 v136, v64, v72
v_mul_f32 v137, v65, v73
v_mfma_f32_16x16x32_bf16 v[92:95], v[164:167], a[128:131], v[92:95]
v_mul_f32 v138, v66, v74
v_mul_f32 v139, v67, v75
v_mfma_f32_16x16x32_bf16 v[92:95], v[168:171], a[144:147], v[92:95]
ds_read_b128 v[148:151], v6 offset:24576
v_fma_f32 v132, v132, v25, v25
v_mfma_f32_16x16x32_bf16 v[96:99], v[168:171], a[148:151], v[96:99]
v_rcp_f32 v132, v132
v_mfma_f32_16x16x32_bf16 v[96:99], v[164:167], a[132:135], v[96:99]
v_fma_f32 v133, v133, v25, v25
v_fma_f32 v134, v134, v25, v25
v_mfma_f32_16x16x32_bf16 v[108:111], v[164:167], a[136:139], v[108:111]
v_rcp_f32 v133, v133
v_mfma_f32_16x16x32_bf16 v[108:111], v[168:171], a[152:155], v[108:111]
ds_read_b128 v[152:155], v6 offset:25600
v_fma_f32 v135, v135, v25, v25
v_mfma_f32_16x16x32_bf16 v[112:115], v[168:171], a[156:159], v[112:115]
s_add_u32 s83, s82, Lcw2-Lcp
v_rcp_f32 v134, v134
v_mfma_f32_16x16x32_bf16 v[112:115], v[164:167], a[140:143], v[112:115]
s_min_u32 s83, s83, Lcode_end-Lcp-4
v_rcp_f32 v135, v135
v_mfma_f32_16x16x32_bf16 v[120:123], v[172:175], a[140:143], v[120:123]
v_mov_b32 v222, s83
v_mul_f32 v136, v136, v132
v_mfma_f32_16x16x32_bf16 v[120:123], v[176:179], a[156:159], v[120:123]
ds_read_b128 v[156:159], v6 offset:26624
v_mul_f32 v137, v137, v133
v_mfma_f32_16x16x32_bf16 v[116:119], v[176:179], a[152:155], v[116:119]
global_load_dword v223, v222, s[80:81]
v_mfma_f32_16x16x32_bf16 v[116:119], v[172:175], a[136:139], v[116:119]
v_mul_f32 v138, v138, v134
v_mul_f32 v139, v139, v135
v_mfma_f32_16x16x32_bf16 v[104:107], v[172:175], a[132:135], v[104:107]
v_cvt_pk_bf16_f32 v142, v136, v137
v_cvt_pk_bf16_f32 v143, v138, v139
v_mfma_f32_16x16x32_bf16 v[104:107], v[176:179], a[148:151], v[104:107]
ds_read_b128 v[160:163], v6 offset:27648
v_mul_f32 v124, v76, v76
v_mfma_f32_16x16x32_bf16 v[100:103], v[176:179], a[144:147], v[100:103]
v_permlane16_swap_b32 v140, v142
v_mfma_f32_16x16x32_bf16 v[100:103], v[172:175], a[128:131], v[100:103]
s_waitcnt lgkmcnt(4)
v_permlane16_swap_b32 v141, v143
v_mfma_f32_16x16x32_bf16 v[92:95], v[180:183], a[160:163], v[92:95]
buffer_store_dwordx4 v[140:143], v9, s[8:11], s26 offen sc1
v_mfma_f32_16x16x32_bf16 v[92:95], v[184:187], a[176:179], v[92:95]
s_add_u32 s26, s26, 4096
ds_read_b128 v[164:167], v6 offset:28672
v_mul_f32 v125, v77, v77
v_mfma_f32_16x16x32_bf16 v[96:99], v[184:187], a[180:183], v[96:99]
v_mul_f32 v126, v78, v78
v_mul_f32 v127, v79, v79
v_mfma_f32_16x16x32_bf16 v[96:99], v[180:183], a[164:167], v[96:99]
v_fma_f32 v124, v124, v22, v18
v_fma_f32 v125, v125, v22, v18
v_mfma_f32_16x16x32_bf16 v[108:111], v[180:183], a[168:171], v[108:111]
v_fma_f32 v126, v126, v22, v18
v_fma_f32 v127, v127, v22, v18
v_mfma_f32_16x16x32_bf16 v[108:111], v[184:187], a[184:187], v[108:111]
ds_read_b128 v[168:171], v6 offset:29696
v_mul_f32 v124, v124, v76
v_mfma_f32_16x16x32_bf16 v[112:115], v[184:187], a[188:191], v[112:115]
v_exp_f32 v124, v124
v_mfma_f32_16x16x32_bf16 v[112:115], v[180:183], a[172:175], v[112:115]
v_mul_f32 v125, v125, v77
v_mul_f32 v126, v126, v78
v_mfma_f32_16x16x32_bf16 v[120:123], v[188:191], a[172:175], v[120:123]
v_exp_f32 v125, v125
v_mfma_f32_16x16x32_bf16 v[120:123], v[192:195], a[188:191], v[120:123]
ds_read_b128 v[172:175], v6 offset:30720
v_mul_f32 v127, v127, v79
v_mfma_f32_16x16x32_bf16 v[116:119], v[192:195], a[184:187], v[116:119]
v_exp_f32 v126, v126
v_mfma_f32_16x16x32_bf16 v[116:119], v[188:191], a[168:171], v[116:119]
v_exp_f32 v127, v127
v_mfma_f32_16x16x32_bf16 v[104:107], v[188:191], a[164:167], v[104:107]
v_mul_f32 v128, v76, v84
v_mul_f32 v129, v77, v85
v_mfma_f32_16x16x32_bf16 v[104:107], v[192:195], a[180:183], v[104:107]
ds_read_b128 v[176:179], v6 offset:31744
v_mul_f32 v130, v78, v86
v_mfma_f32_16x16x32_bf16 v[100:103], v[192:195], a[176:179], v[100:103]
v_mul_f32 v131, v79, v87
v_fma_f32 v124, v124, v26, v26
v_mfma_f32_16x16x32_bf16 v[100:103], v[188:191], a[160:163], v[100:103]
s_waitcnt lgkmcnt(4)
v_rcp_f32 v124, v124
v_mfma_f32_16x16x32_bf16 v[92:95], v[148:151], a[192:195], v[92:95]
v_fma_f32 v125, v125, v26, v26
v_fma_f32 v126, v126, v26, v26
v_mfma_f32_16x16x32_bf16 v[92:95], v[152:155], a[208:211], v[92:95]
ds_read_b128 v[180:183], v6 offset:32768
v_fma_f32 v127, v127, v26, v26
v_mfma_f32_16x16x32_bf16 v[96:99], v[152:155], a[212:215], v[96:99]
v_rcp_f32 v125, v125
v_mfma_f32_16x16x32_bf16 v[96:99], v[148:151], a[196:199], v[96:99]
v_rcp_f32 v126, v126
v_mfma_f32_16x16x32_bf16 v[108:111], v[148:151], a[200:203], v[108:111]
v_rcp_f32 v127, v127
v_mfma_f32_16x16x32_bf16 v[108:111], v[152:155], a[216:219], v[108:111]
ds_read_b128 v[184:187], v6 offset:33792
v_mul_f32 v128, v128, v124
v_mfma_f32_16x16x32_bf16 v[112:115], v[152:155], a[220:223], v[112:115]
v_mul_f32 v129, v129, v125
v_mul_f32 v130, v130, v126
v_mfma_f32_16x16x32_bf16 v[112:115], v[148:151], a[204:207], v[112:115]
v_mul_f32 v131, v131, v127
v_cvt_pk_bf16_f32 v144, v128, v129
v_mfma_f32_16x16x32_bf16 v[120:123], v[156:159], a[204:207], v[120:123]
v_cvt_pk_bf16_f32 v145, v130, v131
v_mul_f32 v132, v80, v80
v_mfma_f32_16x16x32_bf16 v[120:123], v[160:163], a[220:223], v[120:123]
ds_read_b128 v[188:191], v6 offset:34816
v_mul_f32 v133, v81, v81
v_mfma_f32_16x16x32_bf16 v[116:119], v[160:163], a[216:219], v[116:119]
v_mul_f32 v134, v82, v82
v_mul_f32 v135, v83, v83
v_mfma_f32_16x16x32_bf16 v[116:119], v[156:159], a[200:203], v[116:119]
v_fma_f32 v132, v132, v23, v19
v_fma_f32 v133, v133, v23, v19
v_mfma_f32_16x16x32_bf16 v[104:107], v[156:159], a[196:199], v[104:107]
s_waitcnt vmcnt(2)
v_cmp_ne_u32 vcc, v12, v220
s_nop 1
s_cbranch_vccnz Lsp5
Lok5:
v_mfma_f32_16x16x32_bf16 v[104:107], v[160:163], a[212:215], v[104:107]
ds_read_b128 v[192:195], v6 offset:35840
v_fma_f32 v134, v134, v23, v19
v_mfma_f32_16x16x32_bf16 v[100:103], v[160:163], a[208:211], v[100:103]
v_fma_f32 v135, v135, v23, v19
v_mul_f32 v132, v132, v80
v_mfma_f32_16x16x32_bf16 v[100:103], v[156:159], a[192:195], v[100:103]
s_waitcnt lgkmcnt(4)
v_exp_f32 v132, v132
v_mfma_f32_16x16x32_bf16 v[92:95], v[164:167], a[224:227], v[92:95]
v_mul_f32 v133, v133, v81
v_mul_f32 v134, v134, v82
v_mfma_f32_16x16x32_bf16 v[92:95], v[168:171], a[240:243], v[92:95]
s_barrier
ds_read_b128 v[148:151], v7 offset:0
v_mfma_f32_16x16x32_bf16 v[96:99], v[168:171], a[244:247], v[96:99]
v_exp_f32 v133, v133
v_mfma_f32_16x16x32_bf16 v[96:99], v[164:167], a[228:231], v[96:99]
v_exp_f32 v134, v134
v_mfma_f32_16x16x32_bf16 v[108:111], v[164:167], a[232:235], v[108:111]
s_add_u32 m0, s25, 110592
v_mul_f32 v135, v135, v83
v_mul_f32 v136, v80, v88
v_mfma_f32_16x16x32_bf16 v[108:111], v[168:171], a[248:251], v[108:111]
ds_read_b128 v[152:155], v7 offset:1024
v_mul_f32 v137, v81, v89
v_mfma_f32_16x16x32_bf16 v[112:115], v[168:171], a[252:255], v[112:115]
buffer_load_dwordx4 v4, s[8:11], s24 offen offset:0 sc1 lds
v_mfma_f32_16x16x32_bf16 v[112:115], v[164:167], a[236:239], v[112:115]
v_exp_f32 v135, v135
v_mfma_f32_16x16x32_bf16 v[120:123], v[172:175], a[236:239], v[120:123]
v_mul_f32 v138, v82, v90
v_mul_f32 v139, v83, v91
v_mfma_f32_16x16x32_bf16 v[120:123], v[176:179], a[252:255], v[120:123]
ds_read_b128 v[156:159], v7 offset:2048
v_fma_f32 v132, v132, v27, v27
v_mfma_f32_16x16x32_bf16 v[116:119], v[176:179], a[248:251], v[116:119]
v_rcp_f32 v132, v132
v_mfma_f32_16x16x32_bf16 v[116:119], v[172:175], a[232:235], v[116:119]
v_fma_f32 v133, v133, v27, v27
v_fma_f32 v134, v134, v27, v27
v_mfma_f32_16x16x32_bf16 v[104:107], v[172:175], a[228:231], v[104:107]
buffer_load_dwordx4 v4, s[8:11], s24 offen offset:1024 sc1 lds
v_mfma_f32_16x16x32_bf16 v[104:107], v[176:179], a[244:247], v[104:107]
ds_read_b128 v[160:163], v7 offset:3072
v_fma_f32 v135, v135, v27, v27
v_mfma_f32_16x16x32_bf16 v[100:103], v[176:179], a[240:243], v[100:103]
v_rcp_f32 v133, v133
v_mfma_f32_16x16x32_bf16 v[100:103], v[172:175], a[224:227], v[100:103]
s_waitcnt lgkmcnt(4)
v_rcp_f32 v134, v134
v_mfma_f32_16x16x32_bf16 v[92:95], v[180:183], v[224:227], v[92:95]
v_rcp_f32 v135, v135
v_mfma_f32_16x16x32_bf16 v[92:95], v[184:187], v[240:243], v[92:95]
ds_read_b128 v[164:167], v7 offset:4096
v_mul_f32 v136, v136, v132
v_mfma_f32_16x16x32_bf16 v[96:99], v[184:187], v[244:247], v[96:99]
v_mul_f32 v137, v137, v133
v_mul_f32 v138, v138, v134
v_mfma_f32_16x16x32_bf16 v[96:99], v[180:183], v[228:231], v[96:99]
v_mul_f32 v139, v139, v135
v_cvt_pk_bf16_f32 v146, v136, v137
v_mfma_f32_16x16x32_bf16 v[108:111], v[180:183], v[232:235], v[108:111]
buffer_load_dwordx4 v4, s[8:11], s24 offen offset:2048 sc1 lds
v_mfma_f32_16x16x32_bf16 v[108:111], v[184:187], v[248:251], v[108:111]
ds_read_b128 v[168:171], v7 offset:5120
v_cvt_pk_bf16_f32 v147, v138, v139
v_mfma_f32_16x16x32_bf16 v[112:115], v[184:187], v[252:255], v[112:115]
v_permlane16_swap_b32 v144, v146
v_mfma_f32_16x16x32_bf16 v[112:115], v[180:183], v[236:239], v[112:115]
v_permlane16_swap_b32 v145, v147
v_mfma_f32_16x16x32_bf16 v[120:123], v[188:191], v[236:239], v[120:123]
buffer_store_dwordx4 v[144:147], v9, s[8:11], s27 offen sc1
v_mfma_f32_16x16x32_bf16 v[120:123], v[192:195], v[252:255], v[120:123]
ds_read_b128 v[172:175], v7 offset:6144
v_mfma_f32_16x16x32_bf16 v[116:119], v[192:195], v[248:251], v[116:119]
v_mfma_f32_16x16x32_bf16 v[116:119], v[188:191], v[232:235], v[116:119]
v_mfma_f32_16x16x32_bf16 v[104:107], v[188:191], v[228:231], v[104:107]
buffer_load_dwordx4 v4, s[8:11], s24 offen offset:3072 sc1 lds
v_mfma_f32_16x16x32_bf16 v[104:107], v[192:195], v[244:247], v[104:107]
s_add_u32 s24, s24, 4096
ds_read_b128 v[176:179], v7 offset:7168
v_mfma_f32_16x16x32_bf16 v[100:103], v[192:195], v[240:243], v[100:103]
v_mfma_f32_16x16x32_bf16 v[100:103], v[188:191], v[224:227], v[100:103]
s_waitcnt lgkmcnt(4)
s_add_u32 s27, s27, 4096
v_mfma_f32_16x16x32_bf16 v[60:63], v[148:151], a[0:3], 0
Lcw2:
v_mfma_f32_16x16x32_bf16 v[60:63], v[152:155], a[16:19], v[60:63]
ds_read_b128 v[180:183], v7 offset:8192
v_mfma_f32_16x16x32_bf16 v[64:67], v[152:155], a[20:23], 0
v_mfma_f32_16x16x32_bf16 v[64:67], v[148:151], a[4:7], v[64:67]
v_mul_f32 v124, v92, v92
v_mul_f32 v125, v93, v93
v_mfma_f32_16x16x32_bf16 v[76:79], v[148:151], a[8:11], 0
s_add_u32 m0, s25, 114688
v_and_b32 v221, 7, v1
v_lshlrev_b32 v221, 9, v221
v_mfma_f32_16x16x32_bf16 v[76:79], v[152:155], a[24:27], v[76:79]
ds_read_b128 v[184:187], v7 offset:9216
v_mul_f32 v126, v94, v94
v_mfma_f32_16x16x32_bf16 v[80:83], v[152:155], a[28:31], 0
buffer_load_dwordx4 v4, s[8:11], s24 offen offset:0 sc1 lds
v_mfma_f32_16x16x32_bf16 v[80:83], v[148:151], a[12:15], v[80:83]
v_mul_f32 v127, v95, v95
v_fma_f32 v124, v124, v20, v16
v_mfma_f32_16x16x32_bf16 v[88:91], v[156:159], a[12:15], 0
v_fma_f32 v125, v125, v20, v16
v_fma_f32 v126, v126, v20, v16
v_mfma_f32_16x16x32_bf16 v[88:91], v[160:163], a[28:31], v[88:91]
ds_read_b128 v[188:191], v7 offset:10240
v_fma_f32 v127, v127, v20, v16
v_mfma_f32_16x16x32_bf16 v[84:87], v[160:163], a[24:27], 0
v_mul_f32 v124, v124, v92
v_mul_f32 v125, v125, v93
v_mfma_f32_16x16x32_bf16 v[84:87], v[156:159], a[8:11], v[84:87]
v_exp_f32 v124, v124
v_mfma_f32_16x16x32_bf16 v[72:75], v[156:159], a[4:7], 0
buffer_load_dwordx4 v4, s[8:11], s24 offen offset:1024 sc1 lds
v_mfma_f32_16x16x32_bf16 v[72:75], v[160:163], a[20:23], v[72:75]
ds_read_b128 v[192:195], v7 offset:11264
v_mul_f32 v126, v126, v94
v_mfma_f32_16x16x32_bf16 v[68:71], v[160:163], a[16:19], 0
v_exp_f32 v125, v125
v_mfma_f32_16x16x32_bf16 v[68:71], v[156:159], a[0:3], v[68:71]
s_waitcnt lgkmcnt(4)
v_exp_f32 v126, v126
v_mfma_f32_16x16x32_bf16 v[60:63], v[164:167], a[32:35], v[60:63]
v_mul_f32 v127, v127, v95
v_mul_f32 v128, v92, v100
v_mfma_f32_16x16x32_bf16 v[60:63], v[168:171], a[48:51], v[60:63]
ds_read_b128 v[148:151], v7 offset:12288
v_mul_f32 v129, v93, v101
v_mfma_f32_16x16x32_bf16 v[64:67], v[168:171], a[52:55], v[64:67]
v_exp_f32 v127, v127
v_mfma_f32_16x16x32_bf16 v[64:67], v[164:167], a[36:39], v[64:67]
v_mul_f32 v130, v94, v102
v_mul_f32 v131, v95, v103
v_mfma_f32_16x16x32_bf16 v[76:79], v[164:167], a[40:43], v[76:79]
buffer_load_dwordx4 v4, s[8:11], s24 offen offset:2048 sc1 lds
v_mfma_f32_16x16x32_bf16 v[76:79], v[168:171], a[56:59], v[76:79]
ds_read_b128 v[152:155], v7 offset:13312
v_fma_f32 v124, v124, v24, v24
v_mfma_f32_16x16x32_bf16 v[80:83], v[168:171], a[60:63], v[80:83]
v_rcp_f32 v124, v124
v_mfma_f32_16x16x32_bf16 v[80:83], v[164:167], a[44:47], v[80:83]
v_fma_f32 v125, v125, v24, v24
v_fma_f32 v126, v126, v24, v24
v_mfma_f32_16x16x32_bf16 v[88:91], v[172:175], a[44:47], v[88:91]
v_rcp_f32 v125, v125
v_mfma_f32_16x16x32_bf16 v[88:91], v[176:179], a[60:63], v[88:91]
ds_read_b128 v[156:159], v7 offset:14336
v_fma_f32 v127, v127, v24, v24
v_mfma_f32_16x16x32_bf16 v[84:87], v[176:179], a[56:59], v[84:87]
v_rcp_f32 v126, v126
v_mfma_f32_16x16x32_bf16 v[84:87], v[172:175], a[40:43], v[84:87]
v_rcp_f32 v127, v127
v_mfma_f32_16x16x32_bf16 v[72:75], v[172:175], a[36:39], v[72:75]
buffer_load_dwordx4 v4, s[8:11], s24 offen offset:3072 sc1 lds
v_mfma_f32_16x16x32_bf16 v[72:75], v[176:179], a[52:55], v[72:75]
s_add_u32 s24, s24, 4096
ds_read_b128 v[160:163], v7 offset:15360
v_mul_f32 v128, v128, v124
v_mfma_f32_16x16x32_bf16 v[68:71], v[176:179], a[48:51], v[68:71]
v_mul_f32 v129, v129, v125
v_mul_f32 v130, v130, v126
v_mfma_f32_16x16x32_bf16 v[68:71], v[172:175], a[32:35], v[68:71]
s_waitcnt lgkmcnt(4)
v_mul_f32 v131, v131, v127
v_cvt_pk_bf16_f32 v140, v128, v129
v_mfma_f32_16x16x32_bf16 v[60:63], v[180:183], a[64:67], v[60:63]
v_cvt_pk_bf16_f32 v141, v130, v131
v_mul_f32 v132, v96, v96
v_mfma_f32_16x16x32_bf16 v[60:63], v[184:187], a[80:83], v[60:63]
ds_read_b128 v[164:167], v7 offset:16384
v_mul_f32 v133, v97, v97
v_mfma_f32_16x16x32_bf16 v[64:67], v[184:187], a[84:87], v[64:67]
v_mul_f32 v134, v98, v98
v_mul_f32 v135, v99, v99
v_mfma_f32_16x16x32_bf16 v[64:67], v[180:183], a[68:71], v[64:67]
v_fma_f32 v132, v132, v21, v17
v_fma_f32 v133, v133, v21, v17
v_mfma_f32_16x16x32_bf16 v[76:79], v[180:183], a[72:75], v[76:79]
s_add_u32 m0, s25, 118784
v_fma_f32 v134, v134, v21, v17
v_fma_f32 v135, v135, v21, v17
v_mfma_f32_16x16x32_bf16 v[76:79], v[184:187], a[88:91], v[76:79]
ds_read_b128 v[168:171], v7 offset:17408
v_mul_f32 v132, v132, v96
v_mfma_f32_16x16x32_bf16 v[80:83], v[184:187], a[92:95], v[80:83]
buffer_load_dwordx4 v4, s[8:11], s24 offen offset:0 sc1 lds
v_mfma_f32_16x16x32_bf16 v[80:83], v[180:183], a[76:79], v[80:83]
s_add_u32 s24, s24, 28672
v_exp_f32 v132, v132
v_mfma_f32_16x16x32_bf16 v[88:91], v[188:191], a[76:79], v[88:91]
v_mul_f32 v133, v133, v97
v_mul_f32 v134, v134, v98
v_mfma_f32_16x16x32_bf16 v[88:91], v[192:195], a[92:95], v[88:91]
ds_read_b128 v[172:175], v7 offset:18432
v_mul_f32 v135, v135, v99
v_mfma_f32_16x16x32_bf16 v[84:87], v[192:195], a[88:91], v[84:87]
v_exp_f32 v133, v133
v_mfma_f32_16x16x32_bf16 v[84:87], v[188:191], a[72:75], v[84:87]
v_exp_f32 v134, v134
v_mfma_f32_16x16x32_bf16 v[72:75], v[188:191], a[68:71], v[72:75]
s_add_u32 m0, s25, 0
s_waitcnt vmcnt(6)
buffer_store_dword v12, v13, s[8:11], s40 offen sc1
s_add_u32 s40, s40, 131072
v_mfma_f32_16x16x32_bf16 v[72:75], v[192:195], a[84:87], v[72:75]
ds_read_b128 v[176:179], v7 offset:19456
v_mul_f32 v136, v96, v104
v_mfma_f32_16x16x32_bf16 v[68:71], v[192:195], a[80:83], v[68:71]
buffer_load_dwordx4 v4, s[8:11], s24 offen offset:0 sc1 lds
v_mfma_f32_16x16x32_bf16 v[68:71], v[188:191], a[64:67], v[68:71]
s_waitcnt lgkmcnt(4)
v_exp_f32 v135, v135
v_mfma_f32_16x16x32_bf16 v[60:63], v[148:151], a[96:99], v[60:63]
v_mul_f32 v137, v97, v105
v_mul_f32 v138, v98, v106
v_mfma_f32_16x16x32_bf16 v[60:63], v[152:155], a[112:115], v[60:63]
ds_read_b128 v[180:183], v7 offset:20480
v_mul_f32 v139, v99, v107
v_mfma_f32_16x16x32_bf16 v[64:67], v[152:155], a[116:119], v[64:67]
v_fma_f32 v132, v132, v25, v25
v_fma_f32 v133, v133, v25, v25
v_mfma_f32_16x16x32_bf16 v[64:67], v[148:151], a[100:103], v[64:67]
v_rcp_f32 v132, v132
v_mfma_f32_16x16x32_bf16 v[76:79], v[148:151], a[104:107], v[76:79]
buffer_load_dwordx4 v4, s[8:11], s24 offen offset:1024 sc1 lds
v_mfma_f32_16x16x32_bf16 v[76:79], v[152:155], a[120:123], v[76:79]
ds_read_b128 v[184:187], v7 offset:21504
v_fma_f32 v134, v134, v25, v25
v_mfma_f32_16x16x32_bf16 v[80:83], v[152:155], a[124:127], v[80:83]
v_rcp_f32 v133, v133
v_mfma_f32_16x16x32_bf16 v[80:83], v[148:151], a[108:111], v[80:83]
v_rcp_f32 v134, v134
v_mfma_f32_16x16x32_bf16 v[88:91], v[156:159], a[108:111], v[88:91]
v_fma_f32 v135, v135, v25, v25
v_mul_f32 v136, v136, v132
v_mfma_f32_16x16x32_bf16 v[88:91], v[160:163], a[124:127], v[88:91]
ds_read_b128 v[188:191], v7 offset:22528
v_mul_f32 v137, v137, v133
v_mfma_f32_16x16x32_bf16 v[84:87], v[160:163], a[120:123], v[84:87]
v_rcp_f32 v135, v135
v_mfma_f32_16x16x32_bf16 v[84:87], v[156:159], a[104:107], v[84:87]
v_mul_f32 v138, v138, v134
v_mul_f32 v139, v139, v135
v_mfma_f32_16x16x32_bf16 v[72:75], v[156:159], a[100:103], v[72:75]
buffer_load_dwordx4 v4, s[8:11], s24 offen offset:2048 sc1 lds
v_mfma_f32_16x16x32_bf16 v[72:75], v[160:163], a[116:119], v[72:75]
ds_read_b128 v[192:195], v7 offset:23552
v_cvt_pk_bf16_f32 v142, v136, v137
v_mfma_f32_16x16x32_bf16 v[68:71], v[160:163], a[112:115], v[68:71]
s_nop 0
v_permlane16_swap_b32 v140, v142
v_mfma_f32_16x16x32_bf16 v[68:71], v[156:159], a[96:99], v[68:71]
s_waitcnt lgkmcnt(4)
v_cvt_pk_bf16_f32 v143, v138, v139
v_mul_f32 v124, v108, v108
v_mfma_f32_16x16x32_bf16 v[60:63], v[164:167], a[128:131], v[60:63]
v_permlane16_swap_b32 v141, v143
v_mfma_f32_16x16x32_bf16 v[60:63], v[168:171], a[144:147], v[60:63]
ds_read_b128 v[148:151], v7 offset:24576
v_mul_f32 v125, v109, v109
v_mfma_f32_16x16x32_bf16 v[64:67], v[168:171], a[148:151], v[64:67]
buffer_store_dwordx4 v[140:143], v9, s[8:11], s26 offen sc1
v_mfma_f32_16x16x32_bf16 v[64:67], v[164:167], a[132:135], v[64:67]
s_add_u32 s26, s26, 4096
v_mul_f32 v126, v110, v110
v_mul_f32 v127, v111, v111
v_mfma_f32_16x16x32_bf16 v[76:79], v[164:167], a[136:139], v[76:79]
buffer_load_dwordx4 v4, s[8:11], s24 offen offset:3072 sc1 lds
v_mfma_f32_16x16x32_bf16 v[76:79], v[168:171], a[152:155], v[76:79]
s_add_u32 s24, s24, 4096
ds_read_b128 v[152:155], v7 offset:25600
v_fma_f32 v124, v124, v22, v18
v_mfma_f32_16x16x32_bf16 v[80:83], v[168:171], a[156:159], v[80:83]
s_add_u32 s83, s82, Lcw3-Lcp
v_fma_f32 v125, v125, v22, v18
v_fma_f32 v126, v126, v22, v18
v_mfma_f32_16x16x32_bf16 v[80:83], v[164:167], a[140:143], v[80:83]
s_min_u32 s83, s83, Lcode_end-Lcp-4
v_fma_f32 v127, v127, v22, v18
v_mul_f32 v124, v124, v108
v_mfma_f32_16x16x32_bf16 v[88:91], v[172:175], a[140:143], v[88:91]
v_mov_b32 v222, s83
v_mul_f32 v125, v125, v109
v_mfma_f32_16x16x32_bf16 v[88:91], v[176:179], a[156:159], v[88:91]
ds_read_b128 v[156:159], v7 offset:26624
v_mul_f32 v126, v126, v110
v_mfma_f32_16x16x32_bf16 v[84:87], v[176:179], a[152:155], v[84:87]
global_load_dword v223, v222, s[80:81]
v_mfma_f32_16x16x32_bf16 v[84:87], v[172:175], a[136:139], v[84:87]
v_exp_f32 v124, v124
v_mfma_f32_16x16x32_bf16 v[72:75], v[172:175], a[132:135], v[72:75]
s_add_u32 m0, s25, 4096
v_exp_f32 v125, v125
v_mfma_f32_16x16x32_bf16 v[72:75], v[176:179], a[148:151], v[72:75]
ds_read_b128 v[160:163], v7 offset:27648
v_mul_f32 v127, v127, v111
v_mfma_f32_16x16x32_bf16 v[68:71], v[176:179], a[144:147], v[68:71]
buffer_load_dwordx4 v4, s[8:11], s24 offen offset:0 sc1 lds
v_mfma_f32_16x16x32_bf16 v[68:71], v[172:175], a[128:131], v[68:71]
s_waitcnt lgkmcnt(4)
v_exp_f32 v126, v126
v_mfma_f32_16x16x32_bf16 v[60:63], v[180:183], a[160:163], v[60:63]
v_exp_f32 v127, v127
v_mfma_f32_16x16x32_bf16 v[60:63], v[184:187], a[176:179], v[60:63]
ds_read_b128 v[164:167], v7 offset:28672
v_mul_f32 v128, v108, v116
v_mfma_f32_16x16x32_bf16 v[64:67], v[184:187], a[180:183], v[64:67]
v_mul_f32 v129, v109, v117
v_mul_f32 v130, v110, v118
v_mfma_f32_16x16x32_bf16 v[64:67], v[180:183], a[164:167], v[64:67]
v_mul_f32 v131, v111, v119
v_fma_f32 v124, v124, v26, v26
v_mfma_f32_16x16x32_bf16 v[76:79], v[180:183], a[168:171], v[76:79]
buffer_load_dwordx4 v4, s[8:11], s24 offen offset:1024 sc1 lds
v_mfma_f32_16x16x32_bf16 v[76:79], v[184:187], a[184:187], v[76:79]
ds_read_b128 v[168:171], v7 offset:29696
v_fma_f32 v125, v125, v26, v26
v_mfma_f32_16x16x32_bf16 v[80:83], v[184:187], a[188:191], v[80:83]
v_rcp_f32 v124, v124
v_mfma_f32_16x16x32_bf16 v[80:83], v[180:183], a[172:175], v[80:83]
v_rcp_f32 v125, v125
v_mfma_f32_16x16x32_bf16 v[88:91], v[188:191], a[172:175], v[88:91]
v_fma_f32 v126, v126, v26, v26
v_fma_f32 v127, v127, v26, v26
v_mfma_f32_16x16x32_bf16 v[88:91], v[192:195], a[188:191], v[88:91]
ds_read_b128 v[172:175], v7 offset:30720
v_mul_f32 v128, v128, v124
v_mfma_f32_16x16x32_bf16 v[84:87], v[192:195], a[184:187], v[84:87]
v_rcp_f32 v126, v126
v_mfma_f32_16x16x32_bf16 v[84:87], v[188:191], a[168:171], v[84:87]
v_rcp_f32 v127, v127
v_mfma_f32_16x16x32_bf16 v[72:75], v[188:191], a[164:167], v[72:75]
buffer_load_dwordx4 v4, s[8:11], s24 offen offset:2048 sc1 lds
v_mfma_f32_16x16x32_bf16 v[72:75], v[192:195], a[180:183], v[72:75]
ds_read_b128 v[176:179], v7 offset:31744
v_mul_f32 v129, v129, v125
v_mfma_f32_16x16x32_bf16 v[68:71], v[192:195], a[176:179], v[68:71]
v_mul_f32 v130, v130, v126
v_mul_f32 v131, v131, v127
v_mfma_f32_16x16x32_bf16 v[68:71], v[188:191], a[160:163], v[68:71]
s_waitcnt lgkmcnt(4)
v_cvt_pk_bf16_f32 v144, v128, v129
v_cvt_pk_bf16_f32 v145, v130, v131
v_mfma_f32_16x16x32_bf16 v[60:63], v[148:151], a[192:195], v[60:63]
v_mul_f32 v132, v112, v112
v_mul_f32 v133, v113, v113
v_mfma_f32_16x16x32_bf16 v[60:63], v[152:155], a[208:211], v[60:63]
ds_read_b128 v[180:183], v7 offset:32768
v_mul_f32 v134, v114, v114
v_mfma_f32_16x16x32_bf16 v[64:67], v[152:155], a[212:215], v[64:67]
v_mul_f32 v135, v115, v115
v_fma_f32 v132, v132, v23, v19
v_mfma_f32_16x16x32_bf16 v[64:67], v[148:151], a[196:199], v[64:67]
v_fma_f32 v133, v133, v23, v19
v_fma_f32 v134, v134, v23, v19
v_mfma_f32_16x16x32_bf16 v[76:79], v[148:151], a[200:203], v[76:79]
buffer_load_dwordx4 v4, s[8:11], s24 offen offset:3072 sc1 lds
v_mfma_f32_16x16x32_bf16 v[76:79], v[152:155], a[216:219], v[76:79]
s_add_u32 s24, s24, 4096
ds_read_b128 v[184:187], v7 offset:33792
v_fma_f32 v135, v135, v23, v19
v_mfma_f32_16x16x32_bf16 v[80:83], v[152:155], a[220:223], v[80:83]
v_mul_f32 v132, v132, v112
v_mul_f32 v133, v133, v113
v_mfma_f32_16x16x32_bf16 v[80:83], v[148:151], a[204:207], v[80:83]
v_exp_f32 v132, v132
v_mfma_f32_16x16x32_bf16 v[88:91], v[156:159], a[204:207], v[88:91]
v_exp_f32 v133, v133
v_mfma_f32_16x16x32_bf16 v[88:91], v[160:163], a[220:223], v[88:91]
ds_read_b128 v[188:191], v7 offset:34816
v_mul_f32 v134, v134, v114
v_mfma_f32_16x16x32_bf16 v[84:87], v[160:163], a[216:219], v[84:87]
v_exp_f32 v134, v134
v_mfma_f32_16x16x32_bf16 v[84:87], v[156:159], a[200:203], v[84:87]
v_mul_f32 v135, v135, v115
v_mul_f32 v136, v112, v120
v_mfma_f32_16x16x32_bf16 v[72:75], v[156:159], a[196:199], v[72:75]
v_exp_f32 v135, v135
v_mfma_f32_16x16x32_bf16 v[72:75], v[160:163], a[212:215], v[72:75]
s_add_u32 m0, s25, 8192
ds_read_b128 v[192:195], v7 offset:35840
v_mul_f32 v137, v113, v121
v_mfma_f32_16x16x32_bf16 v[68:71], v[160:163], a[208:211], v[68:71]
buffer_load_dwordx4 v4, s[8:11], s24 offen offset:0 sc1 lds
v_mfma_f32_16x16x32_bf16 v[68:71], v[156:159], a[192:195], v[68:71]
s_waitcnt lgkmcnt(4)
s_add_u32 s24, s24, 28672
v_mul_f32 v138, v114, v122
v_mfma_f32_16x16x32_bf16 v[60:63], v[164:167], a[224:227], v[60:63]
v_mul_f32 v139, v115, v123
v_fma_f32 v132, v132, v27, v27
v_mfma_f32_16x16x32_bf16 v[60:63], v[168:171], a[240:243], v[60:63]
s_waitcnt vmcnt(12)
s_barrier
ds_read_b128 v[148:151], v8 offset:0
v_mfma_f32_16x16x32_bf16 v[64:67], v[168:171], a[244:247], v[64:67]
v_rcp_f32 v132, v132
v_mfma_f32_16x16x32_bf16 v[64:67], v[164:167], a[228:231], v[64:67]
v_fma_f32 v133, v133, v27, v27
v_fma_f32 v134, v134, v27, v27
v_mfma_f32_16x16x32_bf16 v[76:79], v[164:167], a[232:235], v[76:79]
v_rcp_f32 v133, v133
v_mfma_f32_16x16x32_bf16 v[76:79], v[168:171], a[248:251], v[76:79]
s_add_u32 m0, s25, 36864
ds_read_b128 v[152:155], v8 offset:1024
v_fma_f32 v135, v135, v27, v27
v_mfma_f32_16x16x32_bf16 v[80:83], v[168:171], a[252:255], v[80:83]
buffer_load_dwordx4 v4, s[8:11], s44 offen offset:0 sc1 lds
v_mfma_f32_16x16x32_bf16 v[80:83], v[164:167], a[236:239], v[80:83]
v_rcp_f32 v134, v134
v_mfma_f32_16x16x32_bf16 v[88:91], v[172:175], a[236:239], v[88:91]
v_rcp_f32 v135, v135
v_mfma_f32_16x16x32_bf16 v[88:91], v[176:179], a[252:255], v[88:91]
ds_read_b128 v[156:159], v8 offset:2048
v_mul_f32 v136, v136, v132
v_mfma_f32_16x16x32_bf16 v[84:87], v[176:179], a[248:251], v[84:87]
buffer_load_dwordx4 v4, s[8:11], s44 offen offset:1024 sc1 lds
v_mfma_f32_16x16x32_bf16 v[84:87], v[172:175], a[232:235], v[84:87]
v_mul_f32 v137, v137, v133
v_mul_f32 v138, v138, v134
v_mfma_f32_16x16x32_bf16 v[72:75], v[172:175], a[228:231], v[72:75]
buffer_load_dword v220, v221, s[8:11], s41 offen sc1
v_mfma_f32_16x16x32_bf16 v[72:75], v[176:179], a[244:247], v[72:75]
ds_read_b128 v[160:163], v8 offset:3072
v_mul_f32 v139, v139, v135
v_mfma_f32_16x16x32_bf16 v[68:71], v[176:179], a[240:243], v[68:71]
v_cvt_pk_bf16_f32 v146, v136, v137
v_cvt_pk_bf16_f32 v147, v138, v139
v_mfma_f32_16x16x32_bf16 v[68:71], v[172:175], a[224:227], v[68:71]
s_waitcnt lgkmcnt(4)
buffer_load_dwordx4 v4, s[8:11], s44 offen offset:2048 sc1 lds
v_mfma_f32_16x16x32_bf16 v[60:63], v[180:183], v[224:227], v[60:63]
v_permlane16_swap_b32 v144, v146
v_mfma_f32_16x16x32_bf16 v[60:63], v[184:187], v[240:243], v[60:63]
ds_read_b128 v[164:167], v8 offset:4096
v_mfma_f32_16x16x32_bf16 v[64:67], v[184:187], v[244:247], v[64:67]
v_permlane16_swap_b32 v145, v147
v_mfma_f32_16x16x32_bf16 v[64:67], v[180:183], v[228:231], v[64:67]
buffer_store_dwordx4 v[144:147], v9, s[8:11], s27 offen sc1
v_mfma_f32_16x16x32_bf16 v[76:79], v[180:183], v[232:235], v[76:79]
buffer_load_dwordx4 v4, s[8:11], s44 offen offset:3072 sc1 lds
v_mfma_f32_16x16x32_bf16 v[76:79], v[184:187], v[248:251], v[76:79]
s_add_u32 s44, s44, 4096
ds_read_b128 v[168:171], v8 offset:5120
v_mfma_f32_16x16x32_bf16 v[80:83], v[184:187], v[252:255], v[80:83]
v_mfma_f32_16x16x32_bf16 v[80:83], v[180:183], v[236:239], v[80:83]
v_mfma_f32_16x16x32_bf16 v[88:91], v[188:191], v[236:239], v[88:91]
s_add_u32 m0, s25, 40960
v_mfma_f32_16x16x32_bf16 v[88:91], v[192:195], v[252:255], v[88:91]
ds_read_b128 v[172:175], v8 offset:6144
v_mfma_f32_16x16x32_bf16 v[84:87], v[192:195], v[248:251], v[84:87]
buffer_load_dwordx4 v4, s[8:11], s44 offen offset:0 sc1 lds
v_mfma_f32_16x16x32_bf16 v[84:87], v[188:191], v[232:235], v[84:87]
v_mfma_f32_16x16x32_bf16 v[72:75], v[188:191], v[228:231], v[72:75]
buffer_load_dwordx4 v4, s[8:11], s44 offen offset:1024 sc1 lds
v_mfma_f32_16x16x32_bf16 v[72:75], v[192:195], v[244:247], v[72:75]
ds_read_b128 v[176:179], v8 offset:7168
v_mfma_f32_16x16x32_bf16 v[68:71], v[192:195], v[240:243], v[68:71]
v_mfma_f32_16x16x32_bf16 v[68:71], v[188:191], v[224:227], v[68:71]
s_waitcnt lgkmcnt(4)
s_add_u32 s27, s27, 4096
v_mfma_f32_16x16x32_bf16 v[92:95], v[148:151], a[0:3], 0
v_mfma_f32_16x16x32_bf16 v[92:95], v[152:155], a[16:19], v[92:95]
ds_read_b128 v[180:183], v8 offset:8192
v_mfma_f32_16x16x32_bf16 v[96:99], v[152:155], a[20:23], 0
s_barrier
v_mfma_f32_16x16x32_bf16 v[96:99], v[148:151], a[4:7], v[96:99]
buffer_load_dwordx4 v4, s[8:11], s44 offen offset:2048 sc1 lds
v_mfma_f32_16x16x32_bf16 v[108:111], v[148:151], a[8:11], 0
v_mul_f32 v124, v60, v60
v_mul_f32 v125, v61, v61
v_mfma_f32_16x16x32_bf16 v[108:111], v[152:155], a[24:27], v[108:111]
ds_read_b128 v[184:187], v8 offset:9216
v_mul_f32 v126, v62, v62
v_mfma_f32_16x16x32_bf16 v[112:115], v[152:155], a[28:31], 0
v_mul_f32 v127, v63, v63
v_fma_f32 v124, v124, v20, v16
v_mfma_f32_16x16x32_bf16 v[112:115], v[148:151], a[12:15], v[112:115]
buffer_load_dwordx4 v4, s[8:11], s44 offen offset:3072 sc1 lds
v_mfma_f32_16x16x32_bf16 v[120:123], v[156:159], a[12:15], 0
s_add_u32 s44, s44, 4096
v_fma_f32 v125, v125, v20, v16
v_fma_f32 v126, v126, v20, v16
v_mfma_f32_16x16x32_bf16 v[120:123], v[160:163], a[28:31], v[120:123]
ds_read_b128 v[188:191], v8 offset:10240
v_fma_f32 v127, v127, v20, v16
v_mfma_f32_16x16x32_bf16 v[116:119], v[160:163], a[24:27], 0
v_mul_f32 v124, v124, v60
v_mul_f32 v125, v125, v61
v_mfma_f32_16x16x32_bf16 v[116:119], v[156:159], a[8:11], v[116:119]
s_add_u32 m0, s25, 45056
v_exp_f32 v124, v124
v_mfma_f32_16x16x32_bf16 v[104:107], v[156:159], a[4:7], 0
buffer_load_dwordx4 v4, s[8:11], s44 offen offset:0 sc1 lds
v_mfma_f32_16x16x32_bf16 v[104:107], v[160:163], a[20:23], v[104:107]
s_add_u32 s44, s44, 28672
ds_read_b128 v[192:195], v8 offset:11264
v_mul_f32 v126, v126, v62
v_mfma_f32_16x16x32_bf16 v[100:103], v[160:163], a[16:19], 0
v_exp_f32 v125, v125
v_mfma_f32_16x16x32_bf16 v[100:103], v[156:159], a[0:3], v[100:103]
s_waitcnt lgkmcnt(4)
v_exp_f32 v126, v126
v_mfma_f32_16x16x32_bf16 v[92:95], v[164:167], a[32:35], v[92:95]
s_add_u32 m0, s25, 73728
v_mul_f32 v127, v127, v63
v_mul_f32 v128, v60, v68
v_mfma_f32_16x16x32_bf16 v[92:95], v[168:171], a[48:51], v[92:95]
ds_read_b128 v[148:151], v8 offset:12288
v_mul_f32 v129, v61, v69
v_mfma_f32_16x16x32_bf16 v[96:99], v[168:171], a[52:55], v[96:99]
buffer_load_dwordx4 v4, s[8:11], s44 offen offset:0 sc1 lds
v_mfma_f32_16x16x32_bf16 v[96:99], v[164:167], a[36:39], v[96:99]
v_exp_f32 v127, v127
v_mfma_f32_16x16x32_bf16 v[108:111], v[164:167], a[40:43], v[108:111]
s_waitcnt vmcnt(9)
v_cmp_ne_u32 vcc, v12, v220
s_nop 1
s_cbranch_vccnz Lsp6
Lok6:
s_add_u32 s41, s41, 131072
v_mfma_f32_16x16x32_bf16 v[108:111], v[168:171], a[56:59], v[108:111]
ds_read_b128 v[152:155], v8 offset:13312
v_mul_f32 v130, v62, v70
v_mfma_f32_16x16x32_bf16 v[112:115], v[168:171], a[60:63], v[112:115]
buffer_load_dwordx4 v4, s[8:11], s44 offen offset:1024 sc1 lds
v_mfma_f32_16x16x32_bf16 v[112:115], v[164:167], a[44:47], v[112:115]
v_mul_f32 v131, v63, v71
v_fma_f32 v124, v124, v24, v24
v_mfma_f32_16x16x32_bf16 v[120:123], v[172:175], a[44:47], v[120:123]
v_rcp_f32 v124, v124
v_mfma_f32_16x16x32_bf16 v[120:123], v[176:179], a[60:63], v[120:123]
ds_read_b128 v[156:159], v8 offset:14336
v_fma_f32 v125, v125, v24, v24
v_mfma_f32_16x16x32_bf16 v[116:119], v[176:179], a[56:59], v[116:119]
buffer_load_dwordx4 v[28:31], v4, s[8:11], s46 offen offset:0 sc1
v_mfma_f32_16x16x32_bf16 v[116:119], v[172:175], a[40:43], v[116:119]
v_rcp_f32 v125, v125
v_mfma_f32_16x16x32_bf16 v[104:107], v[172:175], a[36:39], v[104:107]
v_fma_f32 v126, v126, v24, v24
v_fma_f32 v127, v127, v24, v24
v_mfma_f32_16x16x32_bf16 v[104:107], v[176:179], a[52:55], v[104:107]
ds_read_b128 v[160:163], v8 offset:15360
v_mul_f32 v128, v128, v124
v_mfma_f32_16x16x32_bf16 v[100:103], v[176:179], a[48:51], v[100:103]
v_rcp_f32 v126, v126
v_mfma_f32_16x16x32_bf16 v[100:103], v[172:175], a[32:35], v[100:103]
s_waitcnt lgkmcnt(4)
buffer_load_dwordx4 v[32:35], v4, s[8:11], s47 offen offset:0 sc1
v_mfma_f32_16x16x32_bf16 v[92:95], v[180:183], a[64:67], v[92:95]
v_rcp_f32 v127, v127
v_mfma_f32_16x16x32_bf16 v[92:95], v[184:187], a[80:83], v[92:95]
ds_read_b128 v[164:167], v8 offset:16384
v_mul_f32 v129, v129, v125
v_mfma_f32_16x16x32_bf16 v[96:99], v[184:187], a[84:87], v[96:99]
v_mul_f32 v130, v130, v126
v_mul_f32 v131, v131, v127
v_mfma_f32_16x16x32_bf16 v[96:99], v[180:183], a[68:71], v[96:99]
v_cvt_pk_bf16_f32 v140, v128, v129
v_cvt_pk_bf16_f32 v141, v130, v131
v_mfma_f32_16x16x32_bf16 v[108:111], v[180:183], a[72:75], v[108:111]
buffer_load_dwordx4 v[36:39], v4, s[8:11], s46 offen offset:1024 sc1
v_mfma_f32_16x16x32_bf16 v[108:111], v[184:187], a[88:91], v[108:111]
ds_read_b128 v[168:171], v8 offset:17408
v_mul_f32 v132, v64, v64
v_mfma_f32_16x16x32_bf16 v[112:115], v[184:187], a[92:95], v[112:115]
v_mul_f32 v133, v65, v65
v_mul_f32 v134, v66, v66
v_mfma_f32_16x16x32_bf16 v[112:115], v[180:183], a[76:79], v[112:115]
v_mul_f32 v135, v67, v67
v_fma_f32 v132, v132, v21, v17
v_mfma_f32_16x16x32_bf16 v[120:123], v[188:191], a[76:79], v[120:123]
buffer_load_dwordx4 v[40:43], v4, s[8:11], s47 offen offset:1024 sc1
v_mfma_f32_16x16x32_bf16 v[120:123], v[192:195], a[92:95], v[120:123]
ds_read_b128 v[172:175], v8 offset:18432
v_fma_f32 v133, v133, v21, v17
v_mfma_f32_16x16x32_bf16 v[116:119], v[192:195], a[88:91], v[116:119]
v_fma_f32 v134, v134, v21, v17
v_fma_f32 v135, v135, v21, v17
v_mfma_f32_16x16x32_bf16 v[116:119], v[188:191], a[72:75], v[116:119]
v_mul_f32 v132, v132, v64
v_mul_f32 v133, v133, v65
v_mfma_f32_16x16x32_bf16 v[104:107], v[188:191], a[68:71], v[104:107]
buffer_load_dwordx4 v[44:47], v4, s[8:11], s46 offen offset:2048 sc1
v_mfma_f32_16x16x32_bf16 v[104:107], v[192:195], a[84:87], v[104:107]
ds_read_b128 v[176:179], v8 offset:19456
v_mul_f32 v134, v134, v66
v_mfma_f32_16x16x32_bf16 v[100:103], v[192:195], a[80:83], v[100:103]
v_exp_f32 v132, v132
v_mfma_f32_16x16x32_bf16 v[100:103], v[188:191], a[64:67], v[100:103]
s_waitcnt lgkmcnt(4)
v_exp_f32 v133, v133
v_mfma_f32_16x16x32_bf16 v[92:95], v[148:151], a[96:99], v[92:95]
v_exp_f32 v134, v134
v_mfma_f32_16x16x32_bf16 v[92:95], v[152:155], a[112:115], v[92:95]
ds_read_b128 v[180:183], v8 offset:20480
v_mul_f32 v135, v135, v67
v_mfma_f32_16x16x32_bf16 v[96:99], v[152:155], a[116:119], v[96:99]
buffer_load_dwordx4 v[48:51], v4, s[8:11], s47 offen offset:2048 sc1
v_mfma_f32_16x16x32_bf16 v[96:99], v[148:151], a[100:103], v[96:99]
v_exp_f32 v135, v135
v_mfma_f32_16x16x32_bf16 v[108:111], v[148:151], a[104:107], v[108:111]
v_mul_f32 v136, v64, v72
v_mul_f32 v137, v65, v73
v_mfma_f32_16x16x32_bf16 v[108:111], v[152:155], a[120:123], v[108:111]
ds_read_b128 v[184:187], v8 offset:21504
v_mul_f32 v138, v66, v74
v_mfma_f32_16x16x32_bf16 v[112:115], v[152:155], a[124:127], v[112:115]
v_mul_f32 v139, v67, v75
v_fma_f32 v132, v132, v25, v25
v_mfma_f32_16x16x32_bf16 v[112:115], v[148:151], a[108:111], v[112:115]
buffer_load_dwordx4 v[52:55], v4, s[8:11], s46 offen offset:3072 sc1
v_mfma_f32_16x16x32_bf16 v[120:123], v[156:159], a[108:111], v[120:123]
v_rcp_f32 v132, v132
v_mfma_f32_16x16x32_bf16 v[120:123], v[160:163], a[124:127], v[120:123]
ds_read_b128 v[188:191], v8 offset:22528
v_fma_f32 v133, v133, v25, v25
v_mfma_f32_16x16x32_bf16 v[116:119], v[160:163], a[120:123], v[116:119]
v_rcp_f32 v133, v133
v_mfma_f32_16x16x32_bf16 v[116:119], v[156:159], a[104:107], v[116:119]
v_fma_f32 v134, v134, v25, v25
v_fma_f32 v135, v135, v25, v25
v_mfma_f32_16x16x32_bf16 v[104:107], v[156:159], a[100:103], v[104:107]
buffer_load_dwordx4 v[56:59], v4, s[8:11], s47 offen offset:3072 sc1
v_mfma_f32_16x16x32_bf16 v[104:107], v[160:163], a[116:119], v[104:107]
s_add_u32 s46, s46, 4096
ds_read_b128 v[192:195], v8 offset:23552
v_mul_f32 v136, v136, v132
v_mfma_f32_16x16x32_bf16 v[100:103], v[160:163], a[112:115], v[100:103]
s_add_u32 s47, s47, 4096
v_rcp_f32 v134, v134
v_mfma_f32_16x16x32_bf16 v[100:103], v[156:159], a[96:99], v[100:103]
s_waitcnt lgkmcnt(4)
v_rcp_f32 v135, v135
v_mfma_f32_16x16x32_bf16 v[92:95], v[164:167], a[128:131], v[92:95]
buffer_load_dwordx4 v4, s[8:11], s44 offen offset:2048 sc1 lds
v_mfma_f32_16x16x32_bf16 v[92:95], v[168:171], a[144:147], v[92:95]
ds_read_b128 v[148:151], v8 offset:24576
v_mul_f32 v137, v137, v133
v_mfma_f32_16x16x32_bf16 v[96:99], v[168:171], a[148:151], v[96:99]
v_mul_f32 v138, v138, v134
v_mul_f32 v139, v139, v135
v_mfma_f32_16x16x32_bf16 v[96:99], v[164:167], a[132:135], v[96:99]
v_cvt_pk_bf16_f32 v142, v136, v137
v_cvt_pk_bf16_f32 v143, v138, v139
v_mfma_f32_16x16x32_bf16 v[108:111], v[164:167], a[136:139], v[108:111]
buffer_load_dwordx4 v4, s[8:11], s44 offen offset:3072 sc1 lds
v_mfma_f32_16x16x32_bf16 v[108:111], v[168:171], a[152:155], v[108:111]
s_add_u32 s44, s44, 4096
ds_read_b128 v[152:155], v8 offset:25600
v_mul_f32 v124, v76, v76
v_mfma_f32_16x16x32_bf16 v[112:115], v[168:171], a[156:159], v[112:115]
v_permlane16_swap_b32 v140, v142
v_mfma_f32_16x16x32_bf16 v[112:115], v[164:167], a[140:143], v[112:115]
v_permlane16_swap_b32 v141, v143
v_mfma_f32_16x16x32_bf16 v[120:123], v[172:175], a[140:143], v[120:123]
buffer_store_dwordx4 v[140:143], v9, s[8:11], s26 offen sc1
v_mfma_f32_16x16x32_bf16 v[120:123], v[176:179], a[156:159], v[120:123]
s_add_u32 m0, s25, 77824
ds_read_b128 v[156:159], v8 offset:26624
v_mul_f32 v125, v77, v77
v_mfma_f32_16x16x32_bf16 v[116:119], v[176:179], a[152:155], v[116:119]
buffer_load_dwordx4 v4, s[8:11], s44 offen offset:0 sc1 lds
v_mfma_f32_16x16x32_bf16 v[116:119], v[172:175], a[136:139], v[116:119]
s_add_u32 s26, s26, 4096
v_mul_f32 v126, v78, v78
v_mul_f32 v127, v79, v79
v_mfma_f32_16x16x32_bf16 v[104:107], v[172:175], a[132:135], v[104:107]
v_fma_f32 v124, v124, v22, v18
v_fma_f32 v125, v125, v22, v18
v_mfma_f32_16x16x32_bf16 v[104:107], v[176:179], a[148:151], v[104:107]
ds_read_b128 v[160:163], v8 offset:27648
v_fma_f32 v126, v126, v22, v18
v_mfma_f32_16x16x32_bf16 v[100:103], v[176:179], a[144:147], v[100:103]
v_fma_f32 v127, v127, v22, v18
v_mul_f32 v124, v124, v76
v_mfma_f32_16x16x32_bf16 v[100:103], v[172:175], a[128:131], v[100:103]
s_waitcnt lgkmcnt(4)
buffer_load_dwordx4 v4, s[8:11], s44 offen offset:1024 sc1 lds
v_mfma_f32_16x16x32_bf16 v[92:95], v[180:183], a[160:163], v[92:95]
v_exp_f32 v124, v124
v_mfma_f32_16x16x32_bf16 v[92:95], v[184:187], a[176:179], v[92:95]
ds_read_b128 v[164:167], v8 offset:28672
v_mul_f32 v125, v125, v77
v_mfma_f32_16x16x32_bf16 v[96:99], v[184:187], a[180:183], v[96:99]
v_exp_f32 v125, v125
v_mfma_f32_16x16x32_bf16 v[96:99], v[180:183], a[164:167], v[96:99]
v_mul_f32 v126, v126, v78
v_mul_f32 v127, v127, v79
v_mfma_f32_16x16x32_bf16 v[108:111], v[180:183], a[168:171], v[108:111]
buffer_load_dwordx4 v4, s[8:11], s44 offen offset:2048 sc1 lds
v_mfma_f32_16x16x32_bf16 v[108:111], v[184:187], a[184:187], v[108:111]
ds_read_b128 v[168:171], v8 offset:29696
v_mul_f32 v128, v76, v84
v_mfma_f32_16x16x32_bf16 v[112:115], v[184:187], a[188:191], v[112:115]
v_exp_f32 v126, v126
v_mfma_f32_16x16x32_bf16 v[112:115], v[180:183], a[172:175], v[112:115]
v_exp_f32 v127, v127
v_mfma_f32_16x16x32_bf16 v[120:123], v[188:191], a[172:175], v[120:123]
buffer_load_dwordx4 v4, s[8:11], s44 offen offset:3072 sc1 lds
v_mfma_f32_16x16x32_bf16 v[120:123], v[192:195], a[188:191], v[120:123]
s_add_u32 s44, s44, 4096
ds_read_b128 v[172:175], v8 offset:30720
v_mul_f32 v129, v77, v85
v_mfma_f32_16x16x32_bf16 v[116:119], v[192:195], a[184:187], v[116:119]
v_mul_f32 v130, v78, v86
v_mul_f32 v131, v79, v87
v_mfma_f32_16x16x32_bf16 v[116:119], v[188:191], a[168:171], v[116:119]
v_fma_f32 v124, v124, v26, v26
v_fma_f32 v125, v125, v26, v26
v_mfma_f32_16x16x32_bf16 v[104:107], v[188:191], a[164:167], v[104:107]
s_add_u32 m0, s25, 81920
v_rcp_f32 v124, v124
v_mfma_f32_16x16x32_bf16 v[104:107], v[192:195], a[180:183], v[104:107]
ds_read_b128 v[176:179], v8 offset:31744
v_fma_f32 v126, v126, v26, v26
v_mfma_f32_16x16x32_bf16 v[100:103], v[192:195], a[176:179], v[100:103]
buffer_load_dwordx4 v4, s[8:11], s44 offen offset:0 sc1 lds
v_mfma_f32_16x16x32_bf16 v[100:103], v[188:191], a[160:163], v[100:103]
s_waitcnt lgkmcnt(4)
v_rcp_f32 v125, v125
v_mfma_f32_16x16x32_bf16 v[92:95], v[148:151], a[192:195], v[92:95]
s_add_u32 s44, s44, 28672
v_rcp_f32 v126, v126
v_mfma_f32_16x16x32_bf16 v[92:95], v[152:155], a[208:211], v[92:95]
ds_read_b128 v[180:183], v8 offset:32768
v_fma_f32 v127, v127, v26, v26
v_mfma_f32_16x16x32_bf16 v[96:99], v[152:155], a[212:215], v[96:99]
buffer_load_dwordx4 v[204:207], v4, s[8:11], s46 offen offset:0 sc1
v_mfma_f32_16x16x32_bf16 v[96:99], v[148:151], a[196:199], v[96:99]
v_rcp_f32 v127, v127
v_mfma_f32_16x16x32_bf16 v[108:111], v[148:151], a[200:203], v[108:111]
v_mul_f32 v128, v128, v124
v_mul_f32 v129, v129, v125
v_mfma_f32_16x16x32_bf16 v[108:111], v[152:155], a[216:219], v[108:111]
ds_read_b128 v[184:187], v8 offset:33792
v_mul_f32 v130, v130, v126
v_mfma_f32_16x16x32_bf16 v[112:115], v[152:155], a[220:223], v[112:115]
v_mul_f32 v131, v131, v127
v_cvt_pk_bf16_f32 v144, v128, v129
v_mfma_f32_16x16x32_bf16 v[112:115], v[148:151], a[204:207], v[112:115]
buffer_load_dwordx4 v[208:211], v4, s[8:11], s47 offen offset:0 sc1
v_mfma_f32_16x16x32_bf16 v[120:123], v[156:159], a[204:207], v[120:123]
v_cvt_pk_bf16_f32 v145, v130, v131
v_mul_f32 v132, v80, v80
v_mfma_f32_16x16x32_bf16 v[120:123], v[160:163], a[220:223], v[120:123]
ds_read_b128 v[188:191], v8 offset:34816
v_mul_f32 v133, v81, v81
v_mfma_f32_16x16x32_bf16 v[116:119], v[160:163], a[216:219], v[116:119]
v_mul_f32 v134, v82, v82
v_mul_f32 v135, v83, v83
v_mfma_f32_16x16x32_bf16 v[116:119], v[156:159], a[200:203], v[116:119]
v_fma_f32 v132, v132, v23, v19
v_fma_f32 v133, v133, v23, v19
v_mfma_f32_16x16x32_bf16 v[104:107], v[156:159], a[196:199], v[104:107]
buffer_load_dwordx4 v[212:215], v4, s[8:11], s46 offen offset:1024 sc1
v_mfma_f32_16x16x32_bf16 v[104:107], v[160:163], a[212:215], v[104:107]
ds_read_b128 v[192:195], v8 offset:35840
v_fma_f32 v134, v134, v23, v19
v_mfma_f32_16x16x32_bf16 v[100:103], v[160:163], a[208:211], v[100:103]
v_fma_f32 v135, v135, v23, v19
v_mul_f32 v132, v132, v80
v_mfma_f32_16x16x32_bf16 v[100:103], v[156:159], a[192:195], v[100:103]
s_waitcnt lgkmcnt(4)
v_exp_f32 v132, v132
v_mfma_f32_16x16x32_bf16 v[92:95], v[164:167], a[224:227], v[92:95]
buffer_load_dwordx4 v[216:219], v4, s[8:11], s47 offen offset:1024 sc1
v_mfma_f32_16x16x32_bf16 v[92:95], v[168:171], a[240:243], v[92:95]
s_barrier
ds_read_b128 v[148:151], v5 offset:0
v_mfma_f32_16x16x32_bf16 v[96:99], v[168:171], a[244:247], v[96:99]
v_mul_f32 v133, v133, v81
v_mul_f32 v134, v134, v82
v_mfma_f32_16x16x32_bf16 v[96:99], v[164:167], a[228:231], v[96:99]
v_exp_f32 v133, v133
v_mfma_f32_16x16x32_bf16 v[108:111], v[164:167], a[232:235], v[108:111]
v_exp_f32 v134, v134
v_mfma_f32_16x16x32_bf16 v[108:111], v[168:171], a[248:251], v[108:111]
ds_read_b128 v[152:155], v5 offset:1024
v_mul_f32 v135, v135, v83
v_mfma_f32_16x16x32_bf16 v[112:115], v[168:171], a[252:255], v[112:115]
v_exp_f32 v135, v135
v_mfma_f32_16x16x32_bf16 v[112:115], v[164:167], a[236:239], v[112:115]
v_mul_f32 v136, v80, v88
v_mul_f32 v137, v81, v89
v_mfma_f32_16x16x32_bf16 v[120:123], v[172:175], a[236:239], v[120:123]
v_mul_f32 v138, v82, v90
v_mul_f32 v139, v83, v91
v_mfma_f32_16x16x32_bf16 v[120:123], v[176:179], a[252:255], v[120:123]
ds_read_b128 v[156:159], v5 offset:2048
v_fma_f32 v132, v132, v27, v27
v_mfma_f32_16x16x32_bf16 v[116:119], v[176:179], a[248:251], v[116:119]
v_rcp_f32 v132, v132
v_mfma_f32_16x16x32_bf16 v[116:119], v[172:175], a[232:235], v[116:119]
v_fma_f32 v133, v133, v27, v27
v_fma_f32 v134, v134, v27, v27
v_mfma_f32_16x16x32_bf16 v[104:107], v[172:175], a[228:231], v[104:107]
v_rcp_f32 v133, v133
v_mfma_f32_16x16x32_bf16 v[104:107], v[176:179], a[244:247], v[104:107]
ds_read_b128 v[160:163], v5 offset:3072
v_fma_f32 v135, v135, v27, v27
v_mfma_f32_16x16x32_bf16 v[100:103], v[176:179], a[240:243], v[100:103]
v_rcp_f32 v134, v134
v_mfma_f32_16x16x32_bf16 v[100:103], v[172:175], a[224:227], v[100:103]
s_waitcnt lgkmcnt(4)
v_rcp_f32 v135, v135
v_mfma_f32_16x16x32_bf16 v[92:95], v[180:183], v[224:227], v[92:95]
v_mul_f32 v136, v136, v132
v_mul_f32 v137, v137, v133
v_mfma_f32_16x16x32_bf16 v[92:95], v[184:187], v[240:243], v[92:95]
ds_read_b128 v[164:167], v5 offset:4096
v_mul_f32 v138, v138, v134
v_mfma_f32_16x16x32_bf16 v[96:99], v[184:187], v[244:247], v[96:99]
v_mul_f32 v139, v139, v135
v_cvt_pk_bf16_f32 v146, v136, v137
v_mfma_f32_16x16x32_bf16 v[96:99], v[180:183], v[228:231], v[96:99]
s_nop 0
v_permlane16_swap_b32 v144, v146
v_mfma_f32_16x16x32_bf16 v[108:111], v[180:183], v[232:235], v[108:111]
v_cvt_pk_bf16_f32 v147, v138, v139
v_mfma_f32_16x16x32_bf16 v[108:111], v[184:187], v[248:251], v[108:111]
ds_read_b128 v[168:171], v5 offset:5120
v_mfma_f32_16x16x32_bf16 v[112:115], v[184:187], v[252:255], v[112:115]
v_permlane16_swap_b32 v145, v147
v_mfma_f32_16x16x32_bf16 v[112:115], v[180:183], v[236:239], v[112:115]
buffer_store_dwordx4 v[144:147], v9, s[8:11], s27 offen sc1
v_mfma_f32_16x16x32_bf16 v[120:123], v[188:191], v[236:239], v[120:123]
v_mfma_f32_16x16x32_bf16 v[120:123], v[192:195], v[252:255], v[120:123]
ds_read_b128 v[172:175], v5 offset:6144
v_mfma_f32_16x16x32_bf16 v[116:119], v[192:195], v[248:251], v[116:119]
v_mfma_f32_16x16x32_bf16 v[116:119], v[188:191], v[232:235], v[116:119]
v_mfma_f32_16x16x32_bf16 v[104:107], v[188:191], v[228:231], v[104:107]
v_mfma_f32_16x16x32_bf16 v[104:107], v[192:195], v[244:247], v[104:107]
ds_read_b128 v[176:179], v5 offset:7168
v_mfma_f32_16x16x32_bf16 v[100:103], v[192:195], v[240:243], v[100:103]
v_mfma_f32_16x16x32_bf16 v[100:103], v[188:191], v[224:227], v[100:103]
s_waitcnt lgkmcnt(4)
s_add_u32 s27, s27, 4096
v_mfma_f32_16x16x32_bf16 v[60:63], v[148:151], a[0:3], 0
Lcw3:
v_mfma_f32_16x16x32_bf16 v[60:63], v[152:155], a[16:19], v[60:63]
ds_read_b128 v[180:183], v5 offset:8192
v_mfma_f32_16x16x32_bf16 v[64:67], v[152:155], a[20:23], 0
s_barrier
v_mfma_f32_16x16x32_bf16 v[64:67], v[148:151], a[4:7], v[64:67]
v_mul_f32 v124, v92, v92
v_mul_f32 v125, v93, v93
v_mfma_f32_16x16x32_bf16 v[76:79], v[148:151], a[8:11], 0
s_add_u32 m0, s25, 110592
v_mul_f32 v126, v94, v94
v_mul_f32 v127, v95, v95
v_mfma_f32_16x16x32_bf16 v[76:79], v[152:155], a[24:27], v[76:79]
ds_read_b128 v[184:187], v5 offset:9216
v_fma_f32 v124, v124, v20, v16
v_mfma_f32_16x16x32_bf16 v[80:83], v[152:155], a[28:31], 0
buffer_load_dwordx4 v4, s[8:11], s44 offen offset:0 sc1 lds
v_mfma_f32_16x16x32_bf16 v[80:83], v[148:151], a[12:15], v[80:83]
v_fma_f32 v125, v125, v20, v16
v_fma_f32 v126, v126, v20, v16
v_mfma_f32_16x16x32_bf16 v[88:91], v[156:159], a[12:15], 0
v_fma_f32 v127, v127, v20, v16
v_mul_f32 v124, v124, v92
v_mfma_f32_16x16x32_bf16 v[88:91], v[160:163], a[28:31], v[88:91]
ds_read_b128 v[188:191], v5 offset:10240
v_mul_f32 v125, v125, v93
v_mfma_f32_16x16x32_bf16 v[84:87], v[160:163], a[24:27], 0
buffer_load_dwordx4 v4, s[8:11], s44 offen offset:1024 sc1 lds
v_mfma_f32_16x16x32_bf16 v[84:87], v[156:159], a[8:11], v[84:87]
v_exp_f32 v124, v124
v_mfma_f32_16x16x32_bf16 v[72:75], v[156:159], a[4:7], 0
v_exp_f32 v125, v125
v_mfma_f32_16x16x32_bf16 v[72:75], v[160:163], a[20:23], v[72:75]
ds_read_b128 v[192:195], v5 offset:11264
v_mul_f32 v126, v126, v94
v_mfma_f32_16x16x32_bf16 v[68:71], v[160:163], a[16:19], 0
v_exp_f32 v126, v126
v_mfma_f32_16x16x32_bf16 v[68:71], v[156:159], a[0:3], v[68:71]
s_waitcnt lgkmcnt(4)
buffer_load_dwordx4 v4, s[8:11], s44 offen offset:2048 sc1 lds
v_mfma_f32_16x16x32_bf16 v[60:63], v[164:167], a[32:35], v[60:63]
v_mul_f32 v127, v127, v95
v_mul_f32 v128, v92, v100
v_mfma_f32_16x16x32_bf16 v[60:63], v[168:171], a[48:51], v[60:63]
ds_read_b128 v[148:151], v5 offset:12288
v_mul_f32 v129, v93, v101
v_mfma_f32_16x16x32_bf16 v[64:67], v[168:171], a[52:55], v[64:67]
v_exp_f32 v127, v127
v_mfma_f32_16x16x32_bf16 v[64:67], v[164:167], a[36:39], v[64:67]
v_mul_f32 v130, v94, v102
v_mul_f32 v131, v95, v103
v_mfma_f32_16x16x32_bf16 v[76:79], v[164:167], a[40:43], v[76:79]
buffer_load_dwordx4 a[0:3], v4, s[8:11], s46 offen offset:2048 sc1
v_mfma_f32_16x16x32_bf16 v[76:79], v[168:171], a[56:59], v[76:79]
ds_read_b128 v[152:155], v5 offset:13312
v_fma_f32 v124, v124, v24, v24
v_mfma_f32_16x16x32_bf16 v[80:83], v[168:171], a[60:63], v[80:83]
v_rcp_f32 v124, v124
v_mfma_f32_16x16x32_bf16 v[80:83], v[164:167], a[44:47], v[80:83]
v_fma_f32 v125, v125, v24, v24
v_fma_f32 v126, v126, v24, v24
v_mfma_f32_16x16x32_bf16 v[88:91], v[172:175], a[44:47], v[88:91]
buffer_load_dwordx4 a[4:7], v4, s[8:11], s47 offen offset:2048 sc1
v_mfma_f32_16x16x32_bf16 v[88:91], v[176:179], a[60:63], v[88:91]
ds_read_b128 v[156:159], v5 offset:14336
v_fma_f32 v127, v127, v24, v24
v_mfma_f32_16x16x32_bf16 v[84:87], v[176:179], a[56:59], v[84:87]
v_rcp_f32 v125, v125
v_mfma_f32_16x16x32_bf16 v[84:87], v[172:175], a[40:43], v[84:87]
v_rcp_f32 v126, v126
v_mfma_f32_16x16x32_bf16 v[72:75], v[172:175], a[36:39], v[72:75]
buffer_load_dwordx4 a[8:11], v4, s[8:11], s46 offen offset:3072 sc1
v_mfma_f32_16x16x32_bf16 v[72:75], v[176:179], a[52:55], v[72:75]
ds_read_b128 v[160:163], v5 offset:15360
v_mul_f32 v128, v128, v124
v_mfma_f32_16x16x32_bf16 v[68:71], v[176:179], a[48:51], v[68:71]
v_rcp_f32 v127, v127
v_mfma_f32_16x16x32_bf16 v[68:71], v[172:175], a[32:35], v[68:71]
s_waitcnt lgkmcnt(4)
v_mul_f32 v129, v129, v125
v_mul_f32 v130, v130, v126
v_mfma_f32_16x16x32_bf16 v[60:63], v[180:183], a[64:67], v[60:63]
v_mul_f32 v131, v131, v127
v_cvt_pk_bf16_f32 v140, v128, v129
v_mfma_f32_16x16x32_bf16 v[60:63], v[184:187], a[80:83], v[60:63]
ds_read_b128 v[164:167], v5 offset:16384
v_cvt_pk_bf16_f32 v141, v130, v131
v_mfma_f32_16x16x32_bf16 v[64:67], v[184:187], a[84:87], v[64:67]
buffer_load_dwordx4 a[12:15], v4, s[8:11], s47 offen offset:3072 sc1
v_mfma_f32_16x16x32_bf16 v[64:67], v[180:183], a[68:71], v[64:67]
s_add_u32 s46, s46, 4096
v_mul_f32 v132, v96, v96
v_mul_f32 v133, v97, v97
v_mfma_f32_16x16x32_bf16 v[76:79], v[180:183], a[72:75], v[76:79]
s_add_u32 s47, s47, 4096
v_mul_f32 v134, v98, v98
v_mul_f32 v135, v99, v99
v_mfma_f32_16x16x32_bf16 v[76:79], v[184:187], a[88:91], v[76:79]
ds_read_b128 v[168:171], v5 offset:17408
v_fma_f32 v132, v132, v21, v17
v_mfma_f32_16x16x32_bf16 v[80:83], v[184:187], a[92:95], v[80:83]
v_fma_f32 v133, v133, v21, v17
v_fma_f32 v134, v134, v21, v17
v_mfma_f32_16x16x32_bf16 v[80:83], v[180:183], a[76:79], v[80:83]
buffer_load_dwordx4 v4, s[8:11], s44 offen offset:3072 sc1 lds
v_mfma_f32_16x16x32_bf16 v[88:91], v[188:191], a[76:79], v[88:91]
s_add_u32 s44, s44, 4096
v_fma_f32 v135, v135, v21, v17
v_mul_f32 v132, v132, v96
v_mfma_f32_16x16x32_bf16 v[88:91], v[192:195], a[92:95], v[88:91]
s_add_u32 s83, s82, Lcw4-Lcp
ds_read_b128 v[172:175], v5 offset:18432
v_mul_f32 v133, v133, v97
v_mfma_f32_16x16x32_bf16 v[84:87], v[192:195], a[88:91], v[84:87]
s_min_u32 s83, s83, Lcode_end-Lcp-4
v_exp_f32 v132, v132
v_mfma_f32_16x16x32_bf16 v[84:87], v[188:191], a[72:75], v[84:87]
s_add_u32 m0, s25, 114688
v_mov_b32 v222, s83
v_mul_f32 v134, v134, v98
v_mfma_f32_16x16x32_bf16 v[72:75], v[188:191], a[68:71], v[72:75]
buffer_load_dwordx4 v4, s[8:11], s44 offen offset:0 sc1 lds
v_mfma_f32_16x16x32_bf16 v[72:75], v[192:195], a[84:87], v[72:75]
ds_read_b128 v[176:179], v5 offset:19456
v_mul_f32 v135, v135, v99
v_mfma_f32_16x16x32_bf16 v[68:71], v[192:195], a[80:83], v[68:71]
global_load_dword v223, v222, s[80:81]
v_mfma_f32_16x16x32_bf16 v[68:71], v[188:191], a[64:67], v[68:71]
s_waitcnt lgkmcnt(4)
v_exp_f32 v133, v133
v_mfma_f32_16x16x32_bf16 v[60:63], v[148:151], a[96:99], v[60:63]
buffer_load_dwordx4 v4, s[8:11], s44 offen offset:1024 sc1 lds
v_mfma_f32_16x16x32_bf16 v[60:63], v[152:155], a[112:115], v[60:63]
ds_read_b128 v[180:183], v5 offset:20480
v_mul_f32 v136, v96, v104
v_mfma_f32_16x16x32_bf16 v[64:67], v[152:155], a[116:119], v[64:67]
v_exp_f32 v134, v134
v_mfma_f32_16x16x32_bf16 v[64:67], v[148:151], a[100:103], v[64:67]
v_exp_f32 v135, v135
v_mfma_f32_16x16x32_bf16 v[76:79], v[148:151], a[104:107], v[76:79]
buffer_load_dwordx4 v4, s[8:11], s44 offen offset:2048 sc1 lds
v_mfma_f32_16x16x32_bf16 v[76:79], v[152:155], a[120:123], v[76:79]
ds_read_b128 v[184:187], v5 offset:21504
v_mul_f32 v137, v97, v105
v_mfma_f32_16x16x32_bf16 v[80:83], v[152:155], a[124:127], v[80:83]
v_mul_f32 v138, v98, v106
v_mul_f32 v139, v99, v107
v_mfma_f32_16x16x32_bf16 v[80:83], v[148:151], a[108:111], v[80:83]
v_fma_f32 v132, v132, v25, v25
v_fma_f32 v133, v133, v25, v25
v_mfma_f32_16x16x32_bf16 v[88:91], v[156:159], a[108:111], v[88:91]
v_rcp_f32 v132, v132
v_mfma_f32_16x16x32_bf16 v[88:91], v[160:163], a[124:127], v[88:91]
ds_read_b128 v[188:191], v5 offset:22528
v_fma_f32 v134, v134, v25, v25
v_mfma_f32_16x16x32_bf16 v[84:87], v[160:163], a[120:123], v[84:87]
buffer_load_dwordx4 v4, s[8:11], s44 offen offset:3072 sc1 lds
v_mfma_f32_16x16x32_bf16 v[84:87], v[156:159], a[104:107], v[84:87]
s_add_u32 s44, s44, 4096
v_rcp_f32 v133, v133
v_mfma_f32_16x16x32_bf16 v[72:75], v[156:159], a[100:103], v[72:75]
v_rcp_f32 v134, v134
v_mfma_f32_16x16x32_bf16 v[72:75], v[160:163], a[116:119], v[72:75]
ds_read_b128 v[192:195], v5 offset:23552
v_fma_f32 v135, v135, v25, v25
v_mfma_f32_16x16x32_bf16 v[68:71], v[160:163], a[112:115], v[68:71]
s_add_u32 m0, s25, 118784
v_rcp_f32 v135, v135
v_mfma_f32_16x16x32_bf16 v[68:71], v[156:159], a[96:99], v[68:71]
s_waitcnt lgkmcnt(4)
buffer_load_dwordx4 v4, s[8:11], s44 offen offset:0 sc1 lds
v_mfma_f32_16x16x32_bf16 v[60:63], v[164:167], a[128:131], v[60:63]
s_waitcnt vmcnt(14)
buffer_store_dword v12, v13, s[8:11], s40 offen sc1
s_add_u32 s40, s40, 131072
v_mfma_f32_16x16x32_bf16 v[60:63], v[168:171], a[144:147], v[60:63]
s_add_u32 s44, s44, 28672
ds_read_b128 v[148:151], v5 offset:24576
v_mul_f32 v136, v136, v132
v_mfma_f32_16x16x32_bf16 v[64:67], v[168:171], a[148:151], v[64:67]
v_mul_f32 v137, v137, v133
v_mul_f32 v138, v138, v134
v_mfma_f32_16x16x32_bf16 v[64:67], v[164:167], a[132:135], v[64:67]
v_mul_f32 v139, v139, v135
v_cvt_pk_bf16_f32 v142, v136, v137
v_mfma_f32_16x16x32_bf16 v[76:79], v[164:167], a[136:139], v[76:79]
buffer_load_dwordx4 a[16:19], v4, s[8:11], s46 offen offset:0 sc1
v_mfma_f32_16x16x32_bf16 v[76:79], v[168:171], a[152:155], v[76:79]
ds_read_b128 v[152:155], v5 offset:25600
v_cvt_pk_bf16_f32 v143, v138, v139
v_mfma_f32_16x16x32_bf16 v[80:83], v[168:171], a[156:159], v[80:83]
v_permlane16_swap_b32 v140, v142
v_mfma_f32_16x16x32_bf16 v[80:83], v[164:167], a[140:143], v[80:83]
v_permlane16_swap_b32 v141, v143
v_mfma_f32_16x16x32_bf16 v[88:91], v[172:175], a[140:143], v[88:91]
buffer_load_dwordx4 a[20:23], v4, s[8:11], s47 offen offset:0 sc1
v_mfma_f32_16x16x32_bf16 v[88:91], v[176:179], a[156:159], v[88:91]
ds_read_b128 v[156:159], v5 offset:26624
v_mul_f32 v124, v108, v108
v_mfma_f32_16x16x32_bf16 v[84:87], v[176:179], a[152:155], v[84:87]
buffer_store_dwordx4 v[140:143], v9, s[8:11], s26 offen sc1
v_mfma_f32_16x16x32_bf16 v[84:87], v[172:175], a[136:139], v[84:87]
s_add_u32 s26, s26, 4096
v_mul_f32 v125, v109, v109
v_mul_f32 v126, v110, v110
v_mfma_f32_16x16x32_bf16 v[72:75], v[172:175], a[132:135], v[72:75]
buffer_load_dwordx4 a[24:27], v4, s[8:11], s46 offen offset:1024 sc1
v_mfma_f32_16x16x32_bf16 v[72:75], v[176:179], a[148:151], v[72:75]
ds_read_b128 v[160:163], v5 offset:27648
v_mul_f32 v127, v111, v111
v_mfma_f32_16x16x32_bf16 v[68:71], v[176:179], a[144:147], v[68:71]
v_fma_f32 v124, v124, v22, v18
v_fma_f32 v125, v125, v22, v18
v_mfma_f32_16x16x32_bf16 v[68:71], v[172:175], a[128:131], v[68:71]
s_waitcnt lgkmcnt(4)
v_fma_f32 v126, v126, v22, v18
v_fma_f32 v127, v127, v22, v18
v_mfma_f32_16x16x32_bf16 v[60:63], v[180:183], a[160:163], v[60:63]
v_mul_f32 v124, v124, v108
v_mul_f32 v125, v125, v109
v_mfma_f32_16x16x32_bf16 v[60:63], v[184:187], a[176:179], v[60:63]
ds_read_b128 v[164:167], v5 offset:28672
v_mul_f32 v126, v126, v110
v_mfma_f32_16x16x32_bf16 v[64:67], v[184:187], a[180:183], v[64:67]
buffer_load_dwordx4 a[28:31], v4, s[8:11], s47 offen offset:1024 sc1
v_mfma_f32_16x16x32_bf16 v[64:67], v[180:183], a[164:167], v[64:67]
v_exp_f32 v124, v124
v_mfma_f32_16x16x32_bf16 v[76:79], v[180:183], a[168:171], v[76:79]
v_exp_f32 v125, v125
v_mfma_f32_16x16x32_bf16 v[76:79], v[184:187], a[184:187], v[76:79]
ds_read_b128 v[168:171], v5 offset:29696
v_mul_f32 v127, v127, v111
v_mfma_f32_16x16x32_bf16 v[80:83], v[184:187], a[188:191], v[80:83]
v_exp_f32 v126, v126
v_mfma_f32_16x16x32_bf16 v[80:83], v[180:183], a[172:175], v[80:83]
buffer_load_dwordx4 a[32:35], v4, s[8:11], s46 offen offset:2048 sc1
v_mfma_f32_16x16x32_bf16 v[88:91], v[188:191], a[172:175], v[88:91]
v_exp_f32 v127, v127
v_mfma_f32_16x16x32_bf16 v[88:91], v[192:195], a[188:191], v[88:91]
ds_read_b128 v[172:175], v5 offset:30720
v_mul_f32 v128, v108, v116
v_mfma_f32_16x16x32_bf16 v[84:87], v[192:195], a[184:187], v[84:87]
v_mul_f32 v129, v109, v117
v_mul_f32 v130, v110, v118
v_mfma_f32_16x16x32_bf16 v[84:87], v[188:191], a[168:171], v[84:87]
v_mul_f32 v131, v111, v119
v_fma_f32 v124, v124, v26, v26
v_mfma_f32_16x16x32_bf16 v[72:75], v[188:191], a[164:167], v[72:75]
buffer_load_dwordx4 a[36:39], v4, s[8:11], s47 offen offset:2048 sc1
v_mfma_f32_16x16x32_bf16 v[72:75], v[192:195], a[180:183], v[72:75]
ds_read_b128 v[176:179], v5 offset:31744
v_fma_f32 v125, v125, v26, v26
v_mfma_f32_16x16x32_bf16 v[68:71], v[192:195], a[176:179], v[68:71]
v_rcp_f32 v124, v124
v_mfma_f32_16x16x32_bf16 v[68:71], v[188:191], a[160:163], v[68:71]
s_waitcnt lgkmcnt(4)
v_rcp_f32 v125, v125
v_mfma_f32_16x16x32_bf16 v[60:63], v[148:151], a[192:195], v[60:63]
buffer_load_dwordx4 a[40:43], v4, s[8:11], s46 offen offset:3072 sc1
v_mfma_f32_16x16x32_bf16 v[60:63], v[152:155], a[208:211], v[60:63]
ds_read_b128 v[180:183], v5 offset:32768
v_fma_f32 v126, v126, v26, v26
v_mfma_f32_16x16x32_bf16 v[64:67], v[152:155], a[212:215], v[64:67]
v_rcp_f32 v126, v126
v_mfma_f32_16x16x32_bf16 v[64:67], v[148:151], a[196:199], v[64:67]
v_fma_f32 v127, v127, v26, v26
v_mul_f32 v128, v128, v124
v_mfma_f32_16x16x32_bf16 v[76:79], v[148:151], a[200:203], v[76:79]
buffer_load_dwordx4 a[44:47], v4, s[8:11], s47 offen offset:3072 sc1
v_mfma_f32_16x16x32_bf16 v[76:79], v[152:155], a[216:219], v[76:79]
s_add_u32 s46, s46, 4096
ds_read_b128 v[184:187], v5 offset:33792
v_mul_f32 v129, v129, v125
v_mfma_f32_16x16x32_bf16 v[80:83], v[152:155], a[220:223], v[80:83]
s_add_u32 s47, s47, 4096
v_rcp_f32 v127, v127
v_mfma_f32_16x16x32_bf16 v[80:83], v[148:151], a[204:207], v[80:83]
v_mul_f32 v130, v130, v126
v_mul_f32 v131, v131, v127
v_mfma_f32_16x16x32_bf16 v[88:91], v[156:159], a[204:207], v[88:91]
v_cvt_pk_bf16_f32 v144, v128, v129
v_cvt_pk_bf16_f32 v145, v130, v131
v_mfma_f32_16x16x32_bf16 v[88:91], v[160:163], a[220:223], v[88:91]
ds_read_b128 v[188:191], v5 offset:34816
v_mul_f32 v132, v112, v112
v_mfma_f32_16x16x32_bf16 v[84:87], v[160:163], a[216:219], v[84:87]
buffer_load_dwordx4 a[48:51], v4, s[8:11], s46 offen offset:0 sc1
v_mfma_f32_16x16x32_bf16 v[84:87], v[156:159], a[200:203], v[84:87]
v_mul_f32 v133, v113, v113
v_mul_f32 v134, v114, v114
v_mfma_f32_16x16x32_bf16 v[72:75], v[156:159], a[196:199], v[72:75]
v_mul_f32 v135, v115, v115
v_fma_f32 v132, v132, v23, v19
v_mfma_f32_16x16x32_bf16 v[72:75], v[160:163], a[212:215], v[72:75]
ds_read_b128 v[192:195], v5 offset:35840
v_fma_f32 v133, v133, v23, v19
v_mfma_f32_16x16x32_bf16 v[68:71], v[160:163], a[208:211], v[68:71]
v_fma_f32 v134, v134, v23, v19
v_fma_f32 v135, v135, v23, v19
v_mfma_f32_16x16x32_bf16 v[68:71], v[156:159], a[192:195], v[68:71]
s_waitcnt lgkmcnt(4)
buffer_load_dwordx4 a[52:55], v4, s[8:11], s47 offen offset:0 sc1
v_mfma_f32_16x16x32_bf16 v[60:63], v[164:167], a[224:227], v[60:63]
v_mul_f32 v132, v132, v112
v_mul_f32 v133, v133, v113
v_mfma_f32_16x16x32_bf16 v[60:63], v[168:171], a[240:243], v[60:63]
s_barrier
ds_read_b128 v[148:151], v10 offset:0
v_mfma_f32_16x16x32_bf16 v[64:67], v[168:171], a[244:247], v[64:67]
v_exp_f32 v132, v132
v_mfma_f32_16x16x32_bf16 v[64:67], v[164:167], a[228:231], v[64:67]
v_exp_f32 v133, v133
v_mfma_f32_16x16x32_bf16 v[76:79], v[164:167], a[232:235], v[76:79]
buffer_load_dwordx4 a[56:59], v4, s[8:11], s46 offen offset:1024 sc1
v_mfma_f32_16x16x32_bf16 v[76:79], v[168:171], a[248:251], v[76:79]
ds_read_b128 v[152:155], v10 offset:1024
v_mul_f32 v134, v134, v114
v_mfma_f32_16x16x32_bf16 v[80:83], v[168:171], a[252:255], v[80:83]
v_exp_f32 v134, v134
v_mfma_f32_16x16x32_bf16 v[80:83], v[164:167], a[236:239], v[80:83]
v_mul_f32 v135, v135, v115
v_mul_f32 v136, v112, v120
v_mfma_f32_16x16x32_bf16 v[88:91], v[172:175], a[236:239], v[88:91]
buffer_load_dwordx4 a[60:63], v4, s[8:11], s47 offen offset:1024 sc1
v_mfma_f32_16x16x32_bf16 v[88:91], v[176:179], a[252:255], v[88:91]
ds_read_b128 v[156:159], v10 offset:2048
v_mul_f32 v137, v113, v121
v_mfma_f32_16x16x32_bf16 v[84:87], v[176:179], a[248:251], v[84:87]
v_exp_f32 v135, v135
v_mfma_f32_16x16x32_bf16 v[84:87], v[172:175], a[232:235], v[84:87]
v_mul_f32 v138, v114, v122
v_mul_f32 v139, v115, v123
v_mfma_f32_16x16x32_bf16 v[72:75], v[172:175], a[228:231], v[72:75]
buffer_load_dwordx4 a[64:67], v4, s[8:11], s46 offen offset:2048 sc1
v_mfma_f32_16x16x32_bf16 v[72:75], v[176:179], a[244:247], v[72:75]
ds_read_b128 v[160:163], v10 offset:3072
v_fma_f32 v132, v132, v27, v27
v_mfma_f32_16x16x32_bf16 v[68:71], v[176:179], a[240:243], v[68:71]
v_rcp_f32 v132, v132
v_mfma_f32_16x16x32_bf16 v[68:71], v[172:175], a[224:227], v[68:71]
s_waitcnt lgkmcnt(4)
v_fma_f32 v133, v133, v27, v27
v_fma_f32 v134, v134, v27, v27
v_mfma_f32_16x16x32_bf16 v[60:63], v[180:183], v[224:227], v[60:63]
v_rcp_f32 v133, v133
v_mfma_f32_16x16x32_bf16 v[60:63], v[184:187], v[240:243], v[60:63]
ds_read_b128 v[164:167], v10 offset:4096
v_fma_f32 v135, v135, v27, v27
v_mfma_f32_16x16x32_bf16 v[64:67], v[184:187], v[244:247], v[64:67]
buffer_load_dwordx4 a[68:71], v4, s[8:11], s47 offen offset:2048 sc1
v_mfma_f32_16x16x32_bf16 v[64:67], v[180:183], v[228:231], v[64:67]
v_rcp_f32 v134, v134
v_mfma_f32_16x16x32_bf16 v[76:79], v[180:183], v[232:235], v[76:79]
v_rcp_f32 v135, v135
v_mfma_f32_16x16x32_bf16 v[76:79], v[184:187], v[248:251], v[76:79]
ds_read_b128 v[168:171], v10 offset:5120
v_mul_f32 v136, v136, v132
v_mfma_f32_16x16x32_bf16 v[80:83], v[184:187], v[252:255], v[80:83]
v_mul_f32 v137, v137, v133
v_mul_f32 v138, v138, v134
v_mfma_f32_16x16x32_bf16 v[80:83], v[180:183], v[236:239], v[80:83]
buffer_load_dwordx4 a[72:75], v4, s[8:11], s46 offen offset:3072 sc1
v_mfma_f32_16x16x32_bf16 v[88:91], v[188:191], v[236:239], v[88:91]
v_mul_f32 v139, v139, v135
v_cvt_pk_bf16_f32 v146, v136, v137
v_mfma_f32_16x16x32_bf16 v[88:91], v[192:195], v[252:255], v[88:91]
ds_read_b128 v[172:175], v10 offset:6144
v_cvt_pk_bf16_f32 v147, v138, v139
v_mfma_f32_16x16x32_bf16 v[84:87], v[192:195], v[248:251], v[84:87]
v_permlane16_swap_b32 v144, v146
v_mfma_f32_16x16x32_bf16 v[84:87], v[188:191], v[232:235], v[84:87]
v_permlane16_swap_b32 v145, v147
v_mfma_f32_16x16x32_bf16 v[72:75], v[188:191], v[228:231], v[72:75]
buffer_load_dwordx4 a[76:79], v4, s[8:11], s47 offen offset:3072 sc1
v_mfma_f32_16x16x32_bf16 v[72:75], v[192:195], v[244:247], v[72:75]
s_add_u32 s46, s46, 4096
ds_read_b128 v[176:179], v10 offset:7168
v_mfma_f32_16x16x32_bf16 v[68:71], v[192:195], v[240:243], v[68:71]
s_add_u32 s47, s47, 4096
v_mfma_f32_16x16x32_bf16 v[68:71], v[188:191], v[224:227], v[68:71]
s_waitcnt lgkmcnt(4)
buffer_store_dwordx4 v[144:147], v9, s[8:11], s27 offen sc1
s_add_u32 s27, s27, 4096
v_mfma_f32_16x16x32_bf16 v[92:95], v[148:151], v[28:31], 0
ds_read_b128 v[180:183], v10 offset:8192
v_mfma_f32_16x16x32_bf16 v[92:95], v[152:155], v[36:39], v[92:95]
buffer_load_dwordx4 a[80:83], v4, s[8:11], s46 offen offset:0 sc1
v_mfma_f32_16x16x32_bf16 v[96:99], v[152:155], v[40:43], 0
ds_read_b128 v[184:187], v10 offset:9216
s_barrier
v_mfma_f32_16x16x32_bf16 v[96:99], v[148:151], v[32:35], v[96:99]
v_mfma_f32_16x16x32_bf16 v[104:107], v[156:159], v[32:35], 0
s_add_u32 m0, s25, 0
ds_read_b128 v[188:191], v10 offset:10240
v_mul_f32 v124, v60, v60
v_mul_f32 v125, v61, v61
v_mfma_f32_16x16x32_bf16 v[104:107], v[160:163], v[40:43], v[104:107]
buffer_load_dwordx4 v4, s[8:11], s44 offen offset:0 sc1 lds
v_mfma_f32_16x16x32_bf16 v[100:103], v[160:163], v[36:39], 0
ds_read_b128 v[192:195], v10 offset:11264
v_mul_f32 v126, v62, v62
v_mfma_f32_16x16x32_bf16 v[100:103], v[156:159], v[28:31], v[100:103]
s_waitcnt lgkmcnt(4)
v_mul_f32 v127, v63, v63
v_fma_f32 v124, v124, v20, v16
v_mfma_f32_16x16x32_bf16 v[108:111], v[164:167], v[28:31], 0
ds_read_b128 v[148:151], v10 offset:12288
v_fma_f32 v125, v125, v20, v16
v_mfma_f32_16x16x32_bf16 v[108:111], v[168:171], v[36:39], v[108:111]
buffer_load_dwordx4 v4, s[8:11], s44 offen offset:1024 sc1 lds
v_mfma_f32_16x16x32_bf16 v[112:115], v[168:171], v[40:43], 0
ds_read_b128 v[152:155], v10 offset:13312
v_fma_f32 v126, v126, v20, v16
v_fma_f32 v127, v127, v20, v16
v_mfma_f32_16x16x32_bf16 v[112:115], v[164:167], v[32:35], v[112:115]
v_mul_f32 v124, v124, v60
v_mul_f32 v125, v125, v61
v_mfma_f32_16x16x32_bf16 v[120:123], v[172:175], v[32:35], 0
ds_read_b128 v[156:159], v10 offset:14336
buffer_load_dword v220, v221, s[8:11], s41 offen sc1
v_mfma_f32_16x16x32_bf16 v[120:123], v[176:179], v[40:43], v[120:123]
v_exp_f32 v124, v124
v_mfma_f32_16x16x32_bf16 v[116:119], v[176:179], v[36:39], 0
ds_read_b128 v[160:163], v10 offset:15360
v_mul_f32 v126, v126, v62
v_mfma_f32_16x16x32_bf16 v[116:119], v[172:175], v[28:31], v[116:119]
s_waitcnt lgkmcnt(4)
buffer_load_dwordx4 v4, s[8:11], s44 offen offset:2048 sc1 lds
v_mfma_f32_16x16x32_bf16 v[196:199], v[180:183], v[28:31], 0
ds_read_b128 v[164:167], v11 offset:16384
v_mul_f32 v127, v127, v63
v_mfma_f32_16x16x32_bf16 v[196:199], v[184:187], v[36:39], v[196:199]
v_exp_f32 v125, v125
v_mul_f32 v128, v60, v68
v_mfma_f32_16x16x32_bf16 v[200:203], v[184:187], v[40:43], 0
ds_read_b128 v[168:171], v11 offset:17408
v_mul_f32 v129, v61, v69
v_mfma_f32_16x16x32_bf16 v[200:203], v[180:183], v[32:35], v[200:203]
buffer_load_dwordx4 v4, s[8:11], s44 offen offset:3072 sc1 lds
v_mfma_f32_16x16x32_bf16 v[228:231], v[188:191], v[32:35], 0
s_add_u32 s44, s44, 4096
ds_read_b128 v[172:175], v10 offset:18432
v_mul_f32 v130, v62, v70
v_mfma_f32_16x16x32_bf16 v[228:231], v[192:195], v[40:43], v[228:231]
v_exp_f32 v126, v126
v_mfma_f32_16x16x32_bf16 v[224:227], v[192:195], v[36:39], 0
ds_read_b128 v[176:179], v10 offset:19456
v_mul_f32 v131, v63, v71
v_mfma_f32_16x16x32_bf16 v[224:227], v[188:191], v[28:31], v[224:227]
s_waitcnt lgkmcnt(4)
v_exp_f32 v127, v127
v_fma_f32 v124, v124, v24, v24
v_mfma_f32_16x16x32_bf16 v[232:235], v[148:151], v[28:31], 0
s_add_u32 m0, s25, 4096
ds_read_b128 v[180:183], v10 offset:20480
v_fma_f32 v125, v125, v24, v24
v_mfma_f32_16x16x32_bf16 v[232:235], v[152:155], v[36:39], v[232:235]
buffer_load_dwordx4 v4, s[8:11], s44 offen offset:0 sc1 lds
v_mfma_f32_16x16x32_bf16 v[236:239], v[152:155], v[40:43], 0
ds_read_b128 v[184:187], v10 offset:21504
v_fma_f32 v126, v126, v24, v24
v_mfma_f32_16x16x32_bf16 v[236:239], v[148:151], v[32:35], v[236:239]
v_rcp_f32 v124, v124
v_mfma_f32_16x16x32_bf16 v[244:247], v[156:159], v[32:35], 0
ds_read_b128 v[188:191], v10 offset:22528
v_fma_f32 v127, v127, v24, v24
v_mfma_f32_16x16x32_bf16 v[244:247], v[160:163], v[40:43], v[244:247]
buffer_load_dwordx4 v4, s[8:11], s44 offen offset:1024 sc1 lds
v_mfma_f32_16x16x32_bf16 v[240:243], v[160:163], v[36:39], 0
ds_read_b128 v[192:195], v10 offset:23552
v_rcp_f32 v125, v125
v_mfma_f32_16x16x32_bf16 v[240:243], v[156:159], v[28:31], v[240:243]
s_waitcnt lgkmcnt(4)
v_rcp_f32 v126, v126
v_mfma_f32_16x16x32_bf16 v[248:251], v[164:167], v[28:31], 0
ds_read_b128 v[148:151], v10 offset:24576
v_mul_f32 v128, v128, v124
v_mfma_f32_16x16x32_bf16 v[248:251], v[168:171], v[36:39], v[248:251]
buffer_load_dwordx4 v4, s[8:11], s44 offen offset:2048 sc1 lds
v_mfma_f32_16x16x32_bf16 v[252:255], v[168:171], v[40:43], 0
ds_read_b128 v[152:155], v10 offset:25600
v_mul_f32 v129, v129, v125
v_mfma_f32_16x16x32_bf16 v[252:255], v[164:167], v[32:35], v[252:255]
v_rcp_f32 v127, v127
v_mfma_f32_16x16x32_bf16 v[96:99], v[172:175], v[48:51], v[96:99]
ds_read_b128 v[156:159], v10 offset:26624
v_mul_f32 v130, v130, v126
v_mfma_f32_16x16x32_bf16 v[96:99], v[176:179], v[56:59], v[96:99]
v_mul_f32 v131, v131, v127
v_cvt_pk_bf16_f32 v140, v128, v129
v_cvt_pk_bf16_f32 v141, v130, v131
v_mfma_f32_16x16x32_bf16 v[92:95], v[176:179], v[52:55], v[92:95]
ds_read_b128 v[160:163], v10 offset:27648
v_mul_f32 v132, v64, v64
v_mfma_f32_16x16x32_bf16 v[92:95], v[172:175], v[44:47], v[92:95]
s_waitcnt lgkmcnt(4)
buffer_load_dwordx4 v4, s[8:11], s44 offen offset:3072 sc1 lds
v_mfma_f32_16x16x32_bf16 v[100:103], v[180:183], v[44:47], v[100:103]
s_add_u32 s44, s44, 4096
ds_read_b128 v[164:167], v10 offset:28672
v_mul_f32 v133, v65, v65
v_mfma_f32_16x16x32_bf16 v[100:103], v[184:187], v[52:55], v[100:103]
v_mul_f32 v134, v66, v66
v_mul_f32 v135, v67, v67
v_mfma_f32_16x16x32_bf16 v[104:107], v[184:187], v[56:59], v[104:107]
ds_read_b128 v[168:171], v10 offset:29696
v_fma_f32 v132, v132, v21, v17
v_mfma_f32_16x16x32_bf16 v[104:107], v[180:183], v[48:51], v[104:107]
s_add_u32 m0, s25, 8192
v_fma_f32 v133, v133, v21, v17
v_fma_f32 v134, v134, v21, v17
v_fma_f32 v135, v135, v21, v17
v_mfma_f32_16x16x32_bf16 v[112:115], v[188:191], v[48:51], v[112:115]
ds_read_b128 v[172:175], v10 offset:30720
v_mul_f32 v132, v132, v64
v_mfma_f32_16x16x32_bf16 v[112:115], v[192:195], v[56:59], v[112:115]
buffer_load_dwordx4 v4, s[8:11], s44 offen offset:0 sc1 lds
v_mfma_f32_16x16x32_bf16 v[108:111], v[192:195], v[52:55], v[108:111]
s_add_u32 s44, s44, 28672
ds_read_b128 v[176:179], v10 offset:31744
v_mul_f32 v133, v133, v65
v_mfma_f32_16x16x32_bf16 v[108:111], v[188:191], v[44:47], v[108:111]
s_waitcnt lgkmcnt(4)
v_exp_f32 v132, v132
v_mfma_f32_16x16x32_bf16 v[116:119], v[148:151], v[44:47], v[116:119]
ds_read_b128 v[180:183], v10 offset:32768
v_mul_f32 v134, v134, v66
v_mfma_f32_16x16x32_bf16 v[116:119], v[152:155], v[52:55], v[116:119]
buffer_load_dwordx4 a[84:87], v4, s[8:11], s47 offen offset:0 sc1
v_mfma_f32_16x16x32_bf16 v[120:123], v[152:155], v[56:59], v[120:123]
ds_read_b128 v[184:187], v10 offset:33792
v_exp_f32 v133, v133
v_mfma_f32_16x16x32_bf16 v[120:123], v[148:151], v[48:51], v[120:123]
v_exp_f32 v134, v134
v_mfma_f32_16x16x32_bf16 v[200:203], v[156:159], v[48:51], v[200:203]
ds_read_b128 v[188:191], v11 offset:34816
s_waitcnt vmcnt(8)
v_cmp_ne_u32 vcc, v12, v220
s_nop 1
s_cbranch_vccnz Lsp7
Lok7:
s_add_u32 s41, s41, 131072
v_mfma_f32_16x16x32_bf16 v[200:203], v[160:163], v[56:59], v[200:203]
buffer_load_dwordx4 a[88:91], v4, s[8:11], s46 offen offset:1024 sc1
v_mfma_f32_16x16x32_bf16 v[196:199], v[160:163], v[52:55], v[196:199]
ds_read_b128 v[192:195], v11 offset:35840
v_mul_f32 v135, v135, v67
v_mfma_f32_16x16x32_bf16 v[196:199], v[156:159], v[44:47], v[196:199]
s_waitcnt lgkmcnt(4)
v_exp_f32 v135, v135
v_mfma_f32_16x16x32_bf16 v[224:227], v[164:167], v[44:47], v[224:227]
s_barrier
v_add_u32 v10, 0x9000, v10
ds_read_b128 v[148:151], v10 offset:0
v_add_u32 v11, 0x9000, v11
v_mul_f32 v136, v64, v72
v_mfma_f32_16x16x32_bf16 v[224:227], v[168:171], v[52:55], v[224:227]
buffer_load_dwordx4 a[92:95], v4, s[8:11], s47 offen offset:1024 sc1
v_mfma_f32_16x16x32_bf16 v[228:231], v[168:171], v[56:59], v[228:231]
ds_read_b128 v[152:155], v10 offset:1024
v_mul_f32 v137, v65, v73
v_mfma_f32_16x16x32_bf16 v[228:231], v[164:167], v[48:51], v[228:231]
v_mul_f32 v138, v66, v74
v_mul_f32 v139, v67, v75
v_mfma_f32_16x16x32_bf16 v[236:239], v[172:175], v[48:51], v[236:239]
ds_read_b128 v[156:159], v10 offset:2048
v_fma_f32 v132, v132, v25, v25
v_mfma_f32_16x16x32_bf16 v[236:239], v[176:179], v[56:59], v[236:239]
v_rcp_f32 v132, v132
v_mfma_f32_16x16x32_bf16 v[232:235], v[176:179], v[52:55], v[232:235]
ds_read_b128 v[160:163], v10 offset:3072
v_fma_f32 v133, v133, v25, v25
v_mfma_f32_16x16x32_bf16 v[232:235], v[172:175], v[44:47], v[232:235]
s_waitcnt lgkmcnt(4)
buffer_load_dwordx4 a[96:99], v4, s[8:11], s46 offen offset:2048 sc1
v_fma_f32 v134, v134, v25, v25
v_mfma_f32_16x16x32_bf16 v[240:243], v[180:183], v[44:47], v[240:243]
ds_read_b128 v[164:167], v10 offset:4096
v_fma_f32 v135, v135, v25, v25
v_mfma_f32_16x16x32_bf16 v[240:243], v[184:187], v[52:55], v[240:243]
v_rcp_f32 v133, v133
v_mfma_f32_16x16x32_bf16 v[244:247], v[184:187], v[56:59], v[244:247]
ds_read_b128 v[168:171], v10 offset:5120
v_mul_f32 v136, v136, v132
v_mfma_f32_16x16x32_bf16 v[244:247], v[180:183], v[48:51], v[244:247]
buffer_load_dwordx4 a[100:103], v4, s[8:11], s47 offen offset:2048 sc1
v_mfma_f32_16x16x32_bf16 v[252:255], v[188:191], v[48:51], v[252:255]
ds_read_b128 v[172:175], v10 offset:6144
v_mul_f32 v137, v137, v133
v_mfma_f32_16x16x32_bf16 v[252:255], v[192:195], v[56:59], v[252:255]
v_rcp_f32 v134, v134
v_mfma_f32_16x16x32_bf16 v[248:251], v[192:195], v[52:55], v[248:251]
ds_read_b128 v[176:179], v10 offset:7168
v_rcp_f32 v135, v135
v_mfma_f32_16x16x32_bf16 v[248:251], v[188:191], v[44:47], v[248:251]
s_waitcnt lgkmcnt(4)
v_mul_f32 v138, v138, v134
v_mul_f32 v139, v139, v135
v_mfma_f32_16x16x32_bf16 v[92:95], v[148:151], v[204:207], v[92:95]
Lcw4:
ds_read_b128 v[180:183], v10 offset:8192
v_cvt_pk_bf16_f32 v142, v136, v137
v_mfma_f32_16x16x32_bf16 v[92:95], v[152:155], v[212:215], v[92:95]
buffer_load_dwordx4 a[104:107], v4, s[8:11], s46 offen offset:3072 sc1
v_mfma_f32_16x16x32_bf16 v[96:99], v[152:155], v[216:219], v[96:99]
ds_read_b128 v[184:187], v10 offset:9216
v_cvt_pk_bf16_f32 v143, v138, v139
v_mfma_f32_16x16x32_bf16 v[96:99], v[148:151], v[208:211], v[96:99]
v_permlane16_swap_b32 v140, v142
v_mfma_f32_16x16x32_bf16 v[104:107], v[156:159], v[208:211], v[104:107]
ds_read_b128 v[188:191], v10 offset:10240
v_permlane16_swap_b32 v141, v143
v_mfma_f32_16x16x32_bf16 v[104:107], v[160:163], v[216:219], v[104:107]
buffer_load_dwordx4 a[108:111], v4, s[8:11], s47 offen offset:3072 sc1
v_mfma_f32_16x16x32_bf16 v[100:103], v[160:163], v[212:215], v[100:103]
s_add_u32 s46, s46, 4096
ds_read_b128 v[192:195], v10 offset:11264
v_mul_f32 v124, v76, v76
v_mfma_f32_16x16x32_bf16 v[100:103], v[156:159], v[204:207], v[100:103]
s_waitcnt lgkmcnt(4)
buffer_store_dwordx4 v[140:143], v9, s[8:11], s26 offen sc1
v_mfma_f32_16x16x32_bf16 v[108:111], v[164:167], v[204:207], v[108:111]
s_add_u32 s47, s47, 4096
ds_read_b128 v[148:151], v10 offset:12288
v_mul_f32 v125, v77, v77
v_mfma_f32_16x16x32_bf16 v[108:111], v[168:171], v[212:215], v[108:111]
buffer_load_dwordx4 a[112:115], v4, s[8:11], s46 offen offset:0 sc1
v_mfma_f32_16x16x32_bf16 v[112:115], v[168:171], v[216:219], v[112:115]
s_add_u32 s26, s26, 4096
ds_read_b128 v[152:155], v10 offset:13312
v_mul_f32 v126, v78, v78
v_mfma_f32_16x16x32_bf16 v[112:115], v[164:167], v[208:211], v[112:115]
v_mul_f32 v127, v79, v79
v_fma_f32 v124, v124, v22, v18
v_fma_f32 v125, v125, v22, v18
v_mfma_f32_16x16x32_bf16 v[120:123], v[172:175], v[208:211], v[120:123]
ds_read_b128 v[156:159], v10 offset:14336
v_fma_f32 v126, v126, v22, v18
v_mfma_f32_16x16x32_bf16 v[120:123], v[176:179], v[216:219], v[120:123]
v_fma_f32 v127, v127, v22, v18
v_mul_f32 v124, v124, v76
v_mfma_f32_16x16x32_bf16 v[116:119], v[176:179], v[212:215], v[116:119]
ds_read_b128 v[160:163], v10 offset:15360
v_mul_f32 v125, v125, v77
v_mfma_f32_16x16x32_bf16 v[116:119], v[172:175], v[204:207], v[116:119]
s_waitcnt lgkmcnt(4)
buffer_load_dwordx4 a[116:119], v4, s[8:11], s47 offen offset:0 sc1
v_mfma_f32_16x16x32_bf16 v[196:199], v[180:183], v[204:207], v[196:199]
ds_read_b128 v[164:167], v11 offset:16384
v_mul_f32 v126, v126, v78
v_mfma_f32_16x16x32_bf16 v[196:199], v[184:187], v[212:215], v[196:199]
v_exp_f32 v124, v124
v_mul_f32 v127, v127, v79
v_mfma_f32_16x16x32_bf16 v[200:203], v[184:187], v[216:219], v[200:203]
ds_read_b128 v[168:171], v11 offset:17408
v_mul_f32 v128, v76, v84
v_mfma_f32_16x16x32_bf16 v[200:203], v[180:183], v[208:211], v[200:203]
buffer_load_dwordx4 a[120:123], v4, s[8:11], s46 offen offset:1024 sc1
v_mfma_f32_16x16x32_bf16 v[228:231], v[188:191], v[208:211], v[228:231]
ds_read_b128 v[172:175], v10 offset:18432
v_mul_f32 v129, v77, v85
v_mfma_f32_16x16x32_bf16 v[228:231], v[192:195], v[216:219], v[228:231]
v_exp_f32 v125, v125
v_mfma_f32_16x16x32_bf16 v[224:227], v[192:195], v[212:215], v[224:227]
ds_read_b128 v[176:179], v10 offset:19456
v_mul_f32 v130, v78, v86
v_mfma_f32_16x16x32_bf16 v[224:227], v[188:191], v[204:207], v[224:227]
s_waitcnt lgkmcnt(4)
v_exp_f32 v126, v126
v_mfma_f32_16x16x32_bf16 v[232:235], v[148:151], v[204:207], v[232:235]
ds_read_b128 v[180:183], v10 offset:20480
v_exp_f32 v127, v127
v_mfma_f32_16x16x32_bf16 v[232:235], v[152:155], v[212:215], v[232:235]
buffer_load_dwordx4 a[124:127], v4, s[8:11], s47 offen offset:1024 sc1
v_mfma_f32_16x16x32_bf16 v[236:239], v[152:155], v[216:219], v[236:239]
ds_read_b128 v[184:187], v10 offset:21504
v_mul_f32 v131, v79, v87
v_mfma_f32_16x16x32_bf16 v[236:239], v[148:151], v[208:211], v[236:239]
v_fma_f32 v124, v124, v26, v26
v_fma_f32 v125, v125, v26, v26
v_mfma_f32_16x16x32_bf16 v[244:247], v[156:159], v[208:211], v[244:247]
ds_read_b128 v[188:191], v10 offset:22528
v_fma_f32 v126, v126, v26, v26
v_mfma_f32_16x16x32_bf16 v[244:247], v[160:163], v[216:219], v[244:247]
buffer_load_dwordx4 a[128:131], v4, s[8:11], s46 offen offset:2048 sc1
v_mfma_f32_16x16x32_bf16 v[240:243], v[160:163], v[212:215], v[240:243]
ds_read_b128 v[192:195], v10 offset:23552
v_fma_f32 v127, v127, v26, v26
v_mfma_f32_16x16x32_bf16 v[240:243], v[156:159], v[204:207], v[240:243]
s_waitcnt lgkmcnt(4)
v_rcp_f32 v124, v124
v_mul_f32 v132, v80, v80
v_mfma_f32_16x16x32_bf16 v[248:251], v[164:167], v[204:207], v[248:251]
ds_read_b128 v[148:151], v10 offset:24576
v_mul_f32 v128, v128, v124
v_mfma_f32_16x16x32_bf16 v[248:251], v[168:171], v[212:215], v[248:251]
buffer_load_dwordx4 a[132:135], v4, s[8:11], s47 offen offset:2048 sc1
v_mfma_f32_16x16x32_bf16 v[252:255], v[168:171], v[216:219], v[252:255]
ds_read_b128 v[152:155], v10 offset:25600
v_mul_f32 v133, v81, v81
v_mfma_f32_16x16x32_bf16 v[252:255], v[164:167], v[208:211], v[252:255]
v_rcp_f32 v125, v125
v_mfma_f32_16x16x32_bf16 v[96:99], v[172:175], a[4:7], v[96:99]
ds_read_b128 v[156:159], v10 offset:26624
v_mul_f32 v129, v129, v125
v_mfma_f32_16x16x32_bf16 v[96:99], v[176:179], a[12:15], v[96:99]
v_rcp_f32 v126, v126
v_cvt_pk_bf16_f32 v144, v128, v129
v_mfma_f32_16x16x32_bf16 v[92:95], v[176:179], a[8:11], v[92:95]
ds_read_b128 v[160:163], v10 offset:27648
v_mul_f32 v130, v130, v126
v_mfma_f32_16x16x32_bf16 v[92:95], v[172:175], a[0:3], v[92:95]
s_waitcnt lgkmcnt(4)
buffer_load_dwordx4 a[136:139], v4, s[8:11], s46 offen offset:3072 sc1
v_mfma_f32_16x16x32_bf16 v[100:103], v[180:183], a[0:3], v[100:103]
ds_read_b128 v[164:167], v10 offset:28672
v_mul_f32 v134, v82, v82
v_mfma_f32_16x16x32_bf16 v[100:103], v[184:187], a[8:11], v[100:103]
v_rcp_f32 v127, v127
v_mfma_f32_16x16x32_bf16 v[104:107], v[184:187], a[12:15], v[104:107]
ds_read_b128 v[168:171], v10 offset:29696
v_mul_f32 v131, v131, v127
v_mfma_f32_16x16x32_bf16 v[104:107], v[180:183], a[4:7], v[104:107]
buffer_load_dwordx4 a[140:143], v4, s[8:11], s47 offen offset:3072 sc1
v_mfma_f32_16x16x32_bf16 v[112:115], v[188:191], a[4:7], v[112:115]
s_add_u32 s46, s46, 4096
ds_read_b128 v[172:175], v10 offset:30720
v_cvt_pk_bf16_f32 v145, v130, v131
v_mul_f32 v135, v83, v83
v_mfma_f32_16x16x32_bf16 v[112:115], v[192:195], a[12:15], v[112:115]
s_add_u32 s47, s47, 4096
v_fma_f32 v132, v132, v23, v19
v_fma_f32 v133, v133, v23, v19
v_mfma_f32_16x16x32_bf16 v[108:111], v[192:195], a[8:11], v[108:111]
ds_read_b128 v[176:179], v10 offset:31744
v_fma_f32 v134, v134, v23, v19
v_mfma_f32_16x16x32_bf16 v[108:111], v[188:191], a[0:3], v[108:111]
s_waitcnt lgkmcnt(4)
v_fma_f32 v135, v135, v23, v19
v_mul_f32 v132, v132, v80
v_mfma_f32_16x16x32_bf16 v[116:119], v[148:151], a[0:3], v[116:119]
ds_read_b128 v[180:183], v10 offset:32768
v_mul_f32 v133, v133, v81
v_mfma_f32_16x16x32_bf16 v[116:119], v[152:155], a[8:11], v[116:119]
buffer_load_dwordx4 a[144:147], v4, s[8:11], s46 offen offset:0 sc1
v_mfma_f32_16x16x32_bf16 v[120:123], v[152:155], a[12:15], v[120:123]
ds_read_b128 v[184:187], v10 offset:33792
v_exp_f32 v132, v132
v_mfma_f32_16x16x32_bf16 v[120:123], v[148:151], a[4:7], v[120:123]
v_exp_f32 v133, v133
v_mfma_f32_16x16x32_bf16 v[200:203], v[156:159], a[4:7], v[200:203]
ds_read_b128 v[188:191], v11 offset:34816
v_mul_f32 v134, v134, v82
v_mfma_f32_16x16x32_bf16 v[200:203], v[160:163], a[12:15], v[200:203]
buffer_load_dwordx4 a[148:151], v4, s[8:11], s47 offen offset:0 sc1
v_mfma_f32_16x16x32_bf16 v[196:199], v[160:163], a[8:11], v[196:199]
ds_read_b128 v[192:195], v11 offset:35840
v_mul_f32 v135, v135, v83
v_mfma_f32_16x16x32_bf16 v[196:199], v[156:159], a[0:3], v[196:199]
s_waitcnt lgkmcnt(4)
v_exp_f32 v134, v134
v_mfma_f32_16x16x32_bf16 v[224:227], v[164:167], a[0:3], v[224:227]
s_barrier
v_add_u32 v10, 0x9000, v10
ds_read_b128 v[148:151], v10 offset:0
v_add_u32 v11, 0x9000, v11
v_mfma_f32_16x16x32_bf16 v[224:227], v[168:171], a[8:11], v[224:227]
buffer_load_dwordx4 a[152:155], v4, s[8:11], s46 offen offset:1024 sc1
v_mul_f32 v136, v80, v88
v_mfma_f32_16x16x32_bf16 v[228:231], v[168:171], a[12:15], v[228:231]
ds_read_b128 v[152:155], v10 offset:1024
v_mul_f32 v137, v81, v89
v_mfma_f32_16x16x32_bf16 v[228:231], v[164:167], a[4:7], v[228:231]
v_exp_f32 v135, v135
v_mfma_f32_16x16x32_bf16 v[236:239], v[172:175], a[4:7], v[236:239]
ds_read_b128 v[156:159], v10 offset:2048
v_mul_f32 v138, v82, v90
v_mfma_f32_16x16x32_bf16 v[236:239], v[176:179], a[12:15], v[236:239]
v_mul_f32 v139, v83, v91
v_fma_f32 v132, v132, v27, v27
v_mfma_f32_16x16x32_bf16 v[232:235], v[176:179], a[8:11], v[232:235]
s_add_u32 m0, s25, 36864
ds_read_b128 v[160:163], v10 offset:3072
v_fma_f32 v133, v133, v27, v27
v_mfma_f32_16x16x32_bf16 v[232:235], v[172:175], a[0:3], v[232:235]
s_waitcnt lgkmcnt(4)
buffer_load_dwordx4 v4, s[8:11], s44 offen offset:0 sc1 lds
v_mfma_f32_16x16x32_bf16 v[240:243], v[180:183], a[0:3], v[240:243]
ds_read_b128 v[164:167], v10 offset:4096
v_rcp_f32 v132, v132
v_mfma_f32_16x16x32_bf16 v[240:243], v[184:187], a[8:11], v[240:243]
v_rcp_f32 v133, v133
v_mfma_f32_16x16x32_bf16 v[244:247], v[184:187], a[12:15], v[244:247]
ds_read_b128 v[168:171], v10 offset:5120
v_fma_f32 v134, v134, v27, v27
v_mfma_f32_16x16x32_bf16 v[244:247], v[180:183], a[4:7], v[244:247]
buffer_load_dwordx4 v4, s[8:11], s44 offen offset:1024 sc1 lds
v_mfma_f32_16x16x32_bf16 v[252:255], v[188:191], a[4:7], v[252:255]
ds_read_b128 v[172:175], v10 offset:6144
v_fma_f32 v135, v135, v27, v27
v_mfma_f32_16x16x32_bf16 v[252:255], v[192:195], a[12:15], v[252:255]
v_rcp_f32 v134, v134
v_mfma_f32_16x16x32_bf16 v[248:251], v[192:195], a[8:11], v[248:251]
ds_read_b128 v[176:179], v10 offset:7168
v_rcp_f32 v135, v135
v_mfma_f32_16x16x32_bf16 v[248:251], v[188:191], a[0:3], v[248:251]
s_waitcnt lgkmcnt(4)
v_mul_f32 v136, v136, v132
v_mul_f32 v137, v137, v133
v_mfma_f32_16x16x32_bf16 v[92:95], v[148:151], a[16:19], v[92:95]
ds_read_b128 v[180:183], v10 offset:8192
v_mul_f32 v138, v138, v134
v_mfma_f32_16x16x32_bf16 v[92:95], v[152:155], a[24:27], v[92:95]
buffer_load_dwordx4 v4, s[8:11], s44 offen offset:2048 sc1 lds
v_mfma_f32_16x16x32_bf16 v[96:99], v[152:155], a[28:31], v[96:99]
ds_read_b128 v[184:187], v10 offset:9216
v_mul_f32 v139, v139, v135
v_mfma_f32_16x16x32_bf16 v[96:99], v[148:151], a[20:23], v[96:99]
v_cvt_pk_bf16_f32 v146, v136, v137
v_cvt_pk_bf16_f32 v147, v138, v139
v_mfma_f32_16x16x32_bf16 v[104:107], v[156:159], a[20:23], v[104:107]
s_add_u32 s83, s82, Lcw5-Lcp
ds_read_b128 v[188:191], v10 offset:10240
v_mfma_f32_16x16x32_bf16 v[104:107], v[160:163], a[28:31], v[104:107]
buffer_load_dwordx4 v4, s[8:11], s44 offen offset:3072 sc1 lds
v_mfma_f32_16x16x32_bf16 v[100:103], v[160:163], a[24:27], v[100:103]
s_add_u32 s44, s44, 4096
s_min_u32 s83, s83, Lcode_end-Lcp-4
ds_read_b128 v[192:195], v10 offset:11264
v_mfma_f32_16x16x32_bf16 v[100:103], v[156:159], a[16:19], v[100:103]
s_waitcnt lgkmcnt(4)
v_mov_b32 v222, s83
v_permlane16_swap_b32 v144, v146
v_mfma_f32_16x16x32_bf16 v[108:111], v[164:167], a[16:19], v[108:111]
ds_read_b128 v[148:151], v10 offset:12288
global_load_dword v223, v222, s[80:81]
v_mfma_f32_16x16x32_bf16 v[108:111], v[168:171], a[24:27], v[108:111]
s_add_u32 m0, s25, 40960
v_permlane16_swap_b32 v145, v147
v_mfma_f32_16x16x32_bf16 v[112:115], v[168:171], a[28:31], v[112:115]
ds_read_b128 v[152:155], v10 offset:13312
v_mfma_f32_16x16x32_bf16 v[112:115], v[164:167], a[20:23], v[112:115]
buffer_load_dwordx4 v4, s[8:11], s44 offen offset:0 sc1 lds
buffer_store_dwordx4 v[144:147], v9, s[8:11], s27 offen sc1
s_add_u32 s27, s27, 4096
v_mfma_f32_16x16x32_bf16 v[120:123], v[172:175], a[20:23], v[120:123]
ds_read_b128 v[156:159], v10 offset:14336
v_mfma_f32_16x16x32_bf16 v[120:123], v[176:179], a[28:31], v[120:123]
v_mfma_f32_16x16x32_bf16 v[116:119], v[176:179], a[24:27], v[116:119]
ds_read_b128 v[160:163], v10 offset:15360
v_mfma_f32_16x16x32_bf16 v[116:119], v[172:175], a[16:19], v[116:119]
s_waitcnt lgkmcnt(4)
buffer_load_dwordx4 v4, s[8:11], s44 offen offset:1024 sc1 lds
v_mfma_f32_16x16x32_bf16 v[196:199], v[180:183], a[16:19], v[196:199]
ds_read_b128 v[164:167], v11 offset:16384
v_mfma_f32_16x16x32_bf16 v[196:199], v[184:187], a[24:27], v[196:199]
v_mfma_f32_16x16x32_bf16 v[200:203], v[184:187], a[28:31], v[200:203]
ds_read_b128 v[168:171], v11 offset:17408
v_mfma_f32_16x16x32_bf16 v[200:203], v[180:183], a[20:23], v[200:203]
buffer_load_dwordx4 v4, s[8:11], s44 offen offset:2048 sc1 lds
v_mfma_f32_16x16x32_bf16 v[228:231], v[188:191], a[20:23], v[228:231]
ds_read_b128 v[172:175], v10 offset:18432
v_mfma_f32_16x16x32_bf16 v[228:231], v[192:195], a[28:31], v[228:231]
v_mfma_f32_16x16x32_bf16 v[224:227], v[192:195], a[24:27], v[224:227]
ds_read_b128 v[176:179], v10 offset:19456
v_mfma_f32_16x16x32_bf16 v[224:227], v[188:191], a[16:19], v[224:227]
s_waitcnt lgkmcnt(4)
v_mfma_f32_16x16x32_bf16 v[232:235], v[148:151], a[16:19], v[232:235]
ds_read_b128 v[180:183], v10 offset:20480
v_mfma_f32_16x16x32_bf16 v[232:235], v[152:155], a[24:27], v[232:235]
buffer_load_dwordx4 v4, s[8:11], s44 offen offset:3072 sc1 lds
v_mfma_f32_16x16x32_bf16 v[236:239], v[152:155], a[28:31], v[236:239]
s_add_u32 s44, s44, 4096
ds_read_b128 v[184:187], v10 offset:21504
v_mfma_f32_16x16x32_bf16 v[236:239], v[148:151], a[20:23], v[236:239]
v_mfma_f32_16x16x32_bf16 v[244:247], v[156:159], a[20:23], v[244:247]
s_add_u32 m0, s25, 45056
ds_read_b128 v[188:191], v10 offset:22528
v_mfma_f32_16x16x32_bf16 v[244:247], v[160:163], a[28:31], v[244:247]
buffer_load_dwordx4 v4, s[8:11], s44 offen offset:0 sc1 lds
v_mfma_f32_16x16x32_bf16 v[240:243], v[160:163], a[24:27], v[240:243]
s_add_u32 s44, s44, 28672
ds_read_b128 v[192:195], v10 offset:23552
v_mfma_f32_16x16x32_bf16 v[240:243], v[156:159], a[16:19], v[240:243]
s_waitcnt lgkmcnt(4)
v_mfma_f32_16x16x32_bf16 v[248:251], v[164:167], a[16:19], v[248:251]
ds_read_b128 v[148:151], v10 offset:24576
v_mfma_f32_16x16x32_bf16 v[248:251], v[168:171], a[24:27], v[248:251]
buffer_load_dwordx4 a[156:159], v4, s[8:11], s47 offen offset:1024 sc1
v_mfma_f32_16x16x32_bf16 v[252:255], v[168:171], a[28:31], v[252:255]
ds_read_b128 v[152:155], v10 offset:25600
v_mfma_f32_16x16x32_bf16 v[252:255], v[164:167], a[20:23], v[252:255]
v_mfma_f32_16x16x32_bf16 v[96:99], v[172:175], a[36:39], v[96:99]
ds_read_b128 v[156:159], v10 offset:26624
v_mfma_f32_16x16x32_bf16 v[96:99], v[176:179], a[44:47], v[96:99]
v_mfma_f32_16x16x32_bf16 v[92:95], v[176:179], a[40:43], v[92:95]
ds_read_b128 v[160:163], v10 offset:27648
v_mfma_f32_16x16x32_bf16 v[92:95], v[172:175], a[32:35], v[92:95]
s_waitcnt lgkmcnt(4)
buffer_load_dwordx4 a[160:163], v4, s[8:11], s46 offen offset:2048 sc1
v_mfma_f32_16x16x32_bf16 v[100:103], v[180:183], a[32:35], v[100:103]
ds_read_b128 v[164:167], v10 offset:28672
v_mfma_f32_16x16x32_bf16 v[100:103], v[184:187], a[40:43], v[100:103]
v_mfma_f32_16x16x32_bf16 v[104:107], v[184:187], a[44:47], v[104:107]
ds_read_b128 v[168:171], v10 offset:29696
v_mfma_f32_16x16x32_bf16 v[104:107], v[180:183], a[36:39], v[104:107]
buffer_load_dwordx4 a[164:167], v4, s[8:11], s47 offen offset:2048 sc1
v_mfma_f32_16x16x32_bf16 v[112:115], v[188:191], a[36:39], v[112:115]
ds_read_b128 v[172:175], v10 offset:30720
v_mfma_f32_16x16x32_bf16 v[112:115], v[192:195], a[44:47], v[112:115]
v_mfma_f32_16x16x32_bf16 v[108:111], v[192:195], a[40:43], v[108:111]
ds_read_b128 v[176:179], v10 offset:31744
v_mfma_f32_16x16x32_bf16 v[108:111], v[188:191], a[32:35], v[108:111]
s_waitcnt lgkmcnt(4)
v_mfma_f32_16x16x32_bf16 v[116:119], v[148:151], a[32:35], v[116:119]
ds_read_b128 v[180:183], v10 offset:32768
v_mfma_f32_16x16x32_bf16 v[116:119], v[152:155], a[40:43], v[116:119]
buffer_load_dwordx4 a[168:171], v4, s[8:11], s46 offen offset:3072 sc1
v_mfma_f32_16x16x32_bf16 v[120:123], v[152:155], a[44:47], v[120:123]
ds_read_b128 v[184:187], v10 offset:33792
v_mfma_f32_16x16x32_bf16 v[120:123], v[148:151], a[36:39], v[120:123]
v_mfma_f32_16x16x32_bf16 v[200:203], v[156:159], a[36:39], v[200:203]
ds_read_b128 v[188:191], v11 offset:34816
v_mfma_f32_16x16x32_bf16 v[200:203], v[160:163], a[44:47], v[200:203]
buffer_load_dwordx4 a[172:175], v4, s[8:11], s47 offen offset:3072 sc1
v_mfma_f32_16x16x32_bf16 v[196:199], v[160:163], a[40:43], v[196:199]
s_add_u32 s46, s46, 4096
ds_read_b128 v[192:195], v11 offset:35840
v_mfma_f32_16x16x32_bf16 v[196:199], v[156:159], a[32:35], v[196:199]
s_waitcnt lgkmcnt(4)
s_add_u32 s47, s47, 4096
v_mfma_f32_16x16x32_bf16 v[224:227], v[164:167], a[32:35], v[224:227]
s_waitcnt vmcnt(35)
s_barrier
v_add_u32 v10, 0xfffe5000, v10
ds_read_b128 v[148:151], v10 offset:0
v_add_u32 v11, 0xfffe5000, v11
v_mfma_f32_16x16x32_bf16 v[224:227], v[168:171], a[40:43], v[224:227]
v_mfma_f32_16x16x32_bf16 v[228:231], v[168:171], a[44:47], v[228:231]
s_add_u32 m0, s25, 73728
ds_read_b128 v[152:155], v10 offset:1024
v_mfma_f32_16x16x32_bf16 v[228:231], v[164:167], a[36:39], v[228:231]
buffer_load_dwordx4 v4, s[8:11], s44 offen offset:0 sc1 lds
v_mfma_f32_16x16x32_bf16 v[236:239], v[172:175], a[36:39], v[236:239]
ds_read_b128 v[156:159], v10 offset:2048
v_mfma_f32_16x16x32_bf16 v[236:239], v[176:179], a[44:47], v[236:239]
v_mfma_f32_16x16x32_bf16 v[232:235], v[176:179], a[40:43], v[232:235]
ds_read_b128 v[160:163], v10 offset:3072
s_waitcnt vmcnt(10)
buffer_store_dword v12, v13, s[8:11], s40 offen sc1
v_mfma_f32_16x16x32_bf16 v[232:235], v[172:175], a[32:35], v[232:235]
s_waitcnt lgkmcnt(4)
buffer_load_dwordx4 v4, s[8:11], s44 offen offset:1024 sc1 lds
v_mfma_f32_16x16x32_bf16 v[240:243], v[180:183], a[32:35], v[240:243]
ds_read_b128 v[164:167], v10 offset:4096
v_mfma_f32_16x16x32_bf16 v[240:243], v[184:187], a[40:43], v[240:243]
v_mfma_f32_16x16x32_bf16 v[244:247], v[184:187], a[44:47], v[244:247]
ds_read_b128 v[168:171], v10 offset:5120
v_mfma_f32_16x16x32_bf16 v[244:247], v[180:183], a[36:39], v[244:247]
v_mfma_f32_16x16x32_bf16 v[252:255], v[188:191], a[36:39], v[252:255]
ds_read_b128 v[172:175], v10 offset:6144
v_mfma_f32_16x16x32_bf16 v[252:255], v[192:195], a[44:47], v[252:255]
buffer_load_dwordx4 v4, s[8:11], s44 offen offset:2048 sc1 lds
v_mfma_f32_16x16x32_bf16 v[248:251], v[192:195], a[40:43], v[248:251]
ds_read_b128 v[176:179], v10 offset:7168
v_mfma_f32_16x16x32_bf16 v[248:251], v[188:191], a[32:35], v[248:251]
s_waitcnt lgkmcnt(4)
v_mfma_f32_16x16x32_bf16 v[92:95], v[148:151], a[48:51], v[92:95]
ds_read_b128 v[180:183], v10 offset:8192
v_mfma_f32_16x16x32_bf16 v[92:95], v[152:155], a[56:59], v[92:95]
buffer_load_dwordx4 v4, s[8:11], s44 offen offset:3072 sc1 lds
v_mfma_f32_16x16x32_bf16 v[96:99], v[152:155], a[60:63], v[96:99]
s_add_u32 s44, s44, 4096
ds_read_b128 v[184:187], v10 offset:9216
v_mfma_f32_16x16x32_bf16 v[96:99], v[148:151], a[52:55], v[96:99]
v_mfma_f32_16x16x32_bf16 v[104:107], v[156:159], a[52:55], v[104:107]
ds_read_b128 v[188:191], v10 offset:10240
v_mfma_f32_16x16x32_bf16 v[104:107], v[160:163], a[60:63], v[104:107]
s_add_u32 m0, s25, 77824
v_mfma_f32_16x16x32_bf16 v[100:103], v[160:163], a[56:59], v[100:103]
ds_read_b128 v[192:195], v10 offset:11264
v_mfma_f32_16x16x32_bf16 v[100:103], v[156:159], a[48:51], v[100:103]
s_waitcnt lgkmcnt(4)
buffer_load_dwordx4 v4, s[8:11], s44 offen offset:0 sc1 lds
v_mfma_f32_16x16x32_bf16 v[108:111], v[164:167], a[48:51], v[108:111]
ds_read_b128 v[148:151], v10 offset:12288
v_mfma_f32_16x16x32_bf16 v[108:111], v[168:171], a[56:59], v[108:111]
v_mfma_f32_16x16x32_bf16 v[112:115], v[168:171], a[60:63], v[112:115]
ds_read_b128 v[152:155], v10 offset:13312
v_mfma_f32_16x16x32_bf16 v[112:115], v[164:167], a[52:55], v[112:115]
buffer_load_dwordx4 v4, s[8:11], s44 offen offset:1024 sc1 lds
v_mfma_f32_16x16x32_bf16 v[120:123], v[172:175], a[52:55], v[120:123]
ds_read_b128 v[156:159], v10 offset:14336
v_mfma_f32_16x16x32_bf16 v[120:123], v[176:179], a[60:63], v[120:123]
v_mfma_f32_16x16x32_bf16 v[116:119], v[176:179], a[56:59], v[116:119]
ds_read_b128 v[160:163], v10 offset:15360
v_mfma_f32_16x16x32_bf16 v[116:119], v[172:175], a[48:51], v[116:119]
s_waitcnt lgkmcnt(4)
buffer_load_dwordx4 v4, s[8:11], s44 offen offset:2048 sc1 lds
v_mfma_f32_16x16x32_bf16 v[196:199], v[180:183], a[48:51], v[196:199]
ds_read_b128 v[164:167], v11 offset:16384
v_mfma_f32_16x16x32_bf16 v[196:199], v[184:187], a[56:59], v[196:199]
v_mfma_f32_16x16x32_bf16 v[200:203], v[184:187], a[60:63], v[200:203]
ds_read_b128 v[168:171], v11 offset:17408
v_mfma_f32_16x16x32_bf16 v[200:203], v[180:183], a[52:55], v[200:203]
v_mfma_f32_16x16x32_bf16 v[228:231], v[188:191], a[52:55], v[228:231]
ds_read_b128 v[172:175], v10 offset:18432
v_mfma_f32_16x16x32_bf16 v[228:231], v[192:195], a[60:63], v[228:231]
buffer_load_dwordx4 v4, s[8:11], s44 offen offset:3072 sc1 lds
v_mfma_f32_16x16x32_bf16 v[224:227], v[192:195], a[56:59], v[224:227]
s_add_u32 s44, s44, 4096
ds_read_b128 v[176:179], v10 offset:19456
v_mfma_f32_16x16x32_bf16 v[224:227], v[188:191], a[48:51], v[224:227]
s_waitcnt lgkmcnt(4)
v_mfma_f32_16x16x32_bf16 v[232:235], v[148:151], a[48:51], v[232:235]
ds_read_b128 v[180:183], v10 offset:20480
v_mfma_f32_16x16x32_bf16 v[232:235], v[152:155], a[56:59], v[232:235]
s_add_u32 m0, s25, 81920
v_mfma_f32_16x16x32_bf16 v[236:239], v[152:155], a[60:63], v[236:239]
ds_read_b128 v[184:187], v10 offset:21504
v_mfma_f32_16x16x32_bf16 v[236:239], v[148:151], a[52:55], v[236:239]
buffer_load_dwordx4 v4, s[8:11], s44 offen offset:0 sc1 lds
v_mfma_f32_16x16x32_bf16 v[244:247], v[156:159], a[52:55], v[244:247]
s_add_u32 s44, s44, 28672
ds_read_b128 v[188:191], v10 offset:22528
v_mfma_f32_16x16x32_bf16 v[244:247], v[160:163], a[60:63], v[244:247]
v_mfma_f32_16x16x32_bf16 v[240:243], v[160:163], a[56:59], v[240:243]
ds_read_b128 v[192:195], v10 offset:23552
v_mfma_f32_16x16x32_bf16 v[240:243], v[156:159], a[48:51], v[240:243]
s_waitcnt lgkmcnt(4)
v_mfma_f32_16x16x32_bf16 v[248:251], v[164:167], a[48:51], v[248:251]
ds_read_b128 v[148:151], v10 offset:24576
v_mfma_f32_16x16x32_bf16 v[248:251], v[168:171], a[56:59], v[248:251]
v_mfma_f32_16x16x32_bf16 v[252:255], v[168:171], a[60:63], v[252:255]
ds_read_b128 v[152:155], v10 offset:25600
v_mfma_f32_16x16x32_bf16 v[252:255], v[164:167], a[52:55], v[252:255]
v_mfma_f32_16x16x32_bf16 v[96:99], v[172:175], a[68:71], v[96:99]
ds_read_b128 v[156:159], v10 offset:26624
v_mfma_f32_16x16x32_bf16 v[96:99], v[176:179], a[76:79], v[96:99]
v_mfma_f32_16x16x32_bf16 v[92:95], v[176:179], a[72:75], v[92:95]
ds_read_b128 v[160:163], v10 offset:27648
v_mfma_f32_16x16x32_bf16 v[92:95], v[172:175], a[64:67], v[92:95]
s_waitcnt lgkmcnt(4)
v_mfma_f32_16x16x32_bf16 v[100:103], v[180:183], a[64:67], v[100:103]
ds_read_b128 v[164:167], v10 offset:28672
v_mfma_f32_16x16x32_bf16 v[100:103], v[184:187], a[72:75], v[100:103]
v_mfma_f32_16x16x32_bf16 v[104:107], v[184:187], a[76:79], v[104:107]
ds_read_b128 v[168:171], v10 offset:29696
v_mfma_f32_16x16x32_bf16 v[104:107], v[180:183], a[68:71], v[104:107]
v_mfma_f32_16x16x32_bf16 v[112:115], v[188:191], a[68:71], v[112:115]
ds_read_b128 v[172:175], v10 offset:30720
v_mfma_f32_16x16x32_bf16 v[112:115], v[192:195], a[76:79], v[112:115]
v_mfma_f32_16x16x32_bf16 v[108:111], v[192:195], a[72:75], v[108:111]
ds_read_b128 v[176:179], v10 offset:31744
v_mfma_f32_16x16x32_bf16 v[108:111], v[188:191], a[64:67], v[108:111]
s_waitcnt lgkmcnt(4)
v_mfma_f32_16x16x32_bf16 v[116:119], v[148:151], a[64:67], v[116:119]
ds_read_b128 v[180:183], v10 offset:32768
v_mfma_f32_16x16x32_bf16 v[116:119], v[152:155], a[72:75], v[116:119]
v_mfma_f32_16x16x32_bf16 v[120:123], v[152:155], a[76:79], v[120:123]
ds_read_b128 v[184:187], v10 offset:33792
v_mfma_f32_16x16x32_bf16 v[120:123], v[148:151], a[68:71], v[120:123]
v_mfma_f32_16x16x32_bf16 v[200:203], v[156:159], a[68:71], v[200:203]
ds_read_b128 v[188:191], v11 offset:34816
v_mfma_f32_16x16x32_bf16 v[200:203], v[160:163], a[76:79], v[200:203]
v_mfma_f32_16x16x32_bf16 v[196:199], v[160:163], a[72:75], v[196:199]
ds_read_b128 v[192:195], v11 offset:35840
v_mfma_f32_16x16x32_bf16 v[196:199], v[156:159], a[64:67], v[196:199]
s_waitcnt lgkmcnt(4)
v_mfma_f32_16x16x32_bf16 v[224:227], v[164:167], a[64:67], v[224:227]
s_waitcnt vmcnt(15)
s_barrier
v_add_u32 v10, 0x9000, v10
ds_read_b128 v[148:151], v10 offset:0
buffer_load_dword v220, v221, s[8:11], s41 offen sc1
v_add_u32 v11, 0x9000, v11
v_mfma_f32_16x16x32_bf16 v[224:227], v[168:171], a[72:75], v[224:227]
v_mfma_f32_16x16x32_bf16 v[228:231], v[168:171], a[76:79], v[228:231]
s_add_u32 m0, s25, 110592
ds_read_b128 v[152:155], v10 offset:1024
v_mfma_f32_16x16x32_bf16 v[228:231], v[164:167], a[68:71], v[228:231]
buffer_load_dwordx4 v4, s[8:11], s44 offen offset:0 sc1 lds
v_mfma_f32_16x16x32_bf16 v[236:239], v[172:175], a[68:71], v[236:239]
ds_read_b128 v[156:159], v10 offset:2048
v_mfma_f32_16x16x32_bf16 v[236:239], v[176:179], a[76:79], v[236:239]
v_mfma_f32_16x16x32_bf16 v[232:235], v[176:179], a[72:75], v[232:235]
ds_read_b128 v[160:163], v10 offset:3072
v_mfma_f32_16x16x32_bf16 v[232:235], v[172:175], a[64:67], v[232:235]
s_waitcnt lgkmcnt(4)
buffer_load_dwordx4 v4, s[8:11], s44 offen offset:1024 sc1 lds
v_mfma_f32_16x16x32_bf16 v[240:243], v[180:183], a[64:67], v[240:243]
ds_read_b128 v[164:167], v10 offset:4096
v_mfma_f32_16x16x32_bf16 v[240:243], v[184:187], a[72:75], v[240:243]
v_mfma_f32_16x16x32_bf16 v[244:247], v[184:187], a[76:79], v[244:247]
ds_read_b128 v[168:171], v10 offset:5120
v_mfma_f32_16x16x32_bf16 v[244:247], v[180:183], a[68:71], v[244:247]
v_mfma_f32_16x16x32_bf16 v[252:255], v[188:191], a[68:71], v[252:255]
ds_read_b128 v[172:175], v10 offset:6144
v_mfma_f32_16x16x32_bf16 v[252:255], v[192:195], a[76:79], v[252:255]
buffer_load_dwordx4 v4, s[8:11], s44 offen offset:2048 sc1 lds
v_mfma_f32_16x16x32_bf16 v[248:251], v[192:195], a[72:75], v[248:251]
ds_read_b128 v[176:179], v10 offset:7168
v_mfma_f32_16x16x32_bf16 v[248:251], v[188:191], a[64:67], v[248:251]
s_waitcnt lgkmcnt(4)
v_mfma_f32_16x16x32_bf16 v[92:95], v[148:151], a[80:83], v[92:95]
ds_read_b128 v[180:183], v10 offset:8192
v_mfma_f32_16x16x32_bf16 v[92:95], v[152:155], a[88:91], v[92:95]
buffer_load_dwordx4 v4, s[8:11], s44 offen offset:3072 sc1 lds
v_mfma_f32_16x16x32_bf16 v[96:99], v[152:155], a[92:95], v[96:99]
s_add_u32 s44, s44, 4096
ds_read_b128 v[184:187], v10 offset:9216
v_mfma_f32_16x16x32_bf16 v[96:99], v[148:151], a[84:87], v[96:99]
v_mfma_f32_16x16x32_bf16 v[104:107], v[156:159], a[84:87], v[104:107]
ds_read_b128 v[188:191], v10 offset:10240
v_mfma_f32_16x16x32_bf16 v[104:107], v[160:163], a[92:95], v[104:107]
v_mfma_f32_16x16x32_bf16 v[100:103], v[160:163], a[88:91], v[100:103]
s_add_u32 m0, s25, 114688
ds_read_b128 v[192:195], v10 offset:11264
v_mfma_f32_16x16x32_bf16 v[100:103], v[156:159], a[80:83], v[100:103]
s_waitcnt lgkmcnt(4)
buffer_load_dwordx4 v4, s[8:11], s44 offen offset:0 sc1 lds
v_mfma_f32_16x16x32_bf16 v[108:111], v[164:167], a[80:83], v[108:111]
ds_read_b128 v[148:151], v10 offset:12288
v_mfma_f32_16x16x32_bf16 v[108:111], v[168:171], a[88:91], v[108:111]
v_mfma_f32_16x16x32_bf16 v[112:115], v[168:171], a[92:95], v[112:115]
ds_read_b128 v[152:155], v10 offset:13312
v_mfma_f32_16x16x32_bf16 v[112:115], v[164:167], a[84:87], v[112:115]
buffer_load_dwordx4 v4, s[8:11], s44 offen offset:1024 sc1 lds
v_mfma_f32_16x16x32_bf16 v[120:123], v[172:175], a[84:87], v[120:123]
ds_read_b128 v[156:159], v10 offset:14336
v_mfma_f32_16x16x32_bf16 v[120:123], v[176:179], a[92:95], v[120:123]
v_mfma_f32_16x16x32_bf16 v[116:119], v[176:179], a[88:91], v[116:119]
ds_read_b128 v[160:163], v10 offset:15360
v_mfma_f32_16x16x32_bf16 v[116:119], v[172:175], a[80:83], v[116:119]
s_waitcnt lgkmcnt(4)
buffer_load_dwordx4 v4, s[8:11], s44 offen offset:2048 sc1 lds
v_mfma_f32_16x16x32_bf16 v[196:199], v[180:183], a[80:83], v[196:199]
ds_read_b128 v[164:167], v11 offset:16384
v_mfma_f32_16x16x32_bf16 v[196:199], v[184:187], a[88:91], v[196:199]
v_mfma_f32_16x16x32_bf16 v[200:203], v[184:187], a[92:95], v[200:203]
ds_read_b128 v[168:171], v11 offset:17408
s_waitcnt vmcnt(7)
v_cmp_ne_u32 vcc, v12, v220
s_nop 1
s_cbranch_vccnz Lsp8
Lok8:
v_mfma_f32_16x16x32_bf16 v[200:203], v[180:183], a[84:87], v[200:203]
v_mfma_f32_16x16x32_bf16 v[228:231], v[188:191], a[84:87], v[228:231]
ds_read_b128 v[172:175], v10 offset:18432
v_mfma_f32_16x16x32_bf16 v[228:231], v[192:195], a[92:95], v[228:231]
buffer_load_dwordx4 v4, s[8:11], s44 offen offset:3072 sc1 lds
v_mfma_f32_16x16x32_bf16 v[224:227], v[192:195], a[88:91], v[224:227]
s_add_u32 s44, s44, 4096
ds_read_b128 v[176:179], v10 offset:19456
v_mfma_f32_16x16x32_bf16 v[224:227], v[188:191], a[80:83], v[224:227]
s_waitcnt lgkmcnt(4)
v_mfma_f32_16x16x32_bf16 v[232:235], v[148:151], a[80:83], v[232:235]
ds_read_b128 v[180:183], v10 offset:20480
v_mfma_f32_16x16x32_bf16 v[232:235], v[152:155], a[88:91], v[232:235]
s_add_u32 m0, s25, 118784
v_mfma_f32_16x16x32_bf16 v[236:239], v[152:155], a[92:95], v[236:239]
ds_read_b128 v[184:187], v10 offset:21504
v_mfma_f32_16x16x32_bf16 v[236:239], v[148:151], a[84:87], v[236:239]
buffer_load_dwordx4 v4, s[8:11], s44 offen offset:0 sc1 lds
v_mfma_f32_16x16x32_bf16 v[244:247], v[156:159], a[84:87], v[244:247]
s_add_u32 s44, s44, 28672
ds_read_b128 v[188:191], v10 offset:22528
v_mfma_f32_16x16x32_bf16 v[244:247], v[160:163], a[92:95], v[244:247]
v_mfma_f32_16x16x32_bf16 v[240:243], v[160:163], a[88:91], v[240:243]
ds_read_b128 v[192:195], v10 offset:23552
v_mfma_f32_16x16x32_bf16 v[240:243], v[156:159], a[80:83], v[240:243]
s_waitcnt lgkmcnt(4)
buffer_load_dwordx4 a[176:179], v4, s[8:11], s46 offen offset:0 sc1
v_mfma_f32_16x16x32_bf16 v[248:251], v[164:167], a[80:83], v[248:251]
ds_read_b128 v[148:151], v10 offset:24576
v_mfma_f32_16x16x32_bf16 v[248:251], v[168:171], a[88:91], v[248:251]
v_mfma_f32_16x16x32_bf16 v[252:255], v[168:171], a[92:95], v[252:255]
ds_read_b128 v[152:155], v10 offset:25600
v_mfma_f32_16x16x32_bf16 v[252:255], v[164:167], a[84:87], v[252:255]
buffer_load_dwordx4 a[180:183], v4, s[8:11], s47 offen offset:0 sc1
v_mfma_f32_16x16x32_bf16 v[96:99], v[172:175], a[100:103], v[96:99]
ds_read_b128 v[156:159], v10 offset:26624
v_mfma_f32_16x16x32_bf16 v[96:99], v[176:179], a[108:111], v[96:99]
v_mfma_f32_16x16x32_bf16 v[92:95], v[176:179], a[104:107], v[92:95]
ds_read_b128 v[160:163], v10 offset:27648
v_mfma_f32_16x16x32_bf16 v[92:95], v[172:175], a[96:99], v[92:95]
s_waitcnt lgkmcnt(4)
buffer_load_dwordx4 a[184:187], v4, s[8:11], s46 offen offset:1024 sc1
v_mfma_f32_16x16x32_bf16 v[100:103], v[180:183], a[96:99], v[100:103]
ds_read_b128 v[164:167], v10 offset:28672
v_mfma_f32_16x16x32_bf16 v[100:103], v[184:187], a[104:107], v[100:103]
v_mfma_f32_16x16x32_bf16 v[104:107], v[184:187], a[108:111], v[104:107]
ds_read_b128 v[168:171], v10 offset:29696
v_mfma_f32_16x16x32_bf16 v[104:107], v[180:183], a[100:103], v[104:107]
v_mfma_f32_16x16x32_bf16 v[112:115], v[188:191], a[100:103], v[112:115]
ds_read_b128 v[172:175], v10 offset:30720
v_mfma_f32_16x16x32_bf16 v[112:115], v[192:195], a[108:111], v[112:115]
buffer_load_dwordx4 a[188:191], v4, s[8:11], s47 offen offset:1024 sc1
v_mfma_f32_16x16x32_bf16 v[108:111], v[192:195], a[104:107], v[108:111]
ds_read_b128 v[176:179], v10 offset:31744
v_mfma_f32_16x16x32_bf16 v[108:111], v[188:191], a[96:99], v[108:111]
s_waitcnt lgkmcnt(4)
v_mfma_f32_16x16x32_bf16 v[116:119], v[148:151], a[96:99], v[116:119]
ds_read_b128 v[180:183], v10 offset:32768
v_mfma_f32_16x16x32_bf16 v[116:119], v[152:155], a[104:107], v[116:119]
buffer_load_dwordx4 a[192:195], v4, s[8:11], s46 offen offset:2048 sc1
v_mfma_f32_16x16x32_bf16 v[120:123], v[152:155], a[108:111], v[120:123]
ds_read_b128 v[184:187], v10 offset:33792
v_mfma_f32_16x16x32_bf16 v[120:123], v[148:151], a[100:103], v[120:123]
v_mfma_f32_16x16x32_bf16 v[200:203], v[156:159], a[100:103], v[200:203]
ds_read_b128 v[188:191], v11 offset:34816
v_mfma_f32_16x16x32_bf16 v[200:203], v[160:163], a[108:111], v[200:203]
v_mfma_f32_16x16x32_bf16 v[196:199], v[160:163], a[104:107], v[196:199]
ds_read_b128 v[192:195], v11 offset:35840
v_mfma_f32_16x16x32_bf16 v[196:199], v[156:159], a[96:99], v[196:199]
s_waitcnt lgkmcnt(4)
buffer_load_dwordx4 a[196:199], v4, s[8:11], s47 offen offset:2048 sc1
v_mfma_f32_16x16x32_bf16 v[224:227], v[164:167], a[96:99], v[224:227]
s_barrier
v_add_u32 v10, 0x9000, v10
ds_read_b128 v[148:151], v10 offset:0
v_add_u32 v11, 0x9000, v11
v_mfma_f32_16x16x32_bf16 v[224:227], v[168:171], a[104:107], v[224:227]
v_mfma_f32_16x16x32_bf16 v[228:231], v[168:171], a[108:111], v[228:231]
ds_read_b128 v[152:155], v10 offset:1024
v_mfma_f32_16x16x32_bf16 v[228:231], v[164:167], a[100:103], v[228:231]
buffer_load_dwordx4 a[200:203], v4, s[8:11], s46 offen offset:3072 sc1
v_mfma_f32_16x16x32_bf16 v[236:239], v[172:175], a[100:103], v[236:239]
ds_read_b128 v[156:159], v10 offset:2048
v_mfma_f32_16x16x32_bf16 v[236:239], v[176:179], a[108:111], v[236:239]
v_mfma_f32_16x16x32_bf16 v[232:235], v[176:179], a[104:107], v[232:235]
ds_read_b128 v[160:163], v10 offset:3072
v_mfma_f32_16x16x32_bf16 v[232:235], v[172:175], a[96:99], v[232:235]
s_waitcnt lgkmcnt(4)
buffer_load_dwordx4 a[204:207], v4, s[8:11], s47 offen offset:3072 sc1
v_mfma_f32_16x16x32_bf16 v[240:243], v[180:183], a[96:99], v[240:243]
s_add_u32 s46, s46, 4096
ds_read_b128 v[164:167], v10 offset:4096
v_mfma_f32_16x16x32_bf16 v[240:243], v[184:187], a[104:107], v[240:243]
s_add_u32 s47, s47, 4096
v_mfma_f32_16x16x32_bf16 v[244:247], v[184:187], a[108:111], v[244:247]
ds_read_b128 v[168:171], v10 offset:5120
v_mfma_f32_16x16x32_bf16 v[244:247], v[180:183], a[100:103], v[244:247]
v_mfma_f32_16x16x32_bf16 v[252:255], v[188:191], a[100:103], v[252:255]
ds_read_b128 v[172:175], v10 offset:6144
v_mfma_f32_16x16x32_bf16 v[252:255], v[192:195], a[108:111], v[252:255]
buffer_load_dwordx4 a[208:211], v4, s[8:11], s46 offen offset:0 sc1
v_mfma_f32_16x16x32_bf16 v[248:251], v[192:195], a[104:107], v[248:251]
ds_read_b128 v[176:179], v10 offset:7168
v_mfma_f32_16x16x32_bf16 v[248:251], v[188:191], a[96:99], v[248:251]
s_waitcnt lgkmcnt(4)
v_mfma_f32_16x16x32_bf16 v[92:95], v[148:151], a[112:115], v[92:95]
Lcw5:
ds_read_b128 v[180:183], v10 offset:8192
v_mfma_f32_16x16x32_bf16 v[92:95], v[152:155], a[120:123], v[92:95]
buffer_load_dwordx4 a[212:215], v4, s[8:11], s47 offen offset:0 sc1
v_mfma_f32_16x16x32_bf16 v[96:99], v[152:155], a[124:127], v[96:99]
ds_read_b128 v[184:187], v10 offset:9216
v_mfma_f32_16x16x32_bf16 v[96:99], v[148:151], a[116:119], v[96:99]
v_mfma_f32_16x16x32_bf16 v[104:107], v[156:159], a[116:119], v[104:107]
ds_read_b128 v[188:191], v10 offset:10240
v_mfma_f32_16x16x32_bf16 v[104:107], v[160:163], a[124:127], v[104:107]
v_mfma_f32_16x16x32_bf16 v[100:103], v[160:163], a[120:123], v[100:103]
ds_read_b128 v[192:195], v10 offset:11264
v_mfma_f32_16x16x32_bf16 v[100:103], v[156:159], a[112:115], v[100:103]
s_waitcnt lgkmcnt(4)
buffer_load_dwordx4 a[216:219], v4, s[8:11], s46 offen offset:1024 sc1
v_mfma_f32_16x16x32_bf16 v[108:111], v[164:167], a[112:115], v[108:111]
ds_read_b128 v[148:151], v10 offset:12288
v_mfma_f32_16x16x32_bf16 v[108:111], v[168:171], a[120:123], v[108:111]
v_mfma_f32_16x16x32_bf16 v[112:115], v[168:171], a[124:127], v[112:115]
ds_read_b128 v[152:155], v10 offset:13312
v_mfma_f32_16x16x32_bf16 v[112:115], v[164:167], a[116:119], v[112:115]
buffer_load_dwordx4 a[220:223], v4, s[8:11], s47 offen offset:1024 sc1
v_mfma_f32_16x16x32_bf16 v[120:123], v[172:175], a[116:119], v[120:123]
ds_read_b128 v[156:159], v10 offset:14336
v_mfma_f32_16x16x32_bf16 v[120:123], v[176:179], a[124:127], v[120:123]
v_mfma_f32_16x16x32_bf16 v[116:119], v[176:179], a[120:123], v[116:119]
ds_read_b128 v[160:163], v10 offset:15360
v_mfma_f32_16x16x32_bf16 v[116:119], v[172:175], a[112:115], v[116:119]
s_waitcnt lgkmcnt(4)
buffer_load_dwordx4 a[224:227], v4, s[8:11], s46 offen offset:2048 sc1
v_mfma_f32_16x16x32_bf16 v[196:199], v[180:183], a[112:115], v[196:199]
ds_read_b128 v[164:167], v11 offset:16384
v_mfma_f32_16x16x32_bf16 v[196:199], v[184:187], a[120:123], v[196:199]
v_mfma_f32_16x16x32_bf16 v[200:203], v[184:187], a[124:127], v[200:203]
ds_read_b128 v[168:171], v11 offset:17408
v_mfma_f32_16x16x32_bf16 v[200:203], v[180:183], a[116:119], v[200:203]
v_mfma_f32_16x16x32_bf16 v[228:231], v[188:191], a[116:119], v[228:231]
ds_read_b128 v[172:175], v10 offset:18432
v_mfma_f32_16x16x32_bf16 v[228:231], v[192:195], a[124:127], v[228:231]
buffer_load_dwordx4 a[228:231], v4, s[8:11], s47 offen offset:2048 sc1
v_mfma_f32_16x16x32_bf16 v[224:227], v[192:195], a[120:123], v[224:227]
ds_read_b128 v[176:179], v10 offset:19456
v_mfma_f32_16x16x32_bf16 v[224:227], v[188:191], a[112:115], v[224:227]
s_waitcnt lgkmcnt(4)
v_mfma_f32_16x16x32_bf16 v[232:235], v[148:151], a[112:115], v[232:235]
ds_read_b128 v[180:183], v10 offset:20480
v_mfma_f32_16x16x32_bf16 v[232:235], v[152:155], a[120:123], v[232:235]
buffer_load_dwordx4 a[232:235], v4, s[8:11], s46 offen offset:3072 sc1
v_mfma_f32_16x16x32_bf16 v[236:239], v[152:155], a[124:127], v[236:239]
ds_read_b128 v[184:187], v10 offset:21504
v_mfma_f32_16x16x32_bf16 v[236:239], v[148:151], a[116:119], v[236:239]
v_mfma_f32_16x16x32_bf16 v[244:247], v[156:159], a[116:119], v[244:247]
ds_read_b128 v[188:191], v10 offset:22528
v_mfma_f32_16x16x32_bf16 v[244:247], v[160:163], a[124:127], v[244:247]
v_mfma_f32_16x16x32_bf16 v[240:243], v[160:163], a[120:123], v[240:243]
s_add_u32 s83, s82, Lcw6-Lcp
ds_read_b128 v[192:195], v10 offset:23552
v_mfma_f32_16x16x32_bf16 v[240:243], v[156:159], a[112:115], v[240:243]
s_waitcnt lgkmcnt(4)
buffer_load_dwordx4 a[236:239], v4, s[8:11], s47 offen offset:3072 sc1
v_mfma_f32_16x16x32_bf16 v[248:251], v[164:167], a[112:115], v[248:251]
s_add_u32 s46, s46, 4096
s_min_u32 s83, s83, Lcode_end-Lcp-4
ds_read_b128 v[148:151], v10 offset:24576
v_mfma_f32_16x16x32_bf16 v[248:251], v[168:171], a[120:123], v[248:251]
s_add_u32 s47, s47, 4096
v_mov_b32 v222, s83
v_mfma_f32_16x16x32_bf16 v[252:255], v[168:171], a[124:127], v[252:255]
s_add_u32 m0, s25, 0
ds_read_b128 v[152:155], v10 offset:25600
v_mfma_f32_16x16x32_bf16 v[252:255], v[164:167], a[116:119], v[252:255]
buffer_load_dwordx4 v4, s[8:11], s44 offen offset:0 sc1 lds
v_mfma_f32_16x16x32_bf16 v[96:99], v[172:175], a[132:135], v[96:99]
ds_read_b128 v[156:159], v10 offset:26624
v_mfma_f32_16x16x32_bf16 v[96:99], v[176:179], a[140:143], v[96:99]
global_load_dword v223, v222, s[80:81]
v_mfma_f32_16x16x32_bf16 v[92:95], v[176:179], a[136:139], v[92:95]
ds_read_b128 v[160:163], v10 offset:27648
v_mfma_f32_16x16x32_bf16 v[92:95], v[172:175], a[128:131], v[92:95]
s_waitcnt lgkmcnt(4)
buffer_load_dwordx4 v4, s[8:11], s44 offen offset:1024 sc1 lds
v_mfma_f32_16x16x32_bf16 v[100:103], v[180:183], a[128:131], v[100:103]
ds_read_b128 v[164:167], v10 offset:28672
v_mfma_f32_16x16x32_bf16 v[100:103], v[184:187], a[136:139], v[100:103]
v_mfma_f32_16x16x32_bf16 v[104:107], v[184:187], a[140:143], v[104:107]
ds_read_b128 v[168:171], v10 offset:29696
v_mfma_f32_16x16x32_bf16 v[104:107], v[180:183], a[132:135], v[104:107]
v_mfma_f32_16x16x32_bf16 v[112:115], v[188:191], a[132:135], v[112:115]
ds_read_b128 v[172:175], v10 offset:30720
v_mfma_f32_16x16x32_bf16 v[112:115], v[192:195], a[140:143], v[112:115]
buffer_load_dwordx4 v4, s[8:11], s44 offen offset:2048 sc1 lds
v_mfma_f32_16x16x32_bf16 v[108:111], v[192:195], a[136:139], v[108:111]
ds_read_b128 v[176:179], v10 offset:31744
v_mfma_f32_16x16x32_bf16 v[108:111], v[188:191], a[128:131], v[108:111]
s_waitcnt lgkmcnt(4)
v_mfma_f32_16x16x32_bf16 v[116:119], v[148:151], a[128:131], v[116:119]
ds_read_b128 v[180:183], v10 offset:32768
v_mfma_f32_16x16x32_bf16 v[116:119], v[152:155], a[136:139], v[116:119]
buffer_load_dwordx4 v4, s[8:11], s44 offen offset:3072 sc1 lds
v_mfma_f32_16x16x32_bf16 v[120:123], v[152:155], a[140:143], v[120:123]
s_add_u32 s44, s44, 4096
ds_read_b128 v[184:187], v10 offset:33792
v_mfma_f32_16x16x32_bf16 v[120:123], v[148:151], a[132:135], v[120:123]
v_mfma_f32_16x16x32_bf16 v[200:203], v[156:159], a[132:135], v[200:203]
ds_read_b128 v[188:191], v11 offset:34816
v_mfma_f32_16x16x32_bf16 v[200:203], v[160:163], a[140:143], v[200:203]
v_mfma_f32_16x16x32_bf16 v[196:199], v[160:163], a[136:139], v[196:199]
s_add_u32 m0, s25, 4096
ds_read_b128 v[192:195], v11 offset:35840
v_mfma_f32_16x16x32_bf16 v[196:199], v[156:159], a[128:131], v[196:199]
s_waitcnt lgkmcnt(4)
buffer_load_dwordx4 v4, s[8:11], s44 offen offset:0 sc1 lds
v_mfma_f32_16x16x32_bf16 v[224:227], v[164:167], a[128:131], v[224:227]
s_waitcnt vmcnt(22)
s_barrier
v_add_u32 v10, 0x9000, v10
v_add_u32 v11, 0x9000, v11
ds_read_b128 v[148:151], v11 offset:0
v_mfma_f32_16x16x32_bf16 v[224:227], v[168:171], a[136:139], v[224:227]
v_mfma_f32_16x16x32_bf16 v[228:231], v[168:171], a[140:143], v[228:231]
ds_read_b128 v[152:155], v11 offset:1024
v_mfma_f32_16x16x32_bf16 v[228:231], v[164:167], a[132:135], v[228:231]
buffer_load_dwordx4 v4, s[8:11], s44 offen offset:1024 sc1 lds
v_mfma_f32_16x16x32_bf16 v[236:239], v[172:175], a[132:135], v[236:239]
ds_read_b128 v[156:159], v11 offset:2048
v_mfma_f32_16x16x32_bf16 v[236:239], v[176:179], a[140:143], v[236:239]
v_mfma_f32_16x16x32_bf16 v[232:235], v[176:179], a[136:139], v[232:235]
ds_read_b128 v[160:163], v11 offset:3072
v_mfma_f32_16x16x32_bf16 v[232:235], v[172:175], a[128:131], v[232:235]
s_waitcnt lgkmcnt(4)
buffer_load_dwordx4 v4, s[8:11], s44 offen offset:2048 sc1 lds
v_mfma_f32_16x16x32_bf16 v[240:243], v[180:183], a[128:131], v[240:243]
ds_read_b128 v[164:167], v11 offset:4096
v_mfma_f32_16x16x32_bf16 v[240:243], v[184:187], a[136:139], v[240:243]
v_mfma_f32_16x16x32_bf16 v[244:247], v[184:187], a[140:143], v[244:247]
ds_read_b128 v[168:171], v11 offset:5120
v_mfma_f32_16x16x32_bf16 v[244:247], v[180:183], a[132:135], v[244:247]
v_mfma_f32_16x16x32_bf16 v[252:255], v[188:191], a[132:135], v[252:255]
ds_read_b128 v[172:175], v11 offset:6144
v_mfma_f32_16x16x32_bf16 v[252:255], v[192:195], a[140:143], v[252:255]
buffer_load_dwordx4 v4, s[8:11], s44 offen offset:3072 sc1 lds
v_mfma_f32_16x16x32_bf16 v[248:251], v[192:195], a[136:139], v[248:251]
s_add_u32 s44, s44, 4096
ds_read_b128 v[176:179], v11 offset:7168
v_mfma_f32_16x16x32_bf16 v[248:251], v[188:191], a[128:131], v[248:251]
s_waitcnt lgkmcnt(4)
v_mfma_f32_16x16x32_bf16 v[248:251], v[148:151], a[144:147], v[248:251]
ds_read_b128 v[180:183], v11 offset:8192
v_and_b32 v5, 1, v3
v_mul_u32_u24 v5, 18432, v5
v_lshrrev_b32 v6, 1, v3
v_lshl_add_u32 v5, v6, 8, v5
v_lshl_add_u32 v5, v2, 4, v5
v_mfma_f32_16x16x32_bf16 v[248:251], v[152:155], a[152:155], v[248:251]
s_add_u32 m0, s25, 8192
v_mfma_f32_16x16x32_bf16 v[252:255], v[152:155], a[156:159], v[252:255]
s_cmp_eq_u32 s13, 0
s_cselect_b64 vcc, -1, 0
ds_read_b128 v[184:187], v11 offset:9216
v_cndmask_b32 v222, v14, v4, vcc
v_mfma_f32_16x16x32_bf16 v[252:255], v[148:151], a[148:151], v[252:255]
buffer_load_dwordx4 v4, s[8:11], s44 offen offset:0 sc1 lds
v_mfma_f32_16x16x32_bf16 v[252:255], v[156:159], a[164:167], v[252:255]
s_add_u32 s44, s44, 28672
s_add_u32 s19, s18, 1
ds_read_b128 v[188:191], v11 offset:10240
v_mfma_f32_16x16x32_bf16 v[252:255], v[160:163], a[172:175], v[252:255]
s_and_b32 s19, s19, 3
s_lshl_b32 s19, s19, 7
s_add_u32 s84, s51, s19
v_mfma_f32_16x16x32_bf16 v[248:251], v[160:163], a[168:171], v[248:251]
s_add_u32 m0, s25, 36864
s_add_u32 s19, s18, 2
ds_read_b128 v[192:195], v11 offset:11264
v_mfma_f32_16x16x32_bf16 v[248:251], v[156:159], a[160:163], v[248:251]
s_waitcnt vmcnt(18) lgkmcnt(4)
buffer_load_dwordx4 v4, s[8:11], s44 offen offset:0 sc1 lds
v_mfma_f32_16x16x32_bf16 v[248:251], v[164:167], a[176:179], v[248:251]
s_and_b32 s19, s19, 3
s_lshl_b32 s19, s19, 7
ds_read_b128 v[148:151], v10 offset:12288
v_mfma_f32_16x16x32_bf16 v[248:251], v[168:171], a[184:187], v[248:251]
s_add_u32 s85, s51, s19
s_add_u32 s85, s85, 4
s_add_u32 s19, s18, 3
v_mfma_f32_16x16x32_bf16 v[252:255], v[168:171], a[188:191], v[252:255]
s_and_b32 s19, s19, 3
s_lshl_b32 s19, s19, 7
ds_read_b128 v[152:155], v10 offset:13312
v_mfma_f32_16x16x32_bf16 v[252:255], v[164:167], a[180:183], v[252:255]
buffer_load_dwordx4 v4, s[8:11], s44 offen offset:1024 sc1 lds
v_mfma_f32_16x16x32_bf16 v[252:255], v[172:175], a[196:199], v[252:255]
s_add_u32 s86, s51, s19
s_add_u32 s86, s86, 8
ds_read_b128 v[156:159], v10 offset:14336
v_mfma_f32_16x16x32_bf16 v[252:255], v[176:179], a[204:207], v[252:255]
s_lshl_b32 s19, s18, 7
s_add_u32 s31, s51, s19
s_mul_i32 s19, s18, 2359296
v_mfma_f32_16x16x32_bf16 v[248:251], v[176:179], a[200:203], v[248:251]
s_sub_u32 s24, s48, s19
s_add_u32 s19, s18, 3
ds_read_b128 v[160:163], v10 offset:15360
v_mfma_f32_16x16x32_bf16 v[248:251], v[172:175], a[192:195], v[248:251]
s_waitcnt vmcnt(12) lgkmcnt(4)
buffer_load_dwordx4 v4, s[8:11], s44 offen offset:2048 sc1 lds
v_mfma_f32_16x16x32_bf16 v[248:251], v[180:183], a[208:211], v[248:251]
s_and_b32 s19, s19, 3
s_mul_i32 s19, s19, 2359296
ds_read_b128 v[164:167], v10 offset:16384
v_mfma_f32_16x16x32_bf16 v[248:251], v[184:187], a[216:219], v[248:251]
s_add_u32 s20, s24, s19
s_add_u32 s19, s18, 2
s_and_b32 s19, s19, 3
v_mfma_f32_16x16x32_bf16 v[252:255], v[184:187], a[220:223], v[252:255]
s_mul_i32 s19, s19, 2359296
s_add_u32 s21, s24, s19
ds_read_b128 v[168:171], v10 offset:17408
v_mfma_f32_16x16x32_bf16 v[252:255], v[180:183], a[212:215], v[252:255]
s_add_u32 s19, s18, 1
s_and_b32 s19, s19, 3
s_mul_i32 s19, s19, 2359296
v_mfma_f32_16x16x32_bf16 v[252:255], v[188:191], a[228:231], v[252:255]
s_add_u32 s22, s24, s19
s_sub_u32 s24, s24, 5242880
ds_read_b128 v[172:175], v10 offset:18432
v_mfma_f32_16x16x32_bf16 v[252:255], v[192:195], a[236:239], v[252:255]
buffer_load_dwordx4 v4, s[8:11], s44 offen offset:3072 sc1 lds
v_mfma_f32_16x16x32_bf16 v[248:251], v[192:195], a[232:235], v[248:251]
s_add_u32 s44, s44, 4096
s_lshl_b32 s19, s18, 10
ds_read_b128 v[176:179], v10 offset:19456
v_mfma_f32_16x16x32_bf16 v[248:251], v[188:191], a[224:227], v[248:251]
s_waitcnt lgkmcnt(4)
s_add_u32 s23, s24, s19
v_add_u32 v7, 18432, v4
v_mfma_f32_16x16x32_bf16 v[92:95], v[148:151], a[144:147], v[92:95]
s_sub_u32 s19, s50, s48
ds_read_b128 v[180:183], v10 offset:20480
v_cmp_eq_u32 vcc, s18, v3
v_mfma_f32_16x16x32_bf16 v[92:95], v[152:155], a[152:155], v[92:95]
s_add_u32 m0, s25, 40960
v_add_u32 v8, s19, v5
v_lshlrev_b32 v9, 2, v2
v_mfma_f32_16x16x32_bf16 v[96:99], v[152:155], a[156:159], v[96:99]
ds_read_b128 v[184:187], v10 offset:21504
v_mfma_f32_16x16x32_bf16 v[96:99], v[148:151], a[148:151], v[96:99]
buffer_load_dwordx4 v4, s[8:11], s44 offen offset:0 sc1 lds
v_mfma_f32_16x16x32_bf16 v[96:99], v[156:159], a[164:167], v[96:99]
ds_read_b128 v[188:191], v10 offset:22528
v_mfma_f32_16x16x32_bf16 v[96:99], v[160:163], a[172:175], v[96:99]
v_cvt_pk_bf16_f32 v60, v248, v249
v_cvt_pk_bf16_f32 v61, v250, v251
v_mfma_f32_16x16x32_bf16 v[92:95], v[160:163], a[168:171], v[92:95]
ds_read_b128 v[192:195], v10 offset:23552
v_cvt_pk_bf16_f32 v62, v252, v253
v_mfma_f32_16x16x32_bf16 v[92:95], v[156:159], a[160:163], v[92:95]
s_waitcnt lgkmcnt(4)
buffer_load_dwordx4 v4, s[8:11], s44 offen offset:1024 sc1 lds
v_mfma_f32_16x16x32_bf16 v[92:95], v[164:167], a[176:179], v[92:95]
ds_read_b128 v[148:151], v10 offset:24576
v_cvt_pk_bf16_f32 v63, v254, v255
v_mfma_f32_16x16x32_bf16 v[92:95], v[168:171], a[184:187], v[92:95]
v_permlane16_swap_b32 v60, v62
v_mfma_f32_16x16x32_bf16 v[96:99], v[168:171], a[188:191], v[96:99]
ds_read_b128 v[152:155], v10 offset:25600
v_mfma_f32_16x16x32_bf16 v[96:99], v[164:167], a[180:183], v[96:99]
buffer_load_dwordx4 v4, s[8:11], s44 offen offset:2048 sc1 lds
v_mfma_f32_16x16x32_bf16 v[96:99], v[172:175], a[196:199], v[96:99]
ds_read_b128 v[156:159], v10 offset:26624
v_mfma_f32_16x16x32_bf16 v[96:99], v[176:179], a[204:207], v[96:99]
v_permlane16_swap_b32 v61, v63
v_mfma_f32_16x16x32_bf16 v[92:95], v[176:179], a[200:203], v[92:95]
ds_read_b128 v[160:163], v10 offset:27648
v_cndmask_b32 v8, v14, v8, vcc
v_mfma_f32_16x16x32_bf16 v[92:95], v[172:175], a[192:195], v[92:95]
s_waitcnt lgkmcnt(4)
buffer_load_dwordx4 v4, s[8:11], s44 offen offset:3072 sc1 lds
v_mfma_f32_16x16x32_bf16 v[92:95], v[180:183], a[208:211], v[92:95]
s_add_u32 s44, s44, 4096
ds_read_b128 v[164:167], v10 offset:28672
v_mfma_f32_16x16x32_bf16 v[92:95], v[184:187], a[216:219], v[92:95]
buffer_store_dwordx4 v[60:63], v5, s[8:11], s50 offen sc1
v_mfma_f32_16x16x32_bf16 v[96:99], v[184:187], a[220:223], v[96:99]
ds_read_b128 v[168:171], v10 offset:29696
v_mfma_f32_16x16x32_bf16 v[96:99], v[180:183], a[212:215], v[96:99]
v_mfma_f32_16x16x32_bf16 v[96:99], v[188:191], a[228:231], v[96:99]
s_add_u32 m0, s25, 45056
ds_read_b128 v[172:175], v10 offset:30720
v_mfma_f32_16x16x32_bf16 v[96:99], v[192:195], a[236:239], v[96:99]
buffer_load_dwordx4 v4, s[8:11], s44 offen offset:0 sc1 lds
v_mfma_f32_16x16x32_bf16 v[92:95], v[192:195], a[232:235], v[92:95]
s_add_u32 s44, s44, 28672
ds_read_b128 v[176:179], v10 offset:31744
v_mfma_f32_16x16x32_bf16 v[92:95], v[188:191], a[224:227], v[92:95]
s_waitcnt lgkmcnt(4)
v_mfma_f32_16x16x32_bf16 v[100:103], v[148:151], a[144:147], v[100:103]
ds_read_b128 v[180:183], v10 offset:32768
v_mfma_f32_16x16x32_bf16 v[100:103], v[152:155], a[152:155], v[100:103]
s_bitcmp1_b32 s18, 0
s_cselect_b64 s[26:27], 0, vcc
s_cselect_b64 s[28:29], vcc, 0
v_mfma_f32_16x16x32_bf16 v[104:107], v[152:155], a[156:159], v[104:107]
ds_read_b128 v[184:187], v10 offset:33792
v_mfma_f32_16x16x32_bf16 v[104:107], v[148:151], a[148:151], v[104:107]
v_mfma_f32_16x16x32_bf16 v[104:107], v[156:159], a[164:167], v[104:107]
ds_read_b128 v[188:191], v10 offset:34816
v_mfma_f32_16x16x32_bf16 v[104:107], v[160:163], a[172:175], v[104:107]
v_mfma_f32_16x16x32_bf16 v[100:103], v[160:163], a[168:171], v[100:103]
ds_read_b128 v[192:195], v10 offset:35840
v_mfma_f32_16x16x32_bf16 v[100:103], v[156:159], a[160:163], v[100:103]
s_waitcnt lgkmcnt(4)
v_mfma_f32_16x16x32_bf16 v[100:103], v[164:167], a[176:179], v[100:103]
s_waitcnt vmcnt(10)
s_barrier
v_add_u32 v10, 0xfffe5000, v10
ds_read_b128 v[148:151], v10 offset:0
v_add_u32 v11, 0xfffe5000, v11
v_mfma_f32_16x16x32_bf16 v[100:103], v[168:171], a[184:187], v[100:103]
v_mfma_f32_16x16x32_bf16 v[104:107], v[168:171], a[188:191], v[104:107]
s_add_u32 m0, s25, 73728
ds_read_b128 v[152:155], v10 offset:1024
v_mfma_f32_16x16x32_bf16 v[104:107], v[164:167], a[180:183], v[104:107]
buffer_load_dwordx4 v222, s[8:11], s45 offen offset:0 sc1 lds
v_mfma_f32_16x16x32_bf16 v[104:107], v[172:175], a[196:199], v[104:107]
ds_read_b128 v[156:159], v10 offset:2048
v_mfma_f32_16x16x32_bf16 v[104:107], v[176:179], a[204:207], v[104:107]
v_mfma_f32_16x16x32_bf16 v[100:103], v[176:179], a[200:203], v[100:103]
ds_read_b128 v[160:163], v10 offset:3072
v_mfma_f32_16x16x32_bf16 v[100:103], v[172:175], a[192:195], v[100:103]
s_waitcnt lgkmcnt(4)
v_mfma_f32_16x16x32_bf16 v[100:103], v[180:183], a[208:211], v[100:103]
s_lshl_b32 s19, s43, 7
s_add_u32 s30, s19, 28540928
ds_read_b128 v[164:167], v10 offset:4096
v_mfma_f32_16x16x32_bf16 v[100:103], v[184:187], a[216:219], v[100:103]
s_add_u32 s32, s19, s12
s_add_u32 s32, s32, 7569408
v_mfma_f32_16x16x32_bf16 v[104:107], v[184:187], a[220:223], v[104:107]
ds_read_b128 v[168:171], v10 offset:5120
v_mfma_f32_16x16x32_bf16 v[104:107], v[180:183], a[212:215], v[104:107]
buffer_load_dwordx4 v222, s[8:11], s45 offen offset:1024 sc1 lds
v_mfma_f32_16x16x32_bf16 v[104:107], v[188:191], a[228:231], v[104:107]
ds_read_b128 v[172:175], v10 offset:6144
v_mfma_f32_16x16x32_bf16 v[104:107], v[192:195], a[236:239], v[104:107]
v_mfma_f32_16x16x32_bf16 v[100:103], v[192:195], a[232:235], v[100:103]
ds_read_b128 v[176:179], v10 offset:7168
v_mfma_f32_16x16x32_bf16 v[100:103], v[188:191], a[224:227], v[100:103]
s_waitcnt lgkmcnt(4)
v_mfma_f32_16x16x32_bf16 v[108:111], v[148:151], a[144:147], v[108:111]
ds_read_b128 v[180:183], v10 offset:8192
v_mfma_f32_16x16x32_bf16 v[108:111], v[152:155], a[152:155], v[108:111]
v_mfma_f32_16x16x32_bf16 v[112:115], v[152:155], a[156:159], v[112:115]
ds_read_b128 v[184:187], v10 offset:9216
v_mfma_f32_16x16x32_bf16 v[112:115], v[148:151], a[148:151], v[112:115]
buffer_load_dwordx4 v222, s[8:11], s45 offen offset:2048 sc1 lds
v_mfma_f32_16x16x32_bf16 v[112:115], v[156:159], a[164:167], v[112:115]
ds_read_b128 v[188:191], v10 offset:10240
v_mfma_f32_16x16x32_bf16 v[112:115], v[160:163], a[172:175], v[112:115]
v_cvt_pk_bf16_f32 v28, v92, v93
v_cvt_pk_bf16_f32 v29, v94, v95
v_mfma_f32_16x16x32_bf16 v[108:111], v[160:163], a[168:171], v[108:111]
ds_read_b128 v[192:195], v10 offset:11264
v_cvt_pk_bf16_f32 v30, v100, v101
v_mfma_f32_16x16x32_bf16 v[108:111], v[156:159], a[160:163], v[108:111]
s_waitcnt lgkmcnt(4)
v_cvt_pk_bf16_f32 v31, v102, v103
v_cvt_pk_bf16_f32 v32, v96, v97
v_mfma_f32_16x16x32_bf16 v[108:111], v[164:167], a[176:179], v[108:111]
ds_read_b128 v[148:151], v10 offset:12288
v_cvt_pk_bf16_f32 v33, v98, v99
v_mfma_f32_16x16x32_bf16 v[108:111], v[168:171], a[184:187], v[108:111]
buffer_store_dwordx4 v[28:31], v4, s[8:11], s48 offen offset:0 sc1
v_mfma_f32_16x16x32_bf16 v[112:115], v[168:171], a[188:191], v[112:115]
ds_read_b128 v[152:155], v10 offset:13312
v_cvt_pk_bf16_f32 v34, v104, v105
v_mfma_f32_16x16x32_bf16 v[112:115], v[164:167], a[180:183], v[112:115]
buffer_load_dwordx4 v222, s[8:11], s45 offen offset:3072 sc1 lds
v_mfma_f32_16x16x32_bf16 v[112:115], v[172:175], a[196:199], v[112:115]
s_add_u32 s45, s45, 4096
ds_read_b128 v[156:159], v10 offset:14336
v_cvt_pk_bf16_f32 v35, v106, v107
v_mfma_f32_16x16x32_bf16 v[112:115], v[176:179], a[204:207], v[112:115]
buffer_store_dwordx4 v[32:35], v4, s[8:11], s49 offen offset:0 sc1
v_mfma_f32_16x16x32_bf16 v[108:111], v[176:179], a[200:203], v[108:111]
ds_read_b128 v[160:163], v10 offset:15360
v_mfma_f32_16x16x32_bf16 v[108:111], v[172:175], a[192:195], v[108:111]
s_waitcnt lgkmcnt(4)
v_mfma_f32_16x16x32_bf16 v[108:111], v[180:183], a[208:211], v[108:111]
ds_read_b128 v[164:167], v10 offset:16384
v_mfma_f32_16x16x32_bf16 v[108:111], v[184:187], a[216:219], v[108:111]
v_mfma_f32_16x16x32_bf16 v[112:115], v[184:187], a[220:223], v[112:115]
ds_read_b128 v[168:171], v10 offset:17408
v_mfma_f32_16x16x32_bf16 v[112:115], v[180:183], a[212:215], v[112:115]
v_mfma_f32_16x16x32_bf16 v[112:115], v[188:191], a[228:231], v[112:115]
s_add_u32 m0, s25, 77824
ds_read_b128 v[172:175], v10 offset:18432
v_mfma_f32_16x16x32_bf16 v[112:115], v[192:195], a[236:239], v[112:115]
buffer_load_dwordx4 v222, s[8:11], s45 offen offset:0 sc1 lds
v_mfma_f32_16x16x32_bf16 v[108:111], v[192:195], a[232:235], v[108:111]
ds_read_b128 v[176:179], v10 offset:19456
v_mfma_f32_16x16x32_bf16 v[108:111], v[188:191], a[224:227], v[108:111]
s_waitcnt lgkmcnt(4)
v_mfma_f32_16x16x32_bf16 v[116:119], v[148:151], a[144:147], v[116:119]
ds_read_b128 v[180:183], v10 offset:20480
v_mfma_f32_16x16x32_bf16 v[116:119], v[152:155], a[152:155], v[116:119]
v_mfma_f32_16x16x32_bf16 v[120:123], v[152:155], a[156:159], v[120:123]
ds_read_b128 v[184:187], v10 offset:21504
v_mfma_f32_16x16x32_bf16 v[120:123], v[148:151], a[148:151], v[120:123]
buffer_load_dwordx4 v[124:127], v4, s[8:11], s23 offen sc1
v_mfma_f32_16x16x32_bf16 v[120:123], v[156:159], a[164:167], v[120:123]
ds_read_b128 v[188:191], v10 offset:22528
v_mfma_f32_16x16x32_bf16 v[120:123], v[160:163], a[172:175], v[120:123]
buffer_load_dwordx4 v222, s[8:11], s45 offen offset:1024 sc1 lds
v_mfma_f32_16x16x32_bf16 v[116:119], v[160:163], a[168:171], v[116:119]
ds_read_b128 v[192:195], v10 offset:23552
v_mfma_f32_16x16x32_bf16 v[116:119], v[156:159], a[160:163], v[116:119]
s_waitcnt lgkmcnt(4)
buffer_load_dwordx4 v[128:131], v7, s[8:11], s23 offen sc1
v_mfma_f32_16x16x32_bf16 v[116:119], v[164:167], a[176:179], v[116:119]
ds_read_b128 v[148:151], v10 offset:24576
v_mfma_f32_16x16x32_bf16 v[116:119], v[168:171], a[184:187], v[116:119]
buffer_load_dwordx4 v[132:135], v8, s[8:11], s24 offen sc1
v_mfma_f32_16x16x32_bf16 v[120:123], v[168:171], a[188:191], v[120:123]
ds_read_b128 v[152:155], v10 offset:25600
v_mfma_f32_16x16x32_bf16 v[120:123], v[164:167], a[180:183], v[120:123]
buffer_load_dword v136, v9, s[8:11], s30 offen offset:0 sc1
v_mfma_f32_16x16x32_bf16 v[120:123], v[172:175], a[196:199], v[120:123]
ds_read_b128 v[156:159], v10 offset:26624
v_mfma_f32_16x16x32_bf16 v[120:123], v[176:179], a[204:207], v[120:123]
buffer_load_dwordx4 v222, s[8:11], s45 offen offset:2048 sc1 lds
v_mfma_f32_16x16x32_bf16 v[116:119], v[176:179], a[200:203], v[116:119]
ds_read_b128 v[160:163], v10 offset:27648
v_mfma_f32_16x16x32_bf16 v[116:119], v[172:175], a[192:195], v[116:119]
s_waitcnt lgkmcnt(4)
buffer_load_dword v137, v9, s[8:11], s32 offen offset:0 sc1
v_mfma_f32_16x16x32_bf16 v[116:119], v[180:183], a[208:211], v[116:119]
ds_read_b128 v[164:167], v10 offset:28672
v_mfma_f32_16x16x32_bf16 v[116:119], v[184:187], a[216:219], v[116:119]
buffer_load_dword v138, v9, s[8:11], s30 offen offset:64 sc1
v_mfma_f32_16x16x32_bf16 v[120:123], v[184:187], a[220:223], v[120:123]
ds_read_b128 v[168:171], v10 offset:29696
v_mfma_f32_16x16x32_bf16 v[120:123], v[180:183], a[212:215], v[120:123]
v_mfma_f32_16x16x32_bf16 v[120:123], v[188:191], a[228:231], v[120:123]
ds_read_b128 v[172:175], v10 offset:30720
v_mfma_f32_16x16x32_bf16 v[120:123], v[192:195], a[236:239], v[120:123]
buffer_load_dwordx4 v222, s[8:11], s45 offen offset:3072 sc1 lds
v_mfma_f32_16x16x32_bf16 v[116:119], v[192:195], a[232:235], v[116:119]
s_add_u32 s45, s45, 4096
ds_read_b128 v[176:179], v10 offset:31744
v_mfma_f32_16x16x32_bf16 v[116:119], v[188:191], a[224:227], v[116:119]
s_waitcnt lgkmcnt(4)
buffer_load_dword v139, v9, s[8:11], s32 offen offset:64 sc1
v_mfma_f32_16x16x32_bf16 v[196:199], v[148:151], a[144:147], v[196:199]
ds_read_b128 v[180:183], v10 offset:32768
v_mfma_f32_16x16x32_bf16 v[196:199], v[152:155], a[152:155], v[196:199]
v_mfma_f32_16x16x32_bf16 v[200:203], v[152:155], a[156:159], v[200:203]
ds_read_b128 v[184:187], v10 offset:33792
v_mfma_f32_16x16x32_bf16 v[200:203], v[148:151], a[148:151], v[200:203]
v_mfma_f32_16x16x32_bf16 v[200:203], v[156:159], a[164:167], v[200:203]
ds_read_b128 v[188:191], v10 offset:34816
v_mfma_f32_16x16x32_bf16 v[200:203], v[160:163], a[172:175], v[200:203]
v_cvt_pk_bf16_f32 v36, v108, v109
v_cvt_pk_bf16_f32 v37, v110, v111
v_mfma_f32_16x16x32_bf16 v[196:199], v[160:163], a[168:171], v[196:199]
s_add_u32 m0, s25, 81920
ds_read_b128 v[192:195], v10 offset:35840
v_cvt_pk_bf16_f32 v38, v116, v117
v_mfma_f32_16x16x32_bf16 v[196:199], v[156:159], a[160:163], v[196:199]
s_waitcnt lgkmcnt(4)
buffer_load_dwordx4 v222, s[8:11], s45 offen offset:0 sc1 lds
v_mfma_f32_16x16x32_bf16 v[196:199], v[164:167], a[176:179], v[196:199]
s_waitcnt vmcnt(18)
s_barrier
s_add_u32 s45, s45, 28672
v_add_u32 v10, 0x9000, v10
ds_read_b128 v[148:151], v10 offset:0
v_add_u32 v11, 0x9000, v11
v_mfma_f32_16x16x32_bf16 v[196:199], v[168:171], a[184:187], v[196:199]
v_cvt_pk_bf16_f32 v39, v118, v119
v_cvt_pk_bf16_f32 v40, v112, v113
v_mfma_f32_16x16x32_bf16 v[200:203], v[168:171], a[188:191], v[200:203]
s_add_u32 m0, s25, 110592
ds_read_b128 v[152:155], v10 offset:1024
v_cvt_pk_bf16_f32 v41, v114, v115
v_mfma_f32_16x16x32_bf16 v[200:203], v[164:167], a[180:183], v[200:203]
buffer_load_dwordx4 v222, s[8:11], s45 offen offset:0 sc1 lds
v_mfma_f32_16x16x32_bf16 v[200:203], v[172:175], a[196:199], v[200:203]
ds_read_b128 v[156:159], v10 offset:2048
v_cvt_pk_bf16_f32 v42, v120, v121
v_mfma_f32_16x16x32_bf16 v[200:203], v[176:179], a[204:207], v[200:203]
buffer_store_dwordx4 v[36:39], v4, s[8:11], s48 offen offset:1024 sc1
v_mfma_f32_16x16x32_bf16 v[196:199], v[176:179], a[200:203], v[196:199]
ds_read_b128 v[160:163], v10 offset:3072
v_cvt_pk_bf16_f32 v43, v122, v123
s_waitcnt vmcnt(14)
s_mov_b64 exec, 1
buffer_store_dword v12, v13, s[8:11], s84 offen sc1
buffer_store_dword v12, v13, s[8:11], s86 offen offset:4 sc1
s_mov_b64 exec, -1
v_mfma_f32_16x16x32_bf16 v[196:199], v[172:175], a[192:195], v[196:199]
s_waitcnt lgkmcnt(4)
buffer_store_dwordx4 v[40:43], v4, s[8:11], s49 offen offset:1024 sc1
v_mfma_f32_16x16x32_bf16 v[196:199], v[180:183], a[208:211], v[196:199]
ds_read_b128 v[164:167], v10 offset:4096
v_mfma_f32_16x16x32_bf16 v[196:199], v[184:187], a[216:219], v[196:199]
buffer_load_dwordx4 v222, s[8:11], s45 offen offset:1024 sc1 lds
v_mfma_f32_16x16x32_bf16 v[200:203], v[184:187], a[220:223], v[200:203]
ds_read_b128 v[168:171], v10 offset:5120
v_mfma_f32_16x16x32_bf16 v[200:203], v[180:183], a[212:215], v[200:203]
v_mfma_f32_16x16x32_bf16 v[200:203], v[188:191], a[228:231], v[200:203]
ds_read_b128 v[172:175], v10 offset:6144
v_mfma_f32_16x16x32_bf16 v[200:203], v[192:195], a[236:239], v[200:203]
v_mfma_f32_16x16x32_bf16 v[196:199], v[192:195], a[232:235], v[196:199]
ds_read_b128 v[176:179], v10 offset:7168
v_mfma_f32_16x16x32_bf16 v[196:199], v[188:191], a[224:227], v[196:199]
s_waitcnt lgkmcnt(4)
v_mfma_f32_16x16x32_bf16 v[224:227], v[148:151], a[144:147], v[224:227]
Lcw6:
ds_read_b128 v[180:183], v10 offset:8192
v_mfma_f32_16x16x32_bf16 v[224:227], v[152:155], a[152:155], v[224:227]
buffer_load_dwordx4 v222, s[8:11], s45 offen offset:2048 sc1 lds
v_mfma_f32_16x16x32_bf16 v[228:231], v[152:155], a[156:159], v[228:231]
ds_read_b128 v[184:187], v10 offset:9216
v_mfma_f32_16x16x32_bf16 v[228:231], v[148:151], a[148:151], v[228:231]
v_mfma_f32_16x16x32_bf16 v[228:231], v[156:159], a[164:167], v[228:231]
ds_read_b128 v[188:191], v10 offset:10240
v_mfma_f32_16x16x32_bf16 v[228:231], v[160:163], a[172:175], v[228:231]
v_mfma_f32_16x16x32_bf16 v[224:227], v[160:163], a[168:171], v[224:227]
ds_read_b128 v[192:195], v10 offset:11264
v_mfma_f32_16x16x32_bf16 v[224:227], v[156:159], a[160:163], v[224:227]
s_waitcnt lgkmcnt(4)
buffer_load_dwordx4 v222, s[8:11], s45 offen offset:3072 sc1 lds
v_mfma_f32_16x16x32_bf16 v[224:227], v[164:167], a[176:179], v[224:227]
s_add_u32 s45, s45, 4096
ds_read_b128 v[148:151], v10 offset:12288
v_mfma_f32_16x16x32_bf16 v[224:227], v[168:171], a[184:187], v[224:227]
v_mfma_f32_16x16x32_bf16 v[228:231], v[168:171], a[188:191], v[228:231]
ds_read_b128 v[152:155], v10 offset:13312
v_mfma_f32_16x16x32_bf16 v[228:231], v[164:167], a[180:183], v[228:231]
v_mfma_f32_16x16x32_bf16 v[228:231], v[172:175], a[196:199], v[228:231]
ds_read_b128 v[156:159], v10 offset:14336
v_mfma_f32_16x16x32_bf16 v[228:231], v[176:179], a[204:207], v[228:231]
v_mfma_f32_16x16x32_bf16 v[224:227], v[176:179], a[200:203], v[224:227]
s_add_u32 m0, s25, 114688
ds_read_b128 v[160:163], v10 offset:15360
v_mfma_f32_16x16x32_bf16 v[224:227], v[172:175], a[192:195], v[224:227]
s_waitcnt lgkmcnt(4)
buffer_load_dwordx4 v222, s[8:11], s45 offen offset:0 sc1 lds
v_mfma_f32_16x16x32_bf16 v[224:227], v[180:183], a[208:211], v[224:227]
ds_read_b128 v[164:167], v10 offset:16384
v_mfma_f32_16x16x32_bf16 v[224:227], v[184:187], a[216:219], v[224:227]
v_mfma_f32_16x16x32_bf16 v[228:231], v[184:187], a[220:223], v[228:231]
ds_read_b128 v[168:171], v10 offset:17408
v_mfma_f32_16x16x32_bf16 v[228:231], v[180:183], a[212:215], v[228:231]
v_mfma_f32_16x16x32_bf16 v[228:231], v[188:191], a[228:231], v[228:231]
ds_read_b128 v[172:175], v10 offset:18432
v_mfma_f32_16x16x32_bf16 v[228:231], v[192:195], a[236:239], v[228:231]
buffer_load_dwordx4 v222, s[8:11], s45 offen offset:1024 sc1 lds
v_mfma_f32_16x16x32_bf16 v[224:227], v[192:195], a[232:235], v[224:227]
ds_read_b128 v[176:179], v10 offset:19456
v_mfma_f32_16x16x32_bf16 v[224:227], v[188:191], a[224:227], v[224:227]
s_waitcnt lgkmcnt(4)
v_mfma_f32_16x16x32_bf16 v[232:235], v[148:151], a[144:147], v[232:235]
ds_read_b128 v[180:183], v10 offset:20480
v_mfma_f32_16x16x32_bf16 v[232:235], v[152:155], a[152:155], v[232:235]
v_mfma_f32_16x16x32_bf16 v[236:239], v[152:155], a[156:159], v[236:239]
ds_read_b128 v[184:187], v10 offset:21504
v_mfma_f32_16x16x32_bf16 v[236:239], v[148:151], a[148:151], v[236:239]
v_mfma_f32_16x16x32_bf16 v[236:239], v[156:159], a[164:167], v[236:239]
ds_read_b128 v[188:191], v10 offset:22528
v_mfma_f32_16x16x32_bf16 v[236:239], v[160:163], a[172:175], v[236:239]
buffer_load_dwordx4 v222, s[8:11], s45 offen offset:2048 sc1 lds
v_mfma_f32_16x16x32_bf16 v[232:235], v[160:163], a[168:171], v[232:235]
ds_read_b128 v[192:195], v10 offset:23552
v_cvt_pk_bf16_f32 v44, v196, v197
v_mfma_f32_16x16x32_bf16 v[232:235], v[156:159], a[160:163], v[232:235]
s_waitcnt lgkmcnt(4)
v_cvt_pk_bf16_f32 v45, v198, v199
v_cvt_pk_bf16_f32 v46, v224, v225
v_mfma_f32_16x16x32_bf16 v[232:235], v[164:167], a[176:179], v[232:235]
ds_read_b128 v[148:151], v10 offset:24576
v_cvt_pk_bf16_f32 v47, v226, v227
v_mfma_f32_16x16x32_bf16 v[232:235], v[168:171], a[184:187], v[232:235]
buffer_store_dwordx4 v[44:47], v4, s[8:11], s48 offen offset:2048 sc1
v_mfma_f32_16x16x32_bf16 v[236:239], v[168:171], a[188:191], v[236:239]
ds_read_b128 v[152:155], v10 offset:25600
v_cvt_pk_bf16_f32 v48, v200, v201
v_mfma_f32_16x16x32_bf16 v[236:239], v[164:167], a[180:183], v[236:239]
buffer_load_dwordx4 v222, s[8:11], s45 offen offset:3072 sc1 lds
v_mfma_f32_16x16x32_bf16 v[236:239], v[172:175], a[196:199], v[236:239]
s_add_u32 s45, s45, 4096
ds_read_b128 v[156:159], v10 offset:26624
v_cvt_pk_bf16_f32 v49, v202, v203
v_mfma_f32_16x16x32_bf16 v[236:239], v[176:179], a[204:207], v[236:239]
v_cvt_pk_bf16_f32 v50, v228, v229
v_cvt_pk_bf16_f32 v51, v230, v231
v_mfma_f32_16x16x32_bf16 v[232:235], v[176:179], a[200:203], v[232:235]
ds_read_b128 v[160:163], v10 offset:27648
s_waitcnt vmcnt(8)
s_mov_b64 exec, 1
buffer_store_dword v12, v13, s[8:11], s85 offen sc1
s_mov_b64 exec, -1
v_mfma_f32_16x16x32_bf16 v[232:235], v[172:175], a[192:195], v[232:235]
s_waitcnt lgkmcnt(4)
buffer_store_dwordx4 v[48:51], v4, s[8:11], s49 offen offset:2048 sc1
v_mfma_f32_16x16x32_bf16 v[232:235], v[180:183], a[208:211], v[232:235]
ds_read_b128 v[164:167], v10 offset:28672
v_mfma_f32_16x16x32_bf16 v[232:235], v[184:187], a[216:219], v[232:235]
v_mfma_f32_16x16x32_bf16 v[236:239], v[184:187], a[220:223], v[236:239]
s_add_u32 m0, s25, 118784
ds_read_b128 v[168:171], v10 offset:29696
v_mfma_f32_16x16x32_bf16 v[236:239], v[180:183], a[212:215], v[236:239]
buffer_load_dwordx4 v222, s[8:11], s45 offen offset:0 sc1 lds
v_mfma_f32_16x16x32_bf16 v[236:239], v[188:191], a[228:231], v[236:239]
s_add_u32 s45, s45, 28672
ds_read_b128 v[172:175], v10 offset:30720
v_mfma_f32_16x16x32_bf16 v[236:239], v[192:195], a[236:239], v[236:239]
v_mfma_f32_16x16x32_bf16 v[232:235], v[192:195], a[232:235], v[232:235]
ds_read_b128 v[176:179], v10 offset:31744
v_mfma_f32_16x16x32_bf16 v[232:235], v[188:191], a[224:227], v[232:235]
s_waitcnt lgkmcnt(4)
v_mfma_f32_16x16x32_bf16 v[240:243], v[148:151], a[144:147], v[240:243]
ds_read_b128 v[180:183], v10 offset:32768
v_mfma_f32_16x16x32_bf16 v[240:243], v[152:155], a[152:155], v[240:243]
v_mfma_f32_16x16x32_bf16 v[244:247], v[152:155], a[156:159], v[244:247]
ds_read_b128 v[184:187], v10 offset:33792
v_mfma_f32_16x16x32_bf16 v[244:247], v[148:151], a[148:151], v[244:247]
v_mfma_f32_16x16x32_bf16 v[244:247], v[156:159], a[164:167], v[244:247]
ds_read_b128 v[188:191], v10 offset:34816
v_mfma_f32_16x16x32_bf16 v[244:247], v[160:163], a[172:175], v[244:247]
v_mfma_f32_16x16x32_bf16 v[240:243], v[160:163], a[168:171], v[240:243]
ds_read_b128 v[192:195], v10 offset:35840
v_mfma_f32_16x16x32_bf16 v[240:243], v[156:159], a[160:163], v[240:243]
s_waitcnt lgkmcnt(4)
v_mfma_f32_16x16x32_bf16 v[240:243], v[164:167], a[176:179], v[240:243]
v_mfma_f32_16x16x32_bf16 v[240:243], v[168:171], a[184:187], v[240:243]
v_mfma_f32_16x16x32_bf16 v[244:247], v[168:171], a[188:191], v[244:247]
v_mfma_f32_16x16x32_bf16 v[244:247], v[164:167], a[180:183], v[244:247]
v_mfma_f32_16x16x32_bf16 v[244:247], v[172:175], a[196:199], v[244:247]
v_mfma_f32_16x16x32_bf16 v[244:247], v[176:179], a[204:207], v[244:247]
v_mfma_f32_16x16x32_bf16 v[240:243], v[176:179], a[200:203], v[240:243]
v_mfma_f32_16x16x32_bf16 v[240:243], v[172:175], a[192:195], v[240:243]
s_waitcnt lgkmcnt(0)
v_mfma_f32_16x16x32_bf16 v[240:243], v[180:183], a[208:211], v[240:243]
v_mfma_f32_16x16x32_bf16 v[240:243], v[184:187], a[216:219], v[240:243]
v_mfma_f32_16x16x32_bf16 v[244:247], v[184:187], a[220:223], v[244:247]
v_mfma_f32_16x16x32_bf16 v[244:247], v[180:183], a[212:215], v[244:247]
v_mfma_f32_16x16x32_bf16 v[244:247], v[188:191], a[228:231], v[244:247]
v_mfma_f32_16x16x32_bf16 v[244:247], v[192:195], a[236:239], v[244:247]
v_mov_b32 v79, v12
s_mov_b64 exec, 0xb
v_mov_b32 v79, 0
buffer_atomic_or v79, v13, s[8:11], s31 offen sc0
s_mov_b64 exec, -1
v_mfma_f32_16x16x32_bf16 v[240:243], v[192:195], a[232:235], v[240:243]
v_mfma_f32_16x16x32_bf16 v[240:243], v[188:191], a[224:227], v[240:243]
s_waitcnt vmcnt(2)
s_mov_b64 exec, 1
buffer_store_dword v12, v13, s[8:11], s86 offen sc1
s_mov_b64 exec, -1
s_barrier
s_waitcnt vmcnt(1)
v_cmp_ne_u32 vcc, v12, v79
s_nop 1
s_cbranch_vccnz Lsp9
Lok9:
buffer_load_dwordx4 v[156:159], v8, s[8:11], s20 offen sc1
buffer_load_dwordx4 v[168:171], v8, s[8:11], s21 offen sc1
buffer_load_dwordx4 v[180:183], v8, s[8:11], s22 offen sc1
buffer_load_dwordx4 v[148:151], v4, s[8:11], s20 offen offset:0 sc1
buffer_load_dwordx4 v[152:155], v7, s[8:11], s20 offen offset:0 sc1
buffer_load_dwordx4 v[160:163], v4, s[8:11], s21 offen offset:1024 sc1
buffer_load_dwordx4 v[164:167], v7, s[8:11], s21 offen offset:1024 sc1
v_lshlrev_b32 v64, 16, v60
v_and_b32 v65, 0xffff0000, v60
v_lshlrev_b32 v66, 16, v61
v_and_b32 v67, 0xffff0000, v61
v_lshlrev_b32 v68, 16, v62
v_and_b32 v69, 0xffff0000, v62
v_lshlrev_b32 v70, 16, v63
v_and_b32 v71, 0xffff0000, v63
v_lshlrev_b32 v72, 16, v124
v_and_b32 v73, 0xffff0000, v124
v_pk_add_f32 v[232:233], v[232:233], v[72:73]
v_lshlrev_b32 v74, 16, v125
v_and_b32 v75, 0xffff0000, v125
v_pk_add_f32 v[234:235], v[234:235], v[74:75]
v_lshlrev_b32 v72, 16, v126
v_and_b32 v73, 0xffff0000, v126
v_pk_add_f32 v[240:241], v[240:241], v[72:73]
v_lshlrev_b32 v74, 16, v127
v_and_b32 v75, 0xffff0000, v127
v_pk_add_f32 v[242:243], v[242:243], v[74:75]
v_lshlrev_b32 v72, 16, v128
v_and_b32 v73, 0xffff0000, v128
v_pk_add_f32 v[236:237], v[236:237], v[72:73]
v_lshlrev_b32 v74, 16, v129
v_and_b32 v75, 0xffff0000, v129
v_pk_add_f32 v[238:239], v[238:239], v[74:75]
v_lshlrev_b32 v72, 16, v130
v_and_b32 v73, 0xffff0000, v130
v_pk_add_f32 v[244:245], v[244:245], v[72:73]
v_lshlrev_b32 v74, 16, v131
v_mov_b32 v79, v12
s_mov_b64 exec, 0x4
v_mov_b32 v79, 0
buffer_atomic_or v79, v13, s[8:11], s31 offen sc0
s_mov_b64 exec, -1
v_and_b32 v75, 0xffff0000, v131
v_pk_add_f32 v[246:247], v[246:247], v[74:75]
v_lshlrev_b32 v72, 16, v132
v_and_b32 v73, 0xffff0000, v132
v_pk_add_f32 v[64:65], v[64:65], v[72:73]
v_lshlrev_b32 v74, 16, v133
v_and_b32 v75, 0xffff0000, v133
v_pk_add_f32 v[66:67], v[66:67], v[74:75]
v_lshlrev_b32 v72, 16, v134
v_and_b32 v73, 0xffff0000, v134
v_pk_add_f32 v[68:69], v[68:69], v[72:73]
v_lshlrev_b32 v74, 16, v135
v_and_b32 v75, 0xffff0000, v135
v_pk_add_f32 v[70:71], v[70:71], v[74:75]
v_add_f32 v136, v136, v137
v_add_f32 v138, v138, v139
s_waitcnt vmcnt(7)
v_lshlrev_b32 v72, 16, v156
v_and_b32 v73, 0xffff0000, v156
v_pk_add_f32 v[64:65], v[64:65], v[72:73]
v_lshlrev_b32 v74, 16, v157
v_and_b32 v75, 0xffff0000, v157
v_pk_add_f32 v[66:67], v[66:67], v[74:75]
v_lshlrev_b32 v72, 16, v158
v_and_b32 v73, 0xffff0000, v158
v_pk_add_f32 v[68:69], v[68:69], v[72:73]
v_lshlrev_b32 v74, 16, v159
v_and_b32 v75, 0xffff0000, v159
v_pk_add_f32 v[70:71], v[70:71], v[74:75]
s_waitcnt vmcnt(6)
v_lshlrev_b32 v72, 16, v168
v_and_b32 v73, 0xffff0000, v168
v_pk_add_f32 v[64:65], v[64:65], v[72:73]
v_lshlrev_b32 v74, 16, v169
v_and_b32 v75, 0xffff0000, v169
v_pk_add_f32 v[66:67], v[66:67], v[74:75]
v_lshlrev_b32 v72, 16, v170
v_and_b32 v73, 0xffff0000, v170
v_pk_add_f32 v[68:69], v[68:69], v[72:73]
v_lshlrev_b32 v74, 16, v171
v_and_b32 v75, 0xffff0000, v171
v_pk_add_f32 v[70:71], v[70:71], v[74:75]
s_waitcnt vmcnt(5)
v_lshlrev_b32 v72, 16, v180
v_and_b32 v73, 0xffff0000, v180
v_pk_add_f32 v[64:65], v[64:65], v[72:73]
v_lshlrev_b32 v74, 16, v181
v_and_b32 v75, 0xffff0000, v181
v_pk_add_f32 v[66:67], v[66:67], v[74:75]
v_lshlrev_b32 v72, 16, v182
v_and_b32 v73, 0xffff0000, v182
v_pk_add_f32 v[68:69], v[68:69], v[72:73]
v_lshlrev_b32 v74, 16, v183
v_and_b32 v75, 0xffff0000, v183
v_pk_add_f32 v[70:71], v[70:71], v[74:75]
s_waitcnt vmcnt(0)
v_cmp_ne_u32 vcc, v12, v79
s_nop 1
s_cbranch_vccnz Lsp10
Lok10:
buffer_load_dwordx4 v[172:175], v4, s[8:11], s22 offen offset:2048 sc1
buffer_load_dwordx4 v[176:179], v7, s[8:11], s22 offen offset:2048 sc1
s_cmp_eq_u32 s13, 1
s_cbranch_scc1 Lfinal
s_mul_i32 s92, s7, 129024
s_mul_i32 s93, s3, 14336
s_add_u32 s92, s92, s93
s_add_u32 s92, s92, 73728
s_add_u32 s23, s23, 35389440
s_add_u32 s24, s24, 35389440
s_lshl_b32 s19, s42, 2
s_add_u32 s19, s19, s18
s_lshl_b32 s85, s19, 2
s_lshl_b32 s19, s19, 6
s_add_u32 s19, s19, s43
s_lshl_b32 s19, s19, 8
s_add_u32 s19, s19, 65798144
s_lshl_b32 s84, s43, 11
s_add_u32 s85, s85, s84
s_add_u32 s85, s85, 0x6200000
v_lshlrev_b32 v76, 4, v2
v_lshl_add_u32 v76, v3, 2, v76
v_lshlrev_b32 v78, 7, v1
v_cvt_pk_bf16_f32 v36, v64, v65
v_cvt_pk_bf16_f32 v37, v66, v67
v_cvt_pk_bf16_f32 v38, v68, v69
v_cvt_pk_bf16_f32 v39, v70, v71
buffer_store_dwordx4 v[36:39], v8, s[8:11], s24 offen sc1
v_pk_add_f32 v[52:53], v[64:65], v[66:67]
v_pk_mul_f32 v[54:55], v[64:65], v[64:65]
v_pk_fma_f32 v[54:55], v[66:67], v[66:67], v[54:55]
v_pk_add_f32 v[52:53], v[52:53], v[68:69]
v_pk_fma_f32 v[54:55], v[68:69], v[68:69], v[54:55]
v_pk_add_f32 v[52:53], v[52:53], v[70:71]
v_pk_fma_f32 v[54:55], v[70:71], v[70:71], v[54:55]
v_lshlrev_b32 v72, 16, v148
v_and_b32 v73, 0xffff0000, v148
v_pk_add_f32 v[232:233], v[232:233], v[72:73]
v_lshlrev_b32 v74, 16, v149
v_and_b32 v75, 0xffff0000, v149
v_pk_add_f32 v[234:235], v[234:235], v[74:75]
v_lshlrev_b32 v72, 16, v150
v_and_b32 v73, 0xffff0000, v150
v_pk_add_f32 v[240:241], v[240:241], v[72:73]
v_lshlrev_b32 v74, 16, v151
v_and_b32 v75, 0xffff0000, v151
v_pk_add_f32 v[242:243], v[242:243], v[74:75]
v_lshlrev_b32 v72, 16, v152
v_and_b32 v73, 0xffff0000, v152
v_pk_add_f32 v[236:237], v[236:237], v[72:73]
v_lshlrev_b32 v74, 16, v153
v_and_b32 v75, 0xffff0000, v153
v_pk_add_f32 v[238:239], v[238:239], v[74:75]
v_lshlrev_b32 v72, 16, v154
v_and_b32 v73, 0xffff0000, v154
v_pk_add_f32 v[244:245], v[244:245], v[72:73]
v_lshlrev_b32 v74, 16, v155
v_and_b32 v75, 0xffff0000, v155
v_pk_add_f32 v[246:247], v[246:247], v[74:75]
v_lshlrev_b32 v72, 16, v160
v_and_b32 v73, 0xffff0000, v160
v_pk_add_f32 v[232:233], v[232:233], v[72:73]
v_lshlrev_b32 v74, 16, v161
v_and_b32 v75, 0xffff0000, v161
v_pk_add_f32 v[234:235], v[234:235], v[74:75]
v_lshlrev_b32 v72, 16, v162
v_and_b32 v73, 0xffff0000, v162
v_pk_add_f32 v[240:241], v[240:241], v[72:73]
v_lshlrev_b32 v74, 16, v163
v_and_b32 v75, 0xffff0000, v163
v_pk_add_f32 v[242:243], v[242:243], v[74:75]
v_lshlrev_b32 v72, 16, v164
v_and_b32 v73, 0xffff0000, v164
v_pk_add_f32 v[236:237], v[236:237], v[72:73]
v_lshlrev_b32 v74, 16, v165
v_and_b32 v75, 0xffff0000, v165
v_pk_add_f32 v[238:239], v[238:239], v[74:75]
v_lshlrev_b32 v72, 16, v166
v_and_b32 v73, 0xffff0000, v166
v_pk_add_f32 v[244:245], v[244:245], v[72:73]
v_lshlrev_b32 v74, 16, v167
v_and_b32 v75, 0xffff0000, v167
v_pk_add_f32 v[246:247], v[246:247], v[74:75]
s_waitcnt vmcnt(2)
v_lshlrev_b32 v72, 16, v172
v_and_b32 v73, 0xffff0000, v172
v_pk_add_f32 v[232:233], v[232:233], v[72:73]
v_lshlrev_b32 v74, 16, v173
v_and_b32 v75, 0xffff0000, v173
v_pk_add_f32 v[234:235], v[234:235], v[74:75]
v_lshlrev_b32 v72, 16, v174
v_and_b32 v73, 0xffff0000, v174
v_pk_add_f32 v[240:241], v[240:241], v[72:73]
v_lshlrev_b32 v74, 16, v175
v_and_b32 v75, 0xffff0000, v175
v_pk_add_f32 v[242:243], v[242:243], v[74:75]
v_cvt_pk_bf16_f32 v28, v232, v233
v_cvt_pk_bf16_f32 v29, v234, v235
v_cvt_pk_bf16_f32 v30, v240, v241
v_cvt_pk_bf16_f32 v31, v242, v243
buffer_store_dwordx4 v[28:31], v4, s[8:11], s23 offen sc1
v_pk_add_f32 v[44:45], v[232:233], v[234:235]
v_pk_mul_f32 v[46:47], v[232:233], v[232:233]
v_pk_fma_f32 v[46:47], v[234:235], v[234:235], v[46:47]
v_pk_add_f32 v[44:45], v[44:45], v[240:241]
v_pk_fma_f32 v[46:47], v[240:241], v[240:241], v[46:47]
v_pk_add_f32 v[44:45], v[44:45], v[242:243]
v_pk_fma_f32 v[46:47], v[242:243], v[242:243], v[46:47]
s_waitcnt vmcnt(2)
v_lshlrev_b32 v72, 16, v176
v_and_b32 v73, 0xffff0000, v176
v_pk_add_f32 v[236:237], v[236:237], v[72:73]
v_lshlrev_b32 v74, 16, v177
v_and_b32 v75, 0xffff0000, v177
v_pk_add_f32 v[238:239], v[238:239], v[74:75]
v_lshlrev_b32 v72, 16, v178
v_and_b32 v73, 0xffff0000, v178
v_pk_add_f32 v[244:245], v[244:245], v[72:73]
v_lshlrev_b32 v74, 16, v179
v_and_b32 v75, 0xffff0000, v179
v_pk_add_f32 v[246:247], v[246:247], v[74:75]
v_cvt_pk_bf16_f32 v32, v236, v237
v_cvt_pk_bf16_f32 v33, v238, v239
v_cvt_pk_bf16_f32 v34, v244, v245
v_cvt_pk_bf16_f32 v35, v246, v247
buffer_store_dwordx4 v[32:35], v7, s[8:11], s23 offen sc1
v_pk_add_f32 v[48:49], v[236:237], v[238:239]
v_pk_mul_f32 v[50:51], v[236:237], v[236:237]
v_pk_fma_f32 v[50:51], v[238:239], v[238:239], v[50:51]
v_pk_add_f32 v[48:49], v[48:49], v[244:245]
v_pk_fma_f32 v[50:51], v[244:245], v[244:245], v[50:51]
v_pk_add_f32 v[48:49], v[48:49], v[246:247]
v_pk_fma_f32 v[50:51], v[246:247], v[246:247], v[50:51]
v_add_f32 v44, v44, v45
v_add_f32 v45, v46, v47
v_add_f32 v48, v48, v49
v_add_f32 v49, v50, v51
v_add_f32 v52, v52, v53
v_add_f32 v53, v54, v55
v_cndmask_b32 v46, 0, v52, s[26:27]
v_cndmask_b32 v47, 0, v53, s[26:27]
v_cndmask_b32 v50, 0, v52, s[28:29]
v_cndmask_b32 v51, 0, v53, s[28:29]
v_pk_add_f32 v[44:45], v[44:45], v[46:47]
v_pk_add_f32 v[48:49], v[48:49], v[50:51]
s_nop 0
v_permlane16_swap_b32 v44, v45
v_permlane16_swap_b32 v48, v49
v_add_f32 v44, v44, v45
v_add_f32 v48, v48, v49
s_nop 1
v_permlane32_swap_b32 v44, v48
v_add_f32 v44, v44, v48
buffer_store_dword v44, v76, s[8:11], s19 offen sc1
s_mul_i32 s84, s7, 448
s_add_u32 s84, s84, 28360704
v_and_b32 v77, 1, v3
v_lshl_add_u32 v9, v77, 13, v9
v_lshrrev_b32 v77, 1, v3
s_mov_b32 s86, 37748736
v_mul_lo_u32 v77, v77, s86
v_add_u32 v9, v9, v77
buffer_load_dword v240, v9, s[8:11], s84 offen offset:0 sc1
buffer_load_dword v241, v9, s[8:11], s84 offen offset:64 sc1
buffer_load_dword v242, v9, s[8:11], s84 offen offset:128 sc1
buffer_load_dword v243, v9, s[8:11], s84 offen offset:192 sc1
buffer_load_dword v244, v9, s[8:11], s84 offen offset:256 sc1
buffer_load_dword v245, v9, s[8:11], s84 offen offset:320 sc1
buffer_load_dword v246, v9, s[8:11], s84 offen offset:384 sc1
s_add_u32 m0, s93, 0
s_nop 0
buffer_load_dwordx4 v4, s[8:11], s92 offen offset:0 sc1 lds
buffer_load_dwordx4 v4, s[8:11], s92 offen offset:1024 sc1 lds
buffer_load_dwordx4 v4, s[8:11], s92 offen offset:2048 sc1 lds
buffer_load_dwordx4 v4, s[8:11], s92 offen offset:3072 sc1 lds
s_add_u32 s92, s92, 4096
s_add_u32 m0, s93, 4096
s_nop 0
buffer_load_dwordx4 v4, s[8:11], s92 offen offset:0 sc1 lds
buffer_load_dwordx4 v4, s[8:11], s92 offen offset:1024 sc1 lds
s_add_u32 s12, s12, 37748736
s_add_u32 s13, s13, 1
s_mov_b32 s16, s6
s_mov_b32 s17, s7
s_lshl_b32 s18, s16, 2
s_add_u32 s18, s18, s3
s_mul_i32 s20, s18, 36864
s_add_u32 s20, s20, s12
s_add_u32 s21, s20, 18432
v_add_u32 v5, 0x10000, v4
v_add_u32 v26, 0x20000, v4
v_lshrrev_b32 v9, 4, v0
v_subrev_u32 v11, 160, v0
v_lshrrev_b32 v20, 1, v11
v_cmp_gt_u32 s[42:43], 64, v11
s_mov_b32 s24, 0xB3A266
v_lshrrev_b32 v22, 2, v2
v_cndmask_b32 v9, v9, v20, s[42:43]
v_lshlrev_b32 v20, 2, v9
v_lshrrev_b32 v20, v20, s24
v_and_b32 v20, 15, v20
v_lshrrev_b32 v21, v9, 50
v_and_b32 v21, 1, v21
v_lshlrev_b32 v22, 8, v22
v_and_b32 v23, 3, v2
v_lshl_add_u32 v22, v23, 2, v22
v_lshl_add_u32 v22, v21, 10, v22
v_add_u32 v22, 2048, v22
v_and_b32 v23, 1, v0
v_lshlrev_b32 v24, 9, v23
v_lshl_add_u32 v24, v21, 2, v24
v_add_u32 v24, 6144, v24
v_cndmask_b32 v22, v22, v24, s[42:43]
v_lshl_add_u32 v22, v20, 4, v22
v_subrev_u32 v11, 96, v0
v_cmp_gt_u32 vcc, 64, v11
v_lshrrev_b32 v24, 5, v11
v_lshlrev_b32 v24, 9, v24
v_bfe_u32 v25, v11, 1, 4
v_lshl_add_u32 v24, v25, 4, v24
v_mul_u32_u24 v25, 1028, v23
v_add_u32 v24, v24, v25
v_add_u32 v24, 4096, v24
v_cndmask_b32 v6, v22, v24, vcc
v_and_b32 v6, 0x1fff, v6
v_add_u32 v27, 147456, v6
v_add_u32 v6, 55296, v6
s_and_b32 s24, s3, 1
s_mul_i32 s24, s24, 7168
s_lshr_b32 s25, s3, 1
s_mul_i32 s25, s25, 92160
s_add_u32 s24, s24, s25
s_add_u32 s24, s24, 55296
v_add_u32 v7, s24, v4
v_cmp_gt_u32 vcc, 172, v0
v_lshlrev_b32 v9, 2, v0
v_add_u32 v8, 55296, v9
v_add_u32 v28, 147456, v9
v_cndmask_b32 v10, v14, v9, vcc
v_and_b32 v20, 7, v1
v_cmp_gt_u32 s[44:45], 2, v20
v_cmp_eq_u32 s[46:47], 6, v2
v_mov_b32 v218, 0xff800000
v_mov_b32 v219, 0x358637bd
s_or_b64 s[44:45], s[44:45], s[46:47]
v_cndmask_b32 v219, v218, v219, s[44:45]
v_cndmask_b32 v218, v218, 0, s[44:45]
s_waitcnt vmcnt(13)
s_mov_b64 exec, 0xffff
buffer_store_dword v12, v78, s[8:11], s85 offen sc1
s_mov_b64 exec, -1
v_and_b32 v21, 16, v1
v_cmp_ne_u32 vcc, 0, v21
v_lshrrev_b32 v20, 5, v1
v_lshl_add_u32 v20, v20, 4, v2
v_lshlrev_b32 v20, 3, v20
v_cndmask_b32 v11, v14, v20, vcc
s_mul_i32 s25, s17, 2816
s_add_u32 s25, s25, s12
s_add_u32 s25, s25, 7340032
buffer_load_dwordx4 v4, s[8:11], s92 offen offset:2048 sc1 lds
s_lshl_b32 s26, s18, 15
s_lshl_b32 s27, s17, 10
s_add_u32 s26, s26, s27
s_add_u32 s26, s26, s12
s_add_u32 s26, s26, 4718592
s_add_u32 s28, s26, 16384
s_lshl_b32 s27, s18, 4
s_add_u32 s27, s27, s17
buffer_load_dwordx4 v4, s[8:11], s92 offen offset:3072 sc1 lds
s_lshl_b32 s27, s27, 8
s_add_u32 s27, s27, s12
s_add_u32 s27, s27, 6815744
s_lshl_b32 s32, s13, 21
s_add_u32 s32, s32, 0x6020000
s_lshl_b32 s33, s2, 9
s_add_u32 s32, s32, s33
s_cmp_eq_u32 s3, 0
s_cselect_b64 vcc, -1, 0
s_add_u32 s92, s92, 4096
v_cndmask_b32 v29, v14, v13, vcc
s_and_b32 s39, s15, 3
s_mul_i32 s39, s39, 9
s_lshl_b32 s34, s3, 1
s_add_u32 s34, s34, s39
s_mul_i32 s34, s34, 18432
s_add_u32 s34, s34, 2097152
s_add_u32 s35, s34, 18432
s_mul_i32 s39, s39, 18432
s_add_u32 m0, s93, 8192
s_add_u32 s39, s39, 2244608
s_lshl_b32 s36, s3, 12
s_add_u32 s36, s36, s39
s_lshr_b32 s37, s3, 1
s_lshl_b32 s37, s37, 10
s_add_u32 s37, s37, s39
s_and_b32 s38, s3, 1
s_lshl_b32 s38, s38, 3
buffer_load_dwordx4 v4, s[8:11], s92 offen offset:0 sc1 lds
s_add_u32 s37, s37, s38
s_add_u32 s37, s37, 16384
v_lshlrev_b32 v214, 7, v3
v_lshl_add_u32 v214, v2, 4, v214
v_cmp_gt_u32 vcc, 2, v2
s_lshl_b32 s40, s3, 11
s_add_u32 s40, s40, 2760704
v_cndmask_b32 v214, v14, v214, vcc
buffer_load_dwordx4 v4, s[8:11], s92 offen offset:1024 sc1 lds
s_lshr_b32 s41, s3, 1
s_lshl_b32 s41, s41, 9
s_add_u32 s41, s41, s38
s_add_u32 s41, s41, 2768896
s_mov_b32 s31, 0x6200000
s_lshl_b32 s30, s18, 4
s_add_u32 s30, s30, s17
s_lshl_b32 s30, s30, 7
s_add_u32 s31, s31, s30
buffer_load_dwordx4 v4, s[8:11], s92 offen offset:2048 sc1 lds
s_lshl_b32 s29, s18, 8
s_add_u32 s29, s29, 65798144
v_lshlrev_b32 v238, 16, v3
v_lshl_add_u32 v238, v2, 4, v238
v_lshlrev_b32 v239, 4, v3
v_and_b32 v212, 1, v3
v_cmp_eq_u32 s[54:55], 1, v212
s_lshr_b32 s30, s7, 2
buffer_load_dwordx4 v4, s[8:11], s92 offen offset:3072 sc1 lds
s_cmp_eq_u32 s30, s3
s_cselect_b32 s30, 32, 0
v_cmp_gt_u32 vcc, s30, v1
s_lshl_b32 s30, s18, 9
s_add_u32 s30, s30, 66125824
v_cndmask_b32 v212, v14, v4, vcc
s_waitcnt vmcnt(19)
v_cvt_pk_bf16_f32 v220, v240, v240
s_waitcnt vmcnt(18)
v_cvt_pk_bf16_f32 v222, v241, v241
s_waitcnt vmcnt(17)
v_cvt_pk_bf16_f32 v224, v242, v242
s_add_u32 s92, s92, 4096
s_waitcnt vmcnt(16)
v_cvt_pk_bf16_f32 v226, v243, v243
s_waitcnt vmcnt(15)
v_cvt_pk_bf16_f32 v228, v244, v244
s_waitcnt vmcnt(14)
v_cvt_pk_bf16_f32 v230, v245, v245
s_waitcnt vmcnt(13)
v_cvt_pk_bf16_f32 v232, v246, v246
v_and_b32 v248, 0xffff0000, v220
v_and_b32 v249, 0xffff0000, v222
v_and_b32 v250, 0xffff0000, v224
v_and_b32 v251, 0xffff0000, v226
v_and_b32 v252, 0xffff0000, v228
s_add_u32 m0, s93, 12288
v_and_b32 v253, 0xffff0000, v230
v_and_b32 v254, 0xffff0000, v232
v_sub_f32 v240, v240, v248
v_sub_f32 v241, v241, v249
v_sub_f32 v242, v242, v250
v_sub_f32 v243, v243, v251
v_sub_f32 v244, v244, v252
v_sub_f32 v245, v245, v253
buffer_load_dwordx4 v4, s[8:11], s92 offen offset:0 sc1 lds
v_sub_f32 v246, v246, v254
v_cvt_pk_bf16_f32 v221, v240, 0
v_cvt_pk_bf16_f32 v223, v241, 0
v_cvt_pk_bf16_f32 v225, v242, 0
v_cvt_pk_bf16_f32 v227, v243, 0
v_cvt_pk_bf16_f32 v229, v244, 0
v_cvt_pk_bf16_f32 v231, v245, 0
v_cvt_pk_bf16_f32 v233, v246, 0
buffer_load_dwordx4 v4, s[8:11], s92 offen offset:1024 sc1 lds
v_mov_b32 v213, v12
s_mov_b64 exec, 0xffff
v_mov_b32 v213, 0
buffer_atomic_or v213, v13, s[8:11], s31 offen sc0
s_mov_b64 exec, -1
s_waitcnt vmcnt(0)
v_cmp_ne_u32 vcc, v12, v213
s_nop 1
s_cbranch_vccnz Lsp11
Lok11:
s_barrier
buffer_load_dwordx4 a[0:3], v4, s[8:11], s20 offen offset:0 sc1
buffer_load_dwordx4 a[4:7], v4, s[8:11], s21 offen offset:0 sc1
buffer_load_dwordx4 a[8:11], v4, s[8:11], s20 offen offset:1024 sc1
buffer_load_dwordx4 a[12:15], v4, s[8:11], s21 offen offset:1024 sc1
ds_read_b128 v[96:99], v5 offset:8192
ds_read_b128 v[100:103], v5 offset:9216
ds_read_b128 v[104:107], v5 offset:10240
ds_read_b128 v[108:111], v5 offset:11264
ds_read_b128 v[112:115], v5 offset:12288
ds_read_b128 v[116:119], v5 offset:13312
ds_read_b128 v[120:123], v5 offset:14336
ds_read_b128 v[124:127], v5 offset:15360
buffer_load_dwordx4 v[240:243], v238, s[8:11], s29 offen sc1
s_add_u32 s29, s29, 16384
buffer_load_dwordx4 v[244:247], v238, s[8:11], s29 offen sc1
s_add_u32 s29, s29, 16384
buffer_load_dwordx4 v[248:251], v238, s[8:11], s29 offen sc1
s_add_u32 s29, s29, 16384
buffer_load_dwordx4 v[252:255], v238, s[8:11], s29 offen sc1
s_add_u32 s29, s29, 16384
buffer_load_dwordx4 a[16:19], v4, s[8:11], s20 offen offset:2048 sc1
buffer_load_dwordx4 a[20:23], v4, s[8:11], s21 offen offset:2048 sc1
buffer_load_dwordx4 a[24:27], v4, s[8:11], s20 offen offset:3072 sc1
buffer_load_dwordx4 a[28:31], v4, s[8:11], s21 offen offset:3072 sc1
s_add_u32 s20, s20, 4096
s_add_u32 s21, s21, 4096
buffer_load_dwordx4 a[32:35], v4, s[8:11], s20 offen offset:0 sc1
buffer_load_dwordx4 a[36:39], v4, s[8:11], s21 offen offset:0 sc1
buffer_load_dwordx4 a[40:43], v4, s[8:11], s20 offen offset:1024 sc1
buffer_load_dwordx4 a[44:47], v4, s[8:11], s21 offen offset:1024 sc1
s_waitcnt vmcnt(12) lgkmcnt(4)
v_mfma_f32_16x16x32_bf16 v[32:35], a[0:3], v[96:99], 0
ds_read_b128 v[128:131], v5 offset:16384
v_mfma_f32_16x16x32_bf16 v[32:35], a[8:11], v[100:103], v[32:35]
buffer_load_dwordx4 a[48:51], v4, s[8:11], s20 offen offset:2048 sc1
v_mfma_f32_16x16x32_bf16 v[36:39], a[4:7], v[96:99], 0
ds_read_b128 v[132:135], v5 offset:17408
v_mfma_f32_16x16x32_bf16 v[36:39], a[12:15], v[100:103], v[36:39]
v_mfma_f32_16x16x32_bf16 v[40:43], a[0:3], v[104:107], 0
ds_read_b128 v[136:139], v5 offset:18432
s_waitcnt vmcnt(11)
v_add_f32 v240, v240, v244
s_waitcnt vmcnt(9)
v_add_f32 v248, v248, v252
v_mfma_f32_16x16x32_bf16 v[40:43], a[8:11], v[108:111], v[40:43]
buffer_load_dwordx4 a[52:55], v4, s[8:11], s21 offen offset:2048 sc1
v_mfma_f32_16x16x32_bf16 v[44:47], a[4:7], v[104:107], 0
ds_read_b128 v[140:143], v5 offset:19456
v_add_f32 v241, v241, v245
v_mfma_f32_16x16x32_bf16 v[44:47], a[12:15], v[108:111], v[44:47]
s_waitcnt lgkmcnt(4)
v_add_f32 v249, v249, v253
v_add_f32 v242, v242, v246
v_mfma_f32_16x16x32_bf16 v[64:67], a[0:3], v[112:115], 0
ds_read_b128 v[96:99], v5 offset:20480
v_add_f32 v250, v250, v254
v_mfma_f32_16x16x32_bf16 v[64:67], a[8:11], v[116:119], v[64:67]
buffer_load_dwordx4 a[56:59], v4, s[8:11], s20 offen offset:3072 sc1
v_add_f32 v243, v243, v247
v_mfma_f32_16x16x32_bf16 v[68:71], a[4:7], v[112:115], 0
ds_read_b128 v[100:103], v5 offset:21504
v_add_f32 v251, v251, v255
v_mfma_f32_16x16x32_bf16 v[68:71], a[12:15], v[116:119], v[68:71]
v_add_f32 v240, v240, v248
v_add_f32 v241, v241, v249
v_mfma_f32_16x16x32_bf16 v[88:91], v[112:115], a[0:3], 0
v_add_f32 v242, v242, v250
v_add_f32 v243, v243, v251
v_mfma_f32_16x16x32_bf16 v[88:91], v[116:119], a[8:11], v[88:91]
v_mov_b32 v244, v240
v_mov_b32 v245, v241
v_mfma_f32_16x16x32_bf16 v[92:95], v[112:115], a[4:7], 0
buffer_load_dwordx4 a[60:63], v4, s[8:11], s21 offen offset:3072 sc1
v_mfma_f32_16x16x32_bf16 v[92:95], v[116:119], a[12:15], v[92:95]
s_waitcnt vmcnt(8)
v_permlane16_swap_b32 v240, v244
v_mov_b32 v246, v242
v_mfma_f32_16x16x32_bf16 v[32:35], a[16:19], v[120:123], v[32:35]
s_add_u32 s20, s20, 4096
ds_read_b128 v[104:107], v5 offset:22528
v_mov_b32 v247, v243
v_mfma_f32_16x16x32_bf16 v[32:35], a[24:27], v[124:127], v[32:35]
s_add_u32 s21, s21, 4096
v_permlane16_swap_b32 v241, v245
v_mfma_f32_16x16x32_bf16 v[36:39], a[20:23], v[120:123], v[36:39]
ds_read_b128 v[108:111], v5 offset:23552
v_add_f32 v240, v240, v244
v_mfma_f32_16x16x32_bf16 v[36:39], a[28:31], v[124:127], v[36:39]
s_waitcnt lgkmcnt(4)
buffer_load_dwordx4 a[64:67], v4, s[8:11], s20 offen offset:0 sc1
v_mfma_f32_16x16x32_bf16 v[40:43], a[16:19], v[128:131], v[40:43]
ds_read_b128 v[112:115], v5 offset:24576
v_add_f32 v241, v241, v245
v_mfma_f32_16x16x32_bf16 v[40:43], a[24:27], v[132:135], v[40:43]
buffer_load_dwordx4 a[68:71], v4, s[8:11], s21 offen offset:0 sc1
v_mov_b32 v244, v240
v_mfma_f32_16x16x32_bf16 v[44:47], a[20:23], v[128:131], v[44:47]
ds_read_b128 v[116:119], v5 offset:25600
v_mov_b32 v245, v241
v_mfma_f32_16x16x32_bf16 v[44:47], a[28:31], v[132:135], v[44:47]
v_permlane16_swap_b32 v242, v246
v_mfma_f32_16x16x32_bf16 v[64:67], a[16:19], v[136:139], v[64:67]
ds_read_b128 v[120:123], v5 offset:26624
v_add_f32 v242, v242, v246
v_mfma_f32_16x16x32_bf16 v[64:67], a[24:27], v[140:143], v[64:67]
v_permlane16_swap_b32 v243, v247
v_mfma_f32_16x16x32_bf16 v[68:71], a[20:23], v[136:139], v[68:71]
ds_read_b128 v[124:127], v5 offset:27648
v_add_f32 v243, v243, v247
v_mfma_f32_16x16x32_bf16 v[68:71], a[28:31], v[140:143], v[68:71]
buffer_load_dwordx4 a[72:75], v4, s[8:11], s20 offen offset:1024 sc1
v_mov_b32 v246, v242
v_mfma_f32_16x16x32_bf16 v[88:91], v[136:139], a[16:19], v[88:91]
v_permlane32_swap_b32 v240, v244
v_mfma_f32_16x16x32_bf16 v[88:91], v[140:143], a[24:27], v[88:91]
v_permlane32_swap_b32 v241, v245
v_mfma_f32_16x16x32_bf16 v[92:95], v[136:139], a[20:23], v[92:95]
v_permlane32_swap_b32 v242, v246
v_mfma_f32_16x16x32_bf16 v[92:95], v[140:143], a[28:31], v[92:95]
s_waitcnt vmcnt(7) lgkmcnt(4)
buffer_load_dwordx4 a[76:79], v4, s[8:11], s21 offen offset:1024 sc1
v_mfma_f32_16x16x32_bf16 v[32:35], a[32:35], v[96:99], v[32:35]
ds_read_b128 v[128:131], v5 offset:28672
v_mov_b32 v247, v243
v_mfma_f32_16x16x32_bf16 v[32:35], a[40:43], v[100:103], v[32:35]
s_nop 0
v_permlane32_swap_b32 v243, v247
v_add_f32 v240, v240, v244
v_mfma_f32_16x16x32_bf16 v[36:39], a[36:39], v[96:99], v[36:39]
ds_read_b128 v[132:135], v5 offset:29696
v_add_f32 v241, v241, v245
v_mfma_f32_16x16x32_bf16 v[36:39], a[44:47], v[100:103], v[36:39]
buffer_load_dwordx4 a[80:83], v4, s[8:11], s20 offen offset:2048 sc1
v_mfma_f32_16x16x32_bf16 v[40:43], a[32:35], v[104:107], v[40:43]
ds_read_b128 v[136:139], v5 offset:30720
v_add_f32 v242, v242, v246
v_mfma_f32_16x16x32_bf16 v[40:43], a[40:43], v[108:111], v[40:43]
v_add_f32 v243, v243, v247
v_mul_f32 v240, 0xbae38e39, v240
v_mfma_f32_16x16x32_bf16 v[44:47], a[36:39], v[104:107], v[44:47]
ds_read_b128 v[140:143], v5 offset:31744
v_mul_f32 v241, 0x3ae38e39, v241
v_cvt_pk_bf16_f32 v235, v240, 0
v_mfma_f32_16x16x32_bf16 v[44:47], a[44:47], v[108:111], v[44:47]
s_waitcnt lgkmcnt(4)
buffer_load_dwordx4 a[84:87], v4, s[8:11], s21 offen offset:2048 sc1
v_mfma_f32_16x16x32_bf16 v[64:67], a[32:35], v[112:115], v[64:67]
ds_read_b128 v[96:99], v5 offset:32768
v_fma_f32 v241, -v240, v240, v241
v_mfma_f32_16x16x32_bf16 v[64:67], a[40:43], v[116:119], v[64:67]
v_lshlrev_b32 v244, 16, v235
v_max_f32 v241, 0, v241
v_mfma_f32_16x16x32_bf16 v[68:71], a[36:39], v[112:115], v[68:71]
ds_read_b128 v[100:103], v5 offset:33792
v_sub_f32 v244, v240, v244
v_mfma_f32_16x16x32_bf16 v[68:71], a[44:47], v[116:119], v[68:71]
v_add_f32 v241, 0x3727c5ac, v241
v_cvt_pk_bf16_f32 v234, v240, v244
v_mfma_f32_16x16x32_bf16 v[88:91], v[112:115], a[32:35], v[88:91]
buffer_load_dwordx4 a[88:91], v4, s[8:11], s20 offen offset:3072 sc1
v_mul_f32 v242, 0xbae38e39, v242
v_mfma_f32_16x16x32_bf16 v[88:91], v[116:119], a[40:43], v[88:91]
v_rsq_f32 v24, v241
v_mfma_f32_16x16x32_bf16 v[92:95], v[112:115], a[36:39], v[92:95]
v_mul_f32 v243, 0x3ae38e39, v243
v_cvt_pk_bf16_f32 v237, v242, 0
v_mfma_f32_16x16x32_bf16 v[92:95], v[116:119], a[44:47], v[92:95]
s_waitcnt vmcnt(7)
v_fma_f32 v243, -v242, v242, v243
v_lshlrev_b32 v246, 16, v237
v_mfma_f32_16x16x32_bf16 v[32:35], a[48:51], v[120:123], v[32:35]
ds_read_b128 v[104:107], v5 offset:34816
v_max_f32 v243, 0, v243
v_mfma_f32_16x16x32_bf16 v[32:35], a[56:59], v[124:127], v[32:35]
buffer_load_dwordx4 a[92:95], v4, s[8:11], s21 offen offset:3072 sc1
v_mfma_f32_16x16x32_bf16 v[36:39], a[52:55], v[120:123], v[36:39]
s_add_u32 s20, s20, 4096
ds_read_b128 v[108:111], v5 offset:35840
v_sub_f32 v246, v242, v246
v_add_f32 v243, 0x3727c5ac, v243
v_mfma_f32_16x16x32_bf16 v[36:39], a[60:63], v[124:127], v[36:39]
s_waitcnt lgkmcnt(4)
v_rsq_f32 v25, v243
v_mfma_f32_16x16x32_bf16 v[40:43], a[48:51], v[128:131], v[40:43]
s_add_u32 s21, s21, 4096
ds_read_b128 v[112:115], v5 offset:36864
v_cvt_pk_bf16_f32 v236, v242, v246
v_mfma_f32_16x16x32_bf16 v[40:43], a[56:59], v[132:135], v[40:43]
buffer_load_dwordx4 a[96:99], v4, s[8:11], s20 offen offset:0 sc1
v_mfma_f32_16x16x32_bf16 v[44:47], a[52:55], v[128:131], v[44:47]
ds_read_b128 v[116:119], v5 offset:37888
v_cndmask_b32 v248, -v240, -v242, s[54:55]
v_mfma_f32_16x16x32_bf16 v[44:47], a[60:63], v[132:135], v[44:47]
ds_bpermute_b32 v16, v239, v24 offset:0
v_mov_b32 v249, v248
v_mfma_f32_16x16x32_bf16 v[64:67], a[48:51], v[136:139], v[64:67]
ds_read_b128 v[120:123], v5 offset:38912
ds_bpermute_b32 v17, v239, v24 offset:4
ds_bpermute_b32 v18, v239, v24 offset:8
v_mfma_f32_16x16x32_bf16 v[64:67], a[56:59], v[140:143], v[64:67]
buffer_load_dwordx4 a[100:103], v4, s[8:11], s21 offen offset:0 sc1
v_mfma_f32_16x16x32_bf16 v[68:71], a[52:55], v[136:139], v[68:71]
ds_read_b128 v[124:127], v5 offset:39936
ds_bpermute_b32 v19, v239, v24 offset:12
v_mfma_f32_16x16x32_bf16 v[68:71], a[60:63], v[140:143], v[68:71]
ds_bpermute_b32 v20, v239, v25 offset:0
ds_bpermute_b32 v21, v239, v25 offset:4
v_mfma_f32_16x16x32_bf16 v[88:91], v[136:139], a[48:51], v[88:91]
ds_bpermute_b32 v22, v239, v25 offset:8
ds_bpermute_b32 v23, v239, v25 offset:12
v_mfma_f32_16x16x32_bf16 v[88:91], v[140:143], a[56:59], v[88:91]
buffer_store_dwordx4 v[248:251], v212, s[8:11], s30 offen sc1
v_mfma_f32_16x16x32_bf16 v[92:95], v[136:139], a[52:55], v[92:95]
buffer_load_dwordx4 a[104:107], v4, s[8:11], s20 offen offset:1024 sc1
v_mfma_f32_16x16x32_bf16 v[92:95], v[140:143], a[60:63], v[92:95]
v_mfma_f32_16x16x16_bf16 v[40:43], v[234:235], v[222:223], v[40:43]
v_mfma_f32_16x16x16_bf16 v[44:47], v[236:237], v[222:223], v[44:47]
v_mfma_f32_16x16x16_bf16 v[56:59], v[234:235], v[226:227], 0
buffer_load_dwordx4 a[108:111], v4, s[8:11], s21 offen offset:1024 sc1
v_mfma_f32_16x16x16_bf16 v[60:63], v[236:237], v[226:227], 0
v_mfma_f32_16x16x16_bf16 v[80:83], v[230:231], v[234:235], 0
v_mfma_f32_16x16x16_bf16 v[84:87], v[230:231], v[236:237], 0
s_waitcnt vmcnt(9) lgkmcnt(12)
v_mfma_f32_16x16x32_bf16 v[32:35], a[64:67], v[96:99], v[32:35]
ds_read_b128 v[128:131], v5 offset:40960
v_mfma_f32_16x16x32_bf16 v[32:35], a[72:75], v[100:103], v[32:35]
buffer_load_dwordx4 a[112:115], v4, s[8:11], s20 offen offset:2048 sc1
v_mfma_f32_16x16x32_bf16 v[36:39], a[68:71], v[96:99], v[36:39]
ds_read_b128 v[132:135], v5 offset:41984
v_mfma_f32_16x16x32_bf16 v[36:39], a[76:79], v[100:103], v[36:39]
v_mfma_f32_16x16x16_bf16 v[64:67], v[234:235], v[232:233], v[64:67]
v_mfma_f32_16x16x16_bf16 v[68:71], v[236:237], v[232:233], v[68:71]
buffer_load_dwordx4 a[116:119], v4, s[8:11], s21 offen offset:2048 sc1
v_mfma_f32_16x16x16_bf16 v[88:91], v[232:233], v[234:235], v[88:91]
v_mfma_f32_16x16x16_bf16 v[92:95], v[232:233], v[236:237], v[92:95]
v_mfma_f32_16x16x16_bf16 v[72:75], v[228:229], v[234:235], 0
v_mfma_f32_16x16x16_bf16 v[76:79], v[228:229], v[236:237], 0
buffer_load_dwordx4 a[120:123], v4, s[8:11], s20 offen offset:3072 sc1
v_mfma_f32_16x16x32_bf16 v[40:43], a[64:67], v[104:107], v[40:43]
ds_read_b128 v[136:139], v5 offset:43008
v_mfma_f32_16x16x32_bf16 v[40:43], a[72:75], v[108:111], v[40:43]
v_mfma_f32_16x16x32_bf16 v[44:47], a[68:71], v[104:107], v[44:47]
ds_read_b128 v[140:143], v5 offset:44032
v_mfma_f32_16x16x32_bf16 v[44:47], a[76:79], v[108:111], v[44:47]
v_mfma_f32_16x16x16_bf16 v[32:35], v[234:235], v[220:221], v[32:35]
buffer_load_dwordx4 a[124:127], v4, s[8:11], s21 offen offset:3072 sc1
v_mfma_f32_16x16x16_bf16 v[36:39], v[236:237], v[220:221], v[36:39]
s_add_u32 s20, s20, 4096
v_mfma_f32_16x16x16_bf16 v[48:51], v[234:235], v[224:225], 0
s_add_u32 s21, s21, 4096
v_mfma_f32_16x16x16_bf16 v[52:55], v[236:237], v[224:225], 0
s_waitcnt lgkmcnt(9)
buffer_load_dwordx4 a[128:131], v4, s[8:11], s20 offen offset:0 sc1
v_mfma_f32_16x16x32_bf16 v[64:67], a[64:67], v[112:115], v[64:67]
ds_read_b128 v[96:99], v5 offset:45056
v_mfma_f32_16x16x32_bf16 v[64:67], a[72:75], v[116:119], v[64:67]
v_mfma_f32_16x16x32_bf16 v[68:71], a[68:71], v[112:115], v[68:71]
ds_read_b128 v[100:103], v5 offset:46080
v_mfma_f32_16x16x32_bf16 v[68:71], a[76:79], v[116:119], v[68:71]
v_mfma_f32_16x16x32_bf16 v[88:91], v[112:115], a[64:67], v[88:91]
v_mfma_f32_16x16x32_bf16 v[88:91], v[116:119], a[72:75], v[88:91]
buffer_load_dwordx4 a[132:135], v4, s[8:11], s21 offen offset:0 sc1
v_mfma_f32_16x16x32_bf16 v[92:95], v[112:115], a[68:71], v[92:95]
v_mfma_f32_16x16x32_bf16 v[92:95], v[116:119], a[76:79], v[92:95]
s_waitcnt vmcnt(11)
v_mfma_f32_16x16x32_bf16 v[32:35], a[80:83], v[120:123], v[32:35]
ds_read_b128 v[104:107], v5 offset:47104
buffer_load_dwordx4 a[144:147], v4, s[8:11], s34 offen offset:0 sc1
v_mfma_f32_16x16x32_bf16 v[32:35], a[88:91], v[124:127], v[32:35]
buffer_load_dwordx4 a[136:139], v4, s[8:11], s20 offen offset:1024 sc1
v_mfma_f32_16x16x32_bf16 v[36:39], a[84:87], v[120:123], v[36:39]
ds_read_b128 v[108:111], v5 offset:48128
v_mfma_f32_16x16x32_bf16 v[36:39], a[92:95], v[124:127], v[36:39]
s_waitcnt lgkmcnt(4)
v_mfma_f32_16x16x32_bf16 v[40:43], a[80:83], v[128:131], v[40:43]
ds_read_b128 v[112:115], v5 offset:49152
v_mfma_f32_16x16x32_bf16 v[40:43], a[88:91], v[132:135], v[40:43]
buffer_load_dwordx4 a[140:143], v4, s[8:11], s21 offen offset:1024 sc1
v_mfma_f32_16x16x32_bf16 v[44:47], a[84:87], v[128:131], v[44:47]
ds_read_b128 v[116:119], v5 offset:50176
v_mfma_f32_16x16x32_bf16 v[44:47], a[92:95], v[132:135], v[44:47]
buffer_load_dwordx4 a[148:151], v4, s[8:11], s35 offen offset:0 sc1
v_mfma_f32_16x16x32_bf16 v[64:67], a[80:83], v[136:139], v[64:67]
ds_read_b128 v[120:123], v5 offset:51200
v_mfma_f32_16x16x32_bf16 v[64:67], a[88:91], v[140:143], v[64:67]
v_mfma_f32_16x16x32_bf16 v[68:71], a[84:87], v[136:139], v[68:71]
ds_read_b128 v[124:127], v5 offset:52224
v_mfma_f32_16x16x32_bf16 v[68:71], a[92:95], v[140:143], v[68:71]
buffer_load_dwordx4 a[152:155], v4, s[8:11], s34 offen offset:1024 sc1
v_mfma_f32_16x16x32_bf16 v[88:91], v[136:139], a[80:83], v[88:91]
v_mfma_f32_16x16x32_bf16 v[88:91], v[140:143], a[88:91], v[88:91]
v_mfma_f32_16x16x32_bf16 v[92:95], v[136:139], a[84:87], v[92:95]
v_mfma_f32_16x16x32_bf16 v[92:95], v[140:143], a[92:95], v[92:95]
s_waitcnt vmcnt(11) lgkmcnt(4)
buffer_load_dwordx4 a[156:159], v4, s[8:11], s35 offen offset:1024 sc1
v_mfma_f32_16x16x32_bf16 v[32:35], a[96:99], v[96:99], v[32:35]
ds_read_b128 v[128:131], v5 offset:53248
v_mfma_f32_16x16x32_bf16 v[32:35], a[104:107], v[100:103], v[32:35]
v_mfma_f32_16x16x32_bf16 v[36:39], a[100:103], v[96:99], v[36:39]
ds_read_b128 v[132:135], v5 offset:54272
v_mfma_f32_16x16x32_bf16 v[36:39], a[108:111], v[100:103], v[36:39]
v_mfma_f32_16x16x32_bf16 v[40:43], a[96:99], v[104:107], v[40:43]
ds_read_b128 v[136:139], v5 offset:55296
v_mfma_f32_16x16x32_bf16 v[40:43], a[104:107], v[108:111], v[40:43]
buffer_load_dwordx4 a[160:163], v4, s[8:11], s34 offen offset:2048 sc1
v_mfma_f32_16x16x32_bf16 v[44:47], a[100:103], v[104:107], v[44:47]
ds_read_b128 v[140:143], v5 offset:56320
v_mfma_f32_16x16x32_bf16 v[44:47], a[108:111], v[108:111], v[44:47]
s_waitcnt lgkmcnt(4)
v_mfma_f32_16x16x32_bf16 v[64:67], a[96:99], v[112:115], v[64:67]
ds_read_b128 v[96:99], v5 offset:57344
v_mfma_f32_16x16x32_bf16 v[64:67], a[104:107], v[116:119], v[64:67]
buffer_load_dwordx4 a[164:167], v4, s[8:11], s35 offen offset:2048 sc1
v_mfma_f32_16x16x32_bf16 v[68:71], a[100:103], v[112:115], v[68:71]
ds_read_b128 v[100:103], v5 offset:58368
v_mfma_f32_16x16x32_bf16 v[68:71], a[108:111], v[116:119], v[68:71]
v_mfma_f32_16x16x32_bf16 v[88:91], v[112:115], a[96:99], v[88:91]
v_mfma_f32_16x16x32_bf16 v[88:91], v[116:119], a[104:107], v[88:91]
v_mfma_f32_16x16x32_bf16 v[92:95], v[112:115], a[100:103], v[92:95]
v_mfma_f32_16x16x32_bf16 v[92:95], v[116:119], a[108:111], v[92:95]
s_waitcnt vmcnt(10)
buffer_load_dwordx4 a[168:171], v4, s[8:11], s34 offen offset:3072 sc1
v_mfma_f32_16x16x32_bf16 v[32:35], a[112:115], v[120:123], v[32:35]
ds_read_b128 v[104:107], v5 offset:59392
v_mfma_f32_16x16x32_bf16 v[32:35], a[120:123], v[124:127], v[32:35]
v_mfma_f32_16x16x32_bf16 v[36:39], a[116:119], v[120:123], v[36:39]
ds_read_b128 v[108:111], v5 offset:60416
v_mfma_f32_16x16x32_bf16 v[36:39], a[124:127], v[124:127], v[36:39]
s_waitcnt lgkmcnt(4)
v_mfma_f32_16x16x32_bf16 v[40:43], a[112:115], v[128:131], v[40:43]
ds_read_b128 v[112:115], v5 offset:61440
v_mfma_f32_16x16x32_bf16 v[40:43], a[120:123], v[132:135], v[40:43]
buffer_load_dwordx4 a[172:175], v4, s[8:11], s35 offen offset:3072 sc1
v_mfma_f32_16x16x32_bf16 v[44:47], a[116:119], v[128:131], v[44:47]
s_add_u32 s34, s34, 4096
ds_read_b128 v[116:119], v5 offset:62464
v_mfma_f32_16x16x32_bf16 v[44:47], a[124:127], v[132:135], v[44:47]
s_add_u32 s35, s35, 4096
v_mfma_f32_16x16x32_bf16 v[64:67], a[112:115], v[136:139], v[64:67]
ds_read_b128 v[120:123], v5 offset:63488
v_mfma_f32_16x16x32_bf16 v[64:67], a[120:123], v[140:143], v[64:67]
buffer_load_dwordx4 a[176:179], v4, s[8:11], s34 offen offset:0 sc1
v_mfma_f32_16x16x32_bf16 v[68:71], a[116:119], v[136:139], v[68:71]
ds_read_b128 v[124:127], v5 offset:64512
v_mfma_f32_16x16x32_bf16 v[68:71], a[124:127], v[140:143], v[68:71]
v_mfma_f32_16x16x32_bf16 v[88:91], v[136:139], a[112:115], v[88:91]
v_mfma_f32_16x16x32_bf16 v[88:91], v[140:143], a[120:123], v[88:91]
v_mfma_f32_16x16x32_bf16 v[92:95], v[136:139], a[116:119], v[92:95]
v_mfma_f32_16x16x32_bf16 v[92:95], v[140:143], a[124:127], v[92:95]
s_waitcnt vmcnt(8) lgkmcnt(4)
buffer_load_dwordx4 a[180:183], v4, s[8:11], s35 offen offset:0 sc1
v_mfma_f32_16x16x32_bf16 v[32:35], a[128:131], v[96:99], v[32:35]
ds_read_b128 v[128:131], v26 offset:0
v_mfma_f32_16x16x32_bf16 v[32:35], a[136:139], v[100:103], v[32:35]
v_mfma_f32_16x16x32_bf16 v[36:39], a[132:135], v[96:99], v[36:39]
ds_read_b128 v[132:135], v26 offset:1024
v_mfma_f32_16x16x32_bf16 v[36:39], a[140:143], v[100:103], v[36:39]
buffer_load_dwordx4 a[184:187], v4, s[8:11], s34 offen offset:1024 sc1
v_mfma_f32_16x16x32_bf16 v[40:43], a[128:131], v[104:107], v[40:43]
ds_read_b128 v[136:139], v26 offset:2048
v_mfma_f32_16x16x32_bf16 v[40:43], a[136:139], v[108:111], v[40:43]
v_mfma_f32_16x16x32_bf16 v[44:47], a[132:135], v[104:107], v[44:47]
ds_read_b128 v[140:143], v26 offset:3072
v_mfma_f32_16x16x32_bf16 v[44:47], a[140:143], v[108:111], v[44:47]
s_waitcnt lgkmcnt(4)
v_mfma_f32_16x16x32_bf16 v[64:67], a[128:131], v[112:115], v[64:67]
ds_read_b128 v[96:99], v26 offset:4096
v_mfma_f32_16x16x32_bf16 v[64:67], a[136:139], v[116:119], v[64:67]
buffer_load_dwordx4 a[188:191], v4, s[8:11], s35 offen offset:1024 sc1
v_mfma_f32_16x16x32_bf16 v[68:71], a[132:135], v[112:115], v[68:71]
ds_read_b128 v[100:103], v26 offset:5120
v_mfma_f32_16x16x32_bf16 v[68:71], a[140:143], v[116:119], v[68:71]
v_mfma_f32_16x16x32_bf16 v[88:91], v[112:115], a[128:131], v[88:91]
v_mul_f32 v32, v32, v16
v_mul_f32 v33, v33, v17
v_mul_f32 v34, v34, v18
v_mfma_f32_16x16x32_bf16 v[88:91], v[116:119], a[136:139], v[88:91]
v_mul_f32 v35, v35, v19
v_mul_f32 v36, v36, v20
v_mul_f32 v37, v37, v21
v_mfma_f32_16x16x32_bf16 v[92:95], v[112:115], a[132:135], v[92:95]
buffer_load_dwordx4 a[192:195], v4, s[8:11], s34 offen offset:2048 sc1
v_mul_f32 v38, v38, v22
v_mfma_f32_16x16x32_bf16 v[92:95], v[116:119], a[140:143], v[92:95]
v_mul_f32 v39, v39, v23
v_mul_f32 v164, 0x3fb8aa3b, v32
v_mul_f32 v165, 0x3fb8aa3b, v33
v_mfma_f32_16x16x32_bf16 v[48:51], a[0:3], v[120:123], v[48:51]
ds_read_b128 v[104:107], v26 offset:6144
v_exp_f32 v164, v164 clamp
v_mfma_f32_16x16x32_bf16 v[48:51], a[8:11], v[124:127], v[48:51]
v_exp_f32 v165, v165 clamp
v_mul_f32 v166, 0x3fb8aa3b, v34
v_mfma_f32_16x16x32_bf16 v[52:55], a[4:7], v[120:123], v[52:55]
ds_read_b128 v[108:111], v26 offset:7168
v_exp_f32 v166, v166 clamp
v_mfma_f32_16x16x32_bf16 v[52:55], a[12:15], v[124:127], v[52:55]
s_waitcnt lgkmcnt(4)
buffer_load_dwordx4 a[196:199], v4, s[8:11], s35 offen offset:2048 sc1
v_mul_f32 v167, 0x3fb8aa3b, v35
v_mfma_f32_16x16x32_bf16 v[56:59], a[0:3], v[128:131], v[56:59]
ds_read_b128 v[112:115], v26 offset:8192
v_exp_f32 v167, v167 clamp
v_mfma_f32_16x16x32_bf16 v[56:59], a[8:11], v[132:135], v[56:59]
v_mul_f32 v168, 0x3fb8aa3b, v36
v_mul_f32 v169, 0x3fb8aa3b, v37
v_mfma_f32_16x16x32_bf16 v[60:63], a[4:7], v[128:131], v[60:63]
ds_read_b128 v[116:119], v26 offset:9216
v_exp_f32 v168, v168 clamp
v_mfma_f32_16x16x32_bf16 v[60:63], a[12:15], v[132:135], v[60:63]
v_exp_f32 v169, v169 clamp
v_mul_f32 v170, 0x3fb8aa3b, v38
v_mfma_f32_16x16x32_bf16 v[48:51], a[16:19], v[136:139], v[48:51]
ds_read_b128 v[120:123], v26 offset:10240
v_exp_f32 v170, v170 clamp
v_mfma_f32_16x16x32_bf16 v[48:51], a[24:27], v[140:143], v[48:51]
buffer_load_dwordx4 a[200:203], v4, s[8:11], s34 offen offset:3072 sc1
v_mul_f32 v171, 0x3fb8aa3b, v39
v_mfma_f32_16x16x32_bf16 v[52:55], a[20:23], v[136:139], v[52:55]
ds_read_b128 v[124:127], v26 offset:11264
v_exp_f32 v171, v171 clamp
v_mfma_f32_16x16x32_bf16 v[52:55], a[28:31], v[140:143], v[52:55]
s_waitcnt lgkmcnt(4)
v_max_f32 v32, 0x358637bd, v32
v_max_f32 v33, 0x358637bd, v33
v_max_f32 v34, 0x358637bd, v34
v_mfma_f32_16x16x32_bf16 v[56:59], a[16:19], v[96:99], v[56:59]
ds_read_b128 v[128:131], v26 offset:12288
v_max_f32 v35, 0x358637bd, v35
v_max_f32 v36, 0x358637bd, v36
v_mfma_f32_16x16x32_bf16 v[56:59], a[24:27], v[100:103], v[56:59]
buffer_load_dwordx4 a[204:207], v4, s[8:11], s35 offen offset:3072 sc1
v_max_f32 v37, 0x358637bd, v37
v_mfma_f32_16x16x32_bf16 v[60:63], a[20:23], v[96:99], v[60:63]
s_add_u32 s34, s34, 4096
ds_read_b128 v[132:135], v26 offset:13312
v_max_f32 v38, 0x358637bd, v38
v_max_f32 v39, 0x358637bd, v39
v_mfma_f32_16x16x32_bf16 v[60:63], a[28:31], v[100:103], v[60:63]
s_add_u32 s35, s35, 4096
v_add_f32 v32, v32, v164
v_add_f32 v33, v33, v165
v_mfma_f32_16x16x32_bf16 v[48:51], a[32:35], v[104:107], v[48:51]
ds_read_b128 v[136:139], v26 offset:14336
v_add_f32 v34, v34, v166
v_add_f32 v35, v35, v167
v_mfma_f32_16x16x32_bf16 v[48:51], a[40:43], v[108:111], v[48:51]
v_add_f32 v36, v36, v168
v_add_f32 v37, v37, v169
v_add_f32 v38, v38, v170
v_mfma_f32_16x16x32_bf16 v[52:55], a[36:39], v[104:107], v[52:55]
ds_read_b128 v[140:143], v26 offset:15360
v_add_f32 v39, v39, v171
v_cvt_pk_bf16_f32 v144, v32, v33
v_mfma_f32_16x16x32_bf16 v[52:55], a[44:47], v[108:111], v[52:55]
s_waitcnt lgkmcnt(4)
buffer_load_dwordx4 a[208:211], v4, s[8:11], s34 offen offset:0 sc1
v_cvt_pk_bf16_f32 v145, v34, v35
v_mfma_f32_16x16x32_bf16 v[56:59], a[32:35], v[112:115], v[56:59]
ds_read_b128 v[96:99], v4 offset:0
v_cvt_pk_bf16_f32 v146, v36, v37
v_cvt_pk_bf16_f32 v147, v38, v39
v_mfma_f32_16x16x32_bf16 v[56:59], a[40:43], v[116:119], v[56:59]
v_mul_f32 v40, v40, v16
v_mul_f32 v41, v41, v17
v_mul_f32 v42, v42, v18
v_mfma_f32_16x16x32_bf16 v[60:63], a[36:39], v[112:115], v[60:63]
ds_read_b128 v[100:103], v4 offset:1024
v_mul_f32 v43, v43, v19
v_mul_f32 v44, v44, v20
v_mfma_f32_16x16x32_bf16 v[60:63], a[44:47], v[116:119], v[60:63]
buffer_load_dwordx4 a[212:215], v4, s[8:11], s35 offen offset:0 sc1
v_mul_f32 v45, v45, v21
v_mfma_f32_16x16x32_bf16 v[48:51], a[48:51], v[120:123], v[48:51]
ds_read_b128 v[104:107], v4 offset:2048
v_mul_f32 v46, v46, v22
v_mfma_f32_16x16x32_bf16 v[48:51], a[56:59], v[124:127], v[48:51]
v_mul_f32 v47, v47, v23
v_mul_f32 v172, 0x3fb8aa3b, v40
v_mul_f32 v173, 0x3fb8aa3b, v41
v_mfma_f32_16x16x32_bf16 v[52:55], a[52:55], v[120:123], v[52:55]
ds_read_b128 v[108:111], v4 offset:3072
v_exp_f32 v172, v172 clamp
v_mfma_f32_16x16x32_bf16 v[52:55], a[60:63], v[124:127], v[52:55]
s_waitcnt lgkmcnt(4)
v_exp_f32 v173, v173 clamp
v_mul_f32 v174, 0x3fb8aa3b, v42
v_mfma_f32_16x16x32_bf16 v[56:59], a[48:51], v[128:131], v[56:59]
ds_read_b128 v[112:115], v4 offset:4096
v_exp_f32 v174, v174 clamp
v_mfma_f32_16x16x32_bf16 v[56:59], a[56:59], v[132:135], v[56:59]
buffer_load_dwordx4 a[216:219], v4, s[8:11], s36 offen offset:0 sc1
v_mul_f32 v175, 0x3fb8aa3b, v43
v_mfma_f32_16x16x32_bf16 v[60:63], a[52:55], v[128:131], v[60:63]
ds_read_b128 v[116:119], v4 offset:5120
v_exp_f32 v175, v175 clamp
v_mfma_f32_16x16x32_bf16 v[60:63], a[60:63], v[132:135], v[60:63]
v_mul_f32 v176, 0x3fb8aa3b, v44
v_exp_f32 v176, v176 clamp
v_mfma_f32_16x16x32_bf16 v[48:51], a[64:67], v[136:139], v[48:51]
ds_read_b128 v[120:123], v4 offset:6144
v_mul_f32 v177, 0x3fb8aa3b, v45
v_mul_f32 v178, 0x3fb8aa3b, v46
v_mfma_f32_16x16x32_bf16 v[48:51], a[72:75], v[140:143], v[48:51]
buffer_load_dwordx4 a[220:223], v4, s[8:11], s36 offen offset:1024 sc1
v_mul_f32 v179, 0x3fb8aa3b, v47
v_mfma_f32_16x16x32_bf16 v[52:55], a[68:71], v[136:139], v[52:55]
ds_read_b128 v[124:127], v4 offset:7168
v_max_f32 v40, 0x358637bd, v40
v_mfma_f32_16x16x32_bf16 v[52:55], a[76:79], v[140:143], v[52:55]
s_waitcnt lgkmcnt(4)
v_exp_f32 v177, v177 clamp
v_max_f32 v41, 0x358637bd, v41
v_mfma_f32_16x16x32_bf16 v[56:59], a[64:67], v[96:99], v[56:59]
ds_read_b128 v[128:131], v4 offset:8192
v_exp_f32 v178, v178 clamp
v_mfma_f32_16x16x32_bf16 v[56:59], a[72:75], v[100:103], v[56:59]
v_exp_f32 v179, v179 clamp
v_max_f32 v42, 0x358637bd, v42
v_mfma_f32_16x16x32_bf16 v[60:63], a[68:71], v[96:99], v[60:63]
ds_read_b128 v[132:135], v4 offset:9216
v_max_f32 v43, 0x358637bd, v43
v_max_f32 v44, 0x358637bd, v44
v_mfma_f32_16x16x32_bf16 v[60:63], a[76:79], v[100:103], v[60:63]
buffer_load_dwordx4 a[224:227], v4, s[8:11], s36 offen offset:2048 sc1
v_max_f32 v45, 0x358637bd, v45
v_mfma_f32_16x16x32_bf16 v[48:51], a[80:83], v[104:107], v[48:51]
ds_read_b128 v[136:139], v4 offset:10240
v_max_f32 v46, 0x358637bd, v46
v_max_f32 v47, 0x358637bd, v47
v_mfma_f32_16x16x32_bf16 v[48:51], a[88:91], v[108:111], v[48:51]
v_add_f32 v40, v40, v172
v_add_f32 v41, v41, v173
v_add_f32 v42, v42, v174
v_mfma_f32_16x16x32_bf16 v[52:55], a[84:87], v[104:107], v[52:55]
ds_read_b128 v[140:143], v4 offset:11264
v_add_f32 v43, v43, v175
v_add_f32 v44, v44, v176
v_mfma_f32_16x16x32_bf16 v[52:55], a[92:95], v[108:111], v[52:55]
s_waitcnt lgkmcnt(4)
v_add_f32 v45, v45, v177
v_add_f32 v46, v46, v178
v_add_f32 v47, v47, v179
v_mfma_f32_16x16x32_bf16 v[56:59], a[80:83], v[112:115], v[56:59]
ds_read_b128 v[96:99], v4 offset:12288
v_cvt_pk_bf16_f32 v148, v40, v41
v_mfma_f32_16x16x32_bf16 v[56:59], a[88:91], v[116:119], v[56:59]
buffer_load_dwordx4 a[228:231], v4, s[8:11], s36 offen offset:3072 sc1
v_cvt_pk_bf16_f32 v149, v42, v43
v_mfma_f32_16x16x32_bf16 v[60:63], a[84:87], v[112:115], v[60:63]
ds_read_b128 v[100:103], v4 offset:13312
v_cvt_pk_bf16_f32 v150, v44, v45
v_cvt_pk_bf16_f32 v151, v46, v47
v_mfma_f32_16x16x32_bf16 v[60:63], a[92:95], v[116:119], v[60:63]
v_mul_f32 v64, v64, v16
v_mul_f32 v65, v65, v17
v_mul_f32 v66, v66, v18
v_mfma_f32_16x16x32_bf16 v[48:51], a[96:99], v[120:123], v[48:51]
ds_read_b128 v[104:107], v4 offset:14336
v_mul_f32 v67, v67, v19
v_mul_f32 v68, v68, v20
v_mfma_f32_16x16x32_bf16 v[48:51], a[104:107], v[124:127], v[48:51]
buffer_load_dwordx2 a[232:233], v4, s[8:11], s37 offen sc1
v_mul_f32 v69, v69, v21
v_mfma_f32_16x16x32_bf16 v[52:55], a[100:103], v[120:123], v[52:55]
ds_read_b128 v[108:111], v4 offset:15360
v_mul_f32 v70, v70, v22
v_mul_f32 v71, v71, v23
v_mfma_f32_16x16x32_bf16 v[52:55], a[108:111], v[124:127], v[52:55]
s_waitcnt lgkmcnt(4)
v_fmamk_f32 v164, v64, 0x3fb8aa3b, v218
v_exp_f32 v164, v164 clamp
v_mfma_f32_16x16x32_bf16 v[56:59], a[96:99], v[128:131], v[56:59]
ds_read_b128 v[112:115], v4 offset:16384
v_fmamk_f32 v165, v65, 0x3fb8aa3b, v218
v_fmamk_f32 v166, v66, 0x3fb8aa3b, v218
v_mfma_f32_16x16x32_bf16 v[56:59], a[104:107], v[132:135], v[56:59]
v_exp_f32 v165, v165 clamp
v_mfma_f32_16x16x32_bf16 v[60:63], a[100:103], v[128:131], v[60:63]
ds_read_b128 v[116:119], v4 offset:17408
v_exp_f32 v166, v166 clamp
v_mfma_f32_16x16x32_bf16 v[60:63], a[108:111], v[132:135], v[60:63]
buffer_load_dwordx4 a[236:239], v214, s[8:11], s40 offen offset:0 sc1
v_fmamk_f32 v167, v67, 0x3fb8aa3b, v218
v_mfma_f32_16x16x32_bf16 v[48:51], a[112:115], v[136:139], v[48:51]
ds_read_b128 v[120:123], v4 offset:18432
v_exp_f32 v167, v167 clamp
v_mfma_f32_16x16x32_bf16 v[48:51], a[120:123], v[140:143], v[48:51]
v_fmamk_f32 v168, v68, 0x3fb8aa3b, v218
v_exp_f32 v168, v168 clamp
v_mfma_f32_16x16x32_bf16 v[52:55], a[116:119], v[136:139], v[52:55]
ds_read_b128 v[124:127], v4 offset:19456
v_fmamk_f32 v169, v69, 0x3fb8aa3b, v218
v_fmamk_f32 v170, v70, 0x3fb8aa3b, v218
v_mfma_f32_16x16x32_bf16 v[52:55], a[124:127], v[140:143], v[52:55]
s_waitcnt lgkmcnt(4)
buffer_load_dwordx4 a[240:243], v214, s[8:11], s40 offen offset:512 sc1
v_fmamk_f32 v171, v71, 0x3fb8aa3b, v218
v_mfma_f32_16x16x32_bf16 v[56:59], a[112:115], v[96:99], v[56:59]
ds_read_b128 v[128:131], v4 offset:20480
v_exp_f32 v169, v169 clamp
v_mfma_f32_16x16x32_bf16 v[56:59], a[120:123], v[100:103], v[56:59]
v_exp_f32 v170, v170 clamp
v_max_f32 v64, v219, v64
v_mfma_f32_16x16x32_bf16 v[60:63], a[116:119], v[96:99], v[60:63]
ds_read_b128 v[132:135], v4 offset:21504
v_exp_f32 v171, v171 clamp
v_mfma_f32_16x16x32_bf16 v[60:63], a[124:127], v[100:103], v[60:63]
v_max_f32 v65, v219, v65
v_max_f32 v66, v219, v66
v_mfma_f32_16x16x32_bf16 v[48:51], a[128:131], v[104:107], v[48:51]
ds_read_b128 v[136:139], v4 offset:22528
v_max_f32 v67, v219, v67
v_max_f32 v68, v219, v68
v_mfma_f32_16x16x32_bf16 v[48:51], a[136:139], v[108:111], v[48:51]
buffer_load_dwordx4 a[244:247], v214, s[8:11], s40 offen offset:1024 sc1
v_max_f32 v69, v219, v69
v_mfma_f32_16x16x32_bf16 v[52:55], a[132:135], v[104:107], v[52:55]
ds_read_b128 v[140:143], v4 offset:23552
v_max_f32 v70, v219, v70
v_max_f32 v71, v219, v71
v_mfma_f32_16x16x32_bf16 v[52:55], a[140:143], v[108:111], v[52:55]
s_waitcnt lgkmcnt(4)
v_add_f32 v64, v64, v164
v_add_f32 v65, v65, v165
v_add_f32 v66, v66, v166
v_mfma_f32_16x16x32_bf16 v[56:59], a[128:131], v[112:115], v[56:59]
ds_read_b128 v[96:99], v4 offset:24576
v_add_f32 v67, v67, v167
v_add_f32 v68, v68, v168
v_mfma_f32_16x16x32_bf16 v[56:59], a[136:139], v[116:119], v[56:59]
buffer_load_dwordx4 a[248:251], v214, s[8:11], s40 offen offset:1536 sc1
v_add_f32 v69, v69, v169
v_mfma_f32_16x16x32_bf16 v[60:63], a[132:135], v[112:115], v[60:63]
ds_read_b128 v[100:103], v4 offset:25600
v_add_f32 v70, v70, v170
v_add_f32 v71, v71, v171
v_mfma_f32_16x16x32_bf16 v[60:63], a[140:143], v[116:119], v[60:63]
v_cvt_pk_bf16_f32 v160, v64, v65
v_cvt_pk_bf16_f32 v161, v66, v67
v_cvt_pk_bf16_f32 v162, v68, v69
v_mfma_f32_16x16x32_bf16 v[72:75], v[120:123], a[0:3], v[72:75]
ds_read_b128 v[104:107], v4 offset:26624
v_cvt_pk_bf16_f32 v163, v70, v71
v_mfma_f32_16x16x32_bf16 v[72:75], v[124:127], a[8:11], v[72:75]
v_mul_f32 v48, v48, v16
v_mul_f32 v49, v49, v17
v_cvt_pk_bf16_f32 v152, v48, v49
v_mul_f32 v50, v50, v18
v_mul_f32 v51, v51, v19
v_cvt_pk_bf16_f32 v153, v50, v51
v_mfma_f32_16x16x32_bf16 v[76:79], v[120:123], a[4:7], v[76:79]
ds_read_b128 v[108:111], v4 offset:27648
v_mul_f32 v52, v52, v20
v_mul_f32 v53, v53, v21
v_cvt_pk_bf16_f32 v154, v52, v53
v_mul_f32 v54, v54, v22
v_mul_f32 v55, v55, v23
v_cvt_pk_bf16_f32 v155, v54, v55
v_mfma_f32_16x16x32_bf16 v[76:79], v[124:127], a[12:15], v[76:79]
s_waitcnt lgkmcnt(4)
buffer_load_dwordx2 a[234:235], v214, s[8:11], s41 offen sc1
v_mfma_f32_16x16x32_bf16 v[80:83], v[128:131], a[0:3], v[80:83]
ds_read_b128 v[112:115], v4 offset:28672
v_mul_f32 v56, v56, v16
v_mul_f32 v57, v57, v17
v_cvt_pk_bf16_f32 v156, v56, v57
v_mul_f32 v58, v58, v18
v_mul_f32 v59, v59, v19
v_cvt_pk_bf16_f32 v157, v58, v59
v_mfma_f32_16x16x32_bf16 v[80:83], v[132:135], a[8:11], v[80:83]
v_mul_f32 v60, v60, v20
v_mul_f32 v61, v61, v21
v_cvt_pk_bf16_f32 v158, v60, v61
v_mul_f32 v62, v62, v22
v_mul_f32 v63, v63, v23
v_cvt_pk_bf16_f32 v159, v62, v63
v_mfma_f32_16x16x32_bf16 v[188:191], v[144:147], v[160:163], 0
v_mfma_f32_16x16x32_bf16 v[192:195], v[148:151], v[160:163], 0
v_mfma_f32_16x16x32_bf16 v[204:207], v[160:163], v[160:163], 0
v_mfma_f32_16x16x32_bf16 v[180:183], v[144:147], v[152:155], 0
v_mfma_f32_16x16x32_bf16 v[196:199], v[160:163], v[152:155], 0
v_mfma_f32_16x16x32_bf16 v[184:187], v[148:151], v[156:159], 0
v_mfma_f32_16x16x32_bf16 v[200:203], v[160:163], v[156:159], 0
s_nop 1
ds_write_b128 v7, v[188:191] offset:2048
v_mfma_f32_16x16x32_bf16 v[84:87], v[128:131], a[4:7], v[84:87]
ds_read_b128 v[116:119], v4 offset:29696
v_mfma_f32_16x16x32_bf16 v[84:87], v[132:135], a[12:15], v[84:87]
ds_write_b128 v7, v[192:195] offset:3072
v_mfma_f32_16x16x32_bf16 v[72:75], v[136:139], a[16:19], v[72:75]
ds_read_b128 v[120:123], v4 offset:30720
v_mfma_f32_16x16x32_bf16 v[72:75], v[140:143], a[24:27], v[72:75]
ds_write_b64 v7, v[204:205] offset:6144
v_mfma_f32_16x16x32_bf16 v[76:79], v[136:139], a[20:23], v[76:79]
ds_read_b128 v[124:127], v4 offset:31744
ds_write_b128 v7, v[180:183] offset:0
v_mfma_f32_16x16x32_bf16 v[76:79], v[140:143], a[28:31], v[76:79]
s_waitcnt lgkmcnt(8)
buffer_load_dwordx4 a[0:3], v4, s[8:11], s34 offen offset:1024 sc1
v_mfma_f32_16x16x32_bf16 v[80:83], v[96:99], a[16:19], v[80:83]
ds_read_b128 v[128:131], v4 offset:32768
ds_write_b64 v7, v[196:197] offset:4096
v_mfma_f32_16x16x32_bf16 v[80:83], v[100:103], a[24:27], v[80:83]
ds_write_b128 v7, v[184:187] offset:1024
v_mfma_f32_16x16x32_bf16 v[84:87], v[96:99], a[20:23], v[84:87]
ds_read_b128 v[132:135], v4 offset:33792
v_mfma_f32_16x16x32_bf16 v[84:87], v[100:103], a[28:31], v[84:87]
buffer_load_dwordx4 a[4:7], v4, s[8:11], s35 offen offset:1024 sc1
ds_write_b64 v7, v[200:201] offset:5120
v_mfma_f32_16x16x32_bf16 v[72:75], v[104:107], a[32:35], v[72:75]
ds_read_b128 v[136:139], v4 offset:34816
v_mfma_f32_16x16x32_bf16 v[72:75], v[108:111], a[40:43], v[72:75]
v_mfma_f32_16x16x32_bf16 v[76:79], v[104:107], a[36:39], v[76:79]
ds_read_b128 v[140:143], v4 offset:35840
s_waitcnt lgkmcnt(2)
s_barrier
v_mfma_f32_16x16x32_bf16 v[76:79], v[108:111], a[44:47], v[76:79]
ds_read2st64_b32 v[164:165], v8 offset0:0 offset1:28
v_mfma_f32_16x16x32_bf16 v[80:83], v[112:115], a[32:35], v[80:83]
ds_read_b128 v[96:99], v4 offset:36864
ds_read2st64_b32 v[166:167], v28 offset0:0 offset1:28
v_mfma_f32_16x16x32_bf16 v[80:83], v[116:119], a[40:43], v[80:83]
buffer_load_dwordx4 a[8:11], v4, s[8:11], s34 offen offset:2048 sc1
ds_read2st64_b32 v[168:169], v8 offset0:4 offset1:32
v_mfma_f32_16x16x32_bf16 v[84:87], v[112:115], a[36:39], v[84:87]
ds_read_b128 v[100:103], v4 offset:37888
ds_read2st64_b32 v[170:171], v28 offset0:4 offset1:32
v_mfma_f32_16x16x32_bf16 v[84:87], v[116:119], a[44:47], v[84:87]
ds_read2st64_b32 v[172:173], v6 offset0:0 offset1:28
v_mfma_f32_16x16x32_bf16 v[72:75], v[120:123], a[48:51], v[72:75]
ds_read_b128 v[104:107], v4 offset:38912
ds_read2st64_b32 v[174:175], v27 offset0:0 offset1:28
v_mfma_f32_16x16x32_bf16 v[72:75], v[124:127], a[56:59], v[72:75]
buffer_load_dwordx4 a[12:15], v4, s[8:11], s35 offen offset:2048 sc1
v_mfma_f32_16x16x32_bf16 v[76:79], v[120:123], a[52:55], v[76:79]
ds_read_b128 v[108:111], v4 offset:39936
v_mfma_f32_16x16x32_bf16 v[76:79], v[124:127], a[60:63], v[76:79]
s_waitcnt lgkmcnt(10)
v_mfma_f32_16x16x32_bf16 v[80:83], v[128:131], a[48:51], v[80:83]
ds_read_b128 v[112:115], v4 offset:40960
s_waitcnt lgkmcnt(10)
v_add_f32 v164, v164, v165
s_waitcnt lgkmcnt(8)
v_add_f32 v166, v166, v167
v_mfma_f32_16x16x32_bf16 v[80:83], v[132:135], a[56:59], v[80:83]
s_waitcnt lgkmcnt(7)
v_add_f32 v168, v168, v169
s_waitcnt lgkmcnt(5)
v_add_f32 v170, v170, v171
s_waitcnt lgkmcnt(4)
v_add_f32 v172, v172, v173
v_mfma_f32_16x16x32_bf16 v[84:87], v[128:131], a[52:55], v[84:87]
ds_read_b128 v[116:119], v4 offset:41984
s_waitcnt lgkmcnt(3)
v_add_f32 v174, v174, v175
v_mfma_f32_16x16x32_bf16 v[84:87], v[132:135], a[60:63], v[84:87]
buffer_load_dwordx4 a[16:19], v4, s[8:11], s34 offen offset:3072 sc1
v_add_f32 v164, v164, v166
v_mfma_f32_16x16x32_bf16 v[72:75], v[136:139], a[64:67], v[72:75]
ds_read_b128 v[120:123], v4 offset:43008
buffer_atomic_add_f32 v164, v9, s[8:11], s25 offen offset:0
v_mfma_f32_16x16x32_bf16 v[72:75], v[140:143], a[72:75], v[72:75]
v_add_f32 v168, v168, v170
v_add_f32 v172, v172, v174
v_mfma_f32_16x16x32_bf16 v[76:79], v[136:139], a[68:71], v[76:79]
ds_read_b128 v[124:127], v4 offset:44032
buffer_atomic_add_f32 v168, v9, s[8:11], s25 offen offset:1024
v_mfma_f32_16x16x32_bf16 v[76:79], v[140:143], a[76:79], v[76:79]
s_waitcnt lgkmcnt(4)
buffer_load_dwordx4 a[20:23], v4, s[8:11], s35 offen offset:3072 sc1
v_mfma_f32_16x16x32_bf16 v[80:83], v[96:99], a[64:67], v[80:83]
s_add_u32 s34, s34, 4096
ds_read_b128 v[128:131], v4 offset:45056
buffer_atomic_add_f32 v172, v10, s[8:11], s25 offen offset:2048
v_mfma_f32_16x16x32_bf16 v[80:83], v[100:103], a[72:75], v[80:83]
s_add_u32 s35, s35, 4096
v_mfma_f32_16x16x32_bf16 v[84:87], v[96:99], a[68:71], v[84:87]
ds_read_b128 v[132:135], v4 offset:46080
v_mul_f32 v88, v88, v24
v_mfma_f32_16x16x32_bf16 v[84:87], v[100:103], a[76:79], v[84:87]
v_mul_f32 v89, v89, v24
v_mul_f32 v92, v92, v25
v_mfma_f32_16x16x32_bf16 v[72:75], v[104:107], a[80:83], v[72:75]
ds_read_b128 v[136:139], v4 offset:47104
v_mul_f32 v93, v93, v25
v_mfma_f32_16x16x32_bf16 v[72:75], v[108:111], a[88:91], v[72:75]
buffer_load_dwordx4 a[24:27], v4, s[8:11], s34 offen offset:0 sc1
v_mfma_f32_16x16x32_bf16 v[76:79], v[104:107], a[84:87], v[76:79]
ds_read_b128 v[140:143], v4 offset:48128
v_mfma_f32_16x16x32_bf16 v[76:79], v[108:111], a[92:95], v[76:79]
s_waitcnt lgkmcnt(4)
v_mul_f32 v32, 0x3fb8aa3b, v88
v_mul_f32 v33, 0x3fb8aa3b, v89
v_mfma_f32_16x16x32_bf16 v[80:83], v[112:115], a[80:83], v[80:83]
ds_read_b128 v[96:99], v4 offset:49152
v_mfma_f32_16x16x32_bf16 v[80:83], v[116:119], a[88:91], v[80:83]
v_exp_f32 v32, v32 clamp
v_mfma_f32_16x16x32_bf16 v[84:87], v[112:115], a[84:87], v[84:87]
ds_read_b128 v[100:103], v4 offset:50176
v_mfma_f32_16x16x32_bf16 v[84:87], v[116:119], a[92:95], v[84:87]
buffer_load_dwordx4 a[28:31], v4, s[8:11], s35 offen offset:0 sc1
v_mfma_f32_16x16x32_bf16 v[72:75], v[120:123], a[96:99], v[72:75]
ds_read_b128 v[104:107], v4 offset:51200
v_mul_f32 v34, 0x3fb8aa3b, v92
v_mfma_f32_16x16x32_bf16 v[72:75], v[124:127], a[104:107], v[72:75]
v_exp_f32 v33, v33 clamp
v_mfma_f32_16x16x32_bf16 v[76:79], v[120:123], a[100:103], v[76:79]
ds_read_b128 v[108:111], v4 offset:52224
v_mfma_f32_16x16x32_bf16 v[76:79], v[124:127], a[108:111], v[76:79]
s_waitcnt lgkmcnt(4)
buffer_load_dwordx4 a[32:35], v4, s[8:11], s34 offen offset:1024 sc1
v_mfma_f32_16x16x32_bf16 v[80:83], v[128:131], a[96:99], v[80:83]
ds_read_b128 v[112:115], v4 offset:53248
v_mfma_f32_16x16x32_bf16 v[80:83], v[132:135], a[104:107], v[80:83]
v_exp_f32 v34, v34 clamp
v_mfma_f32_16x16x32_bf16 v[84:87], v[128:131], a[100:103], v[84:87]
ds_read_b128 v[116:119], v4 offset:54272
v_mfma_f32_16x16x32_bf16 v[84:87], v[132:135], a[108:111], v[84:87]
v_mul_f32 v35, 0x3fb8aa3b, v93
v_mfma_f32_16x16x32_bf16 v[72:75], v[136:139], a[112:115], v[72:75]
v_exp_f32 v35, v35 clamp
v_mfma_f32_16x16x32_bf16 v[72:75], v[140:143], a[120:123], v[72:75]
buffer_load_dwordx4 a[36:39], v4, s[8:11], s35 offen offset:1024 sc1
v_mfma_f32_16x16x32_bf16 v[76:79], v[136:139], a[116:119], v[76:79]
v_mfma_f32_16x16x32_bf16 v[76:79], v[140:143], a[124:127], v[76:79]
s_waitcnt lgkmcnt(2)
v_max_f32 v88, 0x358637bd, v88
v_max_f32 v89, 0x358637bd, v89
v_mfma_f32_16x16x32_bf16 v[80:83], v[96:99], a[112:115], v[80:83]
v_max_f32 v92, 0x358637bd, v92
v_mfma_f32_16x16x32_bf16 v[80:83], v[100:103], a[120:123], v[80:83]
v_max_f32 v93, 0x358637bd, v93
v_mfma_f32_16x16x32_bf16 v[84:87], v[96:99], a[116:119], v[84:87]
buffer_load_dwordx4 a[40:43], v4, s[8:11], s34 offen offset:2048 sc1
v_mfma_f32_16x16x32_bf16 v[84:87], v[100:103], a[124:127], v[84:87]
v_add_f32 v88, v88, v32
v_mfma_f32_16x16x32_bf16 v[72:75], v[104:107], a[128:131], v[72:75]
v_add_f32 v89, v89, v33
v_mfma_f32_16x16x32_bf16 v[72:75], v[108:111], a[136:139], v[72:75]
v_add_f32 v92, v92, v34
v_add_f32 v93, v93, v35
v_mfma_f32_16x16x32_bf16 v[76:79], v[104:107], a[132:135], v[76:79]
v_cvt_pk_bf16_f32 v56, v88, v89
v_mfma_f32_16x16x32_bf16 v[76:79], v[108:111], a[140:143], v[76:79]
s_waitcnt lgkmcnt(0)
v_cvt_pk_bf16_f32 v57, v92, v93
v_mfma_f32_16x16x32_bf16 v[80:83], v[112:115], a[128:131], v[80:83]
buffer_load_dwordx4 a[44:47], v4, s[8:11], s35 offen offset:2048 sc1
v_mfma_f32_16x16x32_bf16 v[80:83], v[116:119], a[136:139], v[80:83]
buffer_store_dwordx2 v[56:57], v11, s[8:11], s27 offen sc1
v_mfma_f32_16x16x32_bf16 v[84:87], v[112:115], a[132:135], v[84:87]
v_mfma_f32_16x16x32_bf16 v[84:87], v[116:119], a[140:143], v[84:87]
s_mov_b32 s48, 0x3fb8aa3b
s_mov_b32 s49, s48
v_pk_mul_f32 v[72:73], v[72:73], v[24:25] op_sel:[0,0] op_sel_hi:[1,0]
v_pk_mul_f32 v[74:75], v[74:75], v[24:25] op_sel:[0,0] op_sel_hi:[1,0]
s_nop 0
v_pk_mul_f32 v[80:81], v[80:81], v[24:25] op_sel:[0,0] op_sel_hi:[1,0]
v_pk_mul_f32 v[82:83], v[82:83], v[24:25] op_sel:[0,0] op_sel_hi:[1,0]
v_pk_mul_f32 v[96:97], v[72:73], s[48:49]
v_pk_mul_f32 v[98:99], v[74:75], s[48:49]
v_pk_mul_f32 v[100:101], v[80:81], s[48:49]
v_pk_mul_f32 v[102:103], v[82:83], s[48:49]
v_exp_f32 v96, v96 clamp
v_max_f32 v72, 0x358637bd, v72
v_exp_f32 v97, v97 clamp
v_max_f32 v73, 0x358637bd, v73
v_exp_f32 v98, v98 clamp
v_max_f32 v74, 0x358637bd, v74
v_exp_f32 v99, v99 clamp
v_max_f32 v75, 0x358637bd, v75
v_exp_f32 v100, v100 clamp
v_max_f32 v80, 0x358637bd, v80
v_exp_f32 v101, v101 clamp
v_max_f32 v81, 0x358637bd, v81
v_exp_f32 v102, v102 clamp
v_max_f32 v82, 0x358637bd, v82
v_exp_f32 v103, v103 clamp
v_max_f32 v83, 0x358637bd, v83
v_pk_add_f32 v[72:73], v[72:73], v[96:97]
v_pk_add_f32 v[74:75], v[74:75], v[98:99]
v_pk_add_f32 v[80:81], v[80:81], v[100:101]
v_pk_add_f32 v[82:83], v[82:83], v[102:103]
v_cvt_pk_bf16_f32 v48, v72, v73
v_cvt_pk_bf16_f32 v49, v74, v75
v_cvt_pk_bf16_f32 v50, v80, v81
v_cvt_pk_bf16_f32 v51, v82, v83
buffer_store_dwordx4 v[48:51], v4, s[8:11], s26 offen sc1
v_pk_mul_f32 v[76:77], v[76:77], v[24:25] op_sel:[0,1] op_sel_hi:[1,1]
v_pk_mul_f32 v[78:79], v[78:79], v[24:25] op_sel:[0,1] op_sel_hi:[1,1]
v_pk_mul_f32 v[84:85], v[84:85], v[24:25] op_sel:[0,1] op_sel_hi:[1,1]
v_pk_mul_f32 v[86:87], v[86:87], v[24:25] op_sel:[0,1] op_sel_hi:[1,1]
v_pk_mul_f32 v[96:97], v[76:77], s[48:49]
v_pk_mul_f32 v[98:99], v[78:79], s[48:49]
v_pk_mul_f32 v[100:101], v[84:85], s[48:49]
v_pk_mul_f32 v[102:103], v[86:87], s[48:49]
v_exp_f32 v96, v96 clamp
v_max_f32 v76, 0x358637bd, v76
v_exp_f32 v97, v97 clamp
v_max_f32 v77, 0x358637bd, v77
v_exp_f32 v98, v98 clamp
v_max_f32 v78, 0x358637bd, v78
v_exp_f32 v99, v99 clamp
v_max_f32 v79, 0x358637bd, v79
v_exp_f32 v100, v100 clamp
v_max_f32 v84, 0x358637bd, v84
v_exp_f32 v101, v101 clamp
v_max_f32 v85, 0x358637bd, v85
v_exp_f32 v102, v102 clamp
v_max_f32 v86, 0x358637bd, v86
v_exp_f32 v103, v103 clamp
v_max_f32 v87, 0x358637bd, v87
v_pk_add_f32 v[76:77], v[76:77], v[96:97]
v_pk_add_f32 v[78:79], v[78:79], v[98:99]
v_pk_add_f32 v[84:85], v[84:85], v[100:101]
v_pk_add_f32 v[86:87], v[86:87], v[102:103]
v_cvt_pk_bf16_f32 v52, v76, v77
v_cvt_pk_bf16_f32 v53, v78, v79
v_cvt_pk_bf16_f32 v54, v84, v85
v_cvt_pk_bf16_f32 v55, v86, v87
buffer_store_dwordx4 v[52:55], v4, s[8:11], s28 offen sc1
s_waitcnt vmcnt(9)
s_barrier
buffer_store_dword v12, v29, s[8:11], s32 offen sc1
s_branch Lkb
Lfinal:
s_mov_b32 s32, s78
s_mov_b32 s33, s79
s_mov_b32 s34, 0x240000
s_mov_b32 s35, 0x20000
v_lshrrev_b32 v76, 2, v1
v_and_b32 v77, 3, v1
v_mul_u32_u24 v5, 1152, v76
v_lshl_add_u32 v5, v77, 4, v5
v_lshlrev_b32 v9, 6, v77
v_lshl_add_u32 v9, v76, 2, v9
s_or_b64 vcc, s[26:27], s[28:29]
v_mul_u32_u24 v6, 1152, v2
v_cndmask_b32 v140, v136, v138, s[28:29]
v_cndmask_b32 v6, v14, v6, vcc
s_mul_i32 s16, s43, 36864
s_lshl_b32 s17, s42, 2
s_add_u32 s17, s17, s18
s_lshl_b32 s17, s17, 6
s_add_u32 s36, s16, s17
s_add_u32 s37, s36, 18432
s_and_b32 s17, s18, 1
s_mul_i32 s17, s17, 18432
s_add_u32 s16, s16, s17
s_lshl_b32 s17, s42, 1
s_lshr_b32 s19, s18, 1
s_add_u32 s17, s17, s19
s_lshl_b32 s17, s17, 4
s_add_u32 s38, s16, s17
v_pk_add_f32 v[64:65], v[64:65], v[140:141] op_sel_hi:[1,0]
v_pk_add_f32 v[66:67], v[66:67], v[140:141] op_sel_hi:[1,0]
v_pk_add_f32 v[68:69], v[68:69], v[140:141] op_sel_hi:[1,0]
v_pk_add_f32 v[70:71], v[70:71], v[140:141] op_sel_hi:[1,0]
v_cvt_pk_bf16_f32 v36, v64, v65
v_cvt_pk_bf16_f32 v37, v66, v67
v_cvt_pk_bf16_f32 v38, v68, v69
v_cvt_pk_bf16_f32 v39, v70, v71
buffer_store_dwordx4 v[36:39], v6, s[32:35], s38 offen offset:1024 sc1
v_pk_add_f32 v[232:233], v[232:233], v[136:137] op_sel_hi:[1,0]
v_pk_add_f32 v[234:235], v[234:235], v[136:137] op_sel_hi:[1,0]
v_pk_add_f32 v[240:241], v[240:241], v[136:137] op_sel_hi:[1,0]
v_pk_add_f32 v[242:243], v[242:243], v[136:137] op_sel_hi:[1,0]
v_pk_add_f32 v[236:237], v[236:237], v[138:139] op_sel_hi:[1,0]
v_pk_add_f32 v[238:239], v[238:239], v[138:139] op_sel_hi:[1,0]
v_pk_add_f32 v[244:245], v[244:245], v[138:139] op_sel_hi:[1,0]
v_pk_add_f32 v[246:247], v[246:247], v[138:139] op_sel_hi:[1,0]
v_lshlrev_b32 v72, 16, v148
v_and_b32 v73, 0xffff0000, v148
v_pk_add_f32 v[232:233], v[232:233], v[72:73]
v_lshlrev_b32 v74, 16, v149
v_and_b32 v75, 0xffff0000, v149
v_pk_add_f32 v[234:235], v[234:235], v[74:75]
v_lshlrev_b32 v72, 16, v150
v_and_b32 v73, 0xffff0000, v150
v_pk_add_f32 v[240:241], v[240:241], v[72:73]
v_lshlrev_b32 v74, 16, v151
v_and_b32 v75, 0xffff0000, v151
v_pk_add_f32 v[242:243], v[242:243], v[74:75]
v_lshlrev_b32 v72, 16, v152
v_and_b32 v73, 0xffff0000, v152
v_pk_add_f32 v[236:237], v[236:237], v[72:73]
v_lshlrev_b32 v74, 16, v153
v_and_b32 v75, 0xffff0000, v153
v_pk_add_f32 v[238:239], v[238:239], v[74:75]
v_lshlrev_b32 v72, 16, v154
v_and_b32 v73, 0xffff0000, v154
v_pk_add_f32 v[244:245], v[244:245], v[72:73]
v_lshlrev_b32 v74, 16, v155
v_and_b32 v75, 0xffff0000, v155
v_pk_add_f32 v[246:247], v[246:247], v[74:75]
v_lshlrev_b32 v72, 16, v160
v_and_b32 v73, 0xffff0000, v160
v_pk_add_f32 v[232:233], v[232:233], v[72:73]
v_lshlrev_b32 v74, 16, v161
v_and_b32 v75, 0xffff0000, v161
v_pk_add_f32 v[234:235], v[234:235], v[74:75]
v_lshlrev_b32 v72, 16, v162
v_and_b32 v73, 0xffff0000, v162
v_pk_add_f32 v[240:241], v[240:241], v[72:73]
v_lshlrev_b32 v74, 16, v163
v_and_b32 v75, 0xffff0000, v163
v_pk_add_f32 v[242:243], v[242:243], v[74:75]
v_lshlrev_b32 v72, 16, v164
v_and_b32 v73, 0xffff0000, v164
v_pk_add_f32 v[236:237], v[236:237], v[72:73]
v_lshlrev_b32 v74, 16, v165
v_and_b32 v75, 0xffff0000, v165
v_pk_add_f32 v[238:239], v[238:239], v[74:75]
v_lshlrev_b32 v72, 16, v166
v_and_b32 v73, 0xffff0000, v166
v_pk_add_f32 v[244:245], v[244:245], v[72:73]
v_lshlrev_b32 v74, 16, v167
v_and_b32 v75, 0xffff0000, v167
v_pk_add_f32 v[246:247], v[246:247], v[74:75]
s_waitcnt vmcnt(2)
v_lshlrev_b32 v72, 16, v172
v_and_b32 v73, 0xffff0000, v172
v_pk_add_f32 v[232:233], v[232:233], v[72:73]
v_lshlrev_b32 v74, 16, v173
v_and_b32 v75, 0xffff0000, v173
v_pk_add_f32 v[234:235], v[234:235], v[74:75]
v_lshlrev_b32 v72, 16, v174
v_and_b32 v73, 0xffff0000, v174
v_pk_add_f32 v[240:241], v[240:241], v[72:73]
v_lshlrev_b32 v74, 16, v175
v_and_b32 v75, 0xffff0000, v175
v_pk_add_f32 v[242:243], v[242:243], v[74:75]
v_cvt_pk_bf16_f32 v28, v232, v233
ds_bpermute_b32 v40, v9, v28
v_cvt_pk_bf16_f32 v29, v234, v235
ds_bpermute_b32 v41, v9, v29
v_cvt_pk_bf16_f32 v30, v240, v241
ds_bpermute_b32 v42, v9, v30
v_cvt_pk_bf16_f32 v31, v242, v243
ds_bpermute_b32 v43, v9, v31
s_waitcnt vmcnt(1)
v_lshlrev_b32 v72, 16, v176
v_and_b32 v73, 0xffff0000, v176
v_pk_add_f32 v[236:237], v[236:237], v[72:73]
v_lshlrev_b32 v74, 16, v177
v_and_b32 v75, 0xffff0000, v177
v_pk_add_f32 v[238:239], v[238:239], v[74:75]
v_lshlrev_b32 v72, 16, v178
v_and_b32 v73, 0xffff0000, v178
v_pk_add_f32 v[244:245], v[244:245], v[72:73]
v_lshlrev_b32 v74, 16, v179
v_and_b32 v75, 0xffff0000, v179
v_pk_add_f32 v[246:247], v[246:247], v[74:75]
v_cvt_pk_bf16_f32 v32, v236, v237
ds_bpermute_b32 v44, v9, v32
v_cvt_pk_bf16_f32 v33, v238, v239
ds_bpermute_b32 v45, v9, v33
v_cvt_pk_bf16_f32 v34, v244, v245
ds_bpermute_b32 v46, v9, v34
v_cvt_pk_bf16_f32 v35, v246, v247
ds_bpermute_b32 v47, v9, v35
s_waitcnt lgkmcnt(4)
buffer_store_dwordx4 v[40:43], v5, s[32:35], s36 offen sc1 nt
s_waitcnt lgkmcnt(0)
buffer_store_dwordx4 v[44:47], v5, s[32:35], s37 offen sc1 nt
Ldone:
Lexit:
s_endpgm
Lsp1:
s_mov_b32 s95, 0
Lsl1:
buffer_load_dword v26, v25, s[8:11], s29 offen sc1
s_add_u32 s95, s95, 1
s_cmp_gt_u32 s95, 3000000
s_waitcnt vmcnt(0)
s_cbranch_scc1 Lok1
v_cmp_ne_u32 vcc, v12, v26
s_nop 1
s_cbranch_vccnz Lsl1
s_branch Lok1
Lsp2:
s_mov_b32 s95, 0
Lsl2:
buffer_load_dword v11, v7, s[8:11], s33 offen sc1
s_add_u32 s95, s95, 1
s_cmp_gt_u32 s95, 3000000
s_waitcnt vmcnt(0)
s_cbranch_scc1 Lok2
v_cmp_ne_u32 vcc, v12, v11
s_nop 1
s_cbranch_vccnz Lsl2
s_branch Lok2
Lsp3:
s_mov_b32 s95, 0
Lsl3:
v_mov_b32 v167, v12
s_mov_b64 exec, 0xf
v_mov_b32 v167, 0
buffer_atomic_or v167, v13, s[8:11], s28 offen sc0
s_mov_b64 exec, -1
s_add_u32 s95, s95, 1
s_cmp_gt_u32 s95, 3000000
s_waitcnt vmcnt(0)
s_cbranch_scc1 Lok3
v_cmp_ne_u32 vcc, v12, v167
s_nop 1
s_cbranch_vccnz Lsl3
s_branch Lok3
Lsp4:
s_mov_b32 s95, 0
Lsl4:
v_mov_b32 v17, v12
s_mov_b64 exec, 0xff
v_mov_b32 v17, 0
buffer_atomic_or v17, v13, s[8:11], s30 offen sc0
s_mov_b64 exec, -1
s_add_u32 s95, s95, 1
s_cmp_gt_u32 s95, 3000000
s_waitcnt vmcnt(0)
s_cbranch_scc1 Lok4
v_cmp_ne_u32 vcc, v12, v17
s_nop 1
s_cbranch_vccnz Lsl4
s_branch Lok4
Lsp5:
s_mov_b32 s95, 0
Lsl5:
buffer_load_dword v220, v221, s[8:11], s55 offen sc1
s_add_u32 s95, s95, 1
s_cmp_gt_u32 s95, 3000000
s_waitcnt vmcnt(0)
s_cbranch_scc1 Lok5
v_cmp_ne_u32 vcc, v12, v220
s_nop 1
s_cbranch_vccnz Lsl5
s_branch Lok5
Lsp6:
s_mov_b32 s95, 0
Lsl6:
buffer_load_dword v220, v221, s[8:11], s41 offen sc1
s_add_u32 s95, s95, 1
s_cmp_gt_u32 s95, 3000000
s_waitcnt vmcnt(0)
s_cbranch_scc1 Lok6
v_cmp_ne_u32 vcc, v12, v220
s_nop 1
s_cbranch_vccnz Lsl6
s_branch Lok6
Lsp7:
s_mov_b32 s95, 0
Lsl7:
buffer_load_dword v220, v221, s[8:11], s41 offen sc1
s_add_u32 s95, s95, 1
s_cmp_gt_u32 s95, 3000000
s_waitcnt vmcnt(0)
s_cbranch_scc1 Lok7
v_cmp_ne_u32 vcc, v12, v220
s_nop 1
s_cbranch_vccnz Lsl7
s_branch Lok7
Lsp8:
s_mov_b32 s95, 0
Lsl8:
buffer_load_dword v220, v221, s[8:11], s41 offen sc1
s_add_u32 s95, s95, 1
s_cmp_gt_u32 s95, 3000000
s_waitcnt vmcnt(0)
s_cbranch_scc1 Lok8
v_cmp_ne_u32 vcc, v12, v220
s_nop 1
s_cbranch_vccnz Lsl8
s_branch Lok8
Lsp9:
s_mov_b32 s95, 0
Lsl9:
v_mov_b32 v79, v12
s_mov_b64 exec, 0xb
v_mov_b32 v79, 0
buffer_atomic_or v79, v13, s[8:11], s31 offen sc0
s_mov_b64 exec, -1
s_add_u32 s95, s95, 1
s_cmp_gt_u32 s95, 3000000
s_waitcnt vmcnt(0)
s_cbranch_scc1 Lok9
v_cmp_ne_u32 vcc, v12, v79
s_nop 1
s_cbranch_vccnz Lsl9
s_branch Lok9
Lsp10:
s_mov_b32 s95, 0
Lsl10:
v_mov_b32 v79, v12
s_mov_b64 exec, 0x4
v_mov_b32 v79, 0
buffer_atomic_or v79, v13, s[8:11], s31 offen sc0
s_mov_b64 exec, -1
s_add_u32 s95, s95, 1
s_cmp_gt_u32 s95, 3000000
s_waitcnt vmcnt(0)
s_cbranch_scc1 Lok10
v_cmp_ne_u32 vcc, v12, v79
s_nop 1
s_cbranch_vccnz Lsl10
s_branch Lok10
Lsp11:
s_mov_b32 s95, 0
Lsl11:
v_mov_b32 v213, v12
s_mov_b64 exec, 0xffff
v_mov_b32 v213, 0
buffer_atomic_or v213, v13, s[8:11], s31 offen sc0
s_mov_b64 exec, -1
s_add_u32 s95, s95, 1
s_cmp_gt_u32 s95, 3000000
s_waitcnt vmcnt(0)
s_cbranch_scc1 Lok11
v_cmp_ne_u32 vcc, v12, v213
s_nop 1
s_cbranch_vccnz Lsl11
s_branch Lok11
Lcode_end:

.section .rodata,"a"
.p2align 6
.amdhsa_kernel interleave_layers__linear_attn_block__glu_gated_geglu__prompt_kernel
  .amdhsa_next_free_vgpr 512
  .amdhsa_next_free_sgpr 102
  .amdhsa_accum_offset 256
  .amdhsa_group_segment_fixed_size 0
  .amdhsa_kernarg_size 80
  .amdhsa_user_sgpr_count 2
  .amdhsa_user_sgpr_kernarg_segment_ptr 1
  .amdhsa_system_sgpr_workgroup_id_x 1
  .amdhsa_float_denorm_mode_32 3
.end_amdhsa_kernel
```
